```python
import torch

def _softmax(x, axis=-1):
    return torch.softmax(x, dim=axis)
def _gelu(x):
    return torch.nn.functional.gelu(x, approximate="tanh")
def _silu(x):
    return torch.nn.functional.silu(x)
def _sigmoid(x):
    return torch.sigmoid(x)
def _layernorm(x, axis=-1, eps=1e-5):
    m = x.mean(dim=axis, keepdim=True)
    v = x.var(dim=axis, keepdim=True, unbiased=False)
    return (x - m) / torch.sqrt(v + eps)
def _scatter_add(tgt, idx, src, axis=0):
    return tgt.clone().index_add_(axis, idx, src)
def _segment_sum(src, seg, n):
    out = torch.zeros((n,) + src.shape[1:], dtype=src.dtype)
    return out.index_add_(0, seg, src)
def _pad(x, pw):
    flat = tuple(v for pair in reversed(pw) for v in pair)
    return torch.nn.functional.pad(x, flat)

kernel_name = 'parallel_sum__compressed_kv_cla__dense_activation_mish__prompt'

def setup_inputs():

    _w = (lambda a: (lambda t: t.to(torch.bfloat16) if t.is_floating_point() else t)(torch.as_tensor(a)))
    def _A_setup():
        B, H, Sq, Sk, D, M = 1, 32, 2048, 2048, 128, 512
        Dc = 4 * D
        return {
            "x": _w((lambda *s: torch.randn(*s, dtype=torch.bfloat16) * 0.05)(B, Sq, M)),
            "c_kv": _w((lambda *s: torch.randn(*s, dtype=torch.bfloat16) * 0.4)(B, Sk, Dc)),
            "w_q": _w((lambda *s: torch.randn(*s, dtype=torch.bfloat16) * 3.2)(M, H, D) * (M ** -0.5)),
            "w_uk": _w((lambda *s: torch.randn(*s, dtype=torch.bfloat16) * 3.2)(Dc, H, D) * (Dc ** -0.5)),
            "w_uv": _w((lambda *s: torch.randn(*s, dtype=torch.bfloat16) * 0.4)(Dc, H, D) * (Dc ** -0.5)),
            "w_o": _w((lambda *s: torch.randn(*s, dtype=torch.bfloat16) * 0.4)(H, D, M) * ((H * D) ** -0.5)),
        }
    _A_in = _A_setup()

    def _B_setup():
        B, S, D, F = 1, 2048, 512, 1376
        return {
            "x": _w((lambda *s: torch.randn(*s, dtype=torch.bfloat16) * 0.05)(B, S, D)),
            "w1": _w((lambda *s: torch.randn(*s, dtype=torch.bfloat16) * 0.8)(D, F) * (D ** -0.5)),
            "b1": _w((lambda *s: torch.randn(*s, dtype=torch.bfloat16) * 0.2)(F)),
            "w2": _w((lambda *s: torch.randn(*s, dtype=torch.bfloat16) * 0.1)(F, D) * (F ** -0.5)),
        }
    _B_in = _B_setup()

    return {
        "A_x": _A_in["x"],
        "A_c_kv": _A_in["c_kv"],
        "A_w_q": _A_in["w_q"],
        "A_w_uk": _A_in["w_uk"],
        "A_w_uv": _A_in["w_uv"],
        "A_w_o": _A_in["w_o"],
        "B_x": _B_in["x"],
        "B_w1": _B_in["w1"],
        "B_b1": _B_in["b1"],
        "B_w2": _B_in["w2"],
    }

def reference(A_x, A_c_kv, A_w_q, A_w_uk, A_w_uv, A_w_o, B_x, B_w1, B_b1, B_w2):
    def _A_ref(x, c_kv, w_q, w_uk, w_uv, w_o):
        B, Sq, M = x.shape[0], x.shape[1], x.shape[2]
        Sk = c_kv.shape[1]
        H, D = w_q.shape[1], w_q.shape[2]
        q = torch.einsum("bqm,mhd->bhqd", x, w_q)
        k = torch.einsum("bkc,chd->bhkd", c_kv, w_uk)
        v = torch.einsum("bkc,chd->bhkd", c_kv, w_uv)
        scores = torch.einsum("bhqd,bhkd->bhqk", q, k) * (D ** -0.5)
        off = Sk - Sq
        qi = torch.arange(Sq)[:, None]
        kj = torch.arange(Sk)[None, :]
        cmask = kj <= (qi + off)
        scores = torch.where(cmask[None, None], scores, -1e9)
        p = _softmax(scores, axis=-1)
        ctx = torch.einsum("bhqk,bhkd->bhqd", p, v)
        return torch.einsum("bhqd,hdm->bqm", ctx, w_o)

    def _B_ref(x, w1, b1, w2):
        h = torch.einsum("bsd,df->bsf", x, w1) + b1
        sp = torch.log1p(torch.exp(-torch.abs(h))) + torch.where(h > 0, h, torch.zeros_like(h))
        act = h * torch.tanh(sp)
        return torch.einsum("bsf,fd->bsd", act, w2)

    x = A_x
    xn = _layernorm(x, axis=-1)
    return x + _A_ref(xn, A_c_kv, A_w_q, A_w_uk, A_w_uv, A_w_o) + _B_ref(xn, B_w1, B_b1, B_w2)
```

```asm
; @launch grid=(256,1,1) block=(256,1,1) lds=163840
.amdgcn_target "amdgcn-amd-amdhsa--gfx950"
.text
.globl parallel_sum__compressed_kv_cla__dense_activation_mish__prompt_kernel
.p2align 8
.type parallel_sum__compressed_kv_cla__dense_activation_mish__prompt_kernel,@function
parallel_sum__compressed_kv_cla__dense_activation_mish__prompt_kernel:
    s_cmp_ge_u32 s2, 256
    s_cbranch_scc1 mg_exit
    s_load_dwordx16 s[64:79], s[0:1], 0
    s_load_dwordx2 s[54:55], s[0:1], 64
    s_load_dwordx4 s[56:59], s[0:1], 88
    v_and_b32 v1, 63, v0
    v_lshrrev_b32 v62, 6, v0
    v_lshlrev_b32 v7, 4, v1
    v_readfirstlane_b32 s40, v62
    s_and_b32 s41, s2, 7
    s_lshl_b32 s41, s41, 2
    s_lshr_b32 s3, s2, 3
    s_and_b32 s3, s3, 3
    s_add_u32 s41, s41, s3
    s_lshr_b32 s42, s2, 5
    s_and_b32 s43, s40, 1
    s_lshr_b32 s44, s40, 1
    v_lshrrev_b32 v61, 3, v1
    v_and_b32 v62, 7, v1
    s_lshl_b32 s3, s40, 15
    s_mov_b32 s7, s3
    v_lshrrev_b32 v63, 4, v1
    v_xor_b32 v16, v62, v63
    v_lshlrev_b32 v17, 10, v61
    v_lshl_add_u32 v56, v16, 4, v17
    v_xor_b32 v57, 64, v56
    v_and_b32 v16, 15, v1
    v_lshrrev_b32 v17, 1, v16
    v_xor_b32 v17, v17, v63
    v_lshlrev_b32 v16, 7, v16
    v_add_u32 v16, s3, v16
    v_lshl_add_u32 v58, v17, 4, v16
    v_xor_b32 v59, 64, v58
    v_lshrrev_b32 v16, 2, v1
    v_and_b32 v17, 3, v1
    v_lshlrev_b32 v16, 10, v16
    v_lshl_add_u32 v60, v17, 8, v16
    v_bfe_u32 v16, v1, 4, 1
    v_lshlrev_b32 v16, 1, v16
    v_xor_b32 v16, v62, v16
    v_xor_b32 v17, 4, v16
    v_mul_u32_u24 v18, 8192, v61
    v_lshl_add_u32 v48, v16, 4, v18
    v_lshl_add_u32 v49, v17, 4, v18
    v_add_u32 v49, 65536, v49
    v_lshl_add_u32 v50, v16, 4, v18
    v_add_u32 v50, 131072, v50
    v_lshl_add_u32 v51, v17, 4, v18
    v_add_u32 v51, 196608, v51
    v_mul_u32_u24 v18, 2752, v61
    v_lshl_add_u32 v52, v16, 4, v18
    v_lshl_add_u32 v53, v17, 4, v18
    v_add_u32 v53, 22016, v53
    v_lshl_add_u32 v54, v16, 4, v18
    v_add_u32 v54, 44032, v54
    v_lshl_add_u32 v55, v17, 4, v18
    v_add_u32 v55, 66048, v55
    s_lshr_b32 s3, s41, 1
    s_sub_u32 s3, s3, s41
    s_lshl_b32 s3, s3, 6
    s_add_u32 s3, s3, 1984
    v_bfe_u32 v18, v16, 2, 1
    v_mul_lo_u32 v19, v18, s3
    v_sub_u32 v18, s3, v19
    v_add_u32 v52, v19, v52
    v_add_u32 v53, v18, v53
    v_add_u32 v54, v19, v54
    v_add_u32 v55, v18, v55
    v_bfe_u32 v16, v1, 2, 2
    v_lshl_add_u32 v17, v63, 3, v16
    v_lshlrev_b32 v17, 7, v17
    v_and_b32 v18, 3, v1
    v_lshl_add_u32 v17, v18, 3, v17
    s_nop 0
    v_bfe_u32 v18, v1, 3, 1
    v_bfe_u32 v19, v1, 4, 1
    v_lshl_or_b32 v18, v19, 1, v18
    v_xor_b32 v19, 0, v18
    v_lshl_add_u32 v8, v19, 5, v17
    v_xor_b32 v19, 1, v18
    v_lshl_add_u32 v9, v19, 5, v17
    v_xor_b32 v19, 2, v18
    v_lshl_add_u32 v10, v19, 5, v17
    v_xor_b32 v19, 3, v18
    v_lshl_add_u32 v11, v19, 5, v17
    v_mov_b32 v12, v7
    v_add_u32 v13, 175104, v7
    v_add_u32 v14, 350208, v7
    v_add_u32 v15, 525312, v7
    s_lshl_b32 s3, s43, 12
    v_add_u32 v4, s3, v7
    v_add_u32 v5, 0x2000, v4
    s_lshl_b32 s48, s40, 12
    v_lshlrev_b32 v2, 3, v63
    v_lshlrev_b32 v16, 2, v1
    v_add_u32 v16, 163584, v16
    v_mov_b32 v17, 0
    ds_write_b32 v16, v17
    v_cmp_eq_u32 vcc, 0, v0
    v_mov_b32 v16, 0x7f000000
    s_nop 0
    v_cndmask_b32 v6, v16, v17, vcc
    v_lshlrev_b32 v0, 2, v1
    v_add_u32 v0, 162816, v0
    ds_write_b32 v0, v17 offset:0
    ds_write_b32 v0, v17 offset:256
    ds_write_b32 v0, v17 offset:512
    s_waitcnt lgkmcnt(0)
    s_mov_b32 s8, s58
    s_mov_b32 s9, s59
    s_mov_b32 s10, 74888192
    s_mov_b32 s11, 0x20000
    s_mov_b32 s28, s66
    s_mov_b32 s29, s67
    s_mov_b32 s30, 2097152
    s_mov_b32 s31, 0x20000
    s_mov_b32 s32, s70
    s_mov_b32 s33, s71
    s_mov_b32 s34, 4194304
    s_mov_b32 s35, 0x20000
    s_mov_b32 s36, s72
    s_mov_b32 s37, s73
    s_mov_b32 s38, 4194304
    s_mov_b32 s39, 0x20000
    s_mov_b32 s24, s64
    s_mov_b32 s25, s65
    s_mov_b32 s26, 2097152
    s_mov_b32 s27, 0x20000
    s_mov_b32 s12, s68
    s_mov_b32 s13, s69
    s_mov_b32 s14, 4194304
    s_mov_b32 s15, 0x20000
    s_mov_b32 s16, s78
    s_mov_b32 s17, s79
    s_mov_b32 s18, 1409024
    s_mov_b32 s19, 0x20000
    s_mov_b32 s20, s54
    s_mov_b32 s21, s55
    s_mov_b32 s22, 2752
    s_mov_b32 s23, 0x20000
    s_mov_b32 s96, s56
    s_mov_b32 s97, s57
    s_mov_b32 s98, 256
    s_mov_b32 s99, 0x20000
    s_lshl_b32 s65, s2, 3
    s_lshl_b32 s66, s40, 1
    s_add_u32 s65, s65, s66
    s_lshl_b32 s65, s65, 10
    buffer_load_dwordx4 v[192:195], v7, s[24:27], s65 offen
    buffer_load_dwordx4 v[196:199], v7, s[24:27], s65 offen offset:1024
    s_lshr_b32 s70, s65, 14
    s_lshl_b32 s70, s70, 14
    s_lshr_b32 s65, s65, 6
    s_and_b32 s65, s65, 0xf0
    s_add_u32 s70, s70, s65
    s_lshl_b32 s65, s42, 8
    s_lshl_b32 s66, s40, 6
    s_add_u32 s65, s65, s66
    s_add_u32 s56, s65, 0
    s_lshl_b32 s56, s56, 10
    s_add_u32 s57, s65, 8
    s_lshl_b32 s57, s57, 10
    s_add_u32 s58, s65, 16
    s_lshl_b32 s58, s58, 10
    s_add_u32 s59, s65, 24
    s_lshl_b32 s59, s59, 10
    s_add_u32 s60, s65, 32
    s_lshl_b32 s60, s60, 10
    s_add_u32 s61, s65, 40
    s_lshl_b32 s61, s61, 10
    s_add_u32 s62, s65, 48
    s_lshl_b32 s62, s62, 10
    s_add_u32 s63, s65, 56
    s_lshl_b32 s63, s63, 10
    s_lshl_b32 s50, s41, 19
    s_lshl_b32 s65, s65, 8
    s_add_u32 s50, s50, s65
    s_add_u32 s51, s50, 18874368
    s_add_u32 s50, s50, 2097152
    s_lshl_b32 s4, s40, 18
    s_lshl_b32 s65, s41, 8
    s_add_u32 s4, s4, s65
    s_mul_i32 s5, s40, 88064
    s_lshl_b32 s65, s41, 6
    s_add_u32 s5, s5, s65
    s_lshl_b32 s6, s44, 14
    s_lshl_b32 s65, s43, 12
    s_add_u32 s6, s6, s65
    v_lshlrev_b32 v232, 10, v1
    v_lshlrev_b32 v233, 13, v1
    v_mul_u32_u24 v234, 2752, v1
    s_lshr_b32 s66, s2, 3
    s_lshl_b32 s66, s66, 16
    s_lshl_b32 s67, s40, 7
    s_add_u32 s66, s66, s67
    s_lshl_b32 s67, s42, 19
    s_lshl_b32 s68, s41, 8
    s_add_u32 s67, s67, s68
    s_lshl_b32 s68, s43, 7
    s_add_u32 s67, s67, s68
    s_cmp_lg_u32 s44, 0
    s_cbranch_scc1 mg_t1
    s_branch mg_t2
mg_t1:
    s_cmp_lg_u32 s43, 0
    s_cbranch_scc1 mg_t3
    v_and_b32 v235, 15, v1
    v_lshlrev_b32 v235, 13, v235
    v_bfe_u32 v237, v1, 4, 1
    v_lshl_add_u32 v235, v237, 7, v235
    s_lshl_b32 s68, s42, 17
    s_lshl_b32 s69, s41, 8
    s_add_u32 s68, s68, s69
    s_branch mg_t2
mg_t3:
    s_getpc_b64 s[68:69]
mg_pc:
    s_lshr_b32 s71, s2, 3
    s_mul_i32 s71, s71, 2560
    v_add_u32 v235, s71, v7
    v_min_u32 v237, mg_exit-mg_pc-16, v235
    global_load_dwordx4 v[240:243], v237, s[68:69]
    v_add_u32 v235, 0x400, v235
    v_min_u32 v237, mg_exit-mg_pc-16, v235
    global_load_dwordx4 v[240:243], v237, s[68:69]
    v_add_u32 v235, 0x400, v235
    v_min_u32 v237, mg_exit-mg_pc-16, v235
    global_load_dwordx4 v[240:243], v237, s[68:69]
    v_add_u32 v235, 0x400, v235
mg_t2:
    s_mov_b32 s54, s66
    s_mov_b32 s49, s67
    s_add_u32 s69, s4, 0
    s_add_u32 m0, s6, 40960
    s_nop 0
    buffer_load_dwordx4 v48, s[32:35], s69 offen lds
    s_add_u32 m0, s6, 41984
    s_nop 0
    buffer_load_dwordx4 v49, s[32:35], s69 offen lds
    s_add_u32 m0, s6, 43008
    s_nop 0
    buffer_load_dwordx4 v50, s[32:35], s69 offen lds
    s_add_u32 m0, s6, 44032
    s_nop 0
    buffer_load_dwordx4 v51, s[32:35], s69 offen lds
    s_add_u32 m0, s7, 0
    s_nop 0
    buffer_load_dwordx4 v56, s[28:31], s56 offen lds
    s_add_u32 m0, s7, 1024
    s_nop 0
    buffer_load_dwordx4 v57, s[28:31], s57 offen lds
    s_add_u32 m0, s7, 2048
    s_nop 0
    buffer_load_dwordx4 v56, s[28:31], s58 offen lds
    s_add_u32 m0, s7, 3072
    s_nop 0
    buffer_load_dwordx4 v57, s[28:31], s59 offen lds
    s_add_u32 m0, s7, 4096
    s_nop 0
    buffer_load_dwordx4 v56, s[28:31], s60 offen lds
    s_add_u32 m0, s7, 5120
    s_nop 0
    buffer_load_dwordx4 v57, s[28:31], s61 offen lds
    s_add_u32 m0, s7, 6144
    s_nop 0
    buffer_load_dwordx4 v56, s[28:31], s62 offen lds
    s_add_u32 m0, s7, 7168
    s_nop 0
    buffer_load_dwordx4 v57, s[28:31], s63 offen lds
    s_lshl_b32 s71, s40, 5
    s_add_u32 s71, s71, 131072
    v_lshlrev_b32 v224, 7, v1
    v_add_u32 v224, s71, v224
    s_lshl_b32 s71, s40, 11
    s_add_u32 s71, s71, 131072
    v_add_u32 v225, s71, v7
    v_lshrrev_b32 v226, 5, v1
    v_lshlrev_b32 v226, 10, v226
    v_bfe_u32 v227, v1, 3, 2
    v_lshl_add_u32 v226, v227, 8, v226
    v_and_b32 v227, 7, v1
    v_lshl_add_u32 v226, v227, 4, v226
    s_lshr_b32 s73, s2, 1
    s_lshl_b32 s73, s73, 14
    s_and_b32 s71, s2, 1
    s_lshl_b32 s71, s71, 7
    s_add_u32 s73, s73, s71
    s_lshl_b32 s71, s40, 12
    s_add_u32 s54, s73, s71
    s_sub_u32 s65, 15, s42
    s_cmp_eq_u32 s44, 0
    s_cselect_b32 s66, s65, s42
    s_lshl_b32 s66, s66, 3
    s_lshl_b32 s67, s43, 2
    s_add_u32 s66, s66, s67
    s_lshl_b32 s65, s65, 3
    s_add_u32 s65, s65, s67
    s_lshl_b32 s67, s41, 12
    s_add_u32 s67, s67, 35651584
    s_mul_i32 s64, s66, 175104
    s_add_u32 s64, s64, s67
    s_mul_i32 s75, s65, 175104
    s_add_u32 s75, s75, s67
    s_lshl_b32 s3, s66, 14
    s_mul_i32 s70, s66, 175104
    s_add_u32 s70, s70, 35782656
    s_lshl_b32 s69, s41, 10
    s_add_u32 s76, s70, s69
    s_and_b32 s68, s41, 1
    s_mul_i32 s68, s68, 350208
    s_add_u32 s70, s70, s68
    s_lshr_b32 s68, s41, 1
    s_lshl_b32 s69, s68, 10
    s_add_u32 s70, s70, s69
    s_add_u32 s70, s70, 32768
    s_cmp_lt_u32 s41, 22
    s_cselect_b32 s77, s70, 0x7f000000
    s_lshl_b32 s78, s68, 6
    s_add_u32 s78, s78, 2048
    s_lshl_b32 s68, s42, 2
    s_sub_u32 s79, 64, s68
    s_lshl_b32 s46, s42, 4
    s_add_u32 s46, s46, 32
    s_lshl_b32 s68, s41, 19
    s_cmp_eq_u32 s44, 0
    s_mov_b32 s70, 18857984
    s_cselect_b32 s69, 2097152, s70
    s_cselect_b32 s70, 0, 16384
    s_add_u32 s69, s69, s68
    s_add_u32 s24, s8, s69
    s_addc_u32 s25, s9, 0
    s_lshl_b32 s26, s79, 13
    s_add_u32 s26, s26, s70
    s_and_b32 s72, s2, 1
    s_lshl_b32 s72, s72, 7
    s_lshl_b32 s47, s41, 7
    s_add_u32 s47, s47, 58073088
    s_lshl_b32 s73, s42, 4
    s_add_u32 s74, s47, s73
    s_lshl_b32 s73, s40, 2
    s_add_u32 s74, s74, s73
    s_lshl_b32 s45, s42, 7
    s_lshl_b32 s73, s41, 2
    s_add_u32 s45, s45, s73
    s_add_u32 s45, s45, 58077184
    s_lshl_b32 s67, s41, 4
    s_lshl_b32 s68, s43, 3
    s_add_u32 s67, s67, s68
    s_add_u32 s67, s67, 58064896
    s_lshr_b32 s66, s66, 3
    s_lshl_b32 s66, s66, 9
    s_add_u32 s53, s66, s67
    s_lshr_b32 s65, s65, 3
    s_lshl_b32 s65, s65, 9
    s_add_u32 s79, s65, s67
    s_add_u32 s79, s79, 4
    v_cmp_eq_u32 vcc, 0, v1
    v_mov_b32 v62, 0x7f000000
    v_mov_b32 v63, 0
    v_cndmask_b32 v60, v62, v63, vcc
    v_mov_b32 v61, 1
    s_nop 0
    v_mov_b32 v228, 0
    v_mov_b32 v229, 0
    v_mov_b32 v230, 0
    v_mov_b32 v231, 0
    v_and_b32 v62, 31, v1
    v_lshlrev_b32 v62, 2, v62
    v_add_u32 v56, 0x80, v56
    v_add_u32 v57, 0x80, v57
    s_add_u32 m0, s7, 16384
    s_nop 0
    buffer_load_dwordx4 v56, s[28:31], s56 offen lds
    s_add_u32 m0, s7, 17408
    s_nop 0
    buffer_load_dwordx4 v57, s[28:31], s57 offen lds
    s_add_u32 m0, s7, 18432
    s_nop 0
    buffer_load_dwordx4 v56, s[28:31], s58 offen lds
    s_add_u32 m0, s7, 19456
    s_nop 0
    buffer_load_dwordx4 v57, s[28:31], s59 offen lds
    s_add_u32 m0, s7, 20480
    s_nop 0
    buffer_load_dwordx4 v56, s[28:31], s60 offen lds
    s_add_u32 m0, s7, 21504
    s_nop 0
    buffer_load_dwordx4 v57, s[28:31], s61 offen lds
    s_add_u32 m0, s7, 22528
    s_nop 0
    buffer_load_dwordx4 v56, s[28:31], s62 offen lds
    s_add_u32 m0, s7, 23552
    s_nop 0
    buffer_load_dwordx4 v57, s[28:31], s63 offen lds
    v_add_u32 v56, 0x80, v56
    v_add_u32 v57, 0x80, v57
    s_add_u32 s69, s4, 128
    s_add_u32 m0, s6, 73728
    s_nop 0
    buffer_load_dwordx4 v48, s[32:35], s69 offen lds
    s_add_u32 m0, s6, 74752
    s_nop 0
    buffer_load_dwordx4 v49, s[32:35], s69 offen lds
    s_add_u32 m0, s6, 75776
    s_nop 0
    buffer_load_dwordx4 v50, s[32:35], s69 offen lds
    s_add_u32 m0, s6, 76800
    s_nop 0
    buffer_load_dwordx4 v51, s[32:35], s69 offen lds
    s_lshl_b32 s68, s2, 2
    s_add_u32 s68, s68, s40
    s_lshl_b32 s69, s68, 12
    s_lshl_b32 s68, s68, 11
    buffer_load_dwordx4 v[240:243], v7, s[28:31], s68 offen offset:0
    buffer_load_dwordx4 v[240:243], v7, s[28:31], s68 offen offset:1024
    buffer_load_dwordx4 v[240:243], v7, s[32:35], s69 offen offset:0
    buffer_load_dwordx4 v[240:243], v7, s[32:35], s69 offen offset:1024
    buffer_load_dwordx4 v[240:243], v7, s[32:35], s69 offen offset:2048
    buffer_load_dwordx4 v[240:243], v7, s[32:35], s69 offen offset:3072
    s_waitcnt vmcnt(30)
    v_lshlrev_b32 v200, 16, v192
    v_and_b32 v201, 0xffff0000, v192
    v_lshlrev_b32 v202, 16, v193
    v_and_b32 v203, 0xffff0000, v193
    v_lshlrev_b32 v204, 16, v194
    v_and_b32 v205, 0xffff0000, v194
    v_lshlrev_b32 v206, 16, v195
    v_and_b32 v207, 0xffff0000, v195
    v_lshlrev_b32 v208, 16, v196
    v_and_b32 v209, 0xffff0000, v196
    v_lshlrev_b32 v210, 16, v197
    v_and_b32 v211, 0xffff0000, v197
    v_lshlrev_b32 v212, 16, v198
    v_and_b32 v213, 0xffff0000, v198
    v_lshlrev_b32 v214, 16, v199
    v_and_b32 v215, 0xffff0000, v199
    v_add_f32 v216, v200, v201
    v_add_f32 v217, v208, v209
    v_add_f32 v216, v216, v202
    v_add_f32 v217, v217, v210
    v_add_f32 v216, v216, v203
    v_add_f32 v217, v217, v211
    v_add_f32 v216, v216, v204
    v_add_f32 v217, v217, v212
    v_add_f32 v216, v216, v205
    v_add_f32 v217, v217, v213
    v_add_f32 v216, v216, v206
    v_add_f32 v217, v217, v214
    v_add_f32 v216, v216, v207
    v_add_f32 v217, v217, v215
    s_nop 1
    v_add_f32_dpp v216, v216, v216 quad_perm:[1,0,3,2] row_mask:0xf bank_mask:0xf
    v_add_f32_dpp v217, v217, v217 quad_perm:[1,0,3,2] row_mask:0xf bank_mask:0xf
    s_nop 1
    v_add_f32_dpp v216, v216, v216 quad_perm:[2,3,0,1] row_mask:0xf bank_mask:0xf
    v_add_f32_dpp v217, v217, v217 quad_perm:[2,3,0,1] row_mask:0xf bank_mask:0xf
    s_nop 1
    v_add_f32_dpp v216, v216, v216 row_half_mirror row_mask:0xf bank_mask:0xf
    v_add_f32_dpp v217, v217, v217 row_half_mirror row_mask:0xf bank_mask:0xf
    s_nop 1
    v_add_f32_dpp v216, v216, v216 row_mirror row_mask:0xf bank_mask:0xf
    v_add_f32_dpp v217, v217, v217 row_mirror row_mask:0xf bank_mask:0xf
    v_mov_b32 v218, v216
    v_mov_b32 v219, v217
    s_nop 1
    v_permlane16_swap_b32 v216, v218
    v_permlane16_swap_b32 v217, v219
    v_add_f32 v216, v216, v218
    v_add_f32 v217, v217, v219
    v_mov_b32 v218, v216
    v_mov_b32 v219, v217
    s_nop 1
    v_permlane32_swap_b32 v216, v218
    v_permlane32_swap_b32 v217, v219
    v_add_f32 v216, v216, v218
    v_add_f32 v217, v217, v219
    v_mul_f32 v220, 0x3b000000, v216
    v_mul_f32 v221, 0x3b000000, v217
    v_sub_f32 v218, v200, v220
    v_mul_f32 v216, v218, v218
    v_sub_f32 v219, v208, v221
    v_mul_f32 v217, v219, v219
    v_sub_f32 v218, v201, v220
    v_fmac_f32 v216, v218, v218
    v_sub_f32 v219, v209, v221
    v_fmac_f32 v217, v219, v219
    v_sub_f32 v218, v202, v220
    v_fmac_f32 v216, v218, v218
    v_sub_f32 v219, v210, v221
    v_fmac_f32 v217, v219, v219
    v_sub_f32 v218, v203, v220
    v_fmac_f32 v216, v218, v218
    v_sub_f32 v219, v211, v221
    v_fmac_f32 v217, v219, v219
    v_sub_f32 v218, v204, v220
    v_fmac_f32 v216, v218, v218
    v_sub_f32 v219, v212, v221
    v_fmac_f32 v217, v219, v219
    v_sub_f32 v218, v205, v220
    v_fmac_f32 v216, v218, v218
    v_sub_f32 v219, v213, v221
    v_fmac_f32 v217, v219, v219
    v_sub_f32 v218, v206, v220
    v_fmac_f32 v216, v218, v218
    v_sub_f32 v219, v214, v221
    v_fmac_f32 v217, v219, v219
    v_sub_f32 v218, v207, v220
    v_fmac_f32 v216, v218, v218
    v_sub_f32 v219, v215, v221
    v_fmac_f32 v217, v219, v219
    s_nop 1
    v_add_f32_dpp v216, v216, v216 quad_perm:[1,0,3,2] row_mask:0xf bank_mask:0xf
    v_add_f32_dpp v217, v217, v217 quad_perm:[1,0,3,2] row_mask:0xf bank_mask:0xf
    s_nop 1
    v_add_f32_dpp v216, v216, v216 quad_perm:[2,3,0,1] row_mask:0xf bank_mask:0xf
    v_add_f32_dpp v217, v217, v217 quad_perm:[2,3,0,1] row_mask:0xf bank_mask:0xf
    s_nop 1
    v_add_f32_dpp v216, v216, v216 row_half_mirror row_mask:0xf bank_mask:0xf
    v_add_f32_dpp v217, v217, v217 row_half_mirror row_mask:0xf bank_mask:0xf
    s_nop 1
    v_add_f32_dpp v216, v216, v216 row_mirror row_mask:0xf bank_mask:0xf
    v_add_f32_dpp v217, v217, v217 row_mirror row_mask:0xf bank_mask:0xf
    v_mov_b32 v218, v216
    v_mov_b32 v219, v217
    s_nop 1
    v_permlane16_swap_b32 v216, v218
    v_permlane16_swap_b32 v217, v219
    v_add_f32 v216, v216, v218
    v_add_f32 v217, v217, v219
    v_mov_b32 v218, v216
    v_mov_b32 v219, v217
    s_nop 1
    v_permlane32_swap_b32 v216, v218
    v_permlane32_swap_b32 v217, v219
    v_add_f32 v216, v216, v218
    v_add_f32 v217, v217, v219
    v_mul_f32 v216, 0x3b000000, v216
    v_cvt_pk_bf16_f32 v216, v216, v220
    v_mul_f32 v217, 0x3b000000, v217
    v_cvt_pk_bf16_f32 v217, v217, v221
    v_and_b32 v220, 0xffff0000, v216
    v_lshlrev_b32 v216, 16, v216
    v_add_f32 v216, 0x3727c5ac, v216
    v_cvt_pk_bf16_f32 v216, v216, v216
    v_and_b32 v216, 0xffff0000, v216
    v_sqrt_f32 v216, v216
    v_and_b32 v221, 0xffff0000, v217
    v_lshlrev_b32 v217, 16, v217
    v_add_f32 v217, 0x3727c5ac, v217
    v_cvt_pk_bf16_f32 v217, v217, v217
    v_and_b32 v217, 0xffff0000, v217
    v_sqrt_f32 v217, v217
    s_nop 0
    v_cvt_pk_bf16_f32 v216, v216, v216
    v_and_b32 v216, 0xffff0000, v216
    v_rcp_f32 v216, v216
    v_cvt_pk_bf16_f32 v217, v217, v217
    v_and_b32 v217, 0xffff0000, v217
    v_rcp_f32 v217, v217
    v_sub_f32 v200, v200, v220
    v_sub_f32 v201, v201, v220
    v_sub_f32 v202, v202, v220
    v_sub_f32 v203, v203, v220
    v_sub_f32 v204, v204, v220
    v_sub_f32 v205, v205, v220
    v_sub_f32 v206, v206, v220
    v_sub_f32 v207, v207, v220
    v_cvt_pk_bf16_f32 v192, v200, v201
    v_cvt_pk_bf16_f32 v193, v202, v203
    v_cvt_pk_bf16_f32 v194, v204, v205
    v_cvt_pk_bf16_f32 v195, v206, v207
    v_lshlrev_b32 v200, 16, v192
    v_and_b32 v201, 0xffff0000, v192
    v_lshlrev_b32 v202, 16, v193
    v_and_b32 v203, 0xffff0000, v193
    v_lshlrev_b32 v204, 16, v194
    v_and_b32 v205, 0xffff0000, v194
    v_lshlrev_b32 v206, 16, v195
    v_and_b32 v207, 0xffff0000, v195
    v_mul_f32 v200, v200, v216
    v_mul_f32 v201, v201, v216
    v_mul_f32 v202, v202, v216
    v_mul_f32 v203, v203, v216
    v_mul_f32 v204, v204, v216
    v_mul_f32 v205, v205, v216
    v_mul_f32 v206, v206, v216
    v_mul_f32 v207, v207, v216
    v_cvt_pk_bf16_f32 v192, v200, v201
    v_cvt_pk_bf16_f32 v193, v202, v203
    v_cvt_pk_bf16_f32 v194, v204, v205
    v_cvt_pk_bf16_f32 v195, v206, v207
    v_sub_f32 v208, v208, v221
    v_sub_f32 v209, v209, v221
    v_sub_f32 v210, v210, v221
    v_sub_f32 v211, v211, v221
    v_sub_f32 v212, v212, v221
    v_sub_f32 v213, v213, v221
    v_sub_f32 v214, v214, v221
    v_sub_f32 v215, v215, v221
    v_cvt_pk_bf16_f32 v196, v208, v209
    v_cvt_pk_bf16_f32 v197, v210, v211
    v_cvt_pk_bf16_f32 v198, v212, v213
    v_cvt_pk_bf16_f32 v199, v214, v215
    v_lshlrev_b32 v208, 16, v196
    v_and_b32 v209, 0xffff0000, v196
    v_lshlrev_b32 v210, 16, v197
    v_and_b32 v211, 0xffff0000, v197
    v_lshlrev_b32 v212, 16, v198
    v_and_b32 v213, 0xffff0000, v198
    v_lshlrev_b32 v214, 16, v199
    v_and_b32 v215, 0xffff0000, v199
    v_mul_f32 v208, v208, v217
    v_mul_f32 v209, v209, v217
    v_mul_f32 v210, v210, v217
    v_mul_f32 v211, v211, v217
    v_mul_f32 v212, v212, v217
    v_mul_f32 v213, v213, v217
    v_mul_f32 v214, v214, v217
    v_mul_f32 v215, v215, v217
    v_cvt_pk_bf16_f32 v196, v208, v209
    v_cvt_pk_bf16_f32 v197, v210, v211
    v_cvt_pk_bf16_f32 v198, v212, v213
    v_cvt_pk_bf16_f32 v199, v214, v215
    ds_write_b128 v224, v[192:195]
    ds_write_b128 v224, v[196:199] offset:16
    s_waitcnt vmcnt(18)
    ds_read_b128 a[0:3], v58 offset:0
    ds_read_b128 a[4:7], v59 offset:0
    ds_read_b128 a[64:67], v58 offset:2048
    ds_read_b128 a[68:71], v59 offset:2048
    ds_read_b128 a[128:131], v58 offset:4096
    ds_read_b128 a[132:135], v59 offset:4096
    ds_read_b128 a[192:195], v58 offset:6144
    ds_read_b128 a[196:199], v59 offset:6144
    s_waitcnt vmcnt(10)
    ds_read_b128 a[8:11], v58 offset:16384
    ds_read_b128 a[12:15], v59 offset:16384
    ds_read_b128 a[72:75], v58 offset:18432
    ds_read_b128 a[76:79], v59 offset:18432
    ds_read_b128 a[136:139], v58 offset:20480
    ds_read_b128 a[140:143], v59 offset:20480
    ds_read_b128 a[200:203], v58 offset:22528
    ds_read_b128 a[204:207], v59 offset:22528
    s_waitcnt vmcnt(26) lgkmcnt(0)
    s_barrier
    ds_read_b64_tr_b16 v[16:17], v8 offset:40960
    ds_read_b64_tr_b16 v[18:19], v8 offset:41472
    ds_read_b64_tr_b16 v[20:21], v8 offset:45056
    ds_read_b64_tr_b16 v[22:23], v8 offset:45568
    ds_read_b64_tr_b16 v[24:25], v8 offset:57344
    ds_read_b64_tr_b16 v[26:27], v8 offset:57856
    ds_read_b64_tr_b16 v[28:29], v8 offset:61440
    ds_read_b64_tr_b16 v[30:31], v8 offset:61952
    s_waitcnt lgkmcnt(0)
    v_mfma_f32_16x16x32_bf16 v[64:67], v[16:19], a[0:3], 0
    ds_read_b64_tr_b16 v[32:33], v9 offset:40960
    s_waitcnt lgkmcnt(15)
    v_mfma_f32_16x16x32_bf16 v[64:67], v[20:23], a[4:7], v[64:67]
    ds_read_b64_tr_b16 v[34:35], v9 offset:41472
    s_add_u32 m0, s7, 0
    v_mfma_f32_16x16x32_bf16 v[64:67], v[24:27], a[8:11], v[64:67]
    ds_read_b64_tr_b16 v[36:37], v9 offset:45056
    buffer_load_dwordx4 v56, s[28:31], s56 offen lds
    v_mfma_f32_16x16x32_bf16 v[64:67], v[28:31], a[12:15], v[64:67]
    ds_read_b64_tr_b16 v[38:39], v9 offset:45568
    v_mfma_f32_16x16x32_bf16 v[68:71], v[16:19], a[64:67], 0
    ds_read_b64_tr_b16 v[40:41], v9 offset:57344
    v_mfma_f32_16x16x32_bf16 v[68:71], v[20:23], a[68:71], v[68:71]
    ds_read_b64_tr_b16 v[42:43], v9 offset:57856
    s_add_u32 m0, s7, 1024
    v_mfma_f32_16x16x32_bf16 v[68:71], v[24:27], a[72:75], v[68:71]
    ds_read_b64_tr_b16 v[44:45], v9 offset:61440
    buffer_load_dwordx4 v57, s[28:31], s57 offen lds
    v_mfma_f32_16x16x32_bf16 v[68:71], v[28:31], a[76:79], v[68:71]
    ds_read_b64_tr_b16 v[46:47], v9 offset:61952
    v_mfma_f32_16x16x32_bf16 v[72:75], v[16:19], a[128:131], 0
    v_mfma_f32_16x16x32_bf16 v[72:75], v[20:23], a[132:135], v[72:75]
    s_add_u32 m0, s7, 2048
    v_mfma_f32_16x16x32_bf16 v[72:75], v[24:27], a[136:139], v[72:75]
    buffer_load_dwordx4 v56, s[28:31], s58 offen lds
    v_mfma_f32_16x16x32_bf16 v[72:75], v[28:31], a[140:143], v[72:75]
    v_mfma_f32_16x16x32_bf16 v[76:79], v[16:19], a[192:195], 0
    v_mfma_f32_16x16x32_bf16 v[76:79], v[20:23], a[196:199], v[76:79]
    s_add_u32 m0, s7, 3072
    v_mfma_f32_16x16x32_bf16 v[76:79], v[24:27], a[200:203], v[76:79]
    buffer_load_dwordx4 v57, s[28:31], s59 offen lds
    v_mfma_f32_16x16x32_bf16 v[76:79], v[28:31], a[204:207], v[76:79]
    s_waitcnt lgkmcnt(0)
    v_mfma_f32_16x16x32_bf16 v[80:83], v[32:35], a[0:3], 0
    ds_read_b64_tr_b16 v[16:17], v10 offset:40960
    v_mfma_f32_16x16x32_bf16 v[80:83], v[36:39], a[4:7], v[80:83]
    ds_read_b64_tr_b16 v[18:19], v10 offset:41472
    s_add_u32 m0, s7, 4096
    v_mfma_f32_16x16x32_bf16 v[80:83], v[40:43], a[8:11], v[80:83]
    ds_read_b64_tr_b16 v[20:21], v10 offset:45056
    buffer_load_dwordx4 v56, s[28:31], s60 offen lds
    v_mfma_f32_16x16x32_bf16 v[80:83], v[44:47], a[12:15], v[80:83]
    ds_read_b64_tr_b16 v[22:23], v10 offset:45568
    v_mfma_f32_16x16x32_bf16 v[84:87], v[32:35], a[64:67], 0
    ds_read_b64_tr_b16 v[24:25], v10 offset:57344
    v_mfma_f32_16x16x32_bf16 v[84:87], v[36:39], a[68:71], v[84:87]
    ds_read_b64_tr_b16 v[26:27], v10 offset:57856
    s_add_u32 m0, s7, 5120
    v_mfma_f32_16x16x32_bf16 v[84:87], v[40:43], a[72:75], v[84:87]
    ds_read_b64_tr_b16 v[28:29], v10 offset:61440
    buffer_load_dwordx4 v57, s[28:31], s61 offen lds
    v_mfma_f32_16x16x32_bf16 v[84:87], v[44:47], a[76:79], v[84:87]
    ds_read_b64_tr_b16 v[30:31], v10 offset:61952
    v_mfma_f32_16x16x32_bf16 v[88:91], v[32:35], a[128:131], 0
    v_mfma_f32_16x16x32_bf16 v[88:91], v[36:39], a[132:135], v[88:91]
    s_add_u32 m0, s7, 6144
    v_mfma_f32_16x16x32_bf16 v[88:91], v[40:43], a[136:139], v[88:91]
    buffer_load_dwordx4 v56, s[28:31], s62 offen lds
    v_mfma_f32_16x16x32_bf16 v[88:91], v[44:47], a[140:143], v[88:91]
    v_mfma_f32_16x16x32_bf16 v[92:95], v[32:35], a[192:195], 0
    v_mfma_f32_16x16x32_bf16 v[92:95], v[36:39], a[196:199], v[92:95]
    s_add_u32 m0, s7, 7168
    v_mfma_f32_16x16x32_bf16 v[92:95], v[40:43], a[200:203], v[92:95]
    buffer_load_dwordx4 v57, s[28:31], s63 offen lds
    v_add_u32 v56, 0x80, v56
    v_mfma_f32_16x16x32_bf16 v[92:95], v[44:47], a[204:207], v[92:95]
    s_waitcnt lgkmcnt(0)
    v_add_u32 v57, 0x80, v57
    v_mfma_f32_16x16x32_bf16 v[96:99], v[16:19], a[0:3], 0
    ds_read_b64_tr_b16 v[32:33], v11 offset:40960
    s_add_u32 s69, s4, 1048576
    v_mfma_f32_16x16x32_bf16 v[96:99], v[20:23], a[4:7], v[96:99]
    ds_read_b64_tr_b16 v[34:35], v11 offset:41472
    s_add_u32 m0, s6, 106496
    v_mfma_f32_16x16x32_bf16 v[96:99], v[24:27], a[8:11], v[96:99]
    ds_read_b64_tr_b16 v[36:37], v11 offset:45056
    buffer_load_dwordx4 v48, s[32:35], s69 offen lds
    v_mfma_f32_16x16x32_bf16 v[96:99], v[28:31], a[12:15], v[96:99]
    ds_read_b64_tr_b16 v[38:39], v11 offset:45568
    v_mfma_f32_16x16x32_bf16 v[100:103], v[16:19], a[64:67], 0
    ds_read_b64_tr_b16 v[40:41], v11 offset:57344
    v_mfma_f32_16x16x32_bf16 v[100:103], v[20:23], a[68:71], v[100:103]
    ds_read_b64_tr_b16 v[42:43], v11 offset:57856
    s_add_u32 m0, s6, 107520
    v_mfma_f32_16x16x32_bf16 v[100:103], v[24:27], a[72:75], v[100:103]
    ds_read_b64_tr_b16 v[44:45], v11 offset:61440
    buffer_load_dwordx4 v49, s[32:35], s69 offen lds
    v_mfma_f32_16x16x32_bf16 v[100:103], v[28:31], a[76:79], v[100:103]
    ds_read_b64_tr_b16 v[46:47], v11 offset:61952
    v_mfma_f32_16x16x32_bf16 v[104:107], v[16:19], a[128:131], 0
    v_mfma_f32_16x16x32_bf16 v[104:107], v[20:23], a[132:135], v[104:107]
    s_add_u32 m0, s6, 108544
    v_mfma_f32_16x16x32_bf16 v[104:107], v[24:27], a[136:139], v[104:107]
    buffer_load_dwordx4 v50, s[32:35], s69 offen lds
    v_mfma_f32_16x16x32_bf16 v[104:107], v[28:31], a[140:143], v[104:107]
    v_mfma_f32_16x16x32_bf16 v[108:111], v[16:19], a[192:195], 0
    v_mfma_f32_16x16x32_bf16 v[108:111], v[20:23], a[196:199], v[108:111]
    s_add_u32 m0, s6, 109568
    v_mfma_f32_16x16x32_bf16 v[108:111], v[24:27], a[200:203], v[108:111]
    buffer_load_dwordx4 v51, s[32:35], s69 offen lds
    s_waitcnt lgkmcnt(15)
    v_mfma_f32_16x16x32_bf16 v[108:111], v[28:31], a[204:207], v[108:111]
    s_waitcnt vmcnt(18) lgkmcnt(0)
    s_barrier
    v_mfma_f32_16x16x32_bf16 v[112:115], v[32:35], a[0:3], 0
    v_xor_b32 v8, 0x10000, v8
    v_mfma_f32_16x16x32_bf16 v[112:115], v[36:39], a[4:7], v[112:115]
    ds_read_b64_tr_b16 v[16:17], v8 offset:8192
    s_add_u32 m0, s7, 16384
    v_mfma_f32_16x16x32_bf16 v[112:115], v[40:43], a[8:11], v[112:115]
    ds_read_b64_tr_b16 v[18:19], v8 offset:8704
    buffer_load_dwordx4 v56, s[28:31], s56 offen lds
    v_mfma_f32_16x16x32_bf16 v[112:115], v[44:47], a[12:15], v[112:115]
    ds_read_b64_tr_b16 v[20:21], v8 offset:12288
    v_mfma_f32_16x16x32_bf16 v[116:119], v[32:35], a[64:67], 0
    ds_read_b64_tr_b16 v[22:23], v8 offset:12800
    v_mfma_f32_16x16x32_bf16 v[116:119], v[36:39], a[68:71], v[116:119]
    ds_read_b64_tr_b16 v[24:25], v8 offset:24576
    s_add_u32 m0, s7, 17408
    v_mfma_f32_16x16x32_bf16 v[116:119], v[40:43], a[72:75], v[116:119]
    ds_read_b64_tr_b16 v[26:27], v8 offset:25088
    buffer_load_dwordx4 v57, s[28:31], s57 offen lds
    v_mfma_f32_16x16x32_bf16 v[116:119], v[44:47], a[76:79], v[116:119]
    ds_read_b64_tr_b16 v[28:29], v8 offset:28672
    v_mfma_f32_16x16x32_bf16 v[120:123], v[32:35], a[128:131], 0
    ds_read_b64_tr_b16 v[30:31], v8 offset:29184
    v_mfma_f32_16x16x32_bf16 v[120:123], v[36:39], a[132:135], v[120:123]
    s_add_u32 m0, s7, 18432
    v_mfma_f32_16x16x32_bf16 v[120:123], v[40:43], a[136:139], v[120:123]
    buffer_load_dwordx4 v56, s[28:31], s58 offen lds
    v_mfma_f32_16x16x32_bf16 v[120:123], v[44:47], a[140:143], v[120:123]
    v_mfma_f32_16x16x32_bf16 v[124:127], v[32:35], a[192:195], 0
    v_mfma_f32_16x16x32_bf16 v[124:127], v[36:39], a[196:199], v[124:127]
    s_add_u32 m0, s7, 19456
    v_mfma_f32_16x16x32_bf16 v[124:127], v[40:43], a[200:203], v[124:127]
    buffer_load_dwordx4 v57, s[28:31], s59 offen lds
    v_mfma_f32_16x16x32_bf16 v[124:127], v[44:47], a[204:207], v[124:127]
    s_waitcnt lgkmcnt(0)
    v_mfma_f32_16x16x32_bf16 v[128:131], v[16:19], a[0:3], 0
    v_xor_b32 v9, 0x10000, v9
    v_mfma_f32_16x16x32_bf16 v[128:131], v[20:23], a[4:7], v[128:131]
    ds_read_b64_tr_b16 v[32:33], v9 offset:8192
    s_add_u32 m0, s7, 20480
    v_mfma_f32_16x16x32_bf16 v[128:131], v[24:27], a[8:11], v[128:131]
    ds_read_b64_tr_b16 v[34:35], v9 offset:8704
    buffer_load_dwordx4 v56, s[28:31], s60 offen lds
    v_mfma_f32_16x16x32_bf16 v[128:131], v[28:31], a[12:15], v[128:131]
    ds_read_b64_tr_b16 v[36:37], v9 offset:12288
    v_mfma_f32_16x16x32_bf16 v[132:135], v[16:19], a[64:67], 0
    ds_read_b64_tr_b16 v[38:39], v9 offset:12800
    v_mfma_f32_16x16x32_bf16 v[132:135], v[20:23], a[68:71], v[132:135]
    ds_read_b64_tr_b16 v[40:41], v9 offset:24576
    s_add_u32 m0, s7, 21504
    v_mfma_f32_16x16x32_bf16 v[132:135], v[24:27], a[72:75], v[132:135]
    ds_read_b64_tr_b16 v[42:43], v9 offset:25088
    buffer_load_dwordx4 v57, s[28:31], s61 offen lds
    v_mfma_f32_16x16x32_bf16 v[132:135], v[28:31], a[76:79], v[132:135]
    ds_read_b64_tr_b16 v[44:45], v9 offset:28672
    v_mfma_f32_16x16x32_bf16 v[136:139], v[16:19], a[128:131], 0
    ds_read_b64_tr_b16 v[46:47], v9 offset:29184
    v_mfma_f32_16x16x32_bf16 v[136:139], v[20:23], a[132:135], v[136:139]
    s_add_u32 m0, s7, 22528
    v_mfma_f32_16x16x32_bf16 v[136:139], v[24:27], a[136:139], v[136:139]
    buffer_load_dwordx4 v56, s[28:31], s62 offen lds
    v_mfma_f32_16x16x32_bf16 v[136:139], v[28:31], a[140:143], v[136:139]
    v_mfma_f32_16x16x32_bf16 v[140:143], v[16:19], a[192:195], 0
    v_mfma_f32_16x16x32_bf16 v[140:143], v[20:23], a[196:199], v[140:143]
    s_add_u32 m0, s7, 23552
    v_mfma_f32_16x16x32_bf16 v[140:143], v[24:27], a[200:203], v[140:143]
    buffer_load_dwordx4 v57, s[28:31], s63 offen lds
    v_add_u32 v56, 0x80, v56
    v_mfma_f32_16x16x32_bf16 v[140:143], v[28:31], a[204:207], v[140:143]
    s_waitcnt lgkmcnt(0)
    v_add_u32 v57, 0x80, v57
    v_mfma_f32_16x16x32_bf16 v[144:147], v[32:35], a[0:3], 0
    v_xor_b32 v10, 0x10000, v10
    s_waitcnt vmcnt(12)
    v_mfma_f32_16x16x32_bf16 v[144:147], v[36:39], a[4:7], v[144:147]
    ds_read_b64_tr_b16 v[16:17], v10 offset:8192
    ds_read_b128 a[16:19], v58 offset:0
    v_mfma_f32_16x16x32_bf16 v[144:147], v[40:43], a[8:11], v[144:147]
    ds_read_b64_tr_b16 v[18:19], v10 offset:8704
    ds_read_b128 a[20:23], v59 offset:0
    v_mfma_f32_16x16x32_bf16 v[144:147], v[44:47], a[12:15], v[144:147]
    ds_read_b64_tr_b16 v[20:21], v10 offset:12288
    ds_read_b128 a[80:83], v58 offset:2048
    v_mfma_f32_16x16x32_bf16 v[148:151], v[32:35], a[64:67], 0
    ds_read_b64_tr_b16 v[22:23], v10 offset:12800
    ds_read_b128 a[84:87], v59 offset:2048
    v_mfma_f32_16x16x32_bf16 v[148:151], v[36:39], a[68:71], v[148:151]
    ds_read_b64_tr_b16 v[24:25], v10 offset:24576
    ds_read_b128 a[144:147], v58 offset:4096
    v_mfma_f32_16x16x32_bf16 v[148:151], v[40:43], a[72:75], v[148:151]
    ds_read_b64_tr_b16 v[26:27], v10 offset:25088
    ds_read_b128 a[148:151], v59 offset:4096
    v_mfma_f32_16x16x32_bf16 v[148:151], v[44:47], a[76:79], v[148:151]
    ds_read_b64_tr_b16 v[28:29], v10 offset:28672
    ds_read_b128 a[208:211], v58 offset:6144
    v_mfma_f32_16x16x32_bf16 v[152:155], v[32:35], a[128:131], 0
    ds_read_b64_tr_b16 v[30:31], v10 offset:29184
    ds_read_b128 a[212:215], v59 offset:6144
    v_mfma_f32_16x16x32_bf16 v[152:155], v[36:39], a[132:135], v[152:155]
    s_waitcnt lgkmcnt(0)
    s_add_u32 m0, s7, 0
    v_mfma_f32_16x16x32_bf16 v[152:155], v[40:43], a[136:139], v[152:155]
    buffer_load_dwordx4 v56, s[28:31], s56 offen lds
    v_mfma_f32_16x16x32_bf16 v[152:155], v[44:47], a[140:143], v[152:155]
    v_mfma_f32_16x16x32_bf16 v[156:159], v[32:35], a[192:195], 0
    v_mfma_f32_16x16x32_bf16 v[156:159], v[36:39], a[196:199], v[156:159]
    s_add_u32 m0, s7, 1024
    v_mfma_f32_16x16x32_bf16 v[156:159], v[40:43], a[200:203], v[156:159]
    buffer_load_dwordx4 v57, s[28:31], s57 offen lds
    v_mfma_f32_16x16x32_bf16 v[156:159], v[44:47], a[204:207], v[156:159]
    s_waitcnt lgkmcnt(1)
    v_mfma_f32_16x16x32_bf16 v[160:163], v[16:19], a[0:3], 0
    v_xor_b32 v11, 0x10000, v11
    v_mfma_f32_16x16x32_bf16 v[160:163], v[20:23], a[4:7], v[160:163]
    ds_read_b64_tr_b16 v[32:33], v11 offset:8192
    s_add_u32 m0, s7, 2048
    v_mfma_f32_16x16x32_bf16 v[160:163], v[24:27], a[8:11], v[160:163]
    ds_read_b64_tr_b16 v[34:35], v11 offset:8704
    buffer_load_dwordx4 v56, s[28:31], s58 offen lds
    v_mfma_f32_16x16x32_bf16 v[160:163], v[28:31], a[12:15], v[160:163]
    ds_read_b64_tr_b16 v[36:37], v11 offset:12288
    v_mfma_f32_16x16x32_bf16 v[164:167], v[16:19], a[64:67], 0
    ds_read_b64_tr_b16 v[38:39], v11 offset:12800
    v_mfma_f32_16x16x32_bf16 v[164:167], v[20:23], a[68:71], v[164:167]
    ds_read_b64_tr_b16 v[40:41], v11 offset:24576
    s_add_u32 m0, s7, 3072
    v_mfma_f32_16x16x32_bf16 v[164:167], v[24:27], a[72:75], v[164:167]
    ds_read_b64_tr_b16 v[42:43], v11 offset:25088
    buffer_load_dwordx4 v57, s[28:31], s59 offen lds
    v_mfma_f32_16x16x32_bf16 v[164:167], v[28:31], a[76:79], v[164:167]
    ds_read_b64_tr_b16 v[44:45], v11 offset:28672
    v_mfma_f32_16x16x32_bf16 v[168:171], v[16:19], a[128:131], 0
    ds_read_b64_tr_b16 v[46:47], v11 offset:29184
    v_mfma_f32_16x16x32_bf16 v[168:171], v[20:23], a[132:135], v[168:171]
    s_add_u32 m0, s7, 4096
    v_mfma_f32_16x16x32_bf16 v[168:171], v[24:27], a[136:139], v[168:171]
    buffer_load_dwordx4 v56, s[28:31], s60 offen lds
    v_mfma_f32_16x16x32_bf16 v[168:171], v[28:31], a[140:143], v[168:171]
    v_mfma_f32_16x16x32_bf16 v[172:175], v[16:19], a[192:195], 0
    v_mfma_f32_16x16x32_bf16 v[172:175], v[20:23], a[196:199], v[172:175]
    s_add_u32 m0, s7, 5120
    v_mfma_f32_16x16x32_bf16 v[172:175], v[24:27], a[200:203], v[172:175]
    buffer_load_dwordx4 v57, s[28:31], s61 offen lds
    v_mfma_f32_16x16x32_bf16 v[172:175], v[28:31], a[204:207], v[172:175]
    s_waitcnt vmcnt(14) lgkmcnt(0)
    s_barrier
    v_mfma_f32_16x16x32_bf16 v[176:179], v[32:35], a[0:3], 0
    ds_read_b64_tr_b16 v[16:17], v8 offset:40960
    v_mfma_f32_16x16x32_bf16 v[176:179], v[36:39], a[4:7], v[176:179]
    ds_read_b64_tr_b16 v[18:19], v8 offset:41472
    s_add_u32 m0, s7, 6144
    v_mfma_f32_16x16x32_bf16 v[176:179], v[40:43], a[8:11], v[176:179]
    ds_read_b64_tr_b16 v[20:21], v8 offset:45056
    buffer_load_dwordx4 v56, s[28:31], s62 offen lds
    v_mfma_f32_16x16x32_bf16 v[176:179], v[44:47], a[12:15], v[176:179]
    ds_read_b64_tr_b16 v[22:23], v8 offset:45568
    v_mfma_f32_16x16x32_bf16 v[180:183], v[32:35], a[64:67], 0
    ds_read_b64_tr_b16 v[24:25], v8 offset:57344
    v_mfma_f32_16x16x32_bf16 v[180:183], v[36:39], a[68:71], v[180:183]
    ds_read_b64_tr_b16 v[26:27], v8 offset:57856
    s_add_u32 m0, s7, 7168
    v_mfma_f32_16x16x32_bf16 v[180:183], v[40:43], a[72:75], v[180:183]
    ds_read_b64_tr_b16 v[28:29], v8 offset:61440
    buffer_load_dwordx4 v57, s[28:31], s63 offen lds
    v_mfma_f32_16x16x32_bf16 v[180:183], v[44:47], a[76:79], v[180:183]
    ds_read_b64_tr_b16 v[30:31], v8 offset:61952
    v_add_u32 v56, 0x80, v56
    v_mfma_f32_16x16x32_bf16 v[184:187], v[32:35], a[128:131], 0
    v_add_u32 v57, 0x80, v57
    s_waitcnt vmcnt(8)
    v_mfma_f32_16x16x32_bf16 v[184:187], v[36:39], a[132:135], v[184:187]
    ds_read_b128 a[24:27], v58 offset:16384
    ds_read_b128 a[28:31], v59 offset:16384
    v_mfma_f32_16x16x32_bf16 v[184:187], v[40:43], a[136:139], v[184:187]
    ds_read_b128 a[88:91], v58 offset:18432
    ds_read_b128 a[92:95], v59 offset:18432
    v_mfma_f32_16x16x32_bf16 v[184:187], v[44:47], a[140:143], v[184:187]
    ds_read_b128 a[152:155], v58 offset:20480
    ds_read_b128 a[156:159], v59 offset:20480
    v_mfma_f32_16x16x32_bf16 v[188:191], v[32:35], a[192:195], 0
    ds_read_b128 a[216:219], v58 offset:22528
    ds_read_b128 a[220:223], v59 offset:22528
    v_mfma_f32_16x16x32_bf16 v[188:191], v[36:39], a[196:199], v[188:191]
    s_add_u32 s69, s4, 1048704
    s_add_u32 m0, s6, 8192
    v_mfma_f32_16x16x32_bf16 v[188:191], v[40:43], a[200:203], v[188:191]
    buffer_load_dwordx4 v48, s[32:35], s69 offen lds
    v_mfma_f32_16x16x32_bf16 v[188:191], v[44:47], a[204:207], v[188:191]
    s_waitcnt lgkmcnt(0)
    v_mfma_f32_16x16x32_bf16 v[64:67], v[16:19], a[16:19], v[64:67]
    ds_read_b64_tr_b16 v[32:33], v9 offset:40960
    v_mfma_f32_16x16x32_bf16 v[64:67], v[20:23], a[20:23], v[64:67]
    ds_read_b64_tr_b16 v[34:35], v9 offset:41472
    s_add_u32 m0, s6, 9216
    v_mfma_f32_16x16x32_bf16 v[64:67], v[24:27], a[24:27], v[64:67]
    ds_read_b64_tr_b16 v[36:37], v9 offset:45056
    buffer_load_dwordx4 v49, s[32:35], s69 offen lds
    v_mfma_f32_16x16x32_bf16 v[64:67], v[28:31], a[28:31], v[64:67]
    ds_read_b64_tr_b16 v[38:39], v9 offset:45568
    s_lshl_b32 s55, s2, 2
    v_mfma_f32_16x16x32_bf16 v[68:71], v[16:19], a[80:83], v[68:71]
    ds_read_b64_tr_b16 v[40:41], v9 offset:57344
    s_add_u32 s55, s55, s40
    v_mfma_f32_16x16x32_bf16 v[68:71], v[20:23], a[84:87], v[68:71]
    ds_read_b64_tr_b16 v[42:43], v9 offset:57856
    s_add_u32 m0, s6, 10240
    v_mfma_f32_16x16x32_bf16 v[68:71], v[24:27], a[88:91], v[68:71]
    ds_read_b64_tr_b16 v[44:45], v9 offset:61440
    buffer_load_dwordx4 v50, s[32:35], s69 offen lds
    v_mfma_f32_16x16x32_bf16 v[68:71], v[28:31], a[92:95], v[68:71]
    ds_read_b64_tr_b16 v[46:47], v9 offset:61952
    s_lshl_b32 s55, s55, 12
    v_mfma_f32_16x16x32_bf16 v[72:75], v[16:19], a[144:147], v[72:75]
    buffer_load_dwordx4 v[244:247], v7, s[36:39], s55 offen offset:0
    v_mfma_f32_16x16x32_bf16 v[72:75], v[20:23], a[148:151], v[72:75]
    s_add_u32 m0, s6, 11264
    v_mfma_f32_16x16x32_bf16 v[72:75], v[24:27], a[152:155], v[72:75]
    buffer_load_dwordx4 v51, s[32:35], s69 offen lds
    s_waitcnt lgkmcnt(8)
    v_mfma_f32_16x16x32_bf16 v[72:75], v[28:31], a[156:159], v[72:75]
    v_mfma_f32_16x16x32_bf16 v[76:79], v[16:19], a[208:211], v[76:79]
    v_mfma_f32_16x16x32_bf16 v[76:79], v[20:23], a[212:215], v[76:79]
    s_add_u32 m0, s7, 16384
    v_mfma_f32_16x16x32_bf16 v[76:79], v[24:27], a[216:219], v[76:79]
    buffer_load_dwordx4 v56, s[28:31], s56 offen lds
    v_mfma_f32_16x16x32_bf16 v[76:79], v[28:31], a[220:223], v[76:79]
    s_waitcnt lgkmcnt(0)
    buffer_load_dwordx4 v[244:247], v7, s[36:39], s55 offen offset:1024
    v_mfma_f32_16x16x32_bf16 v[80:83], v[32:35], a[16:19], v[80:83]
    ds_read_b64_tr_b16 v[16:17], v10 offset:40960
    v_mfma_f32_16x16x32_bf16 v[80:83], v[36:39], a[20:23], v[80:83]
    ds_read_b64_tr_b16 v[18:19], v10 offset:41472
    s_add_u32 m0, s7, 17408
    v_mfma_f32_16x16x32_bf16 v[80:83], v[40:43], a[24:27], v[80:83]
    ds_read_b64_tr_b16 v[20:21], v10 offset:45056
    buffer_load_dwordx4 v57, s[28:31], s57 offen lds
    v_mfma_f32_16x16x32_bf16 v[80:83], v[44:47], a[28:31], v[80:83]
    ds_read_b64_tr_b16 v[22:23], v10 offset:45568
    v_mfma_f32_16x16x32_bf16 v[84:87], v[32:35], a[80:83], v[84:87]
    ds_read_b64_tr_b16 v[24:25], v10 offset:57344
    v_mfma_f32_16x16x32_bf16 v[84:87], v[36:39], a[84:87], v[84:87]
    ds_read_b64_tr_b16 v[26:27], v10 offset:57856
    s_add_u32 m0, s7, 18432
    v_mfma_f32_16x16x32_bf16 v[84:87], v[40:43], a[88:91], v[84:87]
    ds_read_b64_tr_b16 v[28:29], v10 offset:61440
    buffer_load_dwordx4 v56, s[28:31], s58 offen lds
    v_mfma_f32_16x16x32_bf16 v[84:87], v[44:47], a[92:95], v[84:87]
    ds_read_b64_tr_b16 v[30:31], v10 offset:61952
    v_mfma_f32_16x16x32_bf16 v[88:91], v[32:35], a[144:147], v[88:91]
    v_mfma_f32_16x16x32_bf16 v[88:91], v[36:39], a[148:151], v[88:91]
    s_add_u32 m0, s7, 19456
    v_mfma_f32_16x16x32_bf16 v[88:91], v[40:43], a[152:155], v[88:91]
    buffer_load_dwordx4 v57, s[28:31], s59 offen lds
    v_mfma_f32_16x16x32_bf16 v[88:91], v[44:47], a[156:159], v[88:91]
    v_mfma_f32_16x16x32_bf16 v[92:95], v[32:35], a[208:211], v[92:95]
    v_mfma_f32_16x16x32_bf16 v[92:95], v[36:39], a[212:215], v[92:95]
    s_add_u32 m0, s7, 20480
    v_mfma_f32_16x16x32_bf16 v[92:95], v[40:43], a[216:219], v[92:95]
    buffer_load_dwordx4 v56, s[28:31], s60 offen lds
    buffer_load_dwordx4 v[244:247], v7, s[36:39], s55 offen offset:2048
    v_mfma_f32_16x16x32_bf16 v[92:95], v[44:47], a[220:223], v[92:95]
    s_waitcnt lgkmcnt(0)
    v_mfma_f32_16x16x32_bf16 v[96:99], v[16:19], a[16:19], v[96:99]
    ds_read_b64_tr_b16 v[32:33], v11 offset:40960
    v_mfma_f32_16x16x32_bf16 v[96:99], v[20:23], a[20:23], v[96:99]
    ds_read_b64_tr_b16 v[34:35], v11 offset:41472
    s_add_u32 m0, s7, 21504
    v_mfma_f32_16x16x32_bf16 v[96:99], v[24:27], a[24:27], v[96:99]
    ds_read_b64_tr_b16 v[36:37], v11 offset:45056
    buffer_load_dwordx4 v57, s[28:31], s61 offen lds
    v_mfma_f32_16x16x32_bf16 v[96:99], v[28:31], a[28:31], v[96:99]
    ds_read_b64_tr_b16 v[38:39], v11 offset:45568
    v_mfma_f32_16x16x32_bf16 v[100:103], v[16:19], a[80:83], v[100:103]
    ds_read_b64_tr_b16 v[40:41], v11 offset:57344
    v_mfma_f32_16x16x32_bf16 v[100:103], v[20:23], a[84:87], v[100:103]
    ds_read_b64_tr_b16 v[42:43], v11 offset:57856
    s_add_u32 m0, s7, 22528
    v_mfma_f32_16x16x32_bf16 v[100:103], v[24:27], a[88:91], v[100:103]
    ds_read_b64_tr_b16 v[44:45], v11 offset:61440
    buffer_load_dwordx4 v56, s[28:31], s62 offen lds
    v_mfma_f32_16x16x32_bf16 v[100:103], v[28:31], a[92:95], v[100:103]
    ds_read_b64_tr_b16 v[46:47], v11 offset:61952
    v_mfma_f32_16x16x32_bf16 v[104:107], v[16:19], a[144:147], v[104:107]
    v_mfma_f32_16x16x32_bf16 v[104:107], v[20:23], a[148:151], v[104:107]
    s_add_u32 m0, s7, 23552
    v_mfma_f32_16x16x32_bf16 v[104:107], v[24:27], a[152:155], v[104:107]
    buffer_load_dwordx4 v57, s[28:31], s63 offen lds
    v_add_u32 v56, 0x80, v56
    v_mfma_f32_16x16x32_bf16 v[104:107], v[28:31], a[156:159], v[104:107]
    v_add_u32 v57, 0x80, v57
    s_add_u32 s69, s4, 2097152
    v_mfma_f32_16x16x32_bf16 v[108:111], v[16:19], a[208:211], v[108:111]
    v_mfma_f32_16x16x32_bf16 v[108:111], v[20:23], a[212:215], v[108:111]
    s_add_u32 m0, s6, 40960
    buffer_load_dwordx4 v[244:247], v7, s[36:39], s55 offen offset:3072
    v_mfma_f32_16x16x32_bf16 v[108:111], v[24:27], a[216:219], v[108:111]
    buffer_load_dwordx4 v48, s[32:35], s69 offen lds
    v_mfma_f32_16x16x32_bf16 v[108:111], v[28:31], a[220:223], v[108:111]
    s_waitcnt vmcnt(12) lgkmcnt(0)
    s_barrier
    v_mfma_f32_16x16x32_bf16 v[112:115], v[32:35], a[16:19], v[112:115]
    v_xor_b32 v8, 0x10000, v8
    v_mfma_f32_16x16x32_bf16 v[112:115], v[36:39], a[20:23], v[112:115]
    ds_read_b64_tr_b16 v[16:17], v8 offset:8192
    s_add_u32 m0, s6, 41984
    v_mfma_f32_16x16x32_bf16 v[112:115], v[40:43], a[24:27], v[112:115]
    ds_read_b64_tr_b16 v[18:19], v8 offset:8704
    buffer_load_dwordx4 v49, s[32:35], s69 offen lds
    v_mfma_f32_16x16x32_bf16 v[112:115], v[44:47], a[28:31], v[112:115]
    ds_read_b64_tr_b16 v[20:21], v8 offset:12288
    v_mfma_f32_16x16x32_bf16 v[116:119], v[32:35], a[80:83], v[116:119]
    ds_read_b64_tr_b16 v[22:23], v8 offset:12800
    v_mfma_f32_16x16x32_bf16 v[116:119], v[36:39], a[84:87], v[116:119]
    ds_read_b64_tr_b16 v[24:25], v8 offset:24576
    s_add_u32 m0, s6, 43008
    v_mfma_f32_16x16x32_bf16 v[116:119], v[40:43], a[88:91], v[116:119]
    ds_read_b64_tr_b16 v[26:27], v8 offset:25088
    buffer_load_dwordx4 v50, s[32:35], s69 offen lds
    v_mfma_f32_16x16x32_bf16 v[116:119], v[44:47], a[92:95], v[116:119]
    ds_read_b64_tr_b16 v[28:29], v8 offset:28672
    v_mfma_f32_16x16x32_bf16 v[120:123], v[32:35], a[144:147], v[120:123]
    ds_read_b64_tr_b16 v[30:31], v8 offset:29184
    v_mfma_f32_16x16x32_bf16 v[120:123], v[36:39], a[148:151], v[120:123]
    s_add_u32 m0, s6, 44032
    v_mfma_f32_16x16x32_bf16 v[120:123], v[40:43], a[152:155], v[120:123]
    buffer_load_dwordx4 v51, s[32:35], s69 offen lds
    s_waitcnt vmcnt(20)
    v_mfma_f32_16x16x32_bf16 v[120:123], v[44:47], a[156:159], v[120:123]
    ds_read_b128 a[32:35], v58 offset:0
    ds_read_b128 a[36:39], v59 offset:0
    v_mfma_f32_16x16x32_bf16 v[124:127], v[32:35], a[208:211], v[124:127]
    ds_read_b128 a[96:99], v58 offset:2048
    ds_read_b128 a[100:103], v59 offset:2048
    v_mfma_f32_16x16x32_bf16 v[124:127], v[36:39], a[212:215], v[124:127]
    ds_read_b128 a[160:163], v58 offset:4096
    ds_read_b128 a[164:167], v59 offset:4096
    v_mfma_f32_16x16x32_bf16 v[124:127], v[40:43], a[216:219], v[124:127]
    ds_read_b128 a[224:227], v58 offset:6144
    ds_read_b128 a[228:231], v59 offset:6144
    v_mfma_f32_16x16x32_bf16 v[124:127], v[44:47], a[220:223], v[124:127]
    s_waitcnt lgkmcnt(0)
    s_waitcnt lgkmcnt(8)
    v_mfma_f32_16x16x32_bf16 v[128:131], v[16:19], a[16:19], v[128:131]
    v_xor_b32 v9, 0x10000, v9
    s_add_u32 m0, s7, 0
    v_mfma_f32_16x16x32_bf16 v[128:131], v[20:23], a[20:23], v[128:131]
    ds_read_b64_tr_b16 v[32:33], v9 offset:8192
    buffer_load_dwordx4 v56, s[28:31], s56 offen lds
    v_mfma_f32_16x16x32_bf16 v[128:131], v[24:27], a[24:27], v[128:131]
    ds_read_b64_tr_b16 v[34:35], v9 offset:8704
    v_mfma_f32_16x16x32_bf16 v[128:131], v[28:31], a[28:31], v[128:131]
    ds_read_b64_tr_b16 v[36:37], v9 offset:12288
    v_mfma_f32_16x16x32_bf16 v[132:135], v[16:19], a[80:83], v[132:135]
    ds_read_b64_tr_b16 v[38:39], v9 offset:12800
    s_add_u32 m0, s7, 1024
    v_mfma_f32_16x16x32_bf16 v[132:135], v[20:23], a[84:87], v[132:135]
    ds_read_b64_tr_b16 v[40:41], v9 offset:24576
    buffer_load_dwordx4 v57, s[28:31], s57 offen lds
    v_mfma_f32_16x16x32_bf16 v[132:135], v[24:27], a[88:91], v[132:135]
    ds_read_b64_tr_b16 v[42:43], v9 offset:25088
    v_mfma_f32_16x16x32_bf16 v[132:135], v[28:31], a[92:95], v[132:135]
    ds_read_b64_tr_b16 v[44:45], v9 offset:28672
    v_mfma_f32_16x16x32_bf16 v[136:139], v[16:19], a[144:147], v[136:139]
    ds_read_b64_tr_b16 v[46:47], v9 offset:29184
    s_add_u32 m0, s7, 2048
    v_mfma_f32_16x16x32_bf16 v[136:139], v[20:23], a[148:151], v[136:139]
    buffer_load_dwordx4 v56, s[28:31], s58 offen lds
    v_mfma_f32_16x16x32_bf16 v[136:139], v[24:27], a[152:155], v[136:139]
    v_mfma_f32_16x16x32_bf16 v[136:139], v[28:31], a[156:159], v[136:139]
    v_mfma_f32_16x16x32_bf16 v[140:143], v[16:19], a[208:211], v[140:143]
    s_add_u32 m0, s7, 3072
    v_mfma_f32_16x16x32_bf16 v[140:143], v[20:23], a[212:215], v[140:143]
    buffer_load_dwordx4 v57, s[28:31], s59 offen lds
    v_mfma_f32_16x16x32_bf16 v[140:143], v[24:27], a[216:219], v[140:143]
    v_mfma_f32_16x16x32_bf16 v[140:143], v[28:31], a[220:223], v[140:143]
    s_waitcnt lgkmcnt(0)
    v_mfma_f32_16x16x32_bf16 v[144:147], v[32:35], a[16:19], v[144:147]
    v_xor_b32 v10, 0x10000, v10
    s_add_u32 m0, s7, 4096
    v_mfma_f32_16x16x32_bf16 v[144:147], v[36:39], a[20:23], v[144:147]
    ds_read_b64_tr_b16 v[16:17], v10 offset:8192
    buffer_load_dwordx4 v56, s[28:31], s60 offen lds
    v_mfma_f32_16x16x32_bf16 v[144:147], v[40:43], a[24:27], v[144:147]
    ds_read_b64_tr_b16 v[18:19], v10 offset:8704
    v_mfma_f32_16x16x32_bf16 v[144:147], v[44:47], a[28:31], v[144:147]
    ds_read_b64_tr_b16 v[20:21], v10 offset:12288
    v_mfma_f32_16x16x32_bf16 v[148:151], v[32:35], a[80:83], v[148:151]
    ds_read_b64_tr_b16 v[22:23], v10 offset:12800
    s_add_u32 m0, s7, 5120
    v_mfma_f32_16x16x32_bf16 v[148:151], v[36:39], a[84:87], v[148:151]
    ds_read_b64_tr_b16 v[24:25], v10 offset:24576
    buffer_load_dwordx4 v57, s[28:31], s61 offen lds
    v_mfma_f32_16x16x32_bf16 v[148:151], v[40:43], a[88:91], v[148:151]
    ds_read_b64_tr_b16 v[26:27], v10 offset:25088
    v_mfma_f32_16x16x32_bf16 v[148:151], v[44:47], a[92:95], v[148:151]
    ds_read_b64_tr_b16 v[28:29], v10 offset:28672
    v_mfma_f32_16x16x32_bf16 v[152:155], v[32:35], a[144:147], v[152:155]
    ds_read_b64_tr_b16 v[30:31], v10 offset:29184
    s_add_u32 m0, s7, 6144
    v_mfma_f32_16x16x32_bf16 v[152:155], v[36:39], a[148:151], v[152:155]
    buffer_load_dwordx4 v56, s[28:31], s62 offen lds
    v_mfma_f32_16x16x32_bf16 v[152:155], v[40:43], a[152:155], v[152:155]
    v_mfma_f32_16x16x32_bf16 v[152:155], v[44:47], a[156:159], v[152:155]
    v_mfma_f32_16x16x32_bf16 v[156:159], v[32:35], a[208:211], v[156:159]
    s_add_u32 m0, s7, 7168
    v_mfma_f32_16x16x32_bf16 v[156:159], v[36:39], a[212:215], v[156:159]
    buffer_load_dwordx4 v57, s[28:31], s63 offen lds
    v_add_u32 v56, 0x80, v56
    v_mfma_f32_16x16x32_bf16 v[156:159], v[40:43], a[216:219], v[156:159]
    v_add_u32 v57, 0x80, v57
    s_add_u32 s69, s4, 2097280
    v_mfma_f32_16x16x32_bf16 v[156:159], v[44:47], a[220:223], v[156:159]
    s_waitcnt lgkmcnt(0)
    v_mfma_f32_16x16x32_bf16 v[160:163], v[16:19], a[16:19], v[160:163]
    v_xor_b32 v11, 0x10000, v11
    s_add_u32 m0, s6, 73728
    v_mfma_f32_16x16x32_bf16 v[160:163], v[20:23], a[20:23], v[160:163]
    ds_read_b64_tr_b16 v[32:33], v11 offset:8192
    buffer_load_dwordx4 v48, s[32:35], s69 offen lds
    v_mfma_f32_16x16x32_bf16 v[160:163], v[24:27], a[24:27], v[160:163]
    ds_read_b64_tr_b16 v[34:35], v11 offset:8704
    v_mfma_f32_16x16x32_bf16 v[160:163], v[28:31], a[28:31], v[160:163]
    ds_read_b64_tr_b16 v[36:37], v11 offset:12288
    v_mfma_f32_16x16x32_bf16 v[164:167], v[16:19], a[80:83], v[164:167]
    ds_read_b64_tr_b16 v[38:39], v11 offset:12800
    s_add_u32 m0, s6, 74752
    v_mfma_f32_16x16x32_bf16 v[164:167], v[20:23], a[84:87], v[164:167]
    ds_read_b64_tr_b16 v[40:41], v11 offset:24576
    buffer_load_dwordx4 v49, s[32:35], s69 offen lds
    v_mfma_f32_16x16x32_bf16 v[164:167], v[24:27], a[88:91], v[164:167]
    ds_read_b64_tr_b16 v[42:43], v11 offset:25088
    v_mfma_f32_16x16x32_bf16 v[164:167], v[28:31], a[92:95], v[164:167]
    ds_read_b64_tr_b16 v[44:45], v11 offset:28672
    v_mfma_f32_16x16x32_bf16 v[168:171], v[16:19], a[144:147], v[168:171]
    ds_read_b64_tr_b16 v[46:47], v11 offset:29184
    s_add_u32 m0, s6, 75776
    v_mfma_f32_16x16x32_bf16 v[168:171], v[20:23], a[148:151], v[168:171]
    buffer_load_dwordx4 v50, s[32:35], s69 offen lds
    v_mfma_f32_16x16x32_bf16 v[168:171], v[24:27], a[152:155], v[168:171]
    v_mfma_f32_16x16x32_bf16 v[168:171], v[28:31], a[156:159], v[168:171]
    v_mfma_f32_16x16x32_bf16 v[172:175], v[16:19], a[208:211], v[172:175]
    s_add_u32 m0, s6, 76800
    v_mfma_f32_16x16x32_bf16 v[172:175], v[20:23], a[212:215], v[172:175]
    buffer_load_dwordx4 v51, s[32:35], s69 offen lds
    s_waitcnt vmcnt(17)
    v_mfma_f32_16x16x32_bf16 v[172:175], v[24:27], a[216:219], v[172:175]
    ds_read_b128 a[40:43], v58 offset:16384
    ds_read_b128 a[44:47], v59 offset:16384
    v_mfma_f32_16x16x32_bf16 v[172:175], v[28:31], a[220:223], v[172:175]
    s_waitcnt vmcnt(12) lgkmcnt(2)
    s_barrier
    v_mfma_f32_16x16x32_bf16 v[176:179], v[32:35], a[16:19], v[176:179]
    ds_read_b64_tr_b16 v[16:17], v8 offset:40960
    ds_read_b128 a[104:107], v58 offset:18432
    v_mfma_f32_16x16x32_bf16 v[176:179], v[36:39], a[20:23], v[176:179]
    ds_read_b64_tr_b16 v[18:19], v8 offset:41472
    ds_read_b128 a[108:111], v59 offset:18432
    v_mfma_f32_16x16x32_bf16 v[176:179], v[40:43], a[24:27], v[176:179]
    ds_read_b64_tr_b16 v[20:21], v8 offset:45056
    ds_read_b128 a[168:171], v58 offset:20480
    v_mfma_f32_16x16x32_bf16 v[176:179], v[44:47], a[28:31], v[176:179]
    ds_read_b64_tr_b16 v[22:23], v8 offset:45568
    ds_read_b128 a[172:175], v59 offset:20480
    v_mfma_f32_16x16x32_bf16 v[180:183], v[32:35], a[80:83], v[180:183]
    ds_read_b64_tr_b16 v[24:25], v8 offset:57344
    ds_read_b128 a[232:235], v58 offset:22528
    v_mfma_f32_16x16x32_bf16 v[180:183], v[36:39], a[84:87], v[180:183]
    ds_read_b64_tr_b16 v[26:27], v8 offset:57856
    ds_read_b128 a[236:239], v59 offset:22528
    v_mfma_f32_16x16x32_bf16 v[180:183], v[40:43], a[88:91], v[180:183]
    ds_read_b64_tr_b16 v[28:29], v8 offset:61440
    s_waitcnt lgkmcnt(1)
    v_mfma_f32_16x16x32_bf16 v[180:183], v[44:47], a[92:95], v[180:183]
    ds_read_b64_tr_b16 v[30:31], v8 offset:61952
    s_add_u32 m0, s7, 16384
    v_mfma_f32_16x16x32_bf16 v[184:187], v[32:35], a[144:147], v[184:187]
    buffer_load_dwordx4 v56, s[28:31], s56 offen lds
    v_mfma_f32_16x16x32_bf16 v[184:187], v[36:39], a[148:151], v[184:187]
    v_mfma_f32_16x16x32_bf16 v[184:187], v[40:43], a[152:155], v[184:187]
    v_mfma_f32_16x16x32_bf16 v[184:187], v[44:47], a[156:159], v[184:187]
    s_add_u32 m0, s7, 17408
    v_mfma_f32_16x16x32_bf16 v[188:191], v[32:35], a[208:211], v[188:191]
    buffer_load_dwordx4 v57, s[28:31], s57 offen lds
    v_mfma_f32_16x16x32_bf16 v[188:191], v[36:39], a[212:215], v[188:191]
    v_mfma_f32_16x16x32_bf16 v[188:191], v[40:43], a[216:219], v[188:191]
    v_mfma_f32_16x16x32_bf16 v[188:191], v[44:47], a[220:223], v[188:191]
    s_waitcnt lgkmcnt(0)
    v_mfma_f32_16x16x32_bf16 v[64:67], v[16:19], a[32:35], v[64:67]
    ds_read_b64_tr_b16 v[32:33], v9 offset:40960
    s_add_u32 m0, s7, 18432
    v_mfma_f32_16x16x32_bf16 v[64:67], v[20:23], a[36:39], v[64:67]
    ds_read_b64_tr_b16 v[34:35], v9 offset:41472
    buffer_load_dwordx4 v56, s[28:31], s58 offen lds
    v_mfma_f32_16x16x32_bf16 v[64:67], v[24:27], a[40:43], v[64:67]
    ds_read_b64_tr_b16 v[36:37], v9 offset:45056
    v_mfma_f32_16x16x32_bf16 v[64:67], v[28:31], a[44:47], v[64:67]
    ds_read_b64_tr_b16 v[38:39], v9 offset:45568
    v_mfma_f32_16x16x32_bf16 v[68:71], v[16:19], a[96:99], v[68:71]
    ds_read_b64_tr_b16 v[40:41], v9 offset:57344
    s_add_u32 m0, s7, 19456
    v_mfma_f32_16x16x32_bf16 v[68:71], v[20:23], a[100:103], v[68:71]
    ds_read_b64_tr_b16 v[42:43], v9 offset:57856
    buffer_load_dwordx4 v57, s[28:31], s59 offen lds
    v_mfma_f32_16x16x32_bf16 v[68:71], v[24:27], a[104:107], v[68:71]
    ds_read_b64_tr_b16 v[44:45], v9 offset:61440
    v_mfma_f32_16x16x32_bf16 v[68:71], v[28:31], a[108:111], v[68:71]
    ds_read_b64_tr_b16 v[46:47], v9 offset:61952
    v_mfma_f32_16x16x32_bf16 v[72:75], v[16:19], a[160:163], v[72:75]
    s_add_u32 m0, s7, 20480
    v_mfma_f32_16x16x32_bf16 v[72:75], v[20:23], a[164:167], v[72:75]
    buffer_load_dwordx4 v56, s[28:31], s60 offen lds
    v_mfma_f32_16x16x32_bf16 v[72:75], v[24:27], a[168:171], v[72:75]
    v_mfma_f32_16x16x32_bf16 v[72:75], v[28:31], a[172:175], v[72:75]
    v_mfma_f32_16x16x32_bf16 v[76:79], v[16:19], a[224:227], v[76:79]
    s_add_u32 m0, s7, 21504
    v_mfma_f32_16x16x32_bf16 v[76:79], v[20:23], a[228:231], v[76:79]
    buffer_load_dwordx4 v57, s[28:31], s61 offen lds
    v_mfma_f32_16x16x32_bf16 v[76:79], v[24:27], a[232:235], v[76:79]
    v_mfma_f32_16x16x32_bf16 v[76:79], v[28:31], a[236:239], v[76:79]
    s_waitcnt lgkmcnt(0)
    v_mfma_f32_16x16x32_bf16 v[80:83], v[32:35], a[32:35], v[80:83]
    ds_read_b64_tr_b16 v[16:17], v10 offset:40960
    s_add_u32 m0, s7, 22528
    v_mfma_f32_16x16x32_bf16 v[80:83], v[36:39], a[36:39], v[80:83]
    ds_read_b64_tr_b16 v[18:19], v10 offset:41472
    buffer_load_dwordx4 v56, s[28:31], s62 offen lds
    v_mfma_f32_16x16x32_bf16 v[80:83], v[40:43], a[40:43], v[80:83]
    ds_read_b64_tr_b16 v[20:21], v10 offset:45056
    v_mfma_f32_16x16x32_bf16 v[80:83], v[44:47], a[44:47], v[80:83]
    ds_read_b64_tr_b16 v[22:23], v10 offset:45568
    v_mfma_f32_16x16x32_bf16 v[84:87], v[32:35], a[96:99], v[84:87]
    ds_read_b64_tr_b16 v[24:25], v10 offset:57344
    s_add_u32 m0, s7, 23552
    v_mfma_f32_16x16x32_bf16 v[84:87], v[36:39], a[100:103], v[84:87]
    ds_read_b64_tr_b16 v[26:27], v10 offset:57856
    buffer_load_dwordx4 v57, s[28:31], s63 offen lds
    v_mfma_f32_16x16x32_bf16 v[84:87], v[40:43], a[104:107], v[84:87]
    ds_read_b64_tr_b16 v[28:29], v10 offset:61440
    v_add_u32 v56, 0x80, v56
    v_mfma_f32_16x16x32_bf16 v[84:87], v[44:47], a[108:111], v[84:87]
    ds_read_b64_tr_b16 v[30:31], v10 offset:61952
    v_add_u32 v57, 0x80, v57
    v_mfma_f32_16x16x32_bf16 v[88:91], v[32:35], a[160:163], v[88:91]
    s_add_u32 s69, s4, 3145728
    s_add_u32 m0, s6, 106496
    v_mfma_f32_16x16x32_bf16 v[88:91], v[36:39], a[164:167], v[88:91]
    buffer_load_dwordx4 v48, s[32:35], s69 offen lds
    v_mfma_f32_16x16x32_bf16 v[88:91], v[40:43], a[168:171], v[88:91]
    v_mfma_f32_16x16x32_bf16 v[88:91], v[44:47], a[172:175], v[88:91]
    v_mfma_f32_16x16x32_bf16 v[92:95], v[32:35], a[224:227], v[92:95]
    s_add_u32 m0, s6, 107520
    v_mfma_f32_16x16x32_bf16 v[92:95], v[36:39], a[228:231], v[92:95]
    buffer_load_dwordx4 v49, s[32:35], s69 offen lds
    v_mfma_f32_16x16x32_bf16 v[92:95], v[40:43], a[232:235], v[92:95]
    v_mfma_f32_16x16x32_bf16 v[92:95], v[44:47], a[236:239], v[92:95]
    s_waitcnt lgkmcnt(0)
    v_mfma_f32_16x16x32_bf16 v[96:99], v[16:19], a[32:35], v[96:99]
    ds_read_b64_tr_b16 v[32:33], v11 offset:40960
    s_add_u32 m0, s6, 108544
    v_mfma_f32_16x16x32_bf16 v[96:99], v[20:23], a[36:39], v[96:99]
    ds_read_b64_tr_b16 v[34:35], v11 offset:41472
    buffer_load_dwordx4 v50, s[32:35], s69 offen lds
    v_mfma_f32_16x16x32_bf16 v[96:99], v[24:27], a[40:43], v[96:99]
    ds_read_b64_tr_b16 v[36:37], v11 offset:45056
    v_mfma_f32_16x16x32_bf16 v[96:99], v[28:31], a[44:47], v[96:99]
    ds_read_b64_tr_b16 v[38:39], v11 offset:45568
    v_mfma_f32_16x16x32_bf16 v[100:103], v[16:19], a[96:99], v[100:103]
    ds_read_b64_tr_b16 v[40:41], v11 offset:57344
    s_add_u32 m0, s6, 109568
    v_mfma_f32_16x16x32_bf16 v[100:103], v[20:23], a[100:103], v[100:103]
    ds_read_b64_tr_b16 v[42:43], v11 offset:57856
    buffer_load_dwordx4 v51, s[32:35], s69 offen lds
    v_mfma_f32_16x16x32_bf16 v[100:103], v[24:27], a[104:107], v[100:103]
    ds_read_b64_tr_b16 v[44:45], v11 offset:61440
    s_waitcnt vmcnt(16)
    v_mfma_f32_16x16x32_bf16 v[100:103], v[28:31], a[108:111], v[100:103]
    ds_read_b64_tr_b16 v[46:47], v11 offset:61952
    ds_read_b128 a[48:51], v58 offset:0
    v_mfma_f32_16x16x32_bf16 v[104:107], v[16:19], a[160:163], v[104:107]
    ds_read_b128 a[52:55], v59 offset:0
    ds_read_b128 a[112:115], v58 offset:2048
    v_mfma_f32_16x16x32_bf16 v[104:107], v[20:23], a[164:167], v[104:107]
    ds_read_b128 a[116:119], v59 offset:2048
    ds_read_b128 a[176:179], v58 offset:4096
    v_mfma_f32_16x16x32_bf16 v[104:107], v[24:27], a[168:171], v[104:107]
    ds_read_b128 a[180:183], v59 offset:4096
    ds_read_b128 a[240:243], v58 offset:6144
    v_mfma_f32_16x16x32_bf16 v[104:107], v[28:31], a[172:175], v[104:107]
    ds_read_b128 a[244:247], v59 offset:6144
    s_add_u32 s69, s4, 3145856
    v_mfma_f32_16x16x32_bf16 v[108:111], v[16:19], a[224:227], v[108:111]
    s_add_u32 m0, s6, 8192
    v_mfma_f32_16x16x32_bf16 v[108:111], v[20:23], a[228:231], v[108:111]
    buffer_load_dwordx4 v48, s[32:35], s69 offen lds
    v_mfma_f32_16x16x32_bf16 v[108:111], v[24:27], a[232:235], v[108:111]
    v_mfma_f32_16x16x32_bf16 v[108:111], v[28:31], a[236:239], v[108:111]
    s_waitcnt vmcnt(13) lgkmcnt(8)
    s_barrier
    v_mfma_f32_16x16x32_bf16 v[112:115], v[32:35], a[32:35], v[112:115]
    v_xor_b32 v8, 0x10000, v8
    s_add_u32 m0, s6, 9216
    v_mfma_f32_16x16x32_bf16 v[112:115], v[36:39], a[36:39], v[112:115]
    ds_read_b64_tr_b16 v[16:17], v8 offset:8192
    buffer_load_dwordx4 v49, s[32:35], s69 offen lds
    v_mfma_f32_16x16x32_bf16 v[112:115], v[40:43], a[40:43], v[112:115]
    ds_read_b64_tr_b16 v[18:19], v8 offset:8704
    v_mfma_f32_16x16x32_bf16 v[112:115], v[44:47], a[44:47], v[112:115]
    ds_read_b64_tr_b16 v[20:21], v8 offset:12288
    v_mfma_f32_16x16x32_bf16 v[116:119], v[32:35], a[96:99], v[116:119]
    ds_read_b64_tr_b16 v[22:23], v8 offset:12800
    s_add_u32 m0, s6, 10240
    v_mfma_f32_16x16x32_bf16 v[116:119], v[36:39], a[100:103], v[116:119]
    ds_read_b64_tr_b16 v[24:25], v8 offset:24576
    buffer_load_dwordx4 v50, s[32:35], s69 offen lds
    v_mfma_f32_16x16x32_bf16 v[116:119], v[40:43], a[104:107], v[116:119]
    ds_read_b64_tr_b16 v[26:27], v8 offset:25088
    v_mfma_f32_16x16x32_bf16 v[116:119], v[44:47], a[108:111], v[116:119]
    ds_read_b64_tr_b16 v[28:29], v8 offset:28672
    v_mfma_f32_16x16x32_bf16 v[120:123], v[32:35], a[160:163], v[120:123]
    ds_read_b64_tr_b16 v[30:31], v8 offset:29184
    s_add_u32 m0, s6, 11264
    v_mfma_f32_16x16x32_bf16 v[120:123], v[36:39], a[164:167], v[120:123]
    buffer_load_dwordx4 v51, s[32:35], s69 offen lds
    v_mfma_f32_16x16x32_bf16 v[120:123], v[40:43], a[168:171], v[120:123]
    v_mfma_f32_16x16x32_bf16 v[120:123], v[44:47], a[172:175], v[120:123]
    v_mfma_f32_16x16x32_bf16 v[124:127], v[32:35], a[224:227], v[124:127]
    v_mfma_f32_16x16x32_bf16 v[124:127], v[36:39], a[228:231], v[124:127]
    v_mfma_f32_16x16x32_bf16 v[124:127], v[40:43], a[232:235], v[124:127]
    v_mfma_f32_16x16x32_bf16 v[124:127], v[44:47], a[236:239], v[124:127]
    s_waitcnt lgkmcnt(0)
    v_mfma_f32_16x16x32_bf16 v[128:131], v[16:19], a[32:35], v[128:131]
    v_xor_b32 v9, 0x10000, v9
    v_mfma_f32_16x16x32_bf16 v[128:131], v[20:23], a[36:39], v[128:131]
    ds_read_b64_tr_b16 v[32:33], v9 offset:8192
    ds_read_b128 v[192:195], v225
    v_mfma_f32_16x16x32_bf16 v[128:131], v[24:27], a[40:43], v[128:131]
    ds_read_b64_tr_b16 v[34:35], v9 offset:8704
    v_mfma_f32_16x16x32_bf16 v[128:131], v[28:31], a[44:47], v[128:131]
    ds_read_b64_tr_b16 v[36:37], v9 offset:12288
    v_mfma_f32_16x16x32_bf16 v[132:135], v[16:19], a[96:99], v[132:135]
    ds_read_b64_tr_b16 v[38:39], v9 offset:12800
    v_mfma_f32_16x16x32_bf16 v[132:135], v[20:23], a[100:103], v[132:135]
    ds_read_b64_tr_b16 v[40:41], v9 offset:24576
    ds_read_b128 v[196:199], v225 offset:1024
    v_mfma_f32_16x16x32_bf16 v[132:135], v[24:27], a[104:107], v[132:135]
    ds_read_b64_tr_b16 v[42:43], v9 offset:25088
    v_mfma_f32_16x16x32_bf16 v[132:135], v[28:31], a[108:111], v[132:135]
    ds_read_b64_tr_b16 v[44:45], v9 offset:28672
    v_mfma_f32_16x16x32_bf16 v[136:139], v[16:19], a[160:163], v[136:139]
    ds_read_b64_tr_b16 v[46:47], v9 offset:29184
    v_mfma_f32_16x16x32_bf16 v[136:139], v[20:23], a[164:167], v[136:139]
    s_waitcnt lgkmcnt(3)
    v_mfma_f32_16x16x32_bf16 v[136:139], v[24:27], a[168:171], v[136:139]
    s_waitcnt vmcnt(8)
    ds_read_b128 a[56:59], v58 offset:16384
    v_mfma_f32_16x16x32_bf16 v[136:139], v[28:31], a[172:175], v[136:139]
    ds_read_b128 a[60:63], v59 offset:16384
    ds_read_b128 a[120:123], v58 offset:18432
    v_mfma_f32_16x16x32_bf16 v[140:143], v[16:19], a[224:227], v[140:143]
    ds_read_b128 a[124:127], v59 offset:18432
    ds_read_b128 a[184:187], v58 offset:20480
    v_mfma_f32_16x16x32_bf16 v[140:143], v[20:23], a[228:231], v[140:143]
    ds_read_b128 a[188:191], v59 offset:20480
    ds_read_b128 a[248:251], v58 offset:22528
    v_mfma_f32_16x16x32_bf16 v[140:143], v[24:27], a[232:235], v[140:143]
    ds_read_b128 a[252:255], v59 offset:22528
    s_add_u32 s69, s4, 0
    v_mfma_f32_16x16x32_bf16 v[140:143], v[28:31], a[236:239], v[140:143]
    s_waitcnt lgkmcnt(8)
    s_add_u32 m0, s6, 40960
    v_mfma_f32_16x16x32_bf16 v[144:147], v[32:35], a[32:35], v[144:147]
    v_xor_b32 v10, 0x10000, v10
    buffer_load_dwordx4 v48, s[36:39], s69 offen lds
    v_mfma_f32_16x16x32_bf16 v[144:147], v[36:39], a[36:39], v[144:147]
    ds_read_b64_tr_b16 v[16:17], v10 offset:8192
    buffer_store_dwordx4 v[192:195], v226, s[8:11], s54 offen sc1
    v_mfma_f32_16x16x32_bf16 v[144:147], v[40:43], a[40:43], v[144:147]
    ds_read_b64_tr_b16 v[18:19], v10 offset:8704
    buffer_store_dwordx4 v[196:199], v226, s[8:11], s54 offen offset:2048 sc1
    v_mfma_f32_16x16x32_bf16 v[144:147], v[44:47], a[44:47], v[144:147]
    ds_read_b64_tr_b16 v[20:21], v10 offset:12288
    s_add_u32 m0, s6, 41984
    v_mfma_f32_16x16x32_bf16 v[148:151], v[32:35], a[96:99], v[148:151]
    ds_read_b64_tr_b16 v[22:23], v10 offset:12800
    buffer_load_dwordx4 v49, s[36:39], s69 offen lds
    v_mfma_f32_16x16x32_bf16 v[148:151], v[36:39], a[100:103], v[148:151]
    ds_read_b64_tr_b16 v[24:25], v10 offset:24576
    v_mfma_f32_16x16x32_bf16 v[148:151], v[40:43], a[104:107], v[148:151]
    ds_read_b64_tr_b16 v[26:27], v10 offset:25088
    buffer_store_dwordx2 v[228:229], v60, s[8:11], s53 offen sc1
    v_mfma_f32_16x16x32_bf16 v[148:151], v[44:47], a[108:111], v[148:151]
    ds_read_b64_tr_b16 v[28:29], v10 offset:28672
    s_add_u32 m0, s6, 43008
    v_mfma_f32_16x16x32_bf16 v[152:155], v[32:35], a[160:163], v[152:155]
    ds_read_b64_tr_b16 v[30:31], v10 offset:29184
    buffer_load_dwordx4 v50, s[36:39], s69 offen lds
    v_mfma_f32_16x16x32_bf16 v[152:155], v[36:39], a[164:167], v[152:155]
    v_mfma_f32_16x16x32_bf16 v[152:155], v[40:43], a[168:171], v[152:155]
    buffer_store_dword v228, v60, s[8:11], s74 offen sc1
    v_mfma_f32_16x16x32_bf16 v[152:155], v[44:47], a[172:175], v[152:155]
    s_add_u32 m0, s6, 44032
    v_mfma_f32_16x16x32_bf16 v[156:159], v[32:35], a[224:227], v[156:159]
    buffer_load_dwordx4 v51, s[36:39], s69 offen lds
    v_mfma_f32_16x16x32_bf16 v[156:159], v[36:39], a[228:231], v[156:159]
    v_mfma_f32_16x16x32_bf16 v[156:159], v[40:43], a[232:235], v[156:159]
    buffer_store_dword v228, v6, s[8:11], s45 offen sc1
    v_mfma_f32_16x16x32_bf16 v[156:159], v[44:47], a[236:239], v[156:159]
    s_waitcnt lgkmcnt(0)
    v_mfma_f32_16x16x32_bf16 v[160:163], v[16:19], a[32:35], v[160:163]
    v_xor_b32 v11, 0x10000, v11
    v_mfma_f32_16x16x32_bf16 v[160:163], v[20:23], a[36:39], v[160:163]
    ds_read_b64_tr_b16 v[32:33], v11 offset:8192
    s_lshl_b32 s55, s2, 2
    v_mfma_f32_16x16x32_bf16 v[160:163], v[24:27], a[40:43], v[160:163]
    ds_read_b64_tr_b16 v[34:35], v11 offset:8704
    s_add_u32 s55, s55, s40
    v_mfma_f32_16x16x32_bf16 v[160:163], v[28:31], a[44:47], v[160:163]
    ds_read_b64_tr_b16 v[36:37], v11 offset:12288
    s_lshl_b32 s55, s55, 12
    v_mfma_f32_16x16x32_bf16 v[164:167], v[16:19], a[96:99], v[164:167]
    ds_read_b64_tr_b16 v[38:39], v11 offset:12800
    buffer_load_dwordx4 v[244:247], v7, s[12:15], s55 offen offset:0
    v_mfma_f32_16x16x32_bf16 v[164:167], v[20:23], a[100:103], v[164:167]
    ds_read_b64_tr_b16 v[40:41], v11 offset:24576
    v_mfma_f32_16x16x32_bf16 v[164:167], v[24:27], a[104:107], v[164:167]
    ds_read_b64_tr_b16 v[42:43], v11 offset:25088
    buffer_load_dwordx4 v[244:247], v7, s[12:15], s55 offen offset:1024
    v_mfma_f32_16x16x32_bf16 v[164:167], v[28:31], a[108:111], v[164:167]
    ds_read_b64_tr_b16 v[44:45], v11 offset:28672
    v_mfma_f32_16x16x32_bf16 v[168:171], v[16:19], a[160:163], v[168:171]
    ds_read_b64_tr_b16 v[46:47], v11 offset:29184
    v_mfma_f32_16x16x32_bf16 v[168:171], v[20:23], a[164:167], v[168:171]
    v_mfma_f32_16x16x32_bf16 v[168:171], v[24:27], a[168:171], v[168:171]
    v_mfma_f32_16x16x32_bf16 v[168:171], v[28:31], a[172:175], v[168:171]
    buffer_load_dwordx4 v[244:247], v7, s[12:15], s55 offen offset:2048
    v_mfma_f32_16x16x32_bf16 v[172:175], v[16:19], a[224:227], v[172:175]
    v_mfma_f32_16x16x32_bf16 v[172:175], v[20:23], a[228:231], v[172:175]
    v_mfma_f32_16x16x32_bf16 v[172:175], v[24:27], a[232:235], v[172:175]
    v_mfma_f32_16x16x32_bf16 v[172:175], v[28:31], a[236:239], v[172:175]
    s_waitcnt vmcnt(16) lgkmcnt(0)
    s_barrier
    v_mfma_f32_16x16x32_bf16 v[176:179], v[32:35], a[32:35], v[176:179]
    ds_read_b64_tr_b16 v[16:17], v8 offset:40960
    buffer_load_dwordx4 v[244:247], v7, s[12:15], s55 offen offset:3072
    v_mfma_f32_16x16x32_bf16 v[176:179], v[36:39], a[36:39], v[176:179]
    ds_read_b64_tr_b16 v[18:19], v8 offset:41472
    v_mfma_f32_16x16x32_bf16 v[176:179], v[40:43], a[40:43], v[176:179]
    ds_read_b64_tr_b16 v[20:21], v8 offset:45056
    s_lshl_b32 s55, s2, 2
    v_mfma_f32_16x16x32_bf16 v[176:179], v[44:47], a[44:47], v[176:179]
    ds_read_b64_tr_b16 v[22:23], v8 offset:45568
    s_add_u32 s55, s55, s40
    v_mfma_f32_16x16x32_bf16 v[180:183], v[32:35], a[96:99], v[180:183]
    ds_read_b64_tr_b16 v[24:25], v8 offset:57344
    s_lshl_b32 s55, s55, 11
    v_mfma_f32_16x16x32_bf16 v[180:183], v[36:39], a[100:103], v[180:183]
    ds_read_b64_tr_b16 v[26:27], v8 offset:57856
    buffer_load_dwordx4 v[244:247], v7, s[16:19], s55 offen offset:0
    v_mfma_f32_16x16x32_bf16 v[180:183], v[40:43], a[104:107], v[180:183]
    ds_read_b64_tr_b16 v[28:29], v8 offset:61440
    v_mfma_f32_16x16x32_bf16 v[180:183], v[44:47], a[108:111], v[180:183]
    ds_read_b64_tr_b16 v[30:31], v8 offset:61952
    buffer_load_dwordx4 v[244:247], v7, s[16:19], s55 offen offset:1024
    v_mfma_f32_16x16x32_bf16 v[184:187], v[32:35], a[160:163], v[184:187]
    v_mfma_f32_16x16x32_bf16 v[184:187], v[36:39], a[164:167], v[184:187]
    v_mfma_f32_16x16x32_bf16 v[184:187], v[40:43], a[168:171], v[184:187]
    v_mfma_f32_16x16x32_bf16 v[184:187], v[44:47], a[172:175], v[184:187]
    v_mfma_f32_16x16x32_bf16 v[188:191], v[32:35], a[224:227], v[188:191]
    v_mfma_f32_16x16x32_bf16 v[188:191], v[36:39], a[228:231], v[188:191]
    v_mfma_f32_16x16x32_bf16 v[188:191], v[40:43], a[232:235], v[188:191]
    v_mfma_f32_16x16x32_bf16 v[188:191], v[44:47], a[236:239], v[188:191]
    s_waitcnt lgkmcnt(0)
    v_mfma_f32_16x16x32_bf16 v[64:67], v[16:19], a[48:51], v[64:67]
    ds_read_b64_tr_b16 v[32:33], v9 offset:40960
    s_add_u32 s69, s4, 1048576
    v_mfma_f32_16x16x32_bf16 v[64:67], v[20:23], a[52:55], v[64:67]
    ds_read_b64_tr_b16 v[34:35], v9 offset:41472
    s_add_u32 m0, s6, 73728
    v_mfma_f32_16x16x32_bf16 v[64:67], v[24:27], a[56:59], v[64:67]
    ds_read_b64_tr_b16 v[36:37], v9 offset:45056
    buffer_load_dwordx4 v48, s[36:39], s69 offen lds
    v_mfma_f32_16x16x32_bf16 v[64:67], v[28:31], a[60:63], v[64:67]
    ds_read_b64_tr_b16 v[38:39], v9 offset:45568
    v_and_b32 v240, 15, v1
    v_mfma_f32_16x16x32_bf16 v[68:71], v[16:19], a[112:115], v[68:71]
    ds_read_b64_tr_b16 v[40:41], v9 offset:57344
    v_lshrrev_b32 v241, 4, v1
    v_mfma_f32_16x16x32_bf16 v[68:71], v[20:23], a[116:119], v[68:71]
    ds_read_b64_tr_b16 v[42:43], v9 offset:57856
    s_add_u32 m0, s6, 74752
    v_mfma_f32_16x16x32_bf16 v[68:71], v[24:27], a[120:123], v[68:71]
    ds_read_b64_tr_b16 v[44:45], v9 offset:61440
    buffer_load_dwordx4 v49, s[36:39], s69 offen lds
    v_mfma_f32_16x16x32_bf16 v[68:71], v[28:31], a[124:127], v[68:71]
    ds_read_b64_tr_b16 v[46:47], v9 offset:61952
    v_lshlrev_b32 v241, 2, v241
    v_mfma_f32_16x16x32_bf16 v[72:75], v[16:19], a[176:179], v[72:75]
    v_add_u32 v242, 0, v241
    v_cmp_gt_u32 s[56:57], v242, v240
    v_mfma_f32_16x16x32_bf16 v[72:75], v[20:23], a[180:183], v[72:75]
    s_add_u32 m0, s6, 75776
    v_add_u32 v242, 1, v241
    v_mfma_f32_16x16x32_bf16 v[72:75], v[24:27], a[184:187], v[72:75]
    buffer_load_dwordx4 v50, s[36:39], s69 offen lds
    v_cmp_gt_u32 s[58:59], v242, v240
    v_mfma_f32_16x16x32_bf16 v[72:75], v[28:31], a[188:191], v[72:75]
    v_add_u32 v242, 2, v241
    v_cmp_gt_u32 s[60:61], v242, v240
    v_mfma_f32_16x16x32_bf16 v[76:79], v[16:19], a[240:243], v[76:79]
    v_add_u32 v242, 3, v241
    v_cmp_gt_u32 s[62:63], v242, v240
    v_mfma_f32_16x16x32_bf16 v[76:79], v[20:23], a[244:247], v[76:79]
    s_add_u32 m0, s6, 76800
    v_mfma_f32_16x16x32_bf16 v[76:79], v[24:27], a[248:251], v[76:79]
    buffer_load_dwordx4 v51, s[36:39], s69 offen lds
    v_mfma_f32_16x16x32_bf16 v[76:79], v[28:31], a[252:255], v[76:79]
    s_waitcnt lgkmcnt(0)
    v_mfma_f32_16x16x32_bf16 v[80:83], v[32:35], a[48:51], v[80:83]
    ds_read_b64_tr_b16 v[16:17], v10 offset:40960
    v_mfma_f32_16x16x32_bf16 v[80:83], v[36:39], a[52:55], v[80:83]
    ds_read_b64_tr_b16 v[18:19], v10 offset:41472
    v_mfma_f32_16x16x32_bf16 v[80:83], v[40:43], a[56:59], v[80:83]
    ds_read_b64_tr_b16 v[20:21], v10 offset:45056
    v_mfma_f32_16x16x32_bf16 v[80:83], v[44:47], a[60:63], v[80:83]
    ds_read_b64_tr_b16 v[22:23], v10 offset:45568
    v_mfma_f32_16x16x32_bf16 v[84:87], v[32:35], a[112:115], v[84:87]
    ds_read_b64_tr_b16 v[24:25], v10 offset:57344
    v_mfma_f32_16x16x32_bf16 v[84:87], v[36:39], a[116:119], v[84:87]
    ds_read_b64_tr_b16 v[26:27], v10 offset:57856
    v_mfma_f32_16x16x32_bf16 v[84:87], v[40:43], a[120:123], v[84:87]
    ds_read_b64_tr_b16 v[28:29], v10 offset:61440
    v_mfma_f32_16x16x32_bf16 v[84:87], v[44:47], a[124:127], v[84:87]
    ds_read_b64_tr_b16 v[30:31], v10 offset:61952
    v_mfma_f32_16x16x32_bf16 v[88:91], v[32:35], a[176:179], v[88:91]
    v_mfma_f32_16x16x32_bf16 v[88:91], v[36:39], a[180:183], v[88:91]
    v_mfma_f32_16x16x32_bf16 v[88:91], v[40:43], a[184:187], v[88:91]
    v_mfma_f32_16x16x32_bf16 v[88:91], v[44:47], a[188:191], v[88:91]
    v_mfma_f32_16x16x32_bf16 v[92:95], v[32:35], a[240:243], v[92:95]
    v_mfma_f32_16x16x32_bf16 v[92:95], v[36:39], a[244:247], v[92:95]
    v_mfma_f32_16x16x32_bf16 v[92:95], v[40:43], a[248:251], v[92:95]
    v_mfma_f32_16x16x32_bf16 v[92:95], v[44:47], a[252:255], v[92:95]
    s_waitcnt lgkmcnt(0)
    v_mfma_f32_16x16x32_bf16 v[96:99], v[16:19], a[48:51], v[96:99]
    ds_read_b64_tr_b16 v[32:33], v11 offset:40960
    v_mfma_f32_16x16x32_bf16 v[96:99], v[20:23], a[52:55], v[96:99]
    ds_read_b64_tr_b16 v[34:35], v11 offset:41472
    v_mfma_f32_16x16x32_bf16 v[96:99], v[24:27], a[56:59], v[96:99]
    ds_read_b64_tr_b16 v[36:37], v11 offset:45056
    v_mfma_f32_16x16x32_bf16 v[96:99], v[28:31], a[60:63], v[96:99]
    ds_read_b64_tr_b16 v[38:39], v11 offset:45568
    v_mfma_f32_16x16x32_bf16 v[100:103], v[16:19], a[112:115], v[100:103]
    ds_read_b64_tr_b16 v[40:41], v11 offset:57344
    v_mfma_f32_16x16x32_bf16 v[100:103], v[20:23], a[116:119], v[100:103]
    ds_read_b64_tr_b16 v[42:43], v11 offset:57856
    v_mfma_f32_16x16x32_bf16 v[100:103], v[24:27], a[120:123], v[100:103]
    ds_read_b64_tr_b16 v[44:45], v11 offset:61440
    v_mfma_f32_16x16x32_bf16 v[100:103], v[28:31], a[124:127], v[100:103]
    ds_read_b64_tr_b16 v[46:47], v11 offset:61952
    v_mfma_f32_16x16x32_bf16 v[104:107], v[16:19], a[176:179], v[104:107]
    v_mfma_f32_16x16x32_bf16 v[104:107], v[20:23], a[180:183], v[104:107]
    v_mfma_f32_16x16x32_bf16 v[104:107], v[24:27], a[184:187], v[104:107]
    v_mfma_f32_16x16x32_bf16 v[104:107], v[28:31], a[188:191], v[104:107]
    v_mfma_f32_16x16x32_bf16 v[108:111], v[16:19], a[240:243], v[108:111]
    v_mfma_f32_16x16x32_bf16 v[108:111], v[20:23], a[244:247], v[108:111]
    v_mfma_f32_16x16x32_bf16 v[108:111], v[24:27], a[248:251], v[108:111]
    v_mfma_f32_16x16x32_bf16 v[108:111], v[28:31], a[252:255], v[108:111]
    s_waitcnt vmcnt(10) lgkmcnt(0)
    s_barrier
    v_mfma_f32_16x16x32_bf16 v[112:115], v[32:35], a[48:51], v[112:115]
    v_xor_b32 v8, 0x10000, v8
    v_mfma_f32_16x16x32_bf16 v[112:115], v[36:39], a[52:55], v[112:115]
    ds_read_b64_tr_b16 v[16:17], v8 offset:8192
    v_mfma_f32_16x16x32_bf16 v[112:115], v[40:43], a[56:59], v[112:115]
    ds_read_b64_tr_b16 v[18:19], v8 offset:8704
    v_mfma_f32_16x16x32_bf16 v[112:115], v[44:47], a[60:63], v[112:115]
    ds_read_b64_tr_b16 v[20:21], v8 offset:12288
    v_mfma_f32_16x16x32_bf16 v[116:119], v[32:35], a[112:115], v[116:119]
    ds_read_b64_tr_b16 v[22:23], v8 offset:12800
    v_mfma_f32_16x16x32_bf16 v[116:119], v[36:39], a[116:119], v[116:119]
    ds_read_b64_tr_b16 v[24:25], v8 offset:24576
    v_mfma_f32_16x16x32_bf16 v[116:119], v[40:43], a[120:123], v[116:119]
    ds_read_b64_tr_b16 v[26:27], v8 offset:25088
    v_mfma_f32_16x16x32_bf16 v[116:119], v[44:47], a[124:127], v[116:119]
    ds_read_b64_tr_b16 v[28:29], v8 offset:28672
    v_mfma_f32_16x16x32_bf16 v[120:123], v[32:35], a[176:179], v[120:123]
    ds_read_b64_tr_b16 v[30:31], v8 offset:29184
    v_mfma_f32_16x16x32_bf16 v[120:123], v[36:39], a[180:183], v[120:123]
    v_mfma_f32_16x16x32_bf16 v[120:123], v[40:43], a[184:187], v[120:123]
    v_mfma_f32_16x16x32_bf16 v[120:123], v[44:47], a[188:191], v[120:123]
    v_mfma_f32_16x16x32_bf16 v[124:127], v[32:35], a[240:243], v[124:127]
    v_mfma_f32_16x16x32_bf16 v[124:127], v[36:39], a[244:247], v[124:127]
    v_mfma_f32_16x16x32_bf16 v[124:127], v[40:43], a[248:251], v[124:127]
    v_mfma_f32_16x16x32_bf16 v[124:127], v[44:47], a[252:255], v[124:127]
    s_waitcnt lgkmcnt(0)
    v_mfma_f32_16x16x32_bf16 v[128:131], v[16:19], a[48:51], v[128:131]
    v_xor_b32 v9, 0x10000, v9
    v_mfma_f32_16x16x32_bf16 v[128:131], v[20:23], a[52:55], v[128:131]
    ds_read_b64_tr_b16 v[32:33], v9 offset:8192
    buffer_atomic_add v61, v6, s[96:99], s72 offen
    v_mfma_f32_16x16x32_bf16 v[128:131], v[24:27], a[56:59], v[128:131]
    ds_read_b64_tr_b16 v[34:35], v9 offset:8704
    v_mfma_f32_16x16x32_bf16 v[128:131], v[28:31], a[60:63], v[128:131]
    ds_read_b64_tr_b16 v[36:37], v9 offset:12288
    v_mfma_f32_16x16x32_bf16 v[132:135], v[16:19], a[112:115], v[132:135]
    ds_read_b64_tr_b16 v[38:39], v9 offset:12800
    v_mfma_f32_16x16x32_bf16 v[132:135], v[20:23], a[116:119], v[132:135]
    ds_read_b64_tr_b16 v[40:41], v9 offset:24576
    v_mfma_f32_16x16x32_bf16 v[132:135], v[24:27], a[120:123], v[132:135]
    ds_read_b64_tr_b16 v[42:43], v9 offset:25088
    s_add_u32 s69, s4, 2097152
    v_mfma_f32_16x16x32_bf16 v[132:135], v[28:31], a[124:127], v[132:135]
    ds_read_b64_tr_b16 v[44:45], v9 offset:28672
    s_add_u32 m0, s6, 106496
    v_mfma_f32_16x16x32_bf16 v[136:139], v[16:19], a[176:179], v[136:139]
    ds_read_b64_tr_b16 v[46:47], v9 offset:29184
    buffer_load_dwordx4 v48, s[36:39], s69 offen lds
    v_mfma_f32_16x16x32_bf16 v[136:139], v[20:23], a[180:183], v[136:139]
    v_mfma_f32_16x16x32_bf16 v[136:139], v[24:27], a[184:187], v[136:139]
    s_add_u32 s52, s50, 0
    v_mul_f32 v96, 0x3e0293ee, v96
    v_mfma_f32_16x16x32_bf16 v[136:139], v[28:31], a[188:191], v[136:139]
    v_mul_f32 v97, 0x3e0293ee, v97
    v_mul_f32 v98, 0x3e0293ee, v98
    v_mfma_f32_16x16x32_bf16 v[140:143], v[16:19], a[240:243], v[140:143]
    v_mul_f32 v99, 0x3e0293ee, v99
    v_mul_f32 v112, 0x3e0293ee, v112
    v_mfma_f32_16x16x32_bf16 v[140:143], v[20:23], a[244:247], v[140:143]
    s_add_u32 m0, s6, 107520
    v_mul_f32 v113, 0x3e0293ee, v113
    v_mfma_f32_16x16x32_bf16 v[140:143], v[24:27], a[248:251], v[140:143]
    buffer_load_dwordx4 v49, s[36:39], s69 offen lds
    v_mul_f32 v114, 0x3e0293ee, v114
    v_mfma_f32_16x16x32_bf16 v[140:143], v[28:31], a[252:255], v[140:143]
    s_waitcnt lgkmcnt(0)
    v_mul_f32 v115, 0x3e0293ee, v115
    v_mfma_f32_16x16x32_bf16 v[144:147], v[32:35], a[48:51], v[144:147]
    v_xor_b32 v10, 0x10000, v10
    v_cvt_pk_bf16_f32 v96, v96, v97
    v_mfma_f32_16x16x32_bf16 v[144:147], v[36:39], a[52:55], v[144:147]
    ds_read_b64_tr_b16 v[16:17], v10 offset:8192
    v_cvt_pk_bf16_f32 v97, v98, v99
    v_mfma_f32_16x16x32_bf16 v[144:147], v[40:43], a[56:59], v[144:147]
    ds_read_b64_tr_b16 v[18:19], v10 offset:8704
    v_cvt_pk_bf16_f32 v98, v112, v113
    v_mfma_f32_16x16x32_bf16 v[144:147], v[44:47], a[60:63], v[144:147]
    ds_read_b64_tr_b16 v[20:21], v10 offset:12288
    s_add_u32 m0, s6, 108544
    v_mfma_f32_16x16x32_bf16 v[148:151], v[32:35], a[112:115], v[148:151]
    ds_read_b64_tr_b16 v[22:23], v10 offset:12800
    buffer_load_dwordx4 v50, s[36:39], s69 offen lds
    v_mfma_f32_16x16x32_bf16 v[148:151], v[36:39], a[116:119], v[148:151]
    ds_read_b64_tr_b16 v[24:25], v10 offset:24576
    v_cvt_pk_bf16_f32 v99, v114, v115
    v_mfma_f32_16x16x32_bf16 v[148:151], v[40:43], a[120:123], v[148:151]
    ds_read_b64_tr_b16 v[26:27], v10 offset:25088
    buffer_store_dwordx4 v[96:99], v7, s[8:11], s52 offen offset:1024 sc1
    v_mfma_f32_16x16x32_bf16 v[148:151], v[44:47], a[124:127], v[148:151]
    ds_read_b64_tr_b16 v[28:29], v10 offset:28672
    s_add_u32 s52, s50, 4096
    v_mfma_f32_16x16x32_bf16 v[152:155], v[32:35], a[176:179], v[152:155]
    ds_read_b64_tr_b16 v[30:31], v10 offset:29184
    v_mul_f32 v100, 0x3e0293ee, v100
    v_mfma_f32_16x16x32_bf16 v[152:155], v[36:39], a[180:183], v[152:155]
    v_mul_f32 v101, 0x3e0293ee, v101
    v_mul_f32 v102, 0x3e0293ee, v102
    v_mfma_f32_16x16x32_bf16 v[152:155], v[40:43], a[184:187], v[152:155]
    s_add_u32 m0, s6, 109568
    v_mul_f32 v103, 0x3e0293ee, v103
    v_mfma_f32_16x16x32_bf16 v[152:155], v[44:47], a[188:191], v[152:155]
    buffer_load_dwordx4 v51, s[36:39], s69 offen lds
    v_mul_f32 v116, 0x3e0293ee, v116
    v_mfma_f32_16x16x32_bf16 v[156:159], v[32:35], a[240:243], v[156:159]
    v_mul_f32 v117, 0x3e0293ee, v117
    v_mul_f32 v118, 0x3e0293ee, v118
    v_mfma_f32_16x16x32_bf16 v[156:159], v[36:39], a[244:247], v[156:159]
    v_mul_f32 v119, 0x3e0293ee, v119
    v_cvt_pk_bf16_f32 v100, v100, v101
    v_mfma_f32_16x16x32_bf16 v[156:159], v[40:43], a[248:251], v[156:159]
    v_cvt_pk_bf16_f32 v101, v102, v103
    v_cvt_pk_bf16_f32 v102, v116, v117
    v_mfma_f32_16x16x32_bf16 v[156:159], v[44:47], a[252:255], v[156:159]
    s_waitcnt lgkmcnt(0)
    v_cvt_pk_bf16_f32 v103, v118, v119
    v_mfma_f32_16x16x32_bf16 v[160:163], v[16:19], a[48:51], v[160:163]
    v_xor_b32 v11, 0x10000, v11
    s_add_u32 s69, s4, 128
    v_mfma_f32_16x16x32_bf16 v[160:163], v[20:23], a[52:55], v[160:163]
    ds_read_b64_tr_b16 v[32:33], v11 offset:8192
    s_add_u32 m0, s6, 0
    v_mfma_f32_16x16x32_bf16 v[160:163], v[24:27], a[56:59], v[160:163]
    ds_read_b64_tr_b16 v[34:35], v11 offset:8704
    buffer_load_dwordx4 v48, s[36:39], s69 offen lds
    v_mfma_f32_16x16x32_bf16 v[160:163], v[28:31], a[60:63], v[160:163]
    ds_read_b64_tr_b16 v[36:37], v11 offset:12288
    v_mfma_f32_16x16x32_bf16 v[164:167], v[16:19], a[112:115], v[164:167]
    ds_read_b64_tr_b16 v[38:39], v11 offset:12800
    v_mfma_f32_16x16x32_bf16 v[164:167], v[20:23], a[116:119], v[164:167]
    ds_read_b64_tr_b16 v[40:41], v11 offset:24576
    v_mfma_f32_16x16x32_bf16 v[164:167], v[24:27], a[120:123], v[164:167]
    ds_read_b64_tr_b16 v[42:43], v11 offset:25088
    v_mfma_f32_16x16x32_bf16 v[164:167], v[28:31], a[124:127], v[164:167]
    ds_read_b64_tr_b16 v[44:45], v11 offset:28672
    s_add_u32 m0, s6, 1024
    v_mfma_f32_16x16x32_bf16 v[168:171], v[16:19], a[176:179], v[168:171]
    ds_read_b64_tr_b16 v[46:47], v11 offset:29184
    buffer_load_dwordx4 v49, s[36:39], s69 offen lds
    v_mfma_f32_16x16x32_bf16 v[168:171], v[20:23], a[180:183], v[168:171]
    v_mfma_f32_16x16x32_bf16 v[168:171], v[24:27], a[184:187], v[168:171]
    v_mfma_f32_16x16x32_bf16 v[168:171], v[28:31], a[188:191], v[168:171]
    buffer_store_dwordx4 v[100:103], v7, s[8:11], s52 offen offset:1024 sc1
    s_add_u32 s52, s50, 8192
    v_mfma_f32_16x16x32_bf16 v[172:175], v[16:19], a[240:243], v[172:175]
    v_mul_f32 v104, 0x3e0293ee, v104
    v_mul_f32 v105, 0x3e0293ee, v105
    v_mfma_f32_16x16x32_bf16 v[172:175], v[20:23], a[244:247], v[172:175]
    s_add_u32 m0, s6, 2048
    v_mul_f32 v106, 0x3e0293ee, v106
    v_mfma_f32_16x16x32_bf16 v[172:175], v[24:27], a[248:251], v[172:175]
    buffer_load_dwordx4 v50, s[36:39], s69 offen lds
    v_mul_f32 v107, 0x3e0293ee, v107
    v_mfma_f32_16x16x32_bf16 v[172:175], v[28:31], a[252:255], v[172:175]
    s_waitcnt vmcnt(21) lgkmcnt(0)
    s_barrier
    v_mfma_f32_16x16x32_bf16 v[176:179], v[32:35], a[48:51], v[176:179]
    ds_read_b64_tr_b16 v[16:17], v8 offset:40960
    v_mul_f32 v120, 0x3e0293ee, v120
    v_mfma_f32_16x16x32_bf16 v[176:179], v[36:39], a[52:55], v[176:179]
    ds_read_b64_tr_b16 v[18:19], v8 offset:41472
    v_mul_f32 v121, 0x3e0293ee, v121
    v_mfma_f32_16x16x32_bf16 v[176:179], v[40:43], a[56:59], v[176:179]
    ds_read_b64_tr_b16 v[20:21], v8 offset:45056
    v_mul_f32 v122, 0x3e0293ee, v122
    v_mfma_f32_16x16x32_bf16 v[176:179], v[44:47], a[60:63], v[176:179]
    ds_read_b64_tr_b16 v[22:23], v8 offset:45568
    v_mul_f32 v123, 0x3e0293ee, v123
    v_mfma_f32_16x16x32_bf16 v[180:183], v[32:35], a[112:115], v[180:183]
    ds_read_b64_tr_b16 v[24:25], v8 offset:57344
    s_add_u32 m0, s6, 3072
    v_mfma_f32_16x16x32_bf16 v[180:183], v[36:39], a[116:119], v[180:183]
    ds_read_b64_tr_b16 v[26:27], v8 offset:57856
    buffer_load_dwordx4 v51, s[36:39], s69 offen lds
    v_mfma_f32_16x16x32_bf16 v[180:183], v[40:43], a[120:123], v[180:183]
    ds_read_b64_tr_b16 v[28:29], v8 offset:61440
    v_cvt_pk_bf16_f32 v104, v104, v105
    v_mfma_f32_16x16x32_bf16 v[180:183], v[44:47], a[124:127], v[180:183]
    ds_read_b64_tr_b16 v[30:31], v8 offset:61952
    v_cvt_pk_bf16_f32 v105, v106, v107
    v_mfma_f32_16x16x32_bf16 v[184:187], v[32:35], a[176:179], v[184:187]
    v_cvt_pk_bf16_f32 v106, v120, v121
    v_cvt_pk_bf16_f32 v107, v122, v123
    v_mfma_f32_16x16x32_bf16 v[184:187], v[36:39], a[180:183], v[184:187]
    v_mfma_f32_16x16x32_bf16 v[184:187], v[40:43], a[184:187], v[184:187]
    v_mfma_f32_16x16x32_bf16 v[184:187], v[44:47], a[188:191], v[184:187]
    v_mfma_f32_16x16x32_bf16 v[188:191], v[32:35], a[240:243], v[188:191]
    v_mfma_f32_16x16x32_bf16 v[188:191], v[36:39], a[244:247], v[188:191]
    v_mfma_f32_16x16x32_bf16 v[188:191], v[40:43], a[248:251], v[188:191]
    v_mfma_f32_16x16x32_bf16 v[188:191], v[44:47], a[252:255], v[188:191]
    s_waitcnt lgkmcnt(0)
    v_mfma_f32_16x16x32_bf16 v[192:195], a[0:3], v[16:19], 0
    ds_read_b64_tr_b16 v[32:33], v9 offset:40960
    v_mfma_f32_16x16x32_bf16 v[192:195], a[4:7], v[20:23], v[192:195]
    ds_read_b64_tr_b16 v[34:35], v9 offset:41472
    s_add_u32 s69, s4, 3145728
    v_mfma_f32_16x16x32_bf16 v[192:195], a[8:11], v[24:27], v[192:195]
    ds_read_b64_tr_b16 v[36:37], v9 offset:45056
    s_add_u32 m0, s6, 8192
    v_mfma_f32_16x16x32_bf16 v[192:195], a[12:15], v[28:31], v[192:195]
    ds_read_b64_tr_b16 v[38:39], v9 offset:45568
    buffer_load_dwordx4 v48, s[36:39], s69 offen lds
    v_mfma_f32_16x16x32_bf16 v[196:199], a[64:67], v[16:19], 0
    ds_read_b64_tr_b16 v[40:41], v9 offset:57344
    v_mfma_f32_16x16x32_bf16 v[196:199], a[68:71], v[20:23], v[196:199]
    ds_read_b64_tr_b16 v[42:43], v9 offset:57856
    v_mfma_f32_16x16x32_bf16 v[196:199], a[72:75], v[24:27], v[196:199]
    ds_read_b64_tr_b16 v[44:45], v9 offset:61440
    v_mfma_f32_16x16x32_bf16 v[196:199], a[76:79], v[28:31], v[196:199]
    ds_read_b64_tr_b16 v[46:47], v9 offset:61952
    s_add_u32 m0, s6, 9216
    v_mfma_f32_16x16x32_bf16 v[200:203], a[128:131], v[16:19], 0
    buffer_load_dwordx4 v49, s[36:39], s69 offen lds
    v_mfma_f32_16x16x32_bf16 v[200:203], a[132:135], v[20:23], v[200:203]
    v_mfma_f32_16x16x32_bf16 v[200:203], a[136:139], v[24:27], v[200:203]
    buffer_store_dwordx4 v[104:107], v7, s[8:11], s52 offen offset:1024 sc1
    s_add_u32 s52, s50, 12288
    v_mfma_f32_16x16x32_bf16 v[200:203], a[140:143], v[28:31], v[200:203]
    v_mul_f32 v108, 0x3e0293ee, v108
    v_mul_f32 v109, 0x3e0293ee, v109
    v_mfma_f32_16x16x32_bf16 v[204:207], a[192:195], v[16:19], 0
    v_mul_f32 v110, 0x3e0293ee, v110
    v_mul_f32 v111, 0x3e0293ee, v111
    v_mfma_f32_16x16x32_bf16 v[204:207], a[196:199], v[20:23], v[204:207]
    v_mul_f32 v124, 0x3e0293ee, v124
    v_mul_f32 v125, 0x3e0293ee, v125
    v_mfma_f32_16x16x32_bf16 v[204:207], a[200:203], v[24:27], v[204:207]
    s_add_u32 m0, s6, 10240
    v_mul_f32 v126, 0x3e0293ee, v126
    v_mfma_f32_16x16x32_bf16 v[204:207], a[204:207], v[28:31], v[204:207]
    s_waitcnt lgkmcnt(0)
    buffer_load_dwordx4 v50, s[36:39], s69 offen lds
    v_mfma_f32_16x16x32_bf16 v[208:211], a[0:3], v[32:35], 0
    ds_read_b64_tr_b16 v[16:17], v10 offset:40960
    v_mul_f32 v127, 0x3e0293ee, v127
    v_mfma_f32_16x16x32_bf16 v[208:211], a[4:7], v[36:39], v[208:211]
    ds_read_b64_tr_b16 v[18:19], v10 offset:41472
    v_cvt_pk_bf16_f32 v108, v108, v109
    v_mfma_f32_16x16x32_bf16 v[208:211], a[8:11], v[40:43], v[208:211]
    ds_read_b64_tr_b16 v[20:21], v10 offset:45056
    v_cvt_pk_bf16_f32 v109, v110, v111
    v_mfma_f32_16x16x32_bf16 v[208:211], a[12:15], v[44:47], v[208:211]
    ds_read_b64_tr_b16 v[22:23], v10 offset:45568
    v_cvt_pk_bf16_f32 v110, v124, v125
    v_mfma_f32_16x16x32_bf16 v[212:215], a[64:67], v[32:35], 0
    ds_read_b64_tr_b16 v[24:25], v10 offset:57344
    v_cvt_pk_bf16_f32 v111, v126, v127
    v_mfma_f32_16x16x32_bf16 v[212:215], a[68:71], v[36:39], v[212:215]
    ds_read_b64_tr_b16 v[26:27], v10 offset:57856
    v_mfma_f32_16x16x32_bf16 v[212:215], a[72:75], v[40:43], v[212:215]
    ds_read_b64_tr_b16 v[28:29], v10 offset:61440
    s_add_u32 m0, s6, 11264
    v_mfma_f32_16x16x32_bf16 v[212:215], a[76:79], v[44:47], v[212:215]
    ds_read_b64_tr_b16 v[30:31], v10 offset:61952
    buffer_load_dwordx4 v51, s[36:39], s69 offen lds
    v_mfma_f32_16x16x32_bf16 v[216:219], a[128:131], v[32:35], 0
    v_mfma_f32_16x16x32_bf16 v[216:219], a[132:135], v[36:39], v[216:219]
    v_mfma_f32_16x16x32_bf16 v[216:219], a[136:139], v[40:43], v[216:219]
    v_mfma_f32_16x16x32_bf16 v[216:219], a[140:143], v[44:47], v[216:219]
    v_mfma_f32_16x16x32_bf16 v[220:223], a[192:195], v[32:35], 0
    v_mfma_f32_16x16x32_bf16 v[220:223], a[196:199], v[36:39], v[220:223]
    s_add_u32 s69, s4, 1048704
    s_add_u32 m0, s6, 32768
    v_mfma_f32_16x16x32_bf16 v[220:223], a[200:203], v[40:43], v[220:223]
    buffer_load_dwordx4 v48, s[36:39], s69 offen lds
    v_mfma_f32_16x16x32_bf16 v[220:223], a[204:207], v[44:47], v[220:223]
    s_waitcnt lgkmcnt(0)
    buffer_store_dwordx4 v[108:111], v7, s[8:11], s52 offen offset:1024 sc1
    v_mfma_f32_16x16x32_bf16 v[224:227], a[0:3], v[16:19], 0
    ds_read_b64_tr_b16 v[32:33], v11 offset:40960
    s_add_u32 s52, s50, 0
    v_mfma_f32_16x16x32_bf16 v[224:227], a[4:7], v[20:23], v[224:227]
    ds_read_b64_tr_b16 v[34:35], v11 offset:41472
    v_mul_f32 v64, 0x3e0293ee, v64
    v_mfma_f32_16x16x32_bf16 v[224:227], a[8:11], v[24:27], v[224:227]
    ds_read_b64_tr_b16 v[36:37], v11 offset:45056
    v_mul_f32 v65, 0x3e0293ee, v65
    v_mfma_f32_16x16x32_bf16 v[224:227], a[12:15], v[28:31], v[224:227]
    ds_read_b64_tr_b16 v[38:39], v11 offset:45568
    v_mul_f32 v66, 0x3e0293ee, v66
    v_mfma_f32_16x16x32_bf16 v[228:231], a[64:67], v[16:19], 0
    ds_read_b64_tr_b16 v[40:41], v11 offset:57344
    s_add_u32 m0, s6, 33792
    v_mfma_f32_16x16x32_bf16 v[228:231], a[68:71], v[20:23], v[228:231]
    ds_read_b64_tr_b16 v[42:43], v11 offset:57856
    buffer_load_dwordx4 v49, s[36:39], s69 offen lds
    v_mfma_f32_16x16x32_bf16 v[228:231], a[72:75], v[24:27], v[228:231]
    ds_read_b64_tr_b16 v[44:45], v11 offset:61440
    v_mul_f32 v67, 0x3e0293ee, v67
    v_mfma_f32_16x16x32_bf16 v[228:231], a[76:79], v[28:31], v[228:231]
    ds_read_b64_tr_b16 v[46:47], v11 offset:61952
    v_mul_f32 v80, 0x3e0293ee, v80
    v_mfma_f32_16x16x32_bf16 v[232:235], a[128:131], v[16:19], 0
    v_mul_f32 v81, 0x3e0293ee, v81
    v_mul_f32 v82, 0x3e0293ee, v82
    v_mfma_f32_16x16x32_bf16 v[232:235], a[132:135], v[20:23], v[232:235]
    v_mul_f32 v83, 0x3e0293ee, v83
    v_cvt_pk_bf16_f32 v64, v64, v65
    v_mfma_f32_16x16x32_bf16 v[232:235], a[136:139], v[24:27], v[232:235]
    v_cvt_pk_bf16_f32 v65, v66, v67
    v_cvt_pk_bf16_f32 v66, v80, v81
    v_mfma_f32_16x16x32_bf16 v[232:235], a[140:143], v[28:31], v[232:235]
    v_cvt_pk_bf16_f32 v67, v82, v83
    v_mfma_f32_16x16x32_bf16 v[236:239], a[192:195], v[16:19], 0
    s_add_u32 m0, s6, 34816
    v_mfma_f32_16x16x32_bf16 v[236:239], a[196:199], v[20:23], v[236:239]
    buffer_load_dwordx4 v50, s[36:39], s69 offen lds
    v_mfma_f32_16x16x32_bf16 v[236:239], a[200:203], v[24:27], v[236:239]
    v_mfma_f32_16x16x32_bf16 v[236:239], a[204:207], v[28:31], v[236:239]
    s_waitcnt vmcnt(20) lgkmcnt(0)
    s_barrier
    v_mfma_f32_16x16x32_bf16 v[240:243], a[0:3], v[32:35], 0
    v_xor_b32 v8, 0x10000, v8
    v_mfma_f32_16x16x32_bf16 v[240:243], a[4:7], v[36:39], v[240:243]
    ds_read_b64_tr_b16 v[16:17], v8 offset:8192
    v_mfma_f32_16x16x32_bf16 v[240:243], a[8:11], v[40:43], v[240:243]
    ds_read_b64_tr_b16 v[18:19], v8 offset:8704
    v_mfma_f32_16x16x32_bf16 v[240:243], a[12:15], v[44:47], v[240:243]
    ds_read_b64_tr_b16 v[20:21], v8 offset:12288
    s_add_u32 m0, s6, 35840
    v_mfma_f32_16x16x32_bf16 v[244:247], a[64:67], v[32:35], 0
    ds_read_b64_tr_b16 v[22:23], v8 offset:12800
    buffer_load_dwordx4 v51, s[36:39], s69 offen lds
    v_mfma_f32_16x16x32_bf16 v[244:247], a[68:71], v[36:39], v[244:247]
    ds_read_b64_tr_b16 v[24:25], v8 offset:24576
    buffer_store_dwordx4 v[64:67], v7, s[8:11], s52 offen offset:0 sc1
    v_mfma_f32_16x16x32_bf16 v[244:247], a[72:75], v[40:43], v[244:247]
    ds_read_b64_tr_b16 v[26:27], v8 offset:25088
    s_add_u32 s52, s50, 4096
    v_mfma_f32_16x16x32_bf16 v[244:247], a[76:79], v[44:47], v[244:247]
    ds_read_b64_tr_b16 v[28:29], v8 offset:28672
    v_mul_f32 v68, 0x3e0293ee, v68
    v_mfma_f32_16x16x32_bf16 v[248:251], a[128:131], v[32:35], 0
    ds_read_b64_tr_b16 v[30:31], v8 offset:29184
    v_mul_f32 v69, 0x3e0293ee, v69
    v_mfma_f32_16x16x32_bf16 v[248:251], a[132:135], v[36:39], v[248:251]
    v_mul_f32 v70, 0x3e0293ee, v70
    v_mul_f32 v71, 0x3e0293ee, v71
    v_mfma_f32_16x16x32_bf16 v[248:251], a[136:139], v[40:43], v[248:251]
    v_mul_f32 v84, 0x3e0293ee, v84
    v_mul_f32 v85, 0x3e0293ee, v85
    v_mfma_f32_16x16x32_bf16 v[248:251], a[140:143], v[44:47], v[248:251]
    v_mul_f32 v86, 0x3e0293ee, v86
    v_mul_f32 v87, 0x3e0293ee, v87
    v_mfma_f32_16x16x32_bf16 v[252:255], a[192:195], v[32:35], 0
    v_cvt_pk_bf16_f32 v68, v68, v69
    v_cvt_pk_bf16_f32 v69, v70, v71
    v_mfma_f32_16x16x32_bf16 v[252:255], a[196:199], v[36:39], v[252:255]
    v_cvt_pk_bf16_f32 v70, v84, v85
    v_cvt_pk_bf16_f32 v71, v86, v87
    v_mfma_f32_16x16x32_bf16 v[252:255], a[200:203], v[40:43], v[252:255]
    v_mfma_f32_16x16x32_bf16 v[252:255], a[204:207], v[44:47], v[252:255]
    s_waitcnt lgkmcnt(0)
    v_mfma_f32_16x16x32_bf16 v[192:195], a[16:19], v[16:19], v[192:195]
    v_xor_b32 v9, 0x10000, v9
    v_mfma_f32_16x16x32_bf16 v[192:195], a[20:23], v[20:23], v[192:195]
    ds_read_b64_tr_b16 v[32:33], v9 offset:8192
    s_add_u32 s69, s4, 2097280
    v_mfma_f32_16x16x32_bf16 v[192:195], a[24:27], v[24:27], v[192:195]
    ds_read_b64_tr_b16 v[34:35], v9 offset:8704
    s_add_u32 m0, s6, 65536
    v_mfma_f32_16x16x32_bf16 v[192:195], a[28:31], v[28:31], v[192:195]
    ds_read_b64_tr_b16 v[36:37], v9 offset:12288
    buffer_load_dwordx4 v48, s[36:39], s69 offen lds
    v_mfma_f32_16x16x32_bf16 v[196:199], a[80:83], v[16:19], v[196:199]
    ds_read_b64_tr_b16 v[38:39], v9 offset:12800
    v_mfma_f32_16x16x32_bf16 v[196:199], a[84:87], v[20:23], v[196:199]
    ds_read_b64_tr_b16 v[40:41], v9 offset:24576
    v_mfma_f32_16x16x32_bf16 v[196:199], a[88:91], v[24:27], v[196:199]
    ds_read_b64_tr_b16 v[42:43], v9 offset:25088
    v_mfma_f32_16x16x32_bf16 v[196:199], a[92:95], v[28:31], v[196:199]
    ds_read_b64_tr_b16 v[44:45], v9 offset:28672
    v_mfma_f32_16x16x32_bf16 v[200:203], a[144:147], v[16:19], v[200:203]
    ds_read_b64_tr_b16 v[46:47], v9 offset:29184
    v_mfma_f32_16x16x32_bf16 v[200:203], a[148:151], v[20:23], v[200:203]
    v_mfma_f32_16x16x32_bf16 v[200:203], a[152:155], v[24:27], v[200:203]
    buffer_store_dwordx4 v[68:71], v7, s[8:11], s52 offen offset:0 sc1
    s_add_u32 s52, s50, 8192
    v_mfma_f32_16x16x32_bf16 v[200:203], a[156:159], v[28:31], v[200:203]
    s_add_u32 m0, s6, 66560
    v_mul_f32 v72, 0x3e0293ee, v72
    v_mfma_f32_16x16x32_bf16 v[204:207], a[208:211], v[16:19], v[204:207]
    buffer_load_dwordx4 v49, s[36:39], s69 offen lds
    v_mul_f32 v73, 0x3e0293ee, v73
    v_mfma_f32_16x16x32_bf16 v[204:207], a[212:215], v[20:23], v[204:207]
    v_mul_f32 v74, 0x3e0293ee, v74
    v_mul_f32 v75, 0x3e0293ee, v75
    v_mfma_f32_16x16x32_bf16 v[204:207], a[216:219], v[24:27], v[204:207]
    v_mul_f32 v88, 0x3e0293ee, v88
    v_mul_f32 v89, 0x3e0293ee, v89
    v_mfma_f32_16x16x32_bf16 v[204:207], a[220:223], v[28:31], v[204:207]
    s_waitcnt lgkmcnt(0)
    v_mul_f32 v90, 0x3e0293ee, v90
    v_mfma_f32_16x16x32_bf16 v[208:211], a[16:19], v[32:35], v[208:211]
    v_xor_b32 v10, 0x10000, v10
    v_mul_f32 v91, 0x3e0293ee, v91
    v_mfma_f32_16x16x32_bf16 v[208:211], a[20:23], v[36:39], v[208:211]
    ds_read_b64_tr_b16 v[16:17], v10 offset:8192
    v_cvt_pk_bf16_f32 v72, v72, v73
    v_mfma_f32_16x16x32_bf16 v[208:211], a[24:27], v[40:43], v[208:211]
    ds_read_b64_tr_b16 v[18:19], v10 offset:8704
    v_cvt_pk_bf16_f32 v73, v74, v75
    v_mfma_f32_16x16x32_bf16 v[208:211], a[28:31], v[44:47], v[208:211]
    ds_read_b64_tr_b16 v[20:21], v10 offset:12288
    v_cvt_pk_bf16_f32 v74, v88, v89
    v_mfma_f32_16x16x32_bf16 v[212:215], a[80:83], v[32:35], v[212:215]
    ds_read_b64_tr_b16 v[22:23], v10 offset:12800
    v_cvt_pk_bf16_f32 v75, v90, v91
    v_mfma_f32_16x16x32_bf16 v[212:215], a[84:87], v[36:39], v[212:215]
    ds_read_b64_tr_b16 v[24:25], v10 offset:24576
    v_mfma_f32_16x16x32_bf16 v[212:215], a[88:91], v[40:43], v[212:215]
    ds_read_b64_tr_b16 v[26:27], v10 offset:25088
    v_mfma_f32_16x16x32_bf16 v[212:215], a[92:95], v[44:47], v[212:215]
    ds_read_b64_tr_b16 v[28:29], v10 offset:28672
    s_add_u32 m0, s6, 67584
    v_mfma_f32_16x16x32_bf16 v[216:219], a[144:147], v[32:35], v[216:219]
    ds_read_b64_tr_b16 v[30:31], v10 offset:29184
    buffer_load_dwordx4 v50, s[36:39], s69 offen lds
    v_mfma_f32_16x16x32_bf16 v[216:219], a[148:151], v[36:39], v[216:219]
    v_mfma_f32_16x16x32_bf16 v[216:219], a[152:155], v[40:43], v[216:219]
    v_mfma_f32_16x16x32_bf16 v[216:219], a[156:159], v[44:47], v[216:219]
    v_mfma_f32_16x16x32_bf16 v[220:223], a[208:211], v[32:35], v[220:223]
    v_mfma_f32_16x16x32_bf16 v[220:223], a[212:215], v[36:39], v[220:223]
    v_mfma_f32_16x16x32_bf16 v[220:223], a[216:219], v[40:43], v[220:223]
    v_mfma_f32_16x16x32_bf16 v[220:223], a[220:223], v[44:47], v[220:223]
    s_waitcnt lgkmcnt(0)
    buffer_store_dwordx4 v[72:75], v7, s[8:11], s52 offen offset:0 sc1
    v_mfma_f32_16x16x32_bf16 v[224:227], a[16:19], v[16:19], v[224:227]
    v_xor_b32 v11, 0x10000, v11
    s_add_u32 s52, s50, 12288
    v_mfma_f32_16x16x32_bf16 v[224:227], a[20:23], v[20:23], v[224:227]
    ds_read_b64_tr_b16 v[32:33], v11 offset:8192
    v_mul_f32 v76, 0x3e0293ee, v76
    v_mfma_f32_16x16x32_bf16 v[224:227], a[24:27], v[24:27], v[224:227]
    ds_read_b64_tr_b16 v[34:35], v11 offset:8704
    v_mul_f32 v77, 0x3e0293ee, v77
    v_mfma_f32_16x16x32_bf16 v[224:227], a[28:31], v[28:31], v[224:227]
    ds_read_b64_tr_b16 v[36:37], v11 offset:12288
    s_add_u32 m0, s6, 68608
    v_mfma_f32_16x16x32_bf16 v[228:231], a[80:83], v[16:19], v[228:231]
    ds_read_b64_tr_b16 v[38:39], v11 offset:12800
    buffer_load_dwordx4 v51, s[36:39], s69 offen lds
    v_mfma_f32_16x16x32_bf16 v[228:231], a[84:87], v[20:23], v[228:231]
    ds_read_b64_tr_b16 v[40:41], v11 offset:24576
    v_mul_f32 v78, 0x3e0293ee, v78
    v_mfma_f32_16x16x32_bf16 v[228:231], a[88:91], v[24:27], v[228:231]
    ds_read_b64_tr_b16 v[42:43], v11 offset:25088
    v_mul_f32 v79, 0x3e0293ee, v79
    v_mfma_f32_16x16x32_bf16 v[228:231], a[92:95], v[28:31], v[228:231]
    ds_read_b64_tr_b16 v[44:45], v11 offset:28672
    v_mul_f32 v92, 0x3e0293ee, v92
    v_mfma_f32_16x16x32_bf16 v[232:235], a[144:147], v[16:19], v[232:235]
    ds_read_b64_tr_b16 v[46:47], v11 offset:29184
    v_mul_f32 v93, 0x3e0293ee, v93
    v_mfma_f32_16x16x32_bf16 v[232:235], a[148:151], v[20:23], v[232:235]
    v_mul_f32 v94, 0x3e0293ee, v94
    v_mul_f32 v95, 0x3e0293ee, v95
    v_mfma_f32_16x16x32_bf16 v[232:235], a[152:155], v[24:27], v[232:235]
    v_cvt_pk_bf16_f32 v76, v76, v77
    v_cvt_pk_bf16_f32 v77, v78, v79
    v_mfma_f32_16x16x32_bf16 v[232:235], a[156:159], v[28:31], v[232:235]
    v_cvt_pk_bf16_f32 v78, v92, v93
    v_cvt_pk_bf16_f32 v79, v94, v95
    v_mfma_f32_16x16x32_bf16 v[236:239], a[208:211], v[16:19], v[236:239]
    v_mfma_f32_16x16x32_bf16 v[236:239], a[212:215], v[20:23], v[236:239]
    v_mfma_f32_16x16x32_bf16 v[236:239], a[216:219], v[24:27], v[236:239]
    v_mfma_f32_16x16x32_bf16 v[236:239], a[220:223], v[28:31], v[236:239]
    s_waitcnt vmcnt(22) lgkmcnt(0)
    s_barrier
    v_mfma_f32_16x16x32_bf16 v[240:243], a[16:19], v[32:35], v[240:243]
    ds_read_b64_tr_b16 v[16:17], v8 offset:40960
    v_and_b32 v0, 1, v1
    v_mfma_f32_16x16x32_bf16 v[240:243], a[20:23], v[36:39], v[240:243]
    ds_read_b64_tr_b16 v[18:19], v8 offset:41472
    v_lshlrev_b32 v0, 7, v0
    v_mfma_f32_16x16x32_bf16 v[240:243], a[24:27], v[40:43], v[240:243]
    ds_read_b64_tr_b16 v[20:21], v8 offset:45056
    buffer_load_dword v3, v0, s[96:99], 0 offen sc1
    v_mfma_f32_16x16x32_bf16 v[240:243], a[28:31], v[44:47], v[240:243]
    ds_read_b64_tr_b16 v[22:23], v8 offset:45568
    v_mfma_f32_16x16x32_bf16 v[244:247], a[80:83], v[32:35], v[244:247]
    ds_read_b64_tr_b16 v[24:25], v8 offset:57344
    buffer_store_dwordx4 v[76:79], v7, s[8:11], s52 offen offset:0 sc1
    v_mfma_f32_16x16x32_bf16 v[244:247], a[84:87], v[36:39], v[244:247]
    ds_read_b64_tr_b16 v[26:27], v8 offset:57856
    s_add_u32 s52, s50, 2048
    v_mfma_f32_16x16x32_bf16 v[244:247], a[88:91], v[40:43], v[244:247]
    ds_read_b64_tr_b16 v[28:29], v8 offset:61440
    v_mul_f32 v160, 0x3e0293ee, v160
    v_mfma_f32_16x16x32_bf16 v[244:247], a[92:95], v[44:47], v[244:247]
    ds_read_b64_tr_b16 v[30:31], v8 offset:61952
    v_mul_f32 v161, 0x3e0293ee, v161
    v_mfma_f32_16x16x32_bf16 v[248:251], a[144:147], v[32:35], v[248:251]
    v_mul_f32 v162, 0x3e0293ee, v162
    v_mul_f32 v163, 0x3e0293ee, v163
    v_mfma_f32_16x16x32_bf16 v[248:251], a[148:151], v[36:39], v[248:251]
    v_mul_f32 v176, 0x3e0293ee, v176
    v_mul_f32 v177, 0x3e0293ee, v177
    v_mfma_f32_16x16x32_bf16 v[248:251], a[152:155], v[40:43], v[248:251]
    v_mul_f32 v178, 0x3e0293ee, v178
    v_mul_f32 v179, 0x3e0293ee, v179
    v_mfma_f32_16x16x32_bf16 v[248:251], a[156:159], v[44:47], v[248:251]
    v_cvt_pk_bf16_f32 v160, v160, v161
    v_cvt_pk_bf16_f32 v161, v162, v163
    v_mfma_f32_16x16x32_bf16 v[252:255], a[208:211], v[32:35], v[252:255]
    v_cvt_pk_bf16_f32 v162, v176, v177
    v_cvt_pk_bf16_f32 v163, v178, v179
    v_mfma_f32_16x16x32_bf16 v[252:255], a[212:215], v[36:39], v[252:255]
    v_mfma_f32_16x16x32_bf16 v[252:255], a[216:219], v[40:43], v[252:255]
    v_mfma_f32_16x16x32_bf16 v[252:255], a[220:223], v[44:47], v[252:255]
    s_waitcnt lgkmcnt(0)
    v_mfma_f32_16x16x32_bf16 v[192:195], a[32:35], v[16:19], v[192:195]
    ds_read_b64_tr_b16 v[32:33], v9 offset:40960
    v_mfma_f32_16x16x32_bf16 v[192:195], a[36:39], v[20:23], v[192:195]
    ds_read_b64_tr_b16 v[34:35], v9 offset:41472
    s_add_u32 s69, s4, 3145856
    v_mfma_f32_16x16x32_bf16 v[192:195], a[40:43], v[24:27], v[192:195]
    ds_read_b64_tr_b16 v[36:37], v9 offset:45056
    s_add_u32 m0, s6, 98304
    v_mfma_f32_16x16x32_bf16 v[192:195], a[44:47], v[28:31], v[192:195]
    ds_read_b64_tr_b16 v[38:39], v9 offset:45568
    buffer_load_dwordx4 v48, s[36:39], s69 offen lds
    v_mfma_f32_16x16x32_bf16 v[196:199], a[96:99], v[16:19], v[196:199]
    ds_read_b64_tr_b16 v[40:41], v9 offset:57344
    v_mfma_f32_16x16x32_bf16 v[196:199], a[100:103], v[20:23], v[196:199]
    ds_read_b64_tr_b16 v[42:43], v9 offset:57856
    v_mfma_f32_16x16x32_bf16 v[196:199], a[104:107], v[24:27], v[196:199]
    ds_read_b64_tr_b16 v[44:45], v9 offset:61440
    v_mfma_f32_16x16x32_bf16 v[196:199], a[108:111], v[28:31], v[196:199]
    ds_read_b64_tr_b16 v[46:47], v9 offset:61952
    s_add_u32 m0, s6, 99328
    v_mfma_f32_16x16x32_bf16 v[200:203], a[160:163], v[16:19], v[200:203]
    buffer_load_dwordx4 v49, s[36:39], s69 offen lds
    v_mfma_f32_16x16x32_bf16 v[200:203], a[164:167], v[20:23], v[200:203]
    buffer_store_dwordx4 v[160:163], v7, s[8:11], s52 offen offset:1024 sc1
    s_add_u32 s52, s50, 6144
    v_mfma_f32_16x16x32_bf16 v[200:203], a[168:171], v[24:27], v[200:203]
    v_mul_f32 v164, 0x3e0293ee, v164
    v_mul_f32 v165, 0x3e0293ee, v165
    v_mfma_f32_16x16x32_bf16 v[200:203], a[172:175], v[28:31], v[200:203]
    v_mul_f32 v166, 0x3e0293ee, v166
    v_mul_f32 v167, 0x3e0293ee, v167
    v_mfma_f32_16x16x32_bf16 v[204:207], a[224:227], v[16:19], v[204:207]
    v_mul_f32 v180, 0x3e0293ee, v180
    v_mul_f32 v181, 0x3e0293ee, v181
    v_mfma_f32_16x16x32_bf16 v[204:207], a[228:231], v[20:23], v[204:207]
    v_mul_f32 v182, 0x3e0293ee, v182
    v_mul_f32 v183, 0x3e0293ee, v183
    v_mfma_f32_16x16x32_bf16 v[204:207], a[232:235], v[24:27], v[204:207]
    s_add_u32 m0, s6, 100352
    v_cvt_pk_bf16_f32 v164, v164, v165
    v_mfma_f32_16x16x32_bf16 v[204:207], a[236:239], v[28:31], v[204:207]
    s_waitcnt lgkmcnt(0)
    buffer_load_dwordx4 v50, s[36:39], s69 offen lds
    v_mfma_f32_16x16x32_bf16 v[208:211], a[32:35], v[32:35], v[208:211]
    ds_read_b64_tr_b16 v[16:17], v10 offset:40960
    v_cvt_pk_bf16_f32 v165, v166, v167
    v_mfma_f32_16x16x32_bf16 v[208:211], a[36:39], v[36:39], v[208:211]
    ds_read_b64_tr_b16 v[18:19], v10 offset:41472
    v_cvt_pk_bf16_f32 v166, v180, v181
    v_mfma_f32_16x16x32_bf16 v[208:211], a[40:43], v[40:43], v[208:211]
    ds_read_b64_tr_b16 v[20:21], v10 offset:45056
    v_cvt_pk_bf16_f32 v167, v182, v183
    v_mfma_f32_16x16x32_bf16 v[208:211], a[44:47], v[44:47], v[208:211]
    ds_read_b64_tr_b16 v[22:23], v10 offset:45568
    v_mfma_f32_16x16x32_bf16 v[212:215], a[96:99], v[32:35], v[212:215]
    ds_read_b64_tr_b16 v[24:25], v10 offset:57344
    v_mfma_f32_16x16x32_bf16 v[212:215], a[100:103], v[36:39], v[212:215]
    ds_read_b64_tr_b16 v[26:27], v10 offset:57856
    v_mfma_f32_16x16x32_bf16 v[212:215], a[104:107], v[40:43], v[212:215]
    ds_read_b64_tr_b16 v[28:29], v10 offset:61440
    s_add_u32 m0, s6, 101376
    v_mfma_f32_16x16x32_bf16 v[212:215], a[108:111], v[44:47], v[212:215]
    ds_read_b64_tr_b16 v[30:31], v10 offset:61952
    buffer_load_dwordx4 v51, s[36:39], s69 offen lds
    v_mfma_f32_16x16x32_bf16 v[216:219], a[160:163], v[32:35], v[216:219]
    v_mfma_f32_16x16x32_bf16 v[216:219], a[164:167], v[36:39], v[216:219]
    v_mfma_f32_16x16x32_bf16 v[216:219], a[168:171], v[40:43], v[216:219]
    v_mfma_f32_16x16x32_bf16 v[216:219], a[172:175], v[44:47], v[216:219]
    v_mfma_f32_16x16x32_bf16 v[220:223], a[224:227], v[32:35], v[220:223]
    v_mfma_f32_16x16x32_bf16 v[220:223], a[228:231], v[36:39], v[220:223]
    s_add_u32 s69, s5, 0
    s_add_u32 m0, s6, 40960
    v_mfma_f32_16x16x32_bf16 v[220:223], a[232:235], v[40:43], v[220:223]
    buffer_load_dwordx4 v52, s[16:19], s69 offen lds
    buffer_store_dwordx4 v[164:167], v7, s[8:11], s52 offen offset:1024 sc1
    v_mfma_f32_16x16x32_bf16 v[220:223], a[236:239], v[44:47], v[220:223]
    s_waitcnt lgkmcnt(0)
    s_add_u32 s52, s50, 10240
    v_mfma_f32_16x16x32_bf16 v[224:227], a[32:35], v[16:19], v[224:227]
    ds_read_b64_tr_b16 v[32:33], v11 offset:40960
    v_mul_f32 v168, 0x3e0293ee, v168
    v_mfma_f32_16x16x32_bf16 v[224:227], a[36:39], v[20:23], v[224:227]
    ds_read_b64_tr_b16 v[34:35], v11 offset:41472
    v_mul_f32 v169, 0x3e0293ee, v169
    v_mfma_f32_16x16x32_bf16 v[224:227], a[40:43], v[24:27], v[224:227]
    ds_read_b64_tr_b16 v[36:37], v11 offset:45056
    v_mul_f32 v170, 0x3e0293ee, v170
    v_mfma_f32_16x16x32_bf16 v[224:227], a[44:47], v[28:31], v[224:227]
    ds_read_b64_tr_b16 v[38:39], v11 offset:45568
    v_mul_f32 v171, 0x3e0293ee, v171
    v_mfma_f32_16x16x32_bf16 v[228:231], a[96:99], v[16:19], v[228:231]
    ds_read_b64_tr_b16 v[40:41], v11 offset:57344
    s_add_u32 m0, s6, 41984
    v_mfma_f32_16x16x32_bf16 v[228:231], a[100:103], v[20:23], v[228:231]
    ds_read_b64_tr_b16 v[42:43], v11 offset:57856
    buffer_load_dwordx4 v53, s[16:19], s69 offen lds
    v_mfma_f32_16x16x32_bf16 v[228:231], a[104:107], v[24:27], v[228:231]
    ds_read_b64_tr_b16 v[44:45], v11 offset:61440
    v_mul_f32 v184, 0x3e0293ee, v184
    v_mfma_f32_16x16x32_bf16 v[228:231], a[108:111], v[28:31], v[228:231]
    ds_read_b64_tr_b16 v[46:47], v11 offset:61952
    v_mul_f32 v185, 0x3e0293ee, v185
    v_mfma_f32_16x16x32_bf16 v[232:235], a[160:163], v[16:19], v[232:235]
    v_mul_f32 v186, 0x3e0293ee, v186
    v_mul_f32 v187, 0x3e0293ee, v187
    v_mfma_f32_16x16x32_bf16 v[232:235], a[164:167], v[20:23], v[232:235]
    v_cvt_pk_bf16_f32 v168, v168, v169
    v_cvt_pk_bf16_f32 v169, v170, v171
    v_mfma_f32_16x16x32_bf16 v[232:235], a[168:171], v[24:27], v[232:235]
    v_cvt_pk_bf16_f32 v170, v184, v185
    v_cvt_pk_bf16_f32 v171, v186, v187
    v_mfma_f32_16x16x32_bf16 v[232:235], a[172:175], v[28:31], v[232:235]
    v_mfma_f32_16x16x32_bf16 v[236:239], a[224:227], v[16:19], v[236:239]
    s_add_u32 m0, s6, 43008
    v_mfma_f32_16x16x32_bf16 v[236:239], a[228:231], v[20:23], v[236:239]
    buffer_load_dwordx4 v54, s[16:19], s69 offen lds
    v_mfma_f32_16x16x32_bf16 v[236:239], a[232:235], v[24:27], v[236:239]
    v_mfma_f32_16x16x32_bf16 v[236:239], a[236:239], v[28:31], v[236:239]
    s_waitcnt vmcnt(23) lgkmcnt(0)
    s_barrier
    v_mfma_f32_16x16x32_bf16 v[240:243], a[32:35], v[32:35], v[240:243]
    v_xor_b32 v8, 0x10000, v8
    v_mfma_f32_16x16x32_bf16 v[240:243], a[36:39], v[36:39], v[240:243]
    ds_read_b64_tr_b16 v[16:17], v8 offset:8192
    v_mfma_f32_16x16x32_bf16 v[240:243], a[40:43], v[40:43], v[240:243]
    ds_read_b64_tr_b16 v[18:19], v8 offset:8704
    v_mfma_f32_16x16x32_bf16 v[240:243], a[44:47], v[44:47], v[240:243]
    ds_read_b64_tr_b16 v[20:21], v8 offset:12288
    s_add_u32 m0, s6, 44032
    v_mfma_f32_16x16x32_bf16 v[244:247], a[96:99], v[32:35], v[244:247]
    ds_read_b64_tr_b16 v[22:23], v8 offset:12800
    buffer_load_dwordx4 v55, s[16:19], s69 offen lds
    v_mfma_f32_16x16x32_bf16 v[244:247], a[100:103], v[36:39], v[244:247]
    ds_read_b64_tr_b16 v[24:25], v8 offset:24576
    buffer_store_dwordx4 v[168:171], v7, s[8:11], s52 offen offset:1024 sc1
    v_mfma_f32_16x16x32_bf16 v[244:247], a[104:107], v[40:43], v[244:247]
    ds_read_b64_tr_b16 v[26:27], v8 offset:25088
    s_add_u32 s52, s50, 14336
    v_mfma_f32_16x16x32_bf16 v[244:247], a[108:111], v[44:47], v[244:247]
    ds_read_b64_tr_b16 v[28:29], v8 offset:28672
    v_mul_f32 v172, 0x3e0293ee, v172
    v_mfma_f32_16x16x32_bf16 v[248:251], a[160:163], v[32:35], v[248:251]
    ds_read_b64_tr_b16 v[30:31], v8 offset:29184
    v_mul_f32 v173, 0x3e0293ee, v173
    v_mfma_f32_16x16x32_bf16 v[248:251], a[164:167], v[36:39], v[248:251]
    v_mul_f32 v174, 0x3e0293ee, v174
    v_mul_f32 v175, 0x3e0293ee, v175
    v_mfma_f32_16x16x32_bf16 v[248:251], a[168:171], v[40:43], v[248:251]
    v_mul_f32 v188, 0x3e0293ee, v188
    v_mul_f32 v189, 0x3e0293ee, v189
    v_mfma_f32_16x16x32_bf16 v[248:251], a[172:175], v[44:47], v[248:251]
    v_mul_f32 v190, 0x3e0293ee, v190
    v_mul_f32 v191, 0x3e0293ee, v191
    v_mfma_f32_16x16x32_bf16 v[252:255], a[224:227], v[32:35], v[252:255]
    v_cvt_pk_bf16_f32 v172, v172, v173
    v_cvt_pk_bf16_f32 v173, v174, v175
    v_mfma_f32_16x16x32_bf16 v[252:255], a[228:231], v[36:39], v[252:255]
    v_cvt_pk_bf16_f32 v174, v188, v189
    v_cvt_pk_bf16_f32 v175, v190, v191
    v_mfma_f32_16x16x32_bf16 v[252:255], a[232:235], v[40:43], v[252:255]
    v_mfma_f32_16x16x32_bf16 v[252:255], a[236:239], v[44:47], v[252:255]
    s_waitcnt lgkmcnt(0)
    v_mfma_f32_16x16x32_bf16 v[192:195], a[48:51], v[16:19], v[192:195]
    v_xor_b32 v9, 0x10000, v9
    v_mfma_f32_16x16x32_bf16 v[192:195], a[52:55], v[20:23], v[192:195]
    ds_read_b64_tr_b16 v[32:33], v9 offset:8192
    s_add_u32 s69, s5, 352256
    v_mfma_f32_16x16x32_bf16 v[192:195], a[56:59], v[24:27], v[192:195]
    ds_read_b64_tr_b16 v[34:35], v9 offset:8704
    s_add_u32 m0, s6, 73728
    v_mfma_f32_16x16x32_bf16 v[192:195], a[60:63], v[28:31], v[192:195]
    ds_read_b64_tr_b16 v[36:37], v9 offset:12288
    buffer_load_dwordx4 v52, s[16:19], s69 offen lds
    v_mfma_f32_16x16x32_bf16 v[196:199], a[112:115], v[16:19], v[196:199]
    ds_read_b64_tr_b16 v[38:39], v9 offset:12800
    v_mfma_f32_16x16x32_bf16 v[196:199], a[116:119], v[20:23], v[196:199]
    ds_read_b64_tr_b16 v[40:41], v9 offset:24576
    v_mfma_f32_16x16x32_bf16 v[196:199], a[120:123], v[24:27], v[196:199]
    ds_read_b64_tr_b16 v[42:43], v9 offset:25088
    s_add_u32 m0, s6, 74752
    v_mfma_f32_16x16x32_bf16 v[196:199], a[124:127], v[28:31], v[196:199]
    ds_read_b64_tr_b16 v[44:45], v9 offset:28672
    buffer_load_dwordx4 v53, s[16:19], s69 offen lds
    v_mfma_f32_16x16x32_bf16 v[200:203], a[176:179], v[16:19], v[200:203]
    ds_read_b64_tr_b16 v[46:47], v9 offset:29184
    v_mfma_f32_16x16x32_bf16 v[200:203], a[180:183], v[20:23], v[200:203]
    v_mfma_f32_16x16x32_bf16 v[200:203], a[184:187], v[24:27], v[200:203]
    buffer_store_dwordx4 v[172:175], v7, s[8:11], s52 offen offset:1024 sc1
    s_add_u32 s52, s50, 2048
    v_mfma_f32_16x16x32_bf16 v[200:203], a[188:191], v[28:31], v[200:203]
    v_mul_f32 v128, 0x3e0293ee, v128
    v_mul_f32 v129, 0x3e0293ee, v129
    v_mfma_f32_16x16x32_bf16 v[204:207], a[240:243], v[16:19], v[204:207]
    v_mul_f32 v130, 0x3e0293ee, v130
    v_mul_f32 v131, 0x3e0293ee, v131
    v_mfma_f32_16x16x32_bf16 v[204:207], a[244:247], v[20:23], v[204:207]
    s_add_u32 m0, s6, 75776
    v_mul_f32 v144, 0x3e0293ee, v144
    v_mfma_f32_16x16x32_bf16 v[204:207], a[248:251], v[24:27], v[204:207]
    buffer_load_dwordx4 v54, s[16:19], s69 offen lds
    v_mul_f32 v145, 0x3e0293ee, v145
    v_mfma_f32_16x16x32_bf16 v[204:207], a[252:255], v[28:31], v[204:207]
    s_waitcnt lgkmcnt(0)
    v_mul_f32 v146, 0x3e0293ee, v146
    v_mfma_f32_16x16x32_bf16 v[208:211], a[48:51], v[32:35], v[208:211]
    v_xor_b32 v10, 0x10000, v10
    v_mul_f32 v147, 0x3e0293ee, v147
    v_mfma_f32_16x16x32_bf16 v[208:211], a[52:55], v[36:39], v[208:211]
    ds_read_b64_tr_b16 v[16:17], v10 offset:8192
    v_cvt_pk_bf16_f32 v128, v128, v129
    v_mfma_f32_16x16x32_bf16 v[208:211], a[56:59], v[40:43], v[208:211]
    ds_read_b64_tr_b16 v[18:19], v10 offset:8704
    v_cvt_pk_bf16_f32 v129, v130, v131
    v_mfma_f32_16x16x32_bf16 v[208:211], a[60:63], v[44:47], v[208:211]
    ds_read_b64_tr_b16 v[20:21], v10 offset:12288
    s_add_u32 m0, s6, 76800
    v_mfma_f32_16x16x32_bf16 v[212:215], a[112:115], v[32:35], v[212:215]
    ds_read_b64_tr_b16 v[22:23], v10 offset:12800
    buffer_load_dwordx4 v55, s[16:19], s69 offen lds
    v_mfma_f32_16x16x32_bf16 v[212:215], a[116:119], v[36:39], v[212:215]
    ds_read_b64_tr_b16 v[24:25], v10 offset:24576
    v_cvt_pk_bf16_f32 v130, v144, v145
    v_mfma_f32_16x16x32_bf16 v[212:215], a[120:123], v[40:43], v[212:215]
    ds_read_b64_tr_b16 v[26:27], v10 offset:25088
    v_cvt_pk_bf16_f32 v131, v146, v147
    v_mfma_f32_16x16x32_bf16 v[212:215], a[124:127], v[44:47], v[212:215]
    ds_read_b64_tr_b16 v[28:29], v10 offset:28672
    v_mfma_f32_16x16x32_bf16 v[216:219], a[176:179], v[32:35], v[216:219]
    ds_read_b64_tr_b16 v[30:31], v10 offset:29184
    v_mfma_f32_16x16x32_bf16 v[216:219], a[180:183], v[36:39], v[216:219]
    v_mfma_f32_16x16x32_bf16 v[216:219], a[184:187], v[40:43], v[216:219]
    s_add_u32 s69, s5, 704512
    s_add_u32 m0, s6, 106496
    v_mfma_f32_16x16x32_bf16 v[216:219], a[188:191], v[44:47], v[216:219]
    buffer_load_dwordx4 v52, s[16:19], s69 offen lds
    v_mfma_f32_16x16x32_bf16 v[220:223], a[240:243], v[32:35], v[220:223]
    v_mfma_f32_16x16x32_bf16 v[220:223], a[244:247], v[36:39], v[220:223]
    v_mfma_f32_16x16x32_bf16 v[220:223], a[248:251], v[40:43], v[220:223]
    v_mfma_f32_16x16x32_bf16 v[220:223], a[252:255], v[44:47], v[220:223]
    s_waitcnt lgkmcnt(0)
    buffer_store_dwordx4 v[128:131], v7, s[8:11], s52 offen offset:0 sc1
    v_mfma_f32_16x16x32_bf16 v[224:227], a[48:51], v[16:19], v[224:227]
    v_xor_b32 v11, 0x10000, v11
    s_add_u32 m0, s6, 107520
    v_mfma_f32_16x16x32_bf16 v[224:227], a[52:55], v[20:23], v[224:227]
    ds_read_b64_tr_b16 v[32:33], v11 offset:8192
    buffer_load_dwordx4 v53, s[16:19], s69 offen lds
    v_mfma_f32_16x16x32_bf16 v[224:227], a[56:59], v[24:27], v[224:227]
    ds_read_b64_tr_b16 v[34:35], v11 offset:8704
    s_add_u32 s52, s50, 6144
    v_mfma_f32_16x16x32_bf16 v[224:227], a[60:63], v[28:31], v[224:227]
    ds_read_b64_tr_b16 v[36:37], v11 offset:12288
    v_mul_f32 v132, 0x3e0293ee, v132
    v_mfma_f32_16x16x32_bf16 v[228:231], a[112:115], v[16:19], v[228:231]
    ds_read_b64_tr_b16 v[38:39], v11 offset:12800
    v_mul_f32 v133, 0x3e0293ee, v133
    v_mfma_f32_16x16x32_bf16 v[228:231], a[116:119], v[20:23], v[228:231]
    ds_read_b64_tr_b16 v[40:41], v11 offset:24576
    v_mul_f32 v134, 0x3e0293ee, v134
    v_mfma_f32_16x16x32_bf16 v[228:231], a[120:123], v[24:27], v[228:231]
    ds_read_b64_tr_b16 v[42:43], v11 offset:25088
    v_mul_f32 v135, 0x3e0293ee, v135
    v_mfma_f32_16x16x32_bf16 v[228:231], a[124:127], v[28:31], v[228:231]
    ds_read_b64_tr_b16 v[44:45], v11 offset:28672
    s_add_u32 m0, s6, 108544
    v_mfma_f32_16x16x32_bf16 v[232:235], a[176:179], v[16:19], v[232:235]
    ds_read_b64_tr_b16 v[46:47], v11 offset:29184
    buffer_load_dwordx4 v54, s[16:19], s69 offen lds
    v_mfma_f32_16x16x32_bf16 v[232:235], a[180:183], v[20:23], v[232:235]
    v_mul_f32 v148, 0x3e0293ee, v148
    v_mul_f32 v149, 0x3e0293ee, v149
    v_mfma_f32_16x16x32_bf16 v[232:235], a[184:187], v[24:27], v[232:235]
    v_mul_f32 v150, 0x3e0293ee, v150
    v_mul_f32 v151, 0x3e0293ee, v151
    v_mfma_f32_16x16x32_bf16 v[232:235], a[188:191], v[28:31], v[232:235]
    v_cvt_pk_bf16_f32 v132, v132, v133
    v_cvt_pk_bf16_f32 v133, v134, v135
    v_mfma_f32_16x16x32_bf16 v[236:239], a[240:243], v[16:19], v[236:239]
    v_cvt_pk_bf16_f32 v134, v148, v149
    v_cvt_pk_bf16_f32 v135, v150, v151
    v_mfma_f32_16x16x32_bf16 v[236:239], a[244:247], v[20:23], v[236:239]
    s_add_u32 m0, s6, 109568
    v_mfma_f32_16x16x32_bf16 v[236:239], a[248:251], v[24:27], v[236:239]
    buffer_load_dwordx4 v55, s[16:19], s69 offen lds
    v_mfma_f32_16x16x32_bf16 v[236:239], a[252:255], v[28:31], v[236:239]
    s_waitcnt vmcnt(40) lgkmcnt(0)
    s_barrier
    v_mfma_f32_16x16x32_bf16 v[240:243], a[48:51], v[32:35], v[240:243]
    ds_read_b64_tr_b16 v[16:17], v8 offset:0
    v_mfma_f32_16x16x32_bf16 v[240:243], a[52:55], v[36:39], v[240:243]
    ds_read_b64_tr_b16 v[18:19], v8 offset:512
    v_mfma_f32_16x16x32_bf16 v[240:243], a[56:59], v[40:43], v[240:243]
    ds_read_b64_tr_b16 v[20:21], v8 offset:4096
    v_mfma_f32_16x16x32_bf16 v[240:243], a[60:63], v[44:47], v[240:243]
    ds_read_b64_tr_b16 v[22:23], v8 offset:4608
    v_mfma_f32_16x16x32_bf16 v[244:247], a[112:115], v[32:35], v[244:247]
    ds_read_b64_tr_b16 v[24:25], v8 offset:16384
    buffer_store_dwordx4 v[132:135], v7, s[8:11], s52 offen offset:0 sc1
    v_mfma_f32_16x16x32_bf16 v[244:247], a[116:119], v[36:39], v[244:247]
    ds_read_b64_tr_b16 v[26:27], v8 offset:16896
    s_add_u32 s52, s50, 10240
    v_mfma_f32_16x16x32_bf16 v[244:247], a[120:123], v[40:43], v[244:247]
    ds_read_b64_tr_b16 v[28:29], v8 offset:20480
    v_mul_f32 v136, 0x3e0293ee, v136
    v_mfma_f32_16x16x32_bf16 v[244:247], a[124:127], v[44:47], v[244:247]
    ds_read_b64_tr_b16 v[30:31], v8 offset:20992
    v_mul_f32 v137, 0x3e0293ee, v137
    v_mfma_f32_16x16x32_bf16 v[248:251], a[176:179], v[32:35], v[248:251]
    s_waitcnt vmcnt(23)
    v_cmp_gt_u32 vcc, 0x80, v3
    s_nop 0
    s_cbranch_vccnz mg_ps_1
mg_pb_2:
    v_mfma_f32_16x16x32_bf16 v[248:251], a[180:183], v[36:39], v[248:251]
    v_mul_f32 v138, 0x3e0293ee, v138
    v_mul_f32 v139, 0x3e0293ee, v139
    v_mfma_f32_16x16x32_bf16 v[248:251], a[184:187], v[40:43], v[248:251]
    v_mul_f32 v152, 0x3e0293ee, v152
    v_mul_f32 v153, 0x3e0293ee, v153
    v_mfma_f32_16x16x32_bf16 v[248:251], a[188:191], v[44:47], v[248:251]
    v_mul_f32 v154, 0x3e0293ee, v154
    v_mul_f32 v155, 0x3e0293ee, v155
    v_mfma_f32_16x16x32_bf16 v[252:255], a[240:243], v[32:35], v[252:255]
    v_cvt_pk_bf16_f32 v136, v136, v137
    v_cvt_pk_bf16_f32 v137, v138, v139
    v_mfma_f32_16x16x32_bf16 v[252:255], a[244:247], v[36:39], v[252:255]
    v_cvt_pk_bf16_f32 v138, v152, v153
    v_cvt_pk_bf16_f32 v139, v154, v155
    v_mfma_f32_16x16x32_bf16 v[252:255], a[248:251], v[40:43], v[252:255]
    v_mfma_f32_16x16x32_bf16 v[252:255], a[252:255], v[44:47], v[252:255]
    s_waitcnt lgkmcnt(0)
    v_mfma_f32_16x16x32_bf16 v[64:67], a[0:3], v[16:19], 0
    ds_read_b64_tr_b16 v[32:33], v9 offset:0
    v_mfma_f32_16x16x32_bf16 v[64:67], a[4:7], v[20:23], v[64:67]
    ds_read_b64_tr_b16 v[34:35], v9 offset:512
    s_add_u32 s69, s5, 1056768
    v_mfma_f32_16x16x32_bf16 v[64:67], a[8:11], v[24:27], v[64:67]
    ds_read_b64_tr_b16 v[36:37], v9 offset:4096
    s_add_u32 m0, s6, 8192
    v_mfma_f32_16x16x32_bf16 v[64:67], a[12:15], v[28:31], v[64:67]
    ds_read_b64_tr_b16 v[38:39], v9 offset:4608
    buffer_load_dwordx4 v52, s[16:19], s69 offen lds
    v_mfma_f32_16x16x32_bf16 v[68:71], a[64:67], v[16:19], 0
    ds_read_b64_tr_b16 v[40:41], v9 offset:16384
    v_mfma_f32_16x16x32_bf16 v[68:71], a[68:71], v[20:23], v[68:71]
    ds_read_b64_tr_b16 v[42:43], v9 offset:16896
    v_mfma_f32_16x16x32_bf16 v[68:71], a[72:75], v[24:27], v[68:71]
    ds_read_b64_tr_b16 v[44:45], v9 offset:20480
    v_mfma_f32_16x16x32_bf16 v[68:71], a[76:79], v[28:31], v[68:71]
    ds_read_b64_tr_b16 v[46:47], v9 offset:20992
    s_add_u32 m0, s6, 9216
    v_mfma_f32_16x16x32_bf16 v[72:75], a[128:131], v[16:19], 0
    buffer_load_dwordx4 v53, s[16:19], s69 offen lds
    v_mfma_f32_16x16x32_bf16 v[72:75], a[132:135], v[20:23], v[72:75]
    v_mfma_f32_16x16x32_bf16 v[72:75], a[136:139], v[24:27], v[72:75]
    buffer_store_dwordx4 v[136:139], v7, s[8:11], s52 offen offset:0 sc1
    s_add_u32 s52, s50, 14336
    v_mfma_f32_16x16x32_bf16 v[72:75], a[140:143], v[28:31], v[72:75]
    v_mul_f32 v140, 0x3e0293ee, v140
    v_mul_f32 v141, 0x3e0293ee, v141
    v_mfma_f32_16x16x32_bf16 v[76:79], a[192:195], v[16:19], 0
    v_mul_f32 v142, 0x3e0293ee, v142
    v_mul_f32 v143, 0x3e0293ee, v143
    v_mfma_f32_16x16x32_bf16 v[76:79], a[196:199], v[20:23], v[76:79]
    v_mul_f32 v156, 0x3e0293ee, v156
    v_mul_f32 v157, 0x3e0293ee, v157
    v_mfma_f32_16x16x32_bf16 v[76:79], a[200:203], v[24:27], v[76:79]
    s_add_u32 m0, s6, 10240
    v_mul_f32 v158, 0x3e0293ee, v158
    v_mfma_f32_16x16x32_bf16 v[76:79], a[204:207], v[28:31], v[76:79]
    s_waitcnt lgkmcnt(0)
    buffer_load_dwordx4 v54, s[16:19], s69 offen lds
    v_mfma_f32_16x16x32_bf16 v[80:83], a[0:3], v[32:35], 0
    ds_read_b64_tr_b16 v[16:17], v10 offset:0
    v_mul_f32 v159, 0x3e0293ee, v159
    v_mfma_f32_16x16x32_bf16 v[80:83], a[4:7], v[36:39], v[80:83]
    ds_read_b64_tr_b16 v[18:19], v10 offset:512
    v_cvt_pk_bf16_f32 v140, v140, v141
    v_mfma_f32_16x16x32_bf16 v[80:83], a[8:11], v[40:43], v[80:83]
    ds_read_b64_tr_b16 v[20:21], v10 offset:4096
    v_cvt_pk_bf16_f32 v141, v142, v143
    v_mfma_f32_16x16x32_bf16 v[80:83], a[12:15], v[44:47], v[80:83]
    ds_read_b64_tr_b16 v[22:23], v10 offset:4608
    v_cvt_pk_bf16_f32 v142, v156, v157
    v_mfma_f32_16x16x32_bf16 v[84:87], a[64:67], v[32:35], 0
    ds_read_b64_tr_b16 v[24:25], v10 offset:16384
    v_cvt_pk_bf16_f32 v143, v158, v159
    v_mfma_f32_16x16x32_bf16 v[84:87], a[68:71], v[36:39], v[84:87]
    ds_read_b64_tr_b16 v[26:27], v10 offset:16896
    v_mfma_f32_16x16x32_bf16 v[84:87], a[72:75], v[40:43], v[84:87]
    ds_read_b64_tr_b16 v[28:29], v10 offset:20480
    s_add_u32 m0, s6, 11264
    v_mfma_f32_16x16x32_bf16 v[84:87], a[76:79], v[44:47], v[84:87]
    ds_read_b64_tr_b16 v[30:31], v10 offset:20992
    buffer_load_dwordx4 v55, s[16:19], s69 offen lds
    v_mfma_f32_16x16x32_bf16 v[88:91], a[128:131], v[32:35], 0
    v_mfma_f32_16x16x32_bf16 v[88:91], a[132:135], v[36:39], v[88:91]
    v_mfma_f32_16x16x32_bf16 v[88:91], a[136:139], v[40:43], v[88:91]
    buffer_store_dwordx4 v[140:143], v7, s[8:11], s52 offen offset:0 sc1
    s_add_u32 s52, s51, 0
    v_mfma_f32_16x16x32_bf16 v[88:91], a[140:143], v[44:47], v[88:91]
    v_cvt_pk_bf16_f32 v192, v192, v193
    v_cvt_pk_bf16_f32 v193, v194, v195
    v_mfma_f32_16x16x32_bf16 v[92:95], a[192:195], v[32:35], 0
    v_cvt_pk_bf16_f32 v194, v196, v197
    v_cvt_pk_bf16_f32 v195, v198, v199
    v_mfma_f32_16x16x32_bf16 v[92:95], a[196:199], v[36:39], v[92:95]
    s_lshl_b32 s71, s41, 6
    v_mfma_f32_16x16x32_bf16 v[92:95], a[200:203], v[40:43], v[92:95]
    buffer_load_dwordx2 v[178:179], v2, s[20:23], s71 offen offset:0
    v_mfma_f32_16x16x32_bf16 v[92:95], a[204:207], v[44:47], v[92:95]
    s_waitcnt lgkmcnt(0)
    v_mfma_f32_16x16x32_bf16 v[96:99], a[0:3], v[16:19], 0
    ds_read_b64_tr_b16 v[32:33], v11 offset:0
    v_mfma_f32_16x16x32_bf16 v[96:99], a[4:7], v[20:23], v[96:99]
    ds_read_b64_tr_b16 v[34:35], v11 offset:512
    v_mfma_f32_16x16x32_bf16 v[96:99], a[8:11], v[24:27], v[96:99]
    ds_read_b64_tr_b16 v[36:37], v11 offset:4096
    v_mfma_f32_16x16x32_bf16 v[96:99], a[12:15], v[28:31], v[96:99]
    ds_read_b64_tr_b16 v[38:39], v11 offset:4608
    v_mfma_f32_16x16x32_bf16 v[100:103], a[64:67], v[16:19], 0
    ds_read_b64_tr_b16 v[40:41], v11 offset:16384
    v_mfma_f32_16x16x32_bf16 v[100:103], a[68:71], v[20:23], v[100:103]
    ds_read_b64_tr_b16 v[42:43], v11 offset:16896
    buffer_load_dwordx2 v[182:183], v2, s[20:23], s71 offen offset:32
    v_mfma_f32_16x16x32_bf16 v[100:103], a[72:75], v[24:27], v[100:103]
    ds_read_b64_tr_b16 v[44:45], v11 offset:20480
    v_mfma_f32_16x16x32_bf16 v[100:103], a[76:79], v[28:31], v[100:103]
    ds_read_b64_tr_b16 v[46:47], v11 offset:20992
    v_mfma_f32_16x16x32_bf16 v[104:107], a[128:131], v[16:19], 0
    v_mfma_f32_16x16x32_bf16 v[104:107], a[132:135], v[20:23], v[104:107]
    v_mfma_f32_16x16x32_bf16 v[104:107], a[136:139], v[24:27], v[104:107]
    buffer_store_dwordx4 v[192:195], v7, s[8:11], s52 offen offset:0 sc1
    s_add_u32 s52, s51, 8192
    v_mfma_f32_16x16x32_bf16 v[104:107], a[140:143], v[28:31], v[104:107]
    v_cvt_pk_bf16_f32 v200, v200, v201
    v_cvt_pk_bf16_f32 v201, v202, v203
    v_mfma_f32_16x16x32_bf16 v[108:111], a[192:195], v[16:19], 0
    v_cvt_pk_bf16_f32 v202, v204, v205
    v_cvt_pk_bf16_f32 v203, v206, v207
    v_mfma_f32_16x16x32_bf16 v[108:111], a[196:199], v[20:23], v[108:111]
    buffer_load_dwordx2 v[186:187], v2, s[20:23], s78 offen offset:0
    v_mfma_f32_16x16x32_bf16 v[108:111], a[200:203], v[24:27], v[108:111]
    v_mfma_f32_16x16x32_bf16 v[108:111], a[204:207], v[28:31], v[108:111]
    s_waitcnt vmcnt(41) lgkmcnt(0)
    s_barrier
    v_mfma_f32_16x16x32_bf16 v[112:115], a[0:3], v[32:35], 0
    ds_read_b64_tr_b16 v[16:17], v8 offset:32768
    v_mfma_f32_16x16x32_bf16 v[112:115], a[4:7], v[36:39], v[112:115]
    ds_read_b64_tr_b16 v[18:19], v8 offset:33280
    v_mfma_f32_16x16x32_bf16 v[112:115], a[8:11], v[40:43], v[112:115]
    ds_read_b64_tr_b16 v[20:21], v8 offset:36864
    v_mfma_f32_16x16x32_bf16 v[112:115], a[12:15], v[44:47], v[112:115]
    ds_read_b64_tr_b16 v[22:23], v8 offset:37376
    v_mfma_f32_16x16x32_bf16 v[116:119], a[64:67], v[32:35], 0
    ds_read_b64_tr_b16 v[24:25], v8 offset:49152
    buffer_load_dwordx2 v[190:191], v2, s[20:23], s78 offen offset:32
    v_mfma_f32_16x16x32_bf16 v[116:119], a[68:71], v[36:39], v[116:119]
    ds_read_b64_tr_b16 v[26:27], v8 offset:49664
    v_mfma_f32_16x16x32_bf16 v[116:119], a[72:75], v[40:43], v[116:119]
    ds_read_b64_tr_b16 v[28:29], v8 offset:53248
    v_mfma_f32_16x16x32_bf16 v[116:119], a[76:79], v[44:47], v[116:119]
    ds_read_b64_tr_b16 v[30:31], v8 offset:53760
    v_mfma_f32_16x16x32_bf16 v[120:123], a[128:131], v[32:35], 0
    v_mfma_f32_16x16x32_bf16 v[120:123], a[132:135], v[36:39], v[120:123]
    v_mfma_f32_16x16x32_bf16 v[120:123], a[136:139], v[40:43], v[120:123]
    buffer_store_dwordx4 v[200:203], v7, s[8:11], s52 offen offset:0 sc1
    s_add_u32 s52, s51, 0
    v_mfma_f32_16x16x32_bf16 v[120:123], a[140:143], v[44:47], v[120:123]
    v_cvt_pk_bf16_f32 v208, v208, v209
    v_cvt_pk_bf16_f32 v209, v210, v211
    v_mfma_f32_16x16x32_bf16 v[124:127], a[192:195], v[32:35], 0
    v_cvt_pk_bf16_f32 v210, v212, v213
    v_cvt_pk_bf16_f32 v211, v214, v215
    v_mfma_f32_16x16x32_bf16 v[124:127], a[196:199], v[36:39], v[124:127]
    v_mfma_f32_16x16x32_bf16 v[124:127], a[200:203], v[40:43], v[124:127]
    v_mfma_f32_16x16x32_bf16 v[124:127], a[204:207], v[44:47], v[124:127]
    s_waitcnt lgkmcnt(0)
    v_mfma_f32_16x16x32_bf16 v[64:67], a[16:19], v[16:19], v[64:67]
    ds_read_b64_tr_b16 v[32:33], v9 offset:32768
    v_mfma_f32_16x16x32_bf16 v[64:67], a[20:23], v[20:23], v[64:67]
    ds_read_b64_tr_b16 v[34:35], v9 offset:33280
    s_add_u32 s70, s3, 0
    v_mfma_f32_16x16x32_bf16 v[64:67], a[24:27], v[24:27], v[64:67]
    ds_read_b64_tr_b16 v[36:37], v9 offset:36864
    buffer_load_dwordx4 a[0:3], v7, s[8:11], s70 offen offset:0 sc1
    v_mfma_f32_16x16x32_bf16 v[64:67], a[28:31], v[28:31], v[64:67]
    ds_read_b64_tr_b16 v[38:39], v9 offset:37376
    v_mfma_f32_16x16x32_bf16 v[68:71], a[80:83], v[16:19], v[68:71]
    ds_read_b64_tr_b16 v[40:41], v9 offset:49152
    buffer_load_dwordx4 a[4:7], v7, s[8:11], s70 offen offset:1024 sc1
    v_mfma_f32_16x16x32_bf16 v[68:71], a[84:87], v[20:23], v[68:71]
    ds_read_b64_tr_b16 v[42:43], v9 offset:49664
    v_mfma_f32_16x16x32_bf16 v[68:71], a[88:91], v[24:27], v[68:71]
    ds_read_b64_tr_b16 v[44:45], v9 offset:53248
    v_mfma_f32_16x16x32_bf16 v[68:71], a[92:95], v[28:31], v[68:71]
    ds_read_b64_tr_b16 v[46:47], v9 offset:53760
    v_mfma_f32_16x16x32_bf16 v[72:75], a[144:147], v[16:19], v[72:75]
    buffer_load_dwordx4 a[8:11], v7, s[8:11], s70 offen offset:2048 sc1
    v_mfma_f32_16x16x32_bf16 v[72:75], a[148:151], v[20:23], v[72:75]
    v_mfma_f32_16x16x32_bf16 v[72:75], a[152:155], v[24:27], v[72:75]
    v_mfma_f32_16x16x32_bf16 v[72:75], a[156:159], v[28:31], v[72:75]
    v_mfma_f32_16x16x32_bf16 v[76:79], a[208:211], v[16:19], v[76:79]
    buffer_load_dwordx4 a[12:15], v7, s[8:11], s70 offen offset:3072 sc1
    v_mfma_f32_16x16x32_bf16 v[76:79], a[212:215], v[20:23], v[76:79]
    v_mfma_f32_16x16x32_bf16 v[76:79], a[216:219], v[24:27], v[76:79]
    s_add_u32 s70, s3, 16384
    v_mfma_f32_16x16x32_bf16 v[76:79], a[220:223], v[28:31], v[76:79]
    s_waitcnt lgkmcnt(0)
    buffer_load_dwordx4 a[64:67], v7, s[8:11], s70 offen offset:0 sc1
    v_mfma_f32_16x16x32_bf16 v[80:83], a[16:19], v[32:35], v[80:83]
    ds_read_b64_tr_b16 v[16:17], v10 offset:32768
    v_mfma_f32_16x16x32_bf16 v[80:83], a[20:23], v[36:39], v[80:83]
    ds_read_b64_tr_b16 v[18:19], v10 offset:33280
    v_mfma_f32_16x16x32_bf16 v[80:83], a[24:27], v[40:43], v[80:83]
    ds_read_b64_tr_b16 v[20:21], v10 offset:36864
    v_mfma_f32_16x16x32_bf16 v[80:83], a[28:31], v[44:47], v[80:83]
    ds_read_b64_tr_b16 v[22:23], v10 offset:37376
    buffer_load_dwordx4 a[68:71], v7, s[8:11], s70 offen offset:1024 sc1
    v_mfma_f32_16x16x32_bf16 v[84:87], a[80:83], v[32:35], v[84:87]
    ds_read_b64_tr_b16 v[24:25], v10 offset:49152
    v_mfma_f32_16x16x32_bf16 v[84:87], a[84:87], v[36:39], v[84:87]
    ds_read_b64_tr_b16 v[26:27], v10 offset:49664
    v_mfma_f32_16x16x32_bf16 v[84:87], a[88:91], v[40:43], v[84:87]
    ds_read_b64_tr_b16 v[28:29], v10 offset:53248
    v_mfma_f32_16x16x32_bf16 v[84:87], a[92:95], v[44:47], v[84:87]
    ds_read_b64_tr_b16 v[30:31], v10 offset:53760
    buffer_load_dwordx4 a[72:75], v7, s[8:11], s70 offen offset:2048 sc1
    v_mfma_f32_16x16x32_bf16 v[88:91], a[144:147], v[32:35], v[88:91]
    v_mfma_f32_16x16x32_bf16 v[88:91], a[148:151], v[36:39], v[88:91]
    v_mfma_f32_16x16x32_bf16 v[88:91], a[152:155], v[40:43], v[88:91]
    buffer_load_dwordx4 a[76:79], v7, s[8:11], s70 offen offset:3072 sc1
    v_mfma_f32_16x16x32_bf16 v[88:91], a[156:159], v[44:47], v[88:91]
    v_mfma_f32_16x16x32_bf16 v[92:95], a[208:211], v[32:35], v[92:95]
    v_mfma_f32_16x16x32_bf16 v[92:95], a[212:215], v[36:39], v[92:95]
    s_add_u32 s70, s3, 32768
    v_mfma_f32_16x16x32_bf16 v[92:95], a[216:219], v[40:43], v[92:95]
    buffer_load_dwordx4 a[128:131], v7, s[8:11], s70 offen offset:0 sc1
    v_mfma_f32_16x16x32_bf16 v[92:95], a[220:223], v[44:47], v[92:95]
    s_waitcnt lgkmcnt(0)
    v_mfma_f32_16x16x32_bf16 v[96:99], a[16:19], v[16:19], v[96:99]
    ds_read_b64_tr_b16 v[32:33], v11 offset:32768
    v_mfma_f32_16x16x32_bf16 v[96:99], a[20:23], v[20:23], v[96:99]
    ds_read_b64_tr_b16 v[34:35], v11 offset:33280
    v_mfma_f32_16x16x32_bf16 v[96:99], a[24:27], v[24:27], v[96:99]
    ds_read_b64_tr_b16 v[36:37], v11 offset:36864
    buffer_load_dwordx4 a[132:135], v7, s[8:11], s70 offen offset:1024 sc1
    v_mfma_f32_16x16x32_bf16 v[96:99], a[28:31], v[28:31], v[96:99]
    ds_read_b64_tr_b16 v[38:39], v11 offset:37376
    v_mfma_f32_16x16x32_bf16 v[100:103], a[80:83], v[16:19], v[100:103]
    ds_read_b64_tr_b16 v[40:41], v11 offset:49152
    v_mfma_f32_16x16x32_bf16 v[100:103], a[84:87], v[20:23], v[100:103]
    ds_read_b64_tr_b16 v[42:43], v11 offset:49664
    buffer_load_dwordx4 a[136:139], v7, s[8:11], s70 offen offset:2048 sc1
    v_mfma_f32_16x16x32_bf16 v[100:103], a[88:91], v[24:27], v[100:103]
    ds_read_b64_tr_b16 v[44:45], v11 offset:53248
    v_mfma_f32_16x16x32_bf16 v[100:103], a[92:95], v[28:31], v[100:103]
    ds_read_b64_tr_b16 v[46:47], v11 offset:53760
    v_mfma_f32_16x16x32_bf16 v[104:107], a[144:147], v[16:19], v[104:107]
    v_mfma_f32_16x16x32_bf16 v[104:107], a[148:151], v[20:23], v[104:107]
    buffer_load_dwordx4 a[140:143], v7, s[8:11], s70 offen offset:3072 sc1
    v_mfma_f32_16x16x32_bf16 v[104:107], a[152:155], v[24:27], v[104:107]
    v_mfma_f32_16x16x32_bf16 v[104:107], a[156:159], v[28:31], v[104:107]
    v_mfma_f32_16x16x32_bf16 v[108:111], a[208:211], v[16:19], v[108:111]
    s_add_u32 s70, s3, 49152
    v_mfma_f32_16x16x32_bf16 v[108:111], a[212:215], v[20:23], v[108:111]
    buffer_load_dwordx4 a[192:195], v7, s[8:11], s70 offen offset:0 sc1
    v_mfma_f32_16x16x32_bf16 v[108:111], a[216:219], v[24:27], v[108:111]
    v_mfma_f32_16x16x32_bf16 v[108:111], a[220:223], v[28:31], v[108:111]
    s_waitcnt vmcnt(49) lgkmcnt(0)
    s_barrier
    v_mfma_f32_16x16x32_bf16 v[112:115], a[16:19], v[32:35], v[112:115]
    v_xor_b32 v8, 0x10000, v8
    buffer_load_dwordx4 a[196:199], v7, s[8:11], s70 offen offset:1024 sc1
    v_mfma_f32_16x16x32_bf16 v[112:115], a[20:23], v[36:39], v[112:115]
    ds_read_b64_tr_b16 v[16:17], v8 offset:0
    v_mfma_f32_16x16x32_bf16 v[112:115], a[24:27], v[40:43], v[112:115]
    ds_read_b64_tr_b16 v[18:19], v8 offset:512
    v_mfma_f32_16x16x32_bf16 v[112:115], a[28:31], v[44:47], v[112:115]
    ds_read_b64_tr_b16 v[20:21], v8 offset:4096
    v_mfma_f32_16x16x32_bf16 v[116:119], a[80:83], v[32:35], v[116:119]
    ds_read_b64_tr_b16 v[22:23], v8 offset:4608
    buffer_load_dwordx4 a[200:203], v7, s[8:11], s70 offen offset:2048 sc1
    v_mfma_f32_16x16x32_bf16 v[116:119], a[84:87], v[36:39], v[116:119]
    ds_read_b64_tr_b16 v[24:25], v8 offset:16384
    v_mfma_f32_16x16x32_bf16 v[116:119], a[88:91], v[40:43], v[116:119]
    ds_read_b64_tr_b16 v[26:27], v8 offset:16896
    v_mfma_f32_16x16x32_bf16 v[116:119], a[92:95], v[44:47], v[116:119]
    ds_read_b64_tr_b16 v[28:29], v8 offset:20480
    v_mfma_f32_16x16x32_bf16 v[120:123], a[144:147], v[32:35], v[120:123]
    ds_read_b64_tr_b16 v[30:31], v8 offset:20992
    buffer_load_dwordx4 a[204:207], v7, s[8:11], s70 offen offset:3072 sc1
    v_mfma_f32_16x16x32_bf16 v[120:123], a[148:151], v[36:39], v[120:123]
    v_mfma_f32_16x16x32_bf16 v[120:123], a[152:155], v[40:43], v[120:123]
    v_mfma_f32_16x16x32_bf16 v[120:123], a[156:159], v[44:47], v[120:123]
    v_mfma_f32_16x16x32_bf16 v[124:127], a[208:211], v[32:35], v[124:127]
    v_mfma_f32_16x16x32_bf16 v[124:127], a[212:215], v[36:39], v[124:127]
    v_mfma_f32_16x16x32_bf16 v[124:127], a[216:219], v[40:43], v[124:127]
    v_mfma_f32_16x16x32_bf16 v[124:127], a[220:223], v[44:47], v[124:127]
    s_waitcnt lgkmcnt(0)
    v_mfma_f32_16x16x32_bf16 v[64:67], a[32:35], v[16:19], v[64:67]
    v_xor_b32 v9, 0x10000, v9
    v_mfma_f32_16x16x32_bf16 v[64:67], a[36:39], v[20:23], v[64:67]
    ds_read_b64_tr_b16 v[32:33], v9 offset:0
    s_add_u32 s70, s3, 4096
    v_mfma_f32_16x16x32_bf16 v[64:67], a[40:43], v[24:27], v[64:67]
    ds_read_b64_tr_b16 v[34:35], v9 offset:512
    buffer_load_dwordx4 a[16:19], v7, s[8:11], s70 offen offset:0 sc1
    v_mfma_f32_16x16x32_bf16 v[64:67], a[44:47], v[28:31], v[64:67]
    ds_read_b64_tr_b16 v[36:37], v9 offset:4096
    v_mfma_f32_16x16x32_bf16 v[68:71], a[96:99], v[16:19], v[68:71]
    ds_read_b64_tr_b16 v[38:39], v9 offset:4608
    buffer_load_dwordx4 a[20:23], v7, s[8:11], s70 offen offset:1024 sc1
    v_mfma_f32_16x16x32_bf16 v[68:71], a[100:103], v[20:23], v[68:71]
    ds_read_b64_tr_b16 v[40:41], v9 offset:16384
    v_mfma_f32_16x16x32_bf16 v[68:71], a[104:107], v[24:27], v[68:71]
    ds_read_b64_tr_b16 v[42:43], v9 offset:16896
    v_mfma_f32_16x16x32_bf16 v[68:71], a[108:111], v[28:31], v[68:71]
    ds_read_b64_tr_b16 v[44:45], v9 offset:20480
    v_mfma_f32_16x16x32_bf16 v[72:75], a[160:163], v[16:19], v[72:75]
    ds_read_b64_tr_b16 v[46:47], v9 offset:20992
    buffer_load_dwordx4 a[24:27], v7, s[8:11], s70 offen offset:2048 sc1
    v_mfma_f32_16x16x32_bf16 v[72:75], a[164:167], v[20:23], v[72:75]
    v_mfma_f32_16x16x32_bf16 v[72:75], a[168:171], v[24:27], v[72:75]
    v_mfma_f32_16x16x32_bf16 v[72:75], a[172:175], v[28:31], v[72:75]
    v_mfma_f32_16x16x32_bf16 v[76:79], a[224:227], v[16:19], v[76:79]
    buffer_load_dwordx4 a[28:31], v7, s[8:11], s70 offen offset:3072 sc1
    v_mfma_f32_16x16x32_bf16 v[76:79], a[228:231], v[20:23], v[76:79]
    v_mfma_f32_16x16x32_bf16 v[76:79], a[232:235], v[24:27], v[76:79]
    s_add_u32 s70, s3, 20480
    v_mfma_f32_16x16x32_bf16 v[76:79], a[236:239], v[28:31], v[76:79]
    s_waitcnt lgkmcnt(0)
    buffer_load_dwordx4 a[80:83], v7, s[8:11], s70 offen offset:0 sc1
    v_mfma_f32_16x16x32_bf16 v[80:83], a[32:35], v[32:35], v[80:83]
    v_xor_b32 v10, 0x10000, v10
    v_mfma_f32_16x16x32_bf16 v[80:83], a[36:39], v[36:39], v[80:83]
    ds_read_b64_tr_b16 v[16:17], v10 offset:0
    v_mfma_f32_16x16x32_bf16 v[80:83], a[40:43], v[40:43], v[80:83]
    ds_read_b64_tr_b16 v[18:19], v10 offset:512
    v_mfma_f32_16x16x32_bf16 v[80:83], a[44:47], v[44:47], v[80:83]
    ds_read_b64_tr_b16 v[20:21], v10 offset:4096
    buffer_load_dwordx4 a[84:87], v7, s[8:11], s70 offen offset:1024 sc1
    v_mfma_f32_16x16x32_bf16 v[84:87], a[96:99], v[32:35], v[84:87]
    ds_read_b64_tr_b16 v[22:23], v10 offset:4608
    v_mfma_f32_16x16x32_bf16 v[84:87], a[100:103], v[36:39], v[84:87]
    ds_read_b64_tr_b16 v[24:25], v10 offset:16384
    v_mfma_f32_16x16x32_bf16 v[84:87], a[104:107], v[40:43], v[84:87]
    ds_read_b64_tr_b16 v[26:27], v10 offset:16896
    v_mfma_f32_16x16x32_bf16 v[84:87], a[108:111], v[44:47], v[84:87]
    ds_read_b64_tr_b16 v[28:29], v10 offset:20480
    buffer_load_dwordx4 a[88:91], v7, s[8:11], s70 offen offset:2048 sc1
    v_mfma_f32_16x16x32_bf16 v[88:91], a[160:163], v[32:35], v[88:91]
    ds_read_b64_tr_b16 v[30:31], v10 offset:20992
    v_mfma_f32_16x16x32_bf16 v[88:91], a[164:167], v[36:39], v[88:91]
    v_mfma_f32_16x16x32_bf16 v[88:91], a[168:171], v[40:43], v[88:91]
    buffer_load_dwordx4 a[92:95], v7, s[8:11], s70 offen offset:3072 sc1
    v_mfma_f32_16x16x32_bf16 v[88:91], a[172:175], v[44:47], v[88:91]
    v_mfma_f32_16x16x32_bf16 v[92:95], a[224:227], v[32:35], v[92:95]
    v_mfma_f32_16x16x32_bf16 v[92:95], a[228:231], v[36:39], v[92:95]
    s_add_u32 s70, s3, 36864
    v_mfma_f32_16x16x32_bf16 v[92:95], a[232:235], v[40:43], v[92:95]
    buffer_load_dwordx4 a[144:147], v7, s[8:11], s70 offen offset:0 sc1
    v_mfma_f32_16x16x32_bf16 v[92:95], a[236:239], v[44:47], v[92:95]
    s_waitcnt lgkmcnt(0)
    v_mfma_f32_16x16x32_bf16 v[96:99], a[32:35], v[16:19], v[96:99]
    v_xor_b32 v11, 0x10000, v11
    v_mfma_f32_16x16x32_bf16 v[96:99], a[36:39], v[20:23], v[96:99]
    ds_read_b64_tr_b16 v[32:33], v11 offset:0
    v_mfma_f32_16x16x32_bf16 v[96:99], a[40:43], v[24:27], v[96:99]
    ds_read_b64_tr_b16 v[34:35], v11 offset:512
    buffer_load_dwordx4 a[148:151], v7, s[8:11], s70 offen offset:1024 sc1
    v_mfma_f32_16x16x32_bf16 v[96:99], a[44:47], v[28:31], v[96:99]
    ds_read_b64_tr_b16 v[36:37], v11 offset:4096
    v_mfma_f32_16x16x32_bf16 v[100:103], a[96:99], v[16:19], v[100:103]
    ds_read_b64_tr_b16 v[38:39], v11 offset:4608
    v_mfma_f32_16x16x32_bf16 v[100:103], a[100:103], v[20:23], v[100:103]
    ds_read_b64_tr_b16 v[40:41], v11 offset:16384
    buffer_load_dwordx4 a[152:155], v7, s[8:11], s70 offen offset:2048 sc1
    v_mfma_f32_16x16x32_bf16 v[100:103], a[104:107], v[24:27], v[100:103]
    ds_read_b64_tr_b16 v[42:43], v11 offset:16896
    v_mfma_f32_16x16x32_bf16 v[100:103], a[108:111], v[28:31], v[100:103]
    ds_read_b64_tr_b16 v[44:45], v11 offset:20480
    v_mfma_f32_16x16x32_bf16 v[104:107], a[160:163], v[16:19], v[104:107]
    ds_read_b64_tr_b16 v[46:47], v11 offset:20992
    v_mfma_f32_16x16x32_bf16 v[104:107], a[164:167], v[20:23], v[104:107]
    buffer_load_dwordx4 a[156:159], v7, s[8:11], s70 offen offset:3072 sc1
    v_mfma_f32_16x16x32_bf16 v[104:107], a[168:171], v[24:27], v[104:107]
    v_mfma_f32_16x16x32_bf16 v[104:107], a[172:175], v[28:31], v[104:107]
    v_mfma_f32_16x16x32_bf16 v[108:111], a[224:227], v[16:19], v[108:111]
    s_add_u32 s70, s3, 53248
    v_mfma_f32_16x16x32_bf16 v[108:111], a[228:231], v[20:23], v[108:111]
    buffer_load_dwordx4 a[208:211], v7, s[8:11], s70 offen offset:0 sc1
    v_mfma_f32_16x16x32_bf16 v[108:111], a[232:235], v[24:27], v[108:111]
    v_mfma_f32_16x16x32_bf16 v[108:111], a[236:239], v[28:31], v[108:111]
    s_waitcnt vmcnt(58) lgkmcnt(0)
    s_barrier
    v_mfma_f32_16x16x32_bf16 v[112:115], a[32:35], v[32:35], v[112:115]
    ds_read_b64_tr_b16 v[16:17], v8 offset:32768
    buffer_load_dwordx4 a[212:215], v7, s[8:11], s70 offen offset:1024 sc1
    v_mfma_f32_16x16x32_bf16 v[112:115], a[36:39], v[36:39], v[112:115]
    ds_read_b64_tr_b16 v[18:19], v8 offset:33280
    v_mfma_f32_16x16x32_bf16 v[112:115], a[40:43], v[40:43], v[112:115]
    ds_read_b64_tr_b16 v[20:21], v8 offset:36864
    v_mfma_f32_16x16x32_bf16 v[112:115], a[44:47], v[44:47], v[112:115]
    ds_read_b64_tr_b16 v[22:23], v8 offset:37376
    v_mfma_f32_16x16x32_bf16 v[116:119], a[96:99], v[32:35], v[116:119]
    ds_read_b64_tr_b16 v[24:25], v8 offset:49152
    buffer_load_dwordx4 a[216:219], v7, s[8:11], s70 offen offset:2048 sc1
    v_mfma_f32_16x16x32_bf16 v[116:119], a[100:103], v[36:39], v[116:119]
    ds_read_b64_tr_b16 v[26:27], v8 offset:49664
    v_mfma_f32_16x16x32_bf16 v[116:119], a[104:107], v[40:43], v[116:119]
    ds_read_b64_tr_b16 v[28:29], v8 offset:53248
    v_mfma_f32_16x16x32_bf16 v[116:119], a[108:111], v[44:47], v[116:119]
    ds_read_b64_tr_b16 v[30:31], v8 offset:53760
    v_mfma_f32_16x16x32_bf16 v[120:123], a[160:163], v[32:35], v[120:123]
    buffer_load_dwordx4 a[220:223], v7, s[8:11], s70 offen offset:3072 sc1
    v_mfma_f32_16x16x32_bf16 v[120:123], a[164:167], v[36:39], v[120:123]
    v_mfma_f32_16x16x32_bf16 v[120:123], a[168:171], v[40:43], v[120:123]
    v_mfma_f32_16x16x32_bf16 v[120:123], a[172:175], v[44:47], v[120:123]
    v_mfma_f32_16x16x32_bf16 v[124:127], a[224:227], v[32:35], v[124:127]
    v_mfma_f32_16x16x32_bf16 v[124:127], a[228:231], v[36:39], v[124:127]
    v_mfma_f32_16x16x32_bf16 v[124:127], a[232:235], v[40:43], v[124:127]
    v_mfma_f32_16x16x32_bf16 v[124:127], a[236:239], v[44:47], v[124:127]
    s_waitcnt lgkmcnt(0)
    v_mfma_f32_16x16x32_bf16 v[64:67], a[48:51], v[16:19], v[64:67]
    ds_read_b64_tr_b16 v[32:33], v9 offset:32768
    v_mfma_f32_16x16x32_bf16 v[64:67], a[52:55], v[20:23], v[64:67]
    ds_read_b64_tr_b16 v[34:35], v9 offset:33280
    s_add_u32 s70, s3, 8192
    v_mfma_f32_16x16x32_bf16 v[64:67], a[56:59], v[24:27], v[64:67]
    ds_read_b64_tr_b16 v[36:37], v9 offset:36864
    buffer_load_dwordx4 a[32:35], v7, s[8:11], s70 offen offset:0 sc1
    v_mfma_f32_16x16x32_bf16 v[64:67], a[60:63], v[28:31], v[64:67]
    ds_read_b64_tr_b16 v[38:39], v9 offset:37376
    v_mfma_f32_16x16x32_bf16 v[68:71], a[112:115], v[16:19], v[68:71]
    ds_read_b64_tr_b16 v[40:41], v9 offset:49152
    buffer_load_dwordx4 a[36:39], v7, s[8:11], s70 offen offset:1024 sc1
    v_mfma_f32_16x16x32_bf16 v[68:71], a[116:119], v[20:23], v[68:71]
    ds_read_b64_tr_b16 v[42:43], v9 offset:49664
    v_mfma_f32_16x16x32_bf16 v[68:71], a[120:123], v[24:27], v[68:71]
    ds_read_b64_tr_b16 v[44:45], v9 offset:53248
    v_mfma_f32_16x16x32_bf16 v[68:71], a[124:127], v[28:31], v[68:71]
    ds_read_b64_tr_b16 v[46:47], v9 offset:53760
    v_mfma_f32_16x16x32_bf16 v[72:75], a[176:179], v[16:19], v[72:75]
    buffer_load_dwordx4 a[40:43], v7, s[8:11], s70 offen offset:2048 sc1
    v_mfma_f32_16x16x32_bf16 v[72:75], a[180:183], v[20:23], v[72:75]
    v_mfma_f32_16x16x32_bf16 v[72:75], a[184:187], v[24:27], v[72:75]
    s_waitcnt vmcnt(36)
    v_lshlrev_b32 v176, 16, v178
    v_mfma_f32_16x16x32_bf16 v[72:75], a[188:191], v[28:31], v[72:75]
    v_and_b32 v177, 0xffff0000, v178
    v_lshlrev_b32 v178, 16, v179
    v_mfma_f32_16x16x32_bf16 v[76:79], a[240:243], v[16:19], v[76:79]
    buffer_load_dwordx4 a[44:47], v7, s[8:11], s70 offen offset:3072 sc1
    v_and_b32 v179, 0xffff0000, v179
    v_mfma_f32_16x16x32_bf16 v[76:79], a[244:247], v[20:23], v[76:79]
    v_lshlrev_b32 v180, 16, v182
    v_and_b32 v181, 0xffff0000, v182
    v_mfma_f32_16x16x32_bf16 v[76:79], a[248:251], v[24:27], v[76:79]
    s_add_u32 s70, s3, 24576
    v_lshlrev_b32 v182, 16, v183
    v_mfma_f32_16x16x32_bf16 v[76:79], a[252:255], v[28:31], v[76:79]
    s_waitcnt lgkmcnt(0)
    buffer_load_dwordx4 a[96:99], v7, s[8:11], s70 offen offset:0 sc1
    v_mfma_f32_16x16x32_bf16 v[80:83], a[48:51], v[32:35], v[80:83]
    ds_read_b64_tr_b16 v[16:17], v10 offset:32768
    v_and_b32 v183, 0xffff0000, v183
    v_mfma_f32_16x16x32_bf16 v[80:83], a[52:55], v[36:39], v[80:83]
    ds_read_b64_tr_b16 v[18:19], v10 offset:33280
    v_lshlrev_b32 v184, 16, v186
    v_mfma_f32_16x16x32_bf16 v[80:83], a[56:59], v[40:43], v[80:83]
    ds_read_b64_tr_b16 v[20:21], v10 offset:36864
    v_and_b32 v185, 0xffff0000, v186
    v_mfma_f32_16x16x32_bf16 v[80:83], a[60:63], v[44:47], v[80:83]
    ds_read_b64_tr_b16 v[22:23], v10 offset:37376
    buffer_load_dwordx4 a[100:103], v7, s[8:11], s70 offen offset:1024 sc1
    v_mfma_f32_16x16x32_bf16 v[84:87], a[112:115], v[32:35], v[84:87]
    ds_read_b64_tr_b16 v[24:25], v10 offset:49152
    v_lshlrev_b32 v186, 16, v187
    v_mfma_f32_16x16x32_bf16 v[84:87], a[116:119], v[36:39], v[84:87]
    ds_read_b64_tr_b16 v[26:27], v10 offset:49664
    v_and_b32 v187, 0xffff0000, v187
    v_mfma_f32_16x16x32_bf16 v[84:87], a[120:123], v[40:43], v[84:87]
    ds_read_b64_tr_b16 v[28:29], v10 offset:53248
    v_lshlrev_b32 v188, 16, v190
    v_mfma_f32_16x16x32_bf16 v[84:87], a[124:127], v[44:47], v[84:87]
    ds_read_b64_tr_b16 v[30:31], v10 offset:53760
    buffer_load_dwordx4 a[104:107], v7, s[8:11], s70 offen offset:2048 sc1
    v_mfma_f32_16x16x32_bf16 v[88:91], a[176:179], v[32:35], v[88:91]
    v_and_b32 v189, 0xffff0000, v190
    v_lshlrev_b32 v190, 16, v191
    v_mfma_f32_16x16x32_bf16 v[88:91], a[180:183], v[36:39], v[88:91]
    v_and_b32 v191, 0xffff0000, v191
    v_mfma_f32_16x16x32_bf16 v[88:91], a[184:187], v[40:43], v[88:91]
    buffer_load_dwordx4 a[108:111], v7, s[8:11], s70 offen offset:3072 sc1
    v_mfma_f32_16x16x32_bf16 v[88:91], a[188:191], v[44:47], v[88:91]
    v_mfma_f32_16x16x32_bf16 v[92:95], a[240:243], v[32:35], v[92:95]
    v_mfma_f32_16x16x32_bf16 v[92:95], a[244:247], v[36:39], v[92:95]
    s_add_u32 s70, s3, 40960
    v_mfma_f32_16x16x32_bf16 v[92:95], a[248:251], v[40:43], v[92:95]
    buffer_load_dwordx4 a[160:163], v7, s[8:11], s70 offen offset:0 sc1
    v_mfma_f32_16x16x32_bf16 v[92:95], a[252:255], v[44:47], v[92:95]
    s_waitcnt lgkmcnt(0)
    v_mfma_f32_16x16x32_bf16 v[96:99], a[48:51], v[16:19], v[96:99]
    ds_read_b64_tr_b16 v[32:33], v11 offset:32768
    v_mfma_f32_16x16x32_bf16 v[96:99], a[52:55], v[20:23], v[96:99]
    ds_read_b64_tr_b16 v[34:35], v11 offset:33280
    v_mfma_f32_16x16x32_bf16 v[96:99], a[56:59], v[24:27], v[96:99]
    ds_read_b64_tr_b16 v[36:37], v11 offset:36864
    buffer_load_dwordx4 a[164:167], v7, s[8:11], s70 offen offset:1024 sc1
    v_mfma_f32_16x16x32_bf16 v[96:99], a[60:63], v[28:31], v[96:99]
    ds_read_b64_tr_b16 v[38:39], v11 offset:37376
    v_mfma_f32_16x16x32_bf16 v[100:103], a[112:115], v[16:19], v[100:103]
    ds_read_b64_tr_b16 v[40:41], v11 offset:49152
    v_mfma_f32_16x16x32_bf16 v[100:103], a[116:119], v[20:23], v[100:103]
    ds_read_b64_tr_b16 v[42:43], v11 offset:49664
    buffer_load_dwordx4 a[168:171], v7, s[8:11], s70 offen offset:2048 sc1
    v_mfma_f32_16x16x32_bf16 v[100:103], a[120:123], v[24:27], v[100:103]
    ds_read_b64_tr_b16 v[44:45], v11 offset:53248
    v_mfma_f32_16x16x32_bf16 v[100:103], a[124:127], v[28:31], v[100:103]
    ds_read_b64_tr_b16 v[46:47], v11 offset:53760
    v_mfma_f32_16x16x32_bf16 v[104:107], a[176:179], v[16:19], v[104:107]
    v_mfma_f32_16x16x32_bf16 v[104:107], a[180:183], v[20:23], v[104:107]
    buffer_load_dwordx4 a[172:175], v7, s[8:11], s70 offen offset:3072 sc1
    v_mfma_f32_16x16x32_bf16 v[104:107], a[184:187], v[24:27], v[104:107]
    v_mfma_f32_16x16x32_bf16 v[104:107], a[188:191], v[28:31], v[104:107]
    v_mfma_f32_16x16x32_bf16 v[108:111], a[240:243], v[16:19], v[108:111]
    s_add_u32 s70, s3, 57344
    v_mfma_f32_16x16x32_bf16 v[108:111], a[244:247], v[20:23], v[108:111]
    buffer_load_dwordx4 a[224:227], v7, s[8:11], s70 offen offset:0 sc1
    v_mfma_f32_16x16x32_bf16 v[108:111], a[248:251], v[24:27], v[108:111]
    v_mfma_f32_16x16x32_bf16 v[108:111], a[252:255], v[28:31], v[108:111]
    s_waitcnt vmcnt(63) lgkmcnt(0)
    s_barrier
    v_mfma_f32_16x16x32_bf16 v[112:115], a[48:51], v[32:35], v[112:115]
    v_xor_b32 v8, 0x10000, v8
    buffer_load_dwordx4 a[228:231], v7, s[8:11], s70 offen offset:1024 sc1
    v_mfma_f32_16x16x32_bf16 v[112:115], a[52:55], v[36:39], v[112:115]
    ds_read_b64_tr_b16 v[16:17], v8 offset:40960
    v_mfma_f32_16x16x32_bf16 v[112:115], a[56:59], v[40:43], v[112:115]
    ds_read_b64_tr_b16 v[18:19], v8 offset:41472
    v_mfma_f32_16x16x32_bf16 v[112:115], a[60:63], v[44:47], v[112:115]
    ds_read_b64_tr_b16 v[20:21], v8 offset:45056
    v_mfma_f32_16x16x32_bf16 v[116:119], a[112:115], v[32:35], v[116:119]
    ds_read_b64_tr_b16 v[22:23], v8 offset:45568
    buffer_load_dwordx4 a[232:235], v7, s[8:11], s70 offen offset:2048 sc1
    v_mfma_f32_16x16x32_bf16 v[116:119], a[116:119], v[36:39], v[116:119]
    ds_read_b64_tr_b16 v[24:25], v8 offset:57344
    v_mfma_f32_16x16x32_bf16 v[116:119], a[120:123], v[40:43], v[116:119]
    ds_read_b64_tr_b16 v[26:27], v8 offset:57856
    v_mfma_f32_16x16x32_bf16 v[116:119], a[124:127], v[44:47], v[116:119]
    ds_read_b64_tr_b16 v[28:29], v8 offset:61440
    v_mfma_f32_16x16x32_bf16 v[120:123], a[176:179], v[32:35], v[120:123]
    ds_read_b64_tr_b16 v[30:31], v8 offset:61952
    buffer_load_dwordx4 a[236:239], v7, s[8:11], s70 offen offset:3072 sc1
    v_mfma_f32_16x16x32_bf16 v[120:123], a[180:183], v[36:39], v[120:123]
    v_mfma_f32_16x16x32_bf16 v[120:123], a[184:187], v[40:43], v[120:123]
    v_mfma_f32_16x16x32_bf16 v[120:123], a[188:191], v[44:47], v[120:123]
    v_mfma_f32_16x16x32_bf16 v[124:127], a[240:243], v[32:35], v[124:127]
    v_mfma_f32_16x16x32_bf16 v[124:127], a[244:247], v[36:39], v[124:127]
    v_mfma_f32_16x16x32_bf16 v[124:127], a[248:251], v[40:43], v[124:127]
    v_mfma_f32_16x16x32_bf16 v[124:127], a[252:255], v[44:47], v[124:127]
    s_waitcnt vmcnt(32)
    s_waitcnt lgkmcnt(0)
    v_mfma_f32_16x16x32_bf16 v[128:131], v[16:19], a[0:3], v[176:179]
    v_xor_b32 v9, 0x10000, v9
    v_mfma_f32_16x16x32_bf16 v[128:131], v[20:23], a[4:7], v[128:131]
    ds_read_b64_tr_b16 v[32:33], v9 offset:40960
    s_add_u32 s70, s3, 12288
    v_mfma_f32_16x16x32_bf16 v[128:131], v[24:27], a[8:11], v[128:131]
    ds_read_b64_tr_b16 v[34:35], v9 offset:41472
    buffer_load_dwordx4 a[48:51], v7, s[8:11], s70 offen offset:0 sc1
    v_mfma_f32_16x16x32_bf16 v[128:131], v[28:31], a[12:15], v[128:131]
    ds_read_b64_tr_b16 v[36:37], v9 offset:45056
    v_mfma_f32_16x16x32_bf16 v[132:135], v[16:19], a[64:67], v[176:179]
    ds_read_b64_tr_b16 v[38:39], v9 offset:45568
    buffer_load_dwordx4 a[52:55], v7, s[8:11], s70 offen offset:1024 sc1
    v_mfma_f32_16x16x32_bf16 v[132:135], v[20:23], a[68:71], v[132:135]
    ds_read_b64_tr_b16 v[40:41], v9 offset:57344
    v_mfma_f32_16x16x32_bf16 v[132:135], v[24:27], a[72:75], v[132:135]
    ds_read_b64_tr_b16 v[42:43], v9 offset:57856
    v_mfma_f32_16x16x32_bf16 v[132:135], v[28:31], a[76:79], v[132:135]
    ds_read_b64_tr_b16 v[44:45], v9 offset:61440
    v_mfma_f32_16x16x32_bf16 v[136:139], v[16:19], a[128:131], v[176:179]
    v_xor_b32 v11, 0x10000, v11
    ds_read_b64_tr_b16 v[46:47], v9 offset:61952
    v_mfma_f32_16x16x32_bf16 v[136:139], v[20:23], a[132:135], v[136:139]
    ds_read_b64_tr_b16 v[192:193], v11 offset:40960
    buffer_load_dwordx4 a[56:59], v7, s[8:11], s70 offen offset:2048 sc1
    v_mfma_f32_16x16x32_bf16 v[136:139], v[24:27], a[136:139], v[136:139]
    ds_read_b64_tr_b16 v[194:195], v11 offset:41472
    v_mfma_f32_16x16x32_bf16 v[136:139], v[28:31], a[140:143], v[136:139]
    ds_read_b64_tr_b16 v[196:197], v11 offset:45056
    buffer_load_dwordx4 a[60:63], v7, s[8:11], s70 offen offset:3072 sc1
    v_mfma_f32_16x16x32_bf16 v[140:143], v[16:19], a[192:195], v[176:179]
    ds_read_b64_tr_b16 v[198:199], v11 offset:45568
    v_mfma_f32_16x16x32_bf16 v[140:143], v[20:23], a[196:199], v[140:143]
    ds_read_b64_tr_b16 v[200:201], v11 offset:57344
    v_mfma_f32_16x16x32_bf16 v[140:143], v[24:27], a[200:203], v[140:143]
    ds_read_b64_tr_b16 v[202:203], v11 offset:57856
    s_add_u32 s70, s3, 28672
    v_mfma_f32_16x16x32_bf16 v[140:143], v[28:31], a[204:207], v[140:143]
    ds_read_b64_tr_b16 v[204:205], v11 offset:61440
    ds_read_b64_tr_b16 v[206:207], v11 offset:61952
    s_waitcnt lgkmcnt(8)
    v_mfma_f32_16x16x32_bf16 v[144:147], v[32:35], a[0:3], v[180:183]
    v_xor_b32 v10, 0x10000, v10
    buffer_load_dwordx4 a[112:115], v7, s[8:11], s70 offen offset:0 sc1
    v_mfma_f32_16x16x32_bf16 v[144:147], v[36:39], a[4:7], v[144:147]
    ds_read_b64_tr_b16 v[16:17], v10 offset:40960
    v_mfma_f32_16x16x32_bf16 v[144:147], v[40:43], a[8:11], v[144:147]
    ds_read_b64_tr_b16 v[18:19], v10 offset:41472
    buffer_load_dwordx4 a[116:119], v7, s[8:11], s70 offen offset:1024 sc1
    v_mfma_f32_16x16x32_bf16 v[144:147], v[44:47], a[12:15], v[144:147]
    ds_read_b64_tr_b16 v[20:21], v10 offset:45056
    v_mfma_f32_16x16x32_bf16 v[148:151], v[32:35], a[64:67], v[180:183]
    ds_read_b64_tr_b16 v[22:23], v10 offset:45568
    v_mfma_f32_16x16x32_bf16 v[148:151], v[36:39], a[68:71], v[148:151]
    ds_read_b64_tr_b16 v[24:25], v10 offset:57344
    v_mfma_f32_16x16x32_bf16 v[148:151], v[40:43], a[72:75], v[148:151]
    ds_read_b64_tr_b16 v[26:27], v10 offset:57856
    buffer_load_dwordx4 a[120:123], v7, s[8:11], s70 offen offset:2048 sc1
    v_mfma_f32_16x16x32_bf16 v[148:151], v[44:47], a[76:79], v[148:151]
    ds_read_b64_tr_b16 v[28:29], v10 offset:61440
    v_mfma_f32_16x16x32_bf16 v[152:155], v[32:35], a[128:131], v[180:183]
    ds_read_b64_tr_b16 v[30:31], v10 offset:61952
    v_mfma_f32_16x16x32_bf16 v[152:155], v[36:39], a[132:135], v[152:155]
    v_mfma_f32_16x16x32_bf16 v[152:155], v[40:43], a[136:139], v[152:155]
    buffer_load_dwordx4 a[124:127], v7, s[8:11], s70 offen offset:3072 sc1
    v_mfma_f32_16x16x32_bf16 v[152:155], v[44:47], a[140:143], v[152:155]
    v_mfma_f32_16x16x32_bf16 v[156:159], v[32:35], a[192:195], v[180:183]
    s_add_u32 s70, s3, 45056
    v_mfma_f32_16x16x32_bf16 v[156:159], v[36:39], a[196:199], v[156:159]
    buffer_load_dwordx4 a[176:179], v7, s[8:11], s70 offen offset:0 sc1
    v_mfma_f32_16x16x32_bf16 v[156:159], v[40:43], a[200:203], v[156:159]
    v_mfma_f32_16x16x32_bf16 v[156:159], v[44:47], a[204:207], v[156:159]
    s_waitcnt vmcnt(63) lgkmcnt(0)
    s_barrier
    s_bitcmp1_b32 s41, 0
    s_cbranch_scc1 mg_hp_3
    v_mfma_f32_16x16x32_bf16 v[160:163], v[16:19], a[0:3], v[184:187]
    v_xor_b32 v8, 0x10000, v8
    v_mfma_f32_16x16x32_bf16 v[160:163], v[20:23], a[4:7], v[160:163]
    ds_read_b64_tr_b16 v[32:33], v8 offset:8192
    buffer_load_dwordx4 a[180:183], v7, s[8:11], s70 offen offset:1024 sc1
    v_mfma_f32_16x16x32_bf16 v[160:163], v[24:27], a[8:11], v[160:163]
    ds_read_b64_tr_b16 v[34:35], v8 offset:8704
    v_mfma_f32_16x16x32_bf16 v[160:163], v[28:31], a[12:15], v[160:163]
    ds_read_b64_tr_b16 v[36:37], v8 offset:12288
    v_mfma_f32_16x16x32_bf16 v[164:167], v[16:19], a[64:67], v[184:187]
    ds_read_b64_tr_b16 v[38:39], v8 offset:12800
    buffer_load_dwordx4 a[184:187], v7, s[8:11], s70 offen offset:2048 sc1
    v_mfma_f32_16x16x32_bf16 v[164:167], v[20:23], a[68:71], v[164:167]
    ds_read_b64_tr_b16 v[40:41], v8 offset:24576
    v_mfma_f32_16x16x32_bf16 v[164:167], v[24:27], a[72:75], v[164:167]
    ds_read_b64_tr_b16 v[42:43], v8 offset:25088
    v_mfma_f32_16x16x32_bf16 v[164:167], v[28:31], a[76:79], v[164:167]
    ds_read_b64_tr_b16 v[44:45], v8 offset:28672
    v_mfma_f32_16x16x32_bf16 v[168:171], v[192:195], a[0:3], v[188:191]
    ds_read_b64_tr_b16 v[46:47], v8 offset:29184
    buffer_load_dwordx4 a[188:191], v7, s[8:11], s70 offen offset:3072 sc1
    v_mfma_f32_16x16x32_bf16 v[168:171], v[196:199], a[4:7], v[168:171]
    v_mfma_f32_16x16x32_bf16 v[168:171], v[200:203], a[8:11], v[168:171]
    v_mfma_f32_16x16x32_bf16 v[168:171], v[204:207], a[12:15], v[168:171]
    v_mfma_f32_16x16x32_bf16 v[172:175], v[192:195], a[64:67], v[188:191]
    v_mfma_f32_16x16x32_bf16 v[172:175], v[196:199], a[68:71], v[172:175]
    v_mfma_f32_16x16x32_bf16 v[172:175], v[200:203], a[72:75], v[172:175]
    v_mfma_f32_16x16x32_bf16 v[172:175], v[204:207], a[76:79], v[172:175]
    s_branch mg_hp_4
mg_hp_3:
    v_mfma_f32_16x16x32_bf16 v[160:163], v[16:19], a[128:131], v[184:187]
    v_xor_b32 v8, 0x10000, v8
    v_mfma_f32_16x16x32_bf16 v[160:163], v[20:23], a[132:135], v[160:163]
    ds_read_b64_tr_b16 v[32:33], v8 offset:8192
    buffer_load_dwordx4 a[180:183], v7, s[8:11], s70 offen offset:1024 sc1
    v_mfma_f32_16x16x32_bf16 v[160:163], v[24:27], a[136:139], v[160:163]
    ds_read_b64_tr_b16 v[34:35], v8 offset:8704
    v_mfma_f32_16x16x32_bf16 v[160:163], v[28:31], a[140:143], v[160:163]
    ds_read_b64_tr_b16 v[36:37], v8 offset:12288
    v_mfma_f32_16x16x32_bf16 v[164:167], v[16:19], a[192:195], v[184:187]
    ds_read_b64_tr_b16 v[38:39], v8 offset:12800
    buffer_load_dwordx4 a[184:187], v7, s[8:11], s70 offen offset:2048 sc1
    v_mfma_f32_16x16x32_bf16 v[164:167], v[20:23], a[196:199], v[164:167]
    ds_read_b64_tr_b16 v[40:41], v8 offset:24576
    v_mfma_f32_16x16x32_bf16 v[164:167], v[24:27], a[200:203], v[164:167]
    ds_read_b64_tr_b16 v[42:43], v8 offset:25088
    v_mfma_f32_16x16x32_bf16 v[164:167], v[28:31], a[204:207], v[164:167]
    ds_read_b64_tr_b16 v[44:45], v8 offset:28672
    v_mfma_f32_16x16x32_bf16 v[168:171], v[192:195], a[128:131], v[188:191]
    ds_read_b64_tr_b16 v[46:47], v8 offset:29184
    buffer_load_dwordx4 a[188:191], v7, s[8:11], s70 offen offset:3072 sc1
    v_mfma_f32_16x16x32_bf16 v[168:171], v[196:199], a[132:135], v[168:171]
    v_mfma_f32_16x16x32_bf16 v[168:171], v[200:203], a[136:139], v[168:171]
    v_mfma_f32_16x16x32_bf16 v[168:171], v[204:207], a[140:143], v[168:171]
    v_mfma_f32_16x16x32_bf16 v[172:175], v[192:195], a[192:195], v[188:191]
    v_mfma_f32_16x16x32_bf16 v[172:175], v[196:199], a[196:199], v[172:175]
    v_mfma_f32_16x16x32_bf16 v[172:175], v[200:203], a[200:203], v[172:175]
    v_mfma_f32_16x16x32_bf16 v[172:175], v[204:207], a[204:207], v[172:175]
mg_hp_4:
    s_waitcnt vmcnt(28)
    s_waitcnt lgkmcnt(0)
    v_mfma_f32_16x16x32_bf16 v[128:131], v[32:35], a[16:19], v[128:131]
    v_xor_b32 v9, 0x10000, v9
    v_mfma_f32_16x16x32_bf16 v[128:131], v[36:39], a[20:23], v[128:131]
    ds_read_b64_tr_b16 v[16:17], v9 offset:8192
    s_add_u32 s69, s4, 0
    v_mfma_f32_16x16x32_bf16 v[128:131], v[40:43], a[24:27], v[128:131]
    ds_read_b64_tr_b16 v[18:19], v9 offset:8704
    s_add_u32 m0, s6, 0
    v_mfma_f32_16x16x32_bf16 v[128:131], v[44:47], a[28:31], v[128:131]
    ds_read_b64_tr_b16 v[20:21], v9 offset:12288
    buffer_load_dwordx4 v48, s[12:15], s69 offen lds
    v_mfma_f32_16x16x32_bf16 v[132:135], v[32:35], a[80:83], v[132:135]
    ds_read_b64_tr_b16 v[22:23], v9 offset:12800
    s_add_u32 m0, s6, 1024
    v_mfma_f32_16x16x32_bf16 v[132:135], v[36:39], a[84:87], v[132:135]
    ds_read_b64_tr_b16 v[24:25], v9 offset:24576
    buffer_load_dwordx4 v49, s[12:15], s69 offen lds
    v_mfma_f32_16x16x32_bf16 v[132:135], v[40:43], a[88:91], v[132:135]
    ds_read_b64_tr_b16 v[26:27], v9 offset:25088
    v_mfma_f32_16x16x32_bf16 v[132:135], v[44:47], a[92:95], v[132:135]
    ds_read_b64_tr_b16 v[28:29], v9 offset:28672
    s_add_u32 m0, s6, 2048
    v_mfma_f32_16x16x32_bf16 v[136:139], v[32:35], a[144:147], v[136:139]
    v_xor_b32 v11, 0x10000, v11
    ds_read_b64_tr_b16 v[30:31], v9 offset:29184
    v_mfma_f32_16x16x32_bf16 v[136:139], v[36:39], a[148:151], v[136:139]
    ds_read_b64_tr_b16 v[192:193], v11 offset:8192
    buffer_load_dwordx4 v50, s[12:15], s69 offen lds
    v_mfma_f32_16x16x32_bf16 v[136:139], v[40:43], a[152:155], v[136:139]
    ds_read_b64_tr_b16 v[194:195], v11 offset:8704
    s_add_u32 m0, s6, 3072
    v_mfma_f32_16x16x32_bf16 v[136:139], v[44:47], a[156:159], v[136:139]
    ds_read_b64_tr_b16 v[196:197], v11 offset:12288
    buffer_load_dwordx4 v51, s[12:15], s69 offen lds
    v_mfma_f32_16x16x32_bf16 v[140:143], v[32:35], a[208:211], v[140:143]
    ds_read_b64_tr_b16 v[198:199], v11 offset:12800
    v_mfma_f32_16x16x32_bf16 v[140:143], v[36:39], a[212:215], v[140:143]
    ds_read_b64_tr_b16 v[200:201], v11 offset:24576
    v_mfma_f32_16x16x32_bf16 v[140:143], v[40:43], a[216:219], v[140:143]
    ds_read_b64_tr_b16 v[202:203], v11 offset:25088
    s_add_u32 s69, s4, 1048576
    v_mfma_f32_16x16x32_bf16 v[140:143], v[44:47], a[220:223], v[140:143]
    ds_read_b64_tr_b16 v[204:205], v11 offset:28672
    ds_read_b64_tr_b16 v[206:207], v11 offset:29184
    s_waitcnt lgkmcnt(8)
    v_mfma_f32_16x16x32_bf16 v[144:147], v[16:19], a[16:19], v[144:147]
    v_xor_b32 v10, 0x10000, v10
    s_add_u32 m0, s6, 32768
    v_mfma_f32_16x16x32_bf16 v[144:147], v[20:23], a[20:23], v[144:147]
    ds_read_b64_tr_b16 v[32:33], v10 offset:8192
    buffer_load_dwordx4 v48, s[12:15], s69 offen lds
    v_mfma_f32_16x16x32_bf16 v[144:147], v[24:27], a[24:27], v[144:147]
    ds_read_b64_tr_b16 v[34:35], v10 offset:8704
    s_add_u32 m0, s6, 33792
    v_mfma_f32_16x16x32_bf16 v[144:147], v[28:31], a[28:31], v[144:147]
    ds_read_b64_tr_b16 v[36:37], v10 offset:12288
    buffer_load_dwordx4 v49, s[12:15], s69 offen lds
    v_mfma_f32_16x16x32_bf16 v[148:151], v[16:19], a[80:83], v[148:151]
    ds_read_b64_tr_b16 v[38:39], v10 offset:12800
    v_mfma_f32_16x16x32_bf16 v[148:151], v[20:23], a[84:87], v[148:151]
    ds_read_b64_tr_b16 v[40:41], v10 offset:24576
    s_add_u32 m0, s6, 34816
    v_mfma_f32_16x16x32_bf16 v[148:151], v[24:27], a[88:91], v[148:151]
    ds_read_b64_tr_b16 v[42:43], v10 offset:25088
    buffer_load_dwordx4 v50, s[12:15], s69 offen lds
    v_mfma_f32_16x16x32_bf16 v[148:151], v[28:31], a[92:95], v[148:151]
    ds_read_b64_tr_b16 v[44:45], v10 offset:28672
    v_mfma_f32_16x16x32_bf16 v[152:155], v[16:19], a[144:147], v[152:155]
    ds_read_b64_tr_b16 v[46:47], v10 offset:29184
    v_mfma_f32_16x16x32_bf16 v[152:155], v[20:23], a[148:151], v[152:155]
    s_add_u32 m0, s6, 35840
    v_mfma_f32_16x16x32_bf16 v[152:155], v[24:27], a[152:155], v[152:155]
    buffer_load_dwordx4 v51, s[12:15], s69 offen lds
    v_mfma_f32_16x16x32_bf16 v[152:155], v[28:31], a[156:159], v[152:155]
    v_mfma_f32_16x16x32_bf16 v[156:159], v[16:19], a[208:211], v[156:159]
    s_add_u32 s70, s3, 61440
    v_mfma_f32_16x16x32_bf16 v[156:159], v[20:23], a[212:215], v[156:159]
    buffer_load_dwordx4 a[240:243], v7, s[8:11], s70 offen offset:0 sc1
    v_mfma_f32_16x16x32_bf16 v[156:159], v[24:27], a[216:219], v[156:159]
    v_mfma_f32_16x16x32_bf16 v[156:159], v[28:31], a[220:223], v[156:159]
    s_waitcnt vmcnt(63) lgkmcnt(0)
    s_barrier
    s_bitcmp1_b32 s41, 0
    s_cbranch_scc1 mg_hp_5
    v_mfma_f32_16x16x32_bf16 v[160:163], v[32:35], a[16:19], v[160:163]
    ds_read_b64_tr_b16 v[16:17], v8 offset:40960
    v_mfma_f32_16x16x32_bf16 v[160:163], v[36:39], a[20:23], v[160:163]
    ds_read_b64_tr_b16 v[18:19], v8 offset:41472
    buffer_load_dwordx4 a[244:247], v7, s[8:11], s70 offen offset:1024 sc1
    v_mfma_f32_16x16x32_bf16 v[160:163], v[40:43], a[24:27], v[160:163]
    ds_read_b64_tr_b16 v[20:21], v8 offset:45056
    v_mfma_f32_16x16x32_bf16 v[160:163], v[44:47], a[28:31], v[160:163]
    ds_read_b64_tr_b16 v[22:23], v8 offset:45568
    v_mfma_f32_16x16x32_bf16 v[164:167], v[32:35], a[80:83], v[164:167]
    ds_read_b64_tr_b16 v[24:25], v8 offset:57344
    buffer_load_dwordx4 a[248:251], v7, s[8:11], s70 offen offset:2048 sc1
    v_mfma_f32_16x16x32_bf16 v[164:167], v[36:39], a[84:87], v[164:167]
    ds_read_b64_tr_b16 v[26:27], v8 offset:57856
    v_mfma_f32_16x16x32_bf16 v[164:167], v[40:43], a[88:91], v[164:167]
    ds_read_b64_tr_b16 v[28:29], v8 offset:61440
    v_mfma_f32_16x16x32_bf16 v[164:167], v[44:47], a[92:95], v[164:167]
    ds_read_b64_tr_b16 v[30:31], v8 offset:61952
    v_mfma_f32_16x16x32_bf16 v[168:171], v[192:195], a[16:19], v[168:171]
    buffer_load_dwordx4 a[252:255], v7, s[8:11], s70 offen offset:3072 sc1
    v_mfma_f32_16x16x32_bf16 v[168:171], v[196:199], a[20:23], v[168:171]
    v_mfma_f32_16x16x32_bf16 v[168:171], v[200:203], a[24:27], v[168:171]
    v_mfma_f32_16x16x32_bf16 v[168:171], v[204:207], a[28:31], v[168:171]
    v_mfma_f32_16x16x32_bf16 v[172:175], v[192:195], a[80:83], v[172:175]
    v_mfma_f32_16x16x32_bf16 v[172:175], v[196:199], a[84:87], v[172:175]
    v_mfma_f32_16x16x32_bf16 v[172:175], v[200:203], a[88:91], v[172:175]
    v_mfma_f32_16x16x32_bf16 v[172:175], v[204:207], a[92:95], v[172:175]
    s_branch mg_hp_6
mg_hp_5:
    v_mfma_f32_16x16x32_bf16 v[160:163], v[32:35], a[144:147], v[160:163]
    ds_read_b64_tr_b16 v[16:17], v8 offset:40960
    v_mfma_f32_16x16x32_bf16 v[160:163], v[36:39], a[148:151], v[160:163]
    ds_read_b64_tr_b16 v[18:19], v8 offset:41472
    buffer_load_dwordx4 a[244:247], v7, s[8:11], s70 offen offset:1024 sc1
    v_mfma_f32_16x16x32_bf16 v[160:163], v[40:43], a[152:155], v[160:163]
    ds_read_b64_tr_b16 v[20:21], v8 offset:45056
    v_mfma_f32_16x16x32_bf16 v[160:163], v[44:47], a[156:159], v[160:163]
    ds_read_b64_tr_b16 v[22:23], v8 offset:45568
    v_mfma_f32_16x16x32_bf16 v[164:167], v[32:35], a[208:211], v[164:167]
    ds_read_b64_tr_b16 v[24:25], v8 offset:57344
    buffer_load_dwordx4 a[248:251], v7, s[8:11], s70 offen offset:2048 sc1
    v_mfma_f32_16x16x32_bf16 v[164:167], v[36:39], a[212:215], v[164:167]
    ds_read_b64_tr_b16 v[26:27], v8 offset:57856
    v_mfma_f32_16x16x32_bf16 v[164:167], v[40:43], a[216:219], v[164:167]
    ds_read_b64_tr_b16 v[28:29], v8 offset:61440
    v_mfma_f32_16x16x32_bf16 v[164:167], v[44:47], a[220:223], v[164:167]
    ds_read_b64_tr_b16 v[30:31], v8 offset:61952
    v_mfma_f32_16x16x32_bf16 v[168:171], v[192:195], a[144:147], v[168:171]
    buffer_load_dwordx4 a[252:255], v7, s[8:11], s70 offen offset:3072 sc1
    v_mfma_f32_16x16x32_bf16 v[168:171], v[196:199], a[148:151], v[168:171]
    v_mfma_f32_16x16x32_bf16 v[168:171], v[200:203], a[152:155], v[168:171]
    v_mfma_f32_16x16x32_bf16 v[168:171], v[204:207], a[156:159], v[168:171]
    v_mfma_f32_16x16x32_bf16 v[172:175], v[192:195], a[208:211], v[172:175]
    v_mfma_f32_16x16x32_bf16 v[172:175], v[196:199], a[212:215], v[172:175]
    v_mfma_f32_16x16x32_bf16 v[172:175], v[200:203], a[216:219], v[172:175]
    v_mfma_f32_16x16x32_bf16 v[172:175], v[204:207], a[220:223], v[172:175]
mg_hp_6:
    s_waitcnt vmcnt(24)
    s_waitcnt lgkmcnt(0)
    v_mfma_f32_16x16x32_bf16 v[128:131], v[16:19], a[32:35], v[128:131]
    ds_read_b64_tr_b16 v[32:33], v9 offset:40960
    buffer_store_dwordx4 v[208:211], v7, s[8:11], s52 offen offset:1024 sc1
    v_mfma_f32_16x16x32_bf16 v[128:131], v[20:23], a[36:39], v[128:131]
    ds_read_b64_tr_b16 v[34:35], v9 offset:41472
    s_add_u32 s69, s4, 2097152
    v_mfma_f32_16x16x32_bf16 v[128:131], v[24:27], a[40:43], v[128:131]
    ds_read_b64_tr_b16 v[36:37], v9 offset:45056
    s_add_u32 m0, s6, 65536
    v_mfma_f32_16x16x32_bf16 v[128:131], v[28:31], a[44:47], v[128:131]
    ds_read_b64_tr_b16 v[38:39], v9 offset:45568
    buffer_load_dwordx4 v48, s[12:15], s69 offen lds
    v_mfma_f32_16x16x32_bf16 v[132:135], v[16:19], a[96:99], v[132:135]
    ds_read_b64_tr_b16 v[40:41], v9 offset:57344
    s_add_u32 s52, s51, 8192
    v_mfma_f32_16x16x32_bf16 v[132:135], v[20:23], a[100:103], v[132:135]
    ds_read_b64_tr_b16 v[42:43], v9 offset:57856
    v_cvt_pk_bf16_f32 v216, v216, v217
    v_mfma_f32_16x16x32_bf16 v[132:135], v[24:27], a[104:107], v[132:135]
    ds_read_b64_tr_b16 v[44:45], v9 offset:61440
    v_cvt_pk_bf16_f32 v217, v218, v219
    v_mfma_f32_16x16x32_bf16 v[132:135], v[28:31], a[108:111], v[132:135]
    ds_read_b64_tr_b16 v[46:47], v9 offset:61952
    v_cvt_pk_bf16_f32 v218, v220, v221
    v_mfma_f32_16x16x32_bf16 v[136:139], v[16:19], a[160:163], v[136:139]
    ds_read_b64_tr_b16 v[192:193], v11 offset:40960
    v_cvt_pk_bf16_f32 v219, v222, v223
    v_mfma_f32_16x16x32_bf16 v[136:139], v[20:23], a[164:167], v[136:139]
    ds_read_b64_tr_b16 v[194:195], v11 offset:41472
    v_mfma_f32_16x16x32_bf16 v[136:139], v[24:27], a[168:171], v[136:139]
    ds_read_b64_tr_b16 v[196:197], v11 offset:45056
    s_add_u32 m0, s6, 66560
    v_mfma_f32_16x16x32_bf16 v[136:139], v[28:31], a[172:175], v[136:139]
    ds_read_b64_tr_b16 v[198:199], v11 offset:45568
    buffer_load_dwordx4 v49, s[12:15], s69 offen lds
    v_mfma_f32_16x16x32_bf16 v[140:143], v[16:19], a[224:227], v[140:143]
    ds_read_b64_tr_b16 v[200:201], v11 offset:57344
    v_mfma_f32_16x16x32_bf16 v[140:143], v[20:23], a[228:231], v[140:143]
    ds_read_b64_tr_b16 v[202:203], v11 offset:57856
    v_mfma_f32_16x16x32_bf16 v[140:143], v[24:27], a[232:235], v[140:143]
    ds_read_b64_tr_b16 v[204:205], v11 offset:61440
    v_mfma_f32_16x16x32_bf16 v[140:143], v[28:31], a[236:239], v[140:143]
    ds_read_b64_tr_b16 v[206:207], v11 offset:61952
    s_waitcnt lgkmcnt(8)
    v_mfma_f32_16x16x32_bf16 v[144:147], v[32:35], a[32:35], v[144:147]
    ds_read_b64_tr_b16 v[16:17], v10 offset:40960
    buffer_store_dwordx4 v[216:219], v7, s[8:11], s52 offen offset:1024 sc1
    v_mfma_f32_16x16x32_bf16 v[144:147], v[36:39], a[36:39], v[144:147]
    ds_read_b64_tr_b16 v[18:19], v10 offset:41472
    s_add_u32 s52, s51, 0
    v_mfma_f32_16x16x32_bf16 v[144:147], v[40:43], a[40:43], v[144:147]
    ds_read_b64_tr_b16 v[20:21], v10 offset:45056
    v_cvt_pk_bf16_f32 v224, v224, v225
    v_mfma_f32_16x16x32_bf16 v[144:147], v[44:47], a[44:47], v[144:147]
    ds_read_b64_tr_b16 v[22:23], v10 offset:45568
    v_cvt_pk_bf16_f32 v225, v226, v227
    v_mfma_f32_16x16x32_bf16 v[148:151], v[32:35], a[96:99], v[148:151]
    ds_read_b64_tr_b16 v[24:25], v10 offset:57344
    v_cvt_pk_bf16_f32 v226, v228, v229
    v_mfma_f32_16x16x32_bf16 v[148:151], v[36:39], a[100:103], v[148:151]
    ds_read_b64_tr_b16 v[26:27], v10 offset:57856
    s_add_u32 m0, s6, 67584
    v_mfma_f32_16x16x32_bf16 v[148:151], v[40:43], a[104:107], v[148:151]
    ds_read_b64_tr_b16 v[28:29], v10 offset:61440
    buffer_load_dwordx4 v50, s[12:15], s69 offen lds
    v_mfma_f32_16x16x32_bf16 v[148:151], v[44:47], a[108:111], v[148:151]
    ds_read_b64_tr_b16 v[30:31], v10 offset:61952
    v_cvt_pk_bf16_f32 v227, v230, v231
    v_mfma_f32_16x16x32_bf16 v[152:155], v[32:35], a[160:163], v[152:155]
    v_mfma_f32_16x16x32_bf16 v[152:155], v[36:39], a[164:167], v[152:155]
    v_mfma_f32_16x16x32_bf16 v[152:155], v[40:43], a[168:171], v[152:155]
    v_mfma_f32_16x16x32_bf16 v[152:155], v[44:47], a[172:175], v[152:155]
    v_mfma_f32_16x16x32_bf16 v[156:159], v[32:35], a[224:227], v[156:159]
    v_mfma_f32_16x16x32_bf16 v[156:159], v[36:39], a[228:231], v[156:159]
    v_mfma_f32_16x16x32_bf16 v[156:159], v[40:43], a[232:235], v[156:159]
    v_mfma_f32_16x16x32_bf16 v[156:159], v[44:47], a[236:239], v[156:159]
    s_waitcnt vmcnt(63) lgkmcnt(0)
    s_barrier
    s_bitcmp1_b32 s41, 0
    s_cbranch_scc1 mg_hp_7
    v_mfma_f32_16x16x32_bf16 v[160:163], v[16:19], a[32:35], v[160:163]
    v_xor_b32 v8, 0x10000, v8
    s_add_u32 m0, s6, 68608
    v_mfma_f32_16x16x32_bf16 v[160:163], v[20:23], a[36:39], v[160:163]
    ds_read_b64_tr_b16 v[32:33], v8 offset:8192
    buffer_load_dwordx4 v51, s[12:15], s69 offen lds
    v_mfma_f32_16x16x32_bf16 v[160:163], v[24:27], a[40:43], v[160:163]
    ds_read_b64_tr_b16 v[34:35], v8 offset:8704
    buffer_store_dwordx4 v[224:227], v7, s[8:11], s52 offen offset:2048 sc1
    v_mfma_f32_16x16x32_bf16 v[160:163], v[28:31], a[44:47], v[160:163]
    ds_read_b64_tr_b16 v[36:37], v8 offset:12288
    s_add_u32 s52, s51, 8192
    v_mfma_f32_16x16x32_bf16 v[164:167], v[16:19], a[96:99], v[164:167]
    ds_read_b64_tr_b16 v[38:39], v8 offset:12800
    v_cvt_pk_bf16_f32 v232, v232, v233
    v_mfma_f32_16x16x32_bf16 v[164:167], v[20:23], a[100:103], v[164:167]
    ds_read_b64_tr_b16 v[40:41], v8 offset:24576
    v_cvt_pk_bf16_f32 v233, v234, v235
    v_mfma_f32_16x16x32_bf16 v[164:167], v[24:27], a[104:107], v[164:167]
    ds_read_b64_tr_b16 v[42:43], v8 offset:25088
    v_cvt_pk_bf16_f32 v234, v236, v237
    v_mfma_f32_16x16x32_bf16 v[164:167], v[28:31], a[108:111], v[164:167]
    ds_read_b64_tr_b16 v[44:45], v8 offset:28672
    v_cvt_pk_bf16_f32 v235, v238, v239
    v_mfma_f32_16x16x32_bf16 v[168:171], v[192:195], a[32:35], v[168:171]
    ds_read_b64_tr_b16 v[46:47], v8 offset:29184
    v_mfma_f32_16x16x32_bf16 v[168:171], v[196:199], a[36:39], v[168:171]
    v_mfma_f32_16x16x32_bf16 v[168:171], v[200:203], a[40:43], v[168:171]
    v_mfma_f32_16x16x32_bf16 v[168:171], v[204:207], a[44:47], v[168:171]
    v_mfma_f32_16x16x32_bf16 v[172:175], v[192:195], a[96:99], v[172:175]
    v_mfma_f32_16x16x32_bf16 v[172:175], v[196:199], a[100:103], v[172:175]
    v_mfma_f32_16x16x32_bf16 v[172:175], v[200:203], a[104:107], v[172:175]
    v_mfma_f32_16x16x32_bf16 v[172:175], v[204:207], a[108:111], v[172:175]
    s_branch mg_hp_8
mg_hp_7:
    v_mfma_f32_16x16x32_bf16 v[160:163], v[16:19], a[160:163], v[160:163]
    v_xor_b32 v8, 0x10000, v8
    s_add_u32 m0, s6, 68608
    v_mfma_f32_16x16x32_bf16 v[160:163], v[20:23], a[164:167], v[160:163]
    ds_read_b64_tr_b16 v[32:33], v8 offset:8192
    buffer_load_dwordx4 v51, s[12:15], s69 offen lds
    v_mfma_f32_16x16x32_bf16 v[160:163], v[24:27], a[168:171], v[160:163]
    ds_read_b64_tr_b16 v[34:35], v8 offset:8704
    buffer_store_dwordx4 v[224:227], v7, s[8:11], s52 offen offset:2048 sc1
    v_mfma_f32_16x16x32_bf16 v[160:163], v[28:31], a[172:175], v[160:163]
    ds_read_b64_tr_b16 v[36:37], v8 offset:12288
    s_add_u32 s52, s51, 8192
    v_mfma_f32_16x16x32_bf16 v[164:167], v[16:19], a[224:227], v[164:167]
    ds_read_b64_tr_b16 v[38:39], v8 offset:12800
    v_cvt_pk_bf16_f32 v232, v232, v233
    v_mfma_f32_16x16x32_bf16 v[164:167], v[20:23], a[228:231], v[164:167]
    ds_read_b64_tr_b16 v[40:41], v8 offset:24576
    v_cvt_pk_bf16_f32 v233, v234, v235
    v_mfma_f32_16x16x32_bf16 v[164:167], v[24:27], a[232:235], v[164:167]
    ds_read_b64_tr_b16 v[42:43], v8 offset:25088
    v_cvt_pk_bf16_f32 v234, v236, v237
    v_mfma_f32_16x16x32_bf16 v[164:167], v[28:31], a[236:239], v[164:167]
    ds_read_b64_tr_b16 v[44:45], v8 offset:28672
    v_cvt_pk_bf16_f32 v235, v238, v239
    v_mfma_f32_16x16x32_bf16 v[168:171], v[192:195], a[160:163], v[168:171]
    ds_read_b64_tr_b16 v[46:47], v8 offset:29184
    v_mfma_f32_16x16x32_bf16 v[168:171], v[196:199], a[164:167], v[168:171]
    v_mfma_f32_16x16x32_bf16 v[168:171], v[200:203], a[168:171], v[168:171]
    v_mfma_f32_16x16x32_bf16 v[168:171], v[204:207], a[172:175], v[168:171]
    v_mfma_f32_16x16x32_bf16 v[172:175], v[192:195], a[224:227], v[172:175]
    v_mfma_f32_16x16x32_bf16 v[172:175], v[196:199], a[228:231], v[172:175]
    v_mfma_f32_16x16x32_bf16 v[172:175], v[200:203], a[232:235], v[172:175]
    v_mfma_f32_16x16x32_bf16 v[172:175], v[204:207], a[236:239], v[172:175]
mg_hp_8:
    s_waitcnt vmcnt(7)
    s_waitcnt lgkmcnt(0)
    v_mfma_f32_16x16x32_bf16 v[128:131], v[32:35], a[48:51], v[128:131]
    v_xor_b32 v9, 0x10000, v9
    v_mfma_f32_16x16x32_bf16 v[128:131], v[36:39], a[52:55], v[128:131]
    ds_read_b64_tr_b16 v[16:17], v9 offset:8192
    s_add_u32 s69, s4, 3145728
    v_mfma_f32_16x16x32_bf16 v[128:131], v[40:43], a[56:59], v[128:131]
    ds_read_b64_tr_b16 v[18:19], v9 offset:8704
    s_add_u32 m0, s6, 98304
    v_mfma_f32_16x16x32_bf16 v[128:131], v[44:47], a[60:63], v[128:131]
    ds_read_b64_tr_b16 v[20:21], v9 offset:12288
    buffer_load_dwordx4 v48, s[12:15], s69 offen lds
    v_mfma_f32_16x16x32_bf16 v[132:135], v[32:35], a[112:115], v[132:135]
    ds_read_b64_tr_b16 v[22:23], v9 offset:12800
    buffer_store_dwordx4 v[232:235], v7, s[8:11], s52 offen offset:2048 sc1
    v_mfma_f32_16x16x32_bf16 v[132:135], v[36:39], a[116:119], v[132:135]
    ds_read_b64_tr_b16 v[24:25], v9 offset:24576
    s_add_u32 s52, s51, 0
    v_mfma_f32_16x16x32_bf16 v[132:135], v[40:43], a[120:123], v[132:135]
    ds_read_b64_tr_b16 v[26:27], v9 offset:25088
    v_cvt_pk_bf16_f32 v240, v240, v241
    v_mfma_f32_16x16x32_bf16 v[132:135], v[44:47], a[124:127], v[132:135]
    ds_read_b64_tr_b16 v[28:29], v9 offset:28672
    v_cvt_pk_bf16_f32 v241, v242, v243
    v_mfma_f32_16x16x32_bf16 v[136:139], v[32:35], a[176:179], v[136:139]
    v_xor_b32 v11, 0x10000, v11
    ds_read_b64_tr_b16 v[30:31], v9 offset:29184
    v_mfma_f32_16x16x32_bf16 v[136:139], v[36:39], a[180:183], v[136:139]
    ds_read_b64_tr_b16 v[192:193], v11 offset:8192
    v_cvt_pk_bf16_f32 v242, v244, v245
    v_mfma_f32_16x16x32_bf16 v[136:139], v[40:43], a[184:187], v[136:139]
    ds_read_b64_tr_b16 v[194:195], v11 offset:8704
    s_add_u32 m0, s6, 99328
    v_mfma_f32_16x16x32_bf16 v[136:139], v[44:47], a[188:191], v[136:139]
    ds_read_b64_tr_b16 v[196:197], v11 offset:12288
    buffer_load_dwordx4 v49, s[12:15], s69 offen lds
    v_mfma_f32_16x16x32_bf16 v[140:143], v[32:35], a[240:243], v[140:143]
    ds_read_b64_tr_b16 v[198:199], v11 offset:12800
    v_cvt_pk_bf16_f32 v243, v246, v247
    v_mfma_f32_16x16x32_bf16 v[140:143], v[36:39], a[244:247], v[140:143]
    ds_read_b64_tr_b16 v[200:201], v11 offset:24576
    v_mfma_f32_16x16x32_bf16 v[140:143], v[40:43], a[248:251], v[140:143]
    ds_read_b64_tr_b16 v[202:203], v11 offset:25088
    v_mfma_f32_16x16x32_bf16 v[140:143], v[44:47], a[252:255], v[140:143]
    ds_read_b64_tr_b16 v[204:205], v11 offset:28672
    ds_read_b64_tr_b16 v[206:207], v11 offset:29184
    s_waitcnt lgkmcnt(8)
    v_mfma_f32_16x16x32_bf16 v[144:147], v[16:19], a[48:51], v[144:147]
    v_xor_b32 v10, 0x10000, v10
    v_mfma_f32_16x16x32_bf16 v[144:147], v[20:23], a[52:55], v[144:147]
    ds_read_b64_tr_b16 v[32:33], v10 offset:8192
    v_mfma_f32_16x16x32_bf16 v[144:147], v[24:27], a[56:59], v[144:147]
    ds_read_b64_tr_b16 v[34:35], v10 offset:8704
    v_mfma_f32_16x16x32_bf16 v[144:147], v[28:31], a[60:63], v[144:147]
    ds_read_b64_tr_b16 v[36:37], v10 offset:12288
    v_mfma_f32_16x16x32_bf16 v[148:151], v[16:19], a[112:115], v[148:151]
    ds_read_b64_tr_b16 v[38:39], v10 offset:12800
    buffer_store_dwordx4 v[240:243], v7, s[8:11], s52 offen offset:3072 sc1
    v_mfma_f32_16x16x32_bf16 v[148:151], v[20:23], a[116:119], v[148:151]
    ds_read_b64_tr_b16 v[40:41], v10 offset:24576
    s_add_u32 m0, s6, 100352
    v_mfma_f32_16x16x32_bf16 v[148:151], v[24:27], a[120:123], v[148:151]
    ds_read_b64_tr_b16 v[42:43], v10 offset:25088
    buffer_load_dwordx4 v50, s[12:15], s69 offen lds
    v_mfma_f32_16x16x32_bf16 v[148:151], v[28:31], a[124:127], v[148:151]
    ds_read_b64_tr_b16 v[44:45], v10 offset:28672
    s_add_u32 s52, s51, 8192
    v_mfma_f32_16x16x32_bf16 v[152:155], v[16:19], a[176:179], v[152:155]
    ds_read_b64_tr_b16 v[46:47], v10 offset:29184
    v_cvt_pk_bf16_f32 v248, v248, v249
    v_mfma_f32_16x16x32_bf16 v[152:155], v[20:23], a[180:183], v[152:155]
    v_cvt_pk_bf16_f32 v249, v250, v251
    v_cvt_pk_bf16_f32 v250, v252, v253
    v_mfma_f32_16x16x32_bf16 v[152:155], v[24:27], a[184:187], v[152:155]
    v_cvt_pk_bf16_f32 v251, v254, v255
    v_mfma_f32_16x16x32_bf16 v[152:155], v[28:31], a[188:191], v[152:155]
    v_mfma_f32_16x16x32_bf16 v[156:159], v[16:19], a[240:243], v[156:159]
    v_mfma_f32_16x16x32_bf16 v[156:159], v[20:23], a[244:247], v[156:159]
    v_mfma_f32_16x16x32_bf16 v[156:159], v[24:27], a[248:251], v[156:159]
    v_mfma_f32_16x16x32_bf16 v[156:159], v[28:31], a[252:255], v[156:159]
    s_waitcnt vmcnt(20) lgkmcnt(0)
    s_barrier
    s_bitcmp1_b32 s41, 0
    s_cbranch_scc1 mg_hp_9
    v_mfma_f32_16x16x32_bf16 v[160:163], v[32:35], a[48:51], v[160:163]
    ds_read_b64_tr_b16 v[16:17], v8 offset:0
    s_add_u32 m0, s6, 101376
    v_mfma_f32_16x16x32_bf16 v[160:163], v[36:39], a[52:55], v[160:163]
    ds_read_b64_tr_b16 v[18:19], v8 offset:512
    buffer_load_dwordx4 v51, s[12:15], s69 offen lds
    v_mfma_f32_16x16x32_bf16 v[160:163], v[40:43], a[56:59], v[160:163]
    ds_read_b64_tr_b16 v[20:21], v8 offset:4096
    v_mfma_f32_16x16x32_bf16 v[160:163], v[44:47], a[60:63], v[160:163]
    ds_read_b64_tr_b16 v[22:23], v8 offset:4608
    v_mfma_f32_16x16x32_bf16 v[164:167], v[32:35], a[112:115], v[164:167]
    ds_read_b64_tr_b16 v[24:25], v8 offset:16384
    buffer_store_dwordx4 v[248:251], v7, s[8:11], s52 offen offset:3072 sc1
    v_mfma_f32_16x16x32_bf16 v[164:167], v[36:39], a[116:119], v[164:167]
    ds_read_b64_tr_b16 v[26:27], v8 offset:16896
    s_add_u32 s52, s51, 4096
    v_mfma_f32_16x16x32_bf16 v[164:167], v[40:43], a[120:123], v[164:167]
    ds_read_b64_tr_b16 v[28:29], v8 offset:20480
    v_cvt_pk_bf16_f32 v64, v64, v65
    v_mfma_f32_16x16x32_bf16 v[164:167], v[44:47], a[124:127], v[164:167]
    ds_read_b64_tr_b16 v[30:31], v8 offset:20992
    v_cvt_pk_bf16_f32 v65, v66, v67
    v_mfma_f32_16x16x32_bf16 v[168:171], v[192:195], a[48:51], v[168:171]
    v_cvt_pk_bf16_f32 v66, v68, v69
    v_cvt_pk_bf16_f32 v67, v70, v71
    v_mfma_f32_16x16x32_bf16 v[168:171], v[196:199], a[52:55], v[168:171]
    v_mfma_f32_16x16x32_bf16 v[168:171], v[200:203], a[56:59], v[168:171]
    v_mfma_f32_16x16x32_bf16 v[168:171], v[204:207], a[60:63], v[168:171]
    v_mfma_f32_16x16x32_bf16 v[172:175], v[192:195], a[112:115], v[172:175]
    v_mfma_f32_16x16x32_bf16 v[172:175], v[196:199], a[116:119], v[172:175]
    v_mfma_f32_16x16x32_bf16 v[172:175], v[200:203], a[120:123], v[172:175]
    v_mfma_f32_16x16x32_bf16 v[172:175], v[204:207], a[124:127], v[172:175]
    s_branch mg_hp_10
mg_hp_9:
    v_mfma_f32_16x16x32_bf16 v[160:163], v[32:35], a[176:179], v[160:163]
    ds_read_b64_tr_b16 v[16:17], v8 offset:0
    s_add_u32 m0, s6, 101376
    v_mfma_f32_16x16x32_bf16 v[160:163], v[36:39], a[180:183], v[160:163]
    ds_read_b64_tr_b16 v[18:19], v8 offset:512
    buffer_load_dwordx4 v51, s[12:15], s69 offen lds
    v_mfma_f32_16x16x32_bf16 v[160:163], v[40:43], a[184:187], v[160:163]
    ds_read_b64_tr_b16 v[20:21], v8 offset:4096
    v_mfma_f32_16x16x32_bf16 v[160:163], v[44:47], a[188:191], v[160:163]
    ds_read_b64_tr_b16 v[22:23], v8 offset:4608
    v_mfma_f32_16x16x32_bf16 v[164:167], v[32:35], a[240:243], v[164:167]
    ds_read_b64_tr_b16 v[24:25], v8 offset:16384
    buffer_store_dwordx4 v[248:251], v7, s[8:11], s52 offen offset:3072 sc1
    v_mfma_f32_16x16x32_bf16 v[164:167], v[36:39], a[244:247], v[164:167]
    ds_read_b64_tr_b16 v[26:27], v8 offset:16896
    s_add_u32 s52, s51, 4096
    v_mfma_f32_16x16x32_bf16 v[164:167], v[40:43], a[248:251], v[164:167]
    ds_read_b64_tr_b16 v[28:29], v8 offset:20480
    v_cvt_pk_bf16_f32 v64, v64, v65
    v_mfma_f32_16x16x32_bf16 v[164:167], v[44:47], a[252:255], v[164:167]
    ds_read_b64_tr_b16 v[30:31], v8 offset:20992
    v_cvt_pk_bf16_f32 v65, v66, v67
    v_mfma_f32_16x16x32_bf16 v[168:171], v[192:195], a[176:179], v[168:171]
    v_cvt_pk_bf16_f32 v66, v68, v69
    v_cvt_pk_bf16_f32 v67, v70, v71
    v_mfma_f32_16x16x32_bf16 v[168:171], v[196:199], a[180:183], v[168:171]
    v_mfma_f32_16x16x32_bf16 v[168:171], v[200:203], a[184:187], v[168:171]
    v_mfma_f32_16x16x32_bf16 v[168:171], v[204:207], a[188:191], v[168:171]
    v_mfma_f32_16x16x32_bf16 v[172:175], v[192:195], a[240:243], v[172:175]
    v_mfma_f32_16x16x32_bf16 v[172:175], v[196:199], a[244:247], v[172:175]
    v_mfma_f32_16x16x32_bf16 v[172:175], v[200:203], a[248:251], v[172:175]
    v_mfma_f32_16x16x32_bf16 v[172:175], v[204:207], a[252:255], v[172:175]
mg_hp_10:
    s_waitcnt lgkmcnt(0)
    v_mfma_f32_16x16x32_bf16 v[192:195], v[16:19], a[0:3], 0
    ds_read_b64_tr_b16 v[32:33], v9 offset:0
    v_mfma_f32_16x16x32_bf16 v[192:195], v[20:23], a[4:7], v[192:195]
    ds_read_b64_tr_b16 v[34:35], v9 offset:512
    s_add_u32 s69, s4, 128
    v_mfma_f32_16x16x32_bf16 v[192:195], v[24:27], a[8:11], v[192:195]
    ds_read_b64_tr_b16 v[36:37], v9 offset:4096
    s_add_u32 m0, s6, 40960
    v_mfma_f32_16x16x32_bf16 v[192:195], v[28:31], a[12:15], v[192:195]
    ds_read_b64_tr_b16 v[38:39], v9 offset:4608
    buffer_load_dwordx4 v48, s[12:15], s69 offen lds
    v_mfma_f32_16x16x32_bf16 v[196:199], v[16:19], a[64:67], 0
    ds_read_b64_tr_b16 v[40:41], v9 offset:16384
    v_mfma_f32_16x16x32_bf16 v[196:199], v[20:23], a[68:71], v[196:199]
    ds_read_b64_tr_b16 v[42:43], v9 offset:16896
    v_mfma_f32_16x16x32_bf16 v[196:199], v[24:27], a[72:75], v[196:199]
    ds_read_b64_tr_b16 v[44:45], v9 offset:20480
    v_mfma_f32_16x16x32_bf16 v[196:199], v[28:31], a[76:79], v[196:199]
    ds_read_b64_tr_b16 v[46:47], v9 offset:20992
    v_mfma_f32_16x16x32_bf16 v[200:203], v[16:19], a[128:131], 0
    v_mfma_f32_16x16x32_bf16 v[200:203], v[20:23], a[132:135], v[200:203]
    v_mfma_f32_16x16x32_bf16 v[200:203], v[24:27], a[136:139], v[200:203]
    buffer_store_dwordx4 v[64:67], v7, s[8:11], s52 offen offset:0 sc1
    s_add_u32 s52, s51, 12288
    v_mfma_f32_16x16x32_bf16 v[200:203], v[28:31], a[140:143], v[200:203]
    v_cvt_pk_bf16_f32 v72, v72, v73
    v_cvt_pk_bf16_f32 v73, v74, v75
    v_mfma_f32_16x16x32_bf16 v[204:207], v[16:19], a[192:195], 0
    v_cvt_pk_bf16_f32 v74, v76, v77
    v_cvt_pk_bf16_f32 v75, v78, v79
    v_mfma_f32_16x16x32_bf16 v[204:207], v[20:23], a[196:199], v[204:207]
    v_mul_f32 v56, 0x3fb8aa3b, v128
    v_mul_f32 v57, 0x3fb8aa3b, v129
    v_mfma_f32_16x16x32_bf16 v[204:207], v[24:27], a[200:203], v[204:207]
    s_add_u32 m0, s6, 41984
    v_mul_f32 v58, 0x3fb8aa3b, v130
    v_mfma_f32_16x16x32_bf16 v[204:207], v[28:31], a[204:207], v[204:207]
    s_waitcnt lgkmcnt(0)
    buffer_load_dwordx4 v49, s[12:15], s69 offen lds
    v_mfma_f32_16x16x32_bf16 v[208:211], v[32:35], a[0:3], 0
    ds_read_b64_tr_b16 v[16:17], v10 offset:0
    v_mul_f32 v59, 0x3fb8aa3b, v131
    v_mfma_f32_16x16x32_bf16 v[208:211], v[36:39], a[4:7], v[208:211]
    ds_read_b64_tr_b16 v[18:19], v10 offset:512
    v_min_f32 v56, 0x41e6d4ca, v56
    v_mfma_f32_16x16x32_bf16 v[208:211], v[40:43], a[8:11], v[208:211]
    ds_read_b64_tr_b16 v[20:21], v10 offset:4096
    v_min_f32 v57, 0x41e6d4ca, v57
    v_mfma_f32_16x16x32_bf16 v[208:211], v[44:47], a[12:15], v[208:211]
    ds_read_b64_tr_b16 v[22:23], v10 offset:4608
    v_min_f32 v58, 0x41e6d4ca, v58
    v_mfma_f32_16x16x32_bf16 v[212:215], v[32:35], a[64:67], 0
    ds_read_b64_tr_b16 v[24:25], v10 offset:16384
    v_min_f32 v59, 0x41e6d4ca, v59
    v_mfma_f32_16x16x32_bf16 v[212:215], v[36:39], a[68:71], v[212:215]
    ds_read_b64_tr_b16 v[26:27], v10 offset:16896
    v_mfma_f32_16x16x32_bf16 v[212:215], v[40:43], a[72:75], v[212:215]
    ds_read_b64_tr_b16 v[28:29], v10 offset:20480
    v_mfma_f32_16x16x32_bf16 v[212:215], v[44:47], a[76:79], v[212:215]
    ds_read_b64_tr_b16 v[30:31], v10 offset:20992
    v_mfma_f32_16x16x32_bf16 v[216:219], v[32:35], a[128:131], 0
    v_exp_f32 v56, v56
    v_mfma_f32_16x16x32_bf16 v[216:219], v[36:39], a[132:135], v[216:219]
    v_exp_f32 v57, v57
    v_mfma_f32_16x16x32_bf16 v[216:219], v[40:43], a[136:139], v[216:219]
    buffer_store_dwordx4 v[72:75], v7, s[8:11], s52 offen offset:0 sc1
    s_add_u32 s52, s51, 4096
    v_mfma_f32_16x16x32_bf16 v[216:219], v[44:47], a[140:143], v[216:219]
    v_cvt_pk_bf16_f32 v80, v80, v81
    v_cvt_pk_bf16_f32 v81, v82, v83
    v_mfma_f32_16x16x32_bf16 v[220:223], v[32:35], a[192:195], 0
    v_cvt_pk_bf16_f32 v82, v84, v85
    v_cvt_pk_bf16_f32 v83, v86, v87
    v_mfma_f32_16x16x32_bf16 v[220:223], v[36:39], a[196:199], v[220:223]
    s_add_u32 m0, s6, 43008
    v_mfma_f32_16x16x32_bf16 v[220:223], v[40:43], a[200:203], v[220:223]
    buffer_load_dwordx4 v50, s[12:15], s69 offen lds
    v_mfma_f32_16x16x32_bf16 v[220:223], v[44:47], a[204:207], v[220:223]
    s_waitcnt lgkmcnt(0)
    v_mfma_f32_16x16x32_bf16 v[224:227], v[16:19], a[0:3], 0
    ds_read_b64_tr_b16 v[32:33], v11 offset:0
    v_mfma_f32_16x16x32_bf16 v[224:227], v[20:23], a[4:7], v[224:227]
    ds_read_b64_tr_b16 v[34:35], v11 offset:512
    v_mfma_f32_16x16x32_bf16 v[224:227], v[24:27], a[8:11], v[224:227]
    ds_read_b64_tr_b16 v[36:37], v11 offset:4096
    v_mfma_f32_16x16x32_bf16 v[224:227], v[28:31], a[12:15], v[224:227]
    ds_read_b64_tr_b16 v[38:39], v11 offset:4608
    v_mfma_f32_16x16x32_bf16 v[228:231], v[16:19], a[64:67], 0
    ds_read_b64_tr_b16 v[40:41], v11 offset:16384
    v_mfma_f32_16x16x32_bf16 v[228:231], v[20:23], a[68:71], v[228:231]
    ds_read_b64_tr_b16 v[42:43], v11 offset:16896
    v_mfma_f32_16x16x32_bf16 v[228:231], v[24:27], a[72:75], v[228:231]
    ds_read_b64_tr_b16 v[44:45], v11 offset:20480
    v_mfma_f32_16x16x32_bf16 v[228:231], v[28:31], a[76:79], v[228:231]
    ds_read_b64_tr_b16 v[46:47], v11 offset:20992
    v_mfma_f32_16x16x32_bf16 v[232:235], v[16:19], a[128:131], 0
    v_exp_f32 v58, v58
    v_mfma_f32_16x16x32_bf16 v[232:235], v[20:23], a[132:135], v[232:235]
    v_exp_f32 v59, v59
    v_mfma_f32_16x16x32_bf16 v[232:235], v[24:27], a[136:139], v[232:235]
    buffer_store_dwordx4 v[80:83], v7, s[8:11], s52 offen offset:1024 sc1
    s_add_u32 s52, s51, 12288
    v_mfma_f32_16x16x32_bf16 v[232:235], v[28:31], a[140:143], v[232:235]
    v_cvt_pk_bf16_f32 v88, v88, v89
    v_cvt_pk_bf16_f32 v89, v90, v91
    v_mfma_f32_16x16x32_bf16 v[236:239], v[16:19], a[192:195], 0
    s_add_u32 m0, s6, 44032
    v_cvt_pk_bf16_f32 v90, v92, v93
    v_mfma_f32_16x16x32_bf16 v[236:239], v[20:23], a[196:199], v[236:239]
    buffer_load_dwordx4 v51, s[12:15], s69 offen lds
    v_cvt_pk_bf16_f32 v91, v94, v95
    v_mfma_f32_16x16x32_bf16 v[236:239], v[24:27], a[200:203], v[236:239]
    v_add_f32 v176, 2.0, v56
    v_add_f32 v177, 2.0, v57
    v_mfma_f32_16x16x32_bf16 v[236:239], v[28:31], a[204:207], v[236:239]
    s_waitcnt vmcnt(25) lgkmcnt(0)
    s_barrier
    v_mfma_f32_16x16x32_bf16 v[240:243], v[32:35], a[0:3], 0
    ds_read_b64_tr_b16 v[16:17], v8 offset:32768
    v_add_f32 v178, 2.0, v58
    v_mfma_f32_16x16x32_bf16 v[240:243], v[36:39], a[4:7], v[240:243]
    ds_read_b64_tr_b16 v[18:19], v8 offset:33280
    v_add_f32 v179, 2.0, v59
    v_mfma_f32_16x16x32_bf16 v[240:243], v[40:43], a[8:11], v[240:243]
    ds_read_b64_tr_b16 v[20:21], v8 offset:36864
    v_mul_f32 v128, v128, v56
    v_mfma_f32_16x16x32_bf16 v[240:243], v[44:47], a[12:15], v[240:243]
    ds_read_b64_tr_b16 v[22:23], v8 offset:37376
    v_mul_f32 v129, v129, v57
    v_mfma_f32_16x16x32_bf16 v[244:247], v[32:35], a[64:67], 0
    ds_read_b64_tr_b16 v[24:25], v8 offset:49152
    v_mul_f32 v130, v130, v58
    v_mfma_f32_16x16x32_bf16 v[244:247], v[36:39], a[68:71], v[244:247]
    ds_read_b64_tr_b16 v[26:27], v8 offset:49664
    v_mul_f32 v131, v131, v59
    v_mfma_f32_16x16x32_bf16 v[244:247], v[40:43], a[72:75], v[244:247]
    ds_read_b64_tr_b16 v[28:29], v8 offset:53248
    v_mul_f32 v128, v128, v176
    v_mfma_f32_16x16x32_bf16 v[244:247], v[44:47], a[76:79], v[244:247]
    ds_read_b64_tr_b16 v[30:31], v8 offset:53760
    v_mul_f32 v129, v129, v177
    v_mfma_f32_16x16x32_bf16 v[248:251], v[32:35], a[128:131], 0
    v_mul_f32 v130, v130, v178
    v_mul_f32 v131, v131, v179
    v_mfma_f32_16x16x32_bf16 v[248:251], v[36:39], a[132:135], v[248:251]
    v_fma_f32 v176, v56, v176, 2.0
    v_fma_f32 v177, v57, v177, 2.0
    v_mfma_f32_16x16x32_bf16 v[248:251], v[40:43], a[136:139], v[248:251]
    buffer_store_dwordx4 v[88:91], v7, s[8:11], s52 offen offset:1024 sc1
    s_add_u32 s52, s51, 4096
    v_mfma_f32_16x16x32_bf16 v[248:251], v[44:47], a[140:143], v[248:251]
    v_cvt_pk_bf16_f32 v96, v96, v97
    v_cvt_pk_bf16_f32 v97, v98, v99
    v_mfma_f32_16x16x32_bf16 v[252:255], v[32:35], a[192:195], 0
    v_cvt_pk_bf16_f32 v98, v100, v101
    v_cvt_pk_bf16_f32 v99, v102, v103
    v_mfma_f32_16x16x32_bf16 v[252:255], v[36:39], a[196:199], v[252:255]
    v_fma_f32 v178, v58, v178, 2.0
    v_fma_f32 v179, v59, v179, 2.0
    v_mfma_f32_16x16x32_bf16 v[252:255], v[40:43], a[200:203], v[252:255]
    v_rcp_f32 v176, v176
    v_mfma_f32_16x16x32_bf16 v[252:255], v[44:47], a[204:207], v[252:255]
    v_rcp_f32 v177, v177
    s_waitcnt lgkmcnt(0)
    v_mfma_f32_16x16x32_bf16 v[192:195], v[16:19], a[16:19], v[192:195]
    ds_read_b64_tr_b16 v[32:33], v9 offset:32768
    v_mfma_f32_16x16x32_bf16 v[192:195], v[20:23], a[20:23], v[192:195]
    ds_read_b64_tr_b16 v[34:35], v9 offset:33280
    s_add_u32 s69, s4, 1048704
    v_mfma_f32_16x16x32_bf16 v[192:195], v[24:27], a[24:27], v[192:195]
    ds_read_b64_tr_b16 v[36:37], v9 offset:36864
    s_add_u32 m0, s6, 73728
    v_mfma_f32_16x16x32_bf16 v[192:195], v[28:31], a[28:31], v[192:195]
    ds_read_b64_tr_b16 v[38:39], v9 offset:37376
    buffer_load_dwordx4 v48, s[12:15], s69 offen lds
    v_mfma_f32_16x16x32_bf16 v[196:199], v[16:19], a[80:83], v[196:199]
    ds_read_b64_tr_b16 v[40:41], v9 offset:49152
    v_mfma_f32_16x16x32_bf16 v[196:199], v[20:23], a[84:87], v[196:199]
    ds_read_b64_tr_b16 v[42:43], v9 offset:49664
    v_mfma_f32_16x16x32_bf16 v[196:199], v[24:27], a[88:91], v[196:199]
    ds_read_b64_tr_b16 v[44:45], v9 offset:53248
    v_mfma_f32_16x16x32_bf16 v[196:199], v[28:31], a[92:95], v[196:199]
    ds_read_b64_tr_b16 v[46:47], v9 offset:53760
    v_mfma_f32_16x16x32_bf16 v[200:203], v[16:19], a[144:147], v[200:203]
    v_rcp_f32 v178, v178
    v_mfma_f32_16x16x32_bf16 v[200:203], v[20:23], a[148:151], v[200:203]
    v_rcp_f32 v179, v179
    v_mfma_f32_16x16x32_bf16 v[200:203], v[24:27], a[152:155], v[200:203]
    buffer_store_dwordx4 v[96:99], v7, s[8:11], s52 offen offset:2048 sc1
    s_add_u32 s52, s51, 12288
    v_mfma_f32_16x16x32_bf16 v[200:203], v[28:31], a[156:159], v[200:203]
    v_cvt_pk_bf16_f32 v104, v104, v105
    v_cvt_pk_bf16_f32 v105, v106, v107
    v_mfma_f32_16x16x32_bf16 v[204:207], v[16:19], a[208:211], v[204:207]
    v_cvt_pk_bf16_f32 v106, v108, v109
    v_cvt_pk_bf16_f32 v107, v110, v111
    v_mfma_f32_16x16x32_bf16 v[204:207], v[20:23], a[212:215], v[204:207]
    v_mul_f32 v128, v128, v176
    v_mul_f32 v129, v129, v177
    v_mfma_f32_16x16x32_bf16 v[204:207], v[24:27], a[216:219], v[204:207]
    s_add_u32 m0, s6, 74752
    v_mul_f32 v130, v130, v178
    v_mfma_f32_16x16x32_bf16 v[204:207], v[28:31], a[220:223], v[204:207]
    s_waitcnt lgkmcnt(0)
    buffer_load_dwordx4 v49, s[12:15], s69 offen lds
    v_mfma_f32_16x16x32_bf16 v[208:211], v[32:35], a[16:19], v[208:211]
    ds_read_b64_tr_b16 v[16:17], v10 offset:32768
    v_mul_f32 v131, v131, v179
    v_mfma_f32_16x16x32_bf16 v[208:211], v[36:39], a[20:23], v[208:211]
    ds_read_b64_tr_b16 v[18:19], v10 offset:33280
    v_mul_f32 v56, 0x3fb8aa3b, v144
    v_mfma_f32_16x16x32_bf16 v[208:211], v[40:43], a[24:27], v[208:211]
    ds_read_b64_tr_b16 v[20:21], v10 offset:36864
    v_mul_f32 v57, 0x3fb8aa3b, v145
    v_mfma_f32_16x16x32_bf16 v[208:211], v[44:47], a[28:31], v[208:211]
    ds_read_b64_tr_b16 v[22:23], v10 offset:37376
    v_mul_f32 v58, 0x3fb8aa3b, v146
    v_mfma_f32_16x16x32_bf16 v[212:215], v[32:35], a[80:83], v[212:215]
    ds_read_b64_tr_b16 v[24:25], v10 offset:49152
    v_mul_f32 v59, 0x3fb8aa3b, v147
    v_mfma_f32_16x16x32_bf16 v[212:215], v[36:39], a[84:87], v[212:215]
    ds_read_b64_tr_b16 v[26:27], v10 offset:49664
    v_min_f32 v56, 0x41e6d4ca, v56
    v_mfma_f32_16x16x32_bf16 v[212:215], v[40:43], a[88:91], v[212:215]
    ds_read_b64_tr_b16 v[28:29], v10 offset:53248
    v_min_f32 v57, 0x41e6d4ca, v57
    v_mfma_f32_16x16x32_bf16 v[212:215], v[44:47], a[92:95], v[212:215]
    ds_read_b64_tr_b16 v[30:31], v10 offset:53760
    v_min_f32 v58, 0x41e6d4ca, v58
    v_mfma_f32_16x16x32_bf16 v[216:219], v[32:35], a[144:147], v[216:219]
    v_min_f32 v59, 0x41e6d4ca, v59
    v_mfma_f32_16x16x32_bf16 v[216:219], v[36:39], a[148:151], v[216:219]
    v_exp_f32 v56, v56
    v_mfma_f32_16x16x32_bf16 v[216:219], v[40:43], a[152:155], v[216:219]
    buffer_store_dwordx4 v[104:107], v7, s[8:11], s52 offen offset:2048 sc1
    s_add_u32 s52, s51, 4096
    v_mfma_f32_16x16x32_bf16 v[216:219], v[44:47], a[156:159], v[216:219]
    v_cvt_pk_bf16_f32 v112, v112, v113
    v_cvt_pk_bf16_f32 v113, v114, v115
    v_mfma_f32_16x16x32_bf16 v[220:223], v[32:35], a[208:211], v[220:223]
    v_cvt_pk_bf16_f32 v114, v116, v117
    v_cvt_pk_bf16_f32 v115, v118, v119
    v_mfma_f32_16x16x32_bf16 v[220:223], v[36:39], a[212:215], v[220:223]
    s_add_u32 m0, s6, 75776
    v_mfma_f32_16x16x32_bf16 v[220:223], v[40:43], a[216:219], v[220:223]
    buffer_load_dwordx4 v50, s[12:15], s69 offen lds
    v_mfma_f32_16x16x32_bf16 v[220:223], v[44:47], a[220:223], v[220:223]
    s_waitcnt lgkmcnt(0)
    v_mfma_f32_16x16x32_bf16 v[224:227], v[16:19], a[16:19], v[224:227]
    ds_read_b64_tr_b16 v[32:33], v11 offset:32768
    v_mfma_f32_16x16x32_bf16 v[224:227], v[20:23], a[20:23], v[224:227]
    ds_read_b64_tr_b16 v[34:35], v11 offset:33280
    v_mfma_f32_16x16x32_bf16 v[224:227], v[24:27], a[24:27], v[224:227]
    ds_read_b64_tr_b16 v[36:37], v11 offset:36864
    v_mfma_f32_16x16x32_bf16 v[224:227], v[28:31], a[28:31], v[224:227]
    ds_read_b64_tr_b16 v[38:39], v11 offset:37376
    v_mfma_f32_16x16x32_bf16 v[228:231], v[16:19], a[80:83], v[228:231]
    ds_read_b64_tr_b16 v[40:41], v11 offset:49152
    v_mfma_f32_16x16x32_bf16 v[228:231], v[20:23], a[84:87], v[228:231]
    ds_read_b64_tr_b16 v[42:43], v11 offset:49664
    v_mfma_f32_16x16x32_bf16 v[228:231], v[24:27], a[88:91], v[228:231]
    ds_read_b64_tr_b16 v[44:45], v11 offset:53248
    v_mfma_f32_16x16x32_bf16 v[228:231], v[28:31], a[92:95], v[228:231]
    ds_read_b64_tr_b16 v[46:47], v11 offset:53760
    v_mfma_f32_16x16x32_bf16 v[232:235], v[16:19], a[144:147], v[232:235]
    v_exp_f32 v57, v57
    v_mfma_f32_16x16x32_bf16 v[232:235], v[20:23], a[148:151], v[232:235]
    v_exp_f32 v58, v58
    v_mfma_f32_16x16x32_bf16 v[232:235], v[24:27], a[152:155], v[232:235]
    buffer_store_dwordx4 v[112:115], v7, s[8:11], s52 offen offset:3072 sc1
    s_add_u32 s52, s51, 12288
    v_mfma_f32_16x16x32_bf16 v[232:235], v[28:31], a[156:159], v[232:235]
    v_cvt_pk_bf16_f32 v120, v120, v121
    v_cvt_pk_bf16_f32 v121, v122, v123
    v_mfma_f32_16x16x32_bf16 v[236:239], v[16:19], a[208:211], v[236:239]
    s_add_u32 m0, s6, 76800
    v_cvt_pk_bf16_f32 v122, v124, v125
    v_mfma_f32_16x16x32_bf16 v[236:239], v[20:23], a[212:215], v[236:239]
    buffer_load_dwordx4 v51, s[12:15], s69 offen lds
    v_cvt_pk_bf16_f32 v123, v126, v127
    v_mfma_f32_16x16x32_bf16 v[236:239], v[24:27], a[216:219], v[236:239]
    v_exp_f32 v59, v59
    v_mfma_f32_16x16x32_bf16 v[236:239], v[28:31], a[220:223], v[236:239]
    s_waitcnt vmcnt(23) lgkmcnt(0)
    s_barrier
    v_mfma_f32_16x16x32_bf16 v[240:243], v[32:35], a[16:19], v[240:243]
    v_xor_b32 v8, 0x10000, v8
    v_add_f32 v176, 2.0, v56
    v_mfma_f32_16x16x32_bf16 v[240:243], v[36:39], a[20:23], v[240:243]
    ds_read_b64_tr_b16 v[16:17], v8 offset:0
    v_add_f32 v177, 2.0, v57
    v_mfma_f32_16x16x32_bf16 v[240:243], v[40:43], a[24:27], v[240:243]
    ds_read_b64_tr_b16 v[18:19], v8 offset:512
    v_add_f32 v178, 2.0, v58
    v_mfma_f32_16x16x32_bf16 v[240:243], v[44:47], a[28:31], v[240:243]
    ds_read_b64_tr_b16 v[20:21], v8 offset:4096
    v_add_f32 v179, 2.0, v59
    v_mfma_f32_16x16x32_bf16 v[244:247], v[32:35], a[80:83], v[244:247]
    ds_read_b64_tr_b16 v[22:23], v8 offset:4608
    v_mul_f32 v144, v144, v56
    v_mfma_f32_16x16x32_bf16 v[244:247], v[36:39], a[84:87], v[244:247]
    ds_read_b64_tr_b16 v[24:25], v8 offset:16384
    v_mul_f32 v145, v145, v57
    v_mfma_f32_16x16x32_bf16 v[244:247], v[40:43], a[88:91], v[244:247]
    ds_read_b64_tr_b16 v[26:27], v8 offset:16896
    v_mul_f32 v146, v146, v58
    v_mfma_f32_16x16x32_bf16 v[244:247], v[44:47], a[92:95], v[244:247]
    ds_read_b64_tr_b16 v[28:29], v8 offset:20480
    v_mul_f32 v147, v147, v59
    v_mfma_f32_16x16x32_bf16 v[248:251], v[32:35], a[144:147], v[248:251]
    ds_read_b64_tr_b16 v[30:31], v8 offset:20992
    v_mul_f32 v144, v144, v176
    v_mfma_f32_16x16x32_bf16 v[248:251], v[36:39], a[148:151], v[248:251]
    v_mul_f32 v145, v145, v177
    v_mul_f32 v146, v146, v178
    v_mfma_f32_16x16x32_bf16 v[248:251], v[40:43], a[152:155], v[248:251]
    buffer_store_dwordx4 v[120:123], v7, s[8:11], s52 offen offset:3072 sc1
    v_mul_f32 v147, v147, v179
    v_mfma_f32_16x16x32_bf16 v[248:251], v[44:47], a[156:159], v[248:251]
    v_fma_f32 v176, v56, v176, 2.0
    v_fma_f32 v177, v57, v177, 2.0
    v_mfma_f32_16x16x32_bf16 v[252:255], v[32:35], a[208:211], v[252:255]
    v_fma_f32 v178, v58, v178, 2.0
    v_fma_f32 v179, v59, v179, 2.0
    v_mfma_f32_16x16x32_bf16 v[252:255], v[36:39], a[212:215], v[252:255]
    v_rcp_f32 v176, v176
    v_mfma_f32_16x16x32_bf16 v[252:255], v[40:43], a[216:219], v[252:255]
    v_rcp_f32 v177, v177
    v_mfma_f32_16x16x32_bf16 v[252:255], v[44:47], a[220:223], v[252:255]
    v_rcp_f32 v178, v178
    s_waitcnt lgkmcnt(0)
    v_mfma_f32_16x16x32_bf16 v[192:195], v[16:19], a[32:35], v[192:195]
    v_xor_b32 v9, 0x10000, v9
    v_mfma_f32_16x16x32_bf16 v[192:195], v[20:23], a[36:39], v[192:195]
    ds_read_b64_tr_b16 v[32:33], v9 offset:0
    s_add_u32 s69, s4, 2097280
    v_mfma_f32_16x16x32_bf16 v[192:195], v[24:27], a[40:43], v[192:195]
    ds_read_b64_tr_b16 v[34:35], v9 offset:512
    s_add_u32 m0, s6, 106496
    v_mfma_f32_16x16x32_bf16 v[192:195], v[28:31], a[44:47], v[192:195]
    ds_read_b64_tr_b16 v[36:37], v9 offset:4096
    buffer_load_dwordx4 v48, s[12:15], s69 offen lds
    v_mfma_f32_16x16x32_bf16 v[196:199], v[16:19], a[96:99], v[196:199]
    ds_read_b64_tr_b16 v[38:39], v9 offset:4608
    v_mfma_f32_16x16x32_bf16 v[196:199], v[20:23], a[100:103], v[196:199]
    ds_read_b64_tr_b16 v[40:41], v9 offset:16384
    v_mfma_f32_16x16x32_bf16 v[196:199], v[24:27], a[104:107], v[196:199]
    ds_read_b64_tr_b16 v[42:43], v9 offset:16896
    v_mfma_f32_16x16x32_bf16 v[196:199], v[28:31], a[108:111], v[196:199]
    ds_read_b64_tr_b16 v[44:45], v9 offset:20480
    s_add_u32 m0, s6, 107520
    v_mfma_f32_16x16x32_bf16 v[200:203], v[16:19], a[160:163], v[200:203]
    ds_read_b64_tr_b16 v[46:47], v9 offset:20992
    buffer_load_dwordx4 v49, s[12:15], s69 offen lds
    v_mfma_f32_16x16x32_bf16 v[200:203], v[20:23], a[164:167], v[200:203]
    v_rcp_f32 v179, v179
    v_mfma_f32_16x16x32_bf16 v[200:203], v[24:27], a[168:171], v[200:203]
    v_mul_f32 v144, v144, v176
    v_mul_f32 v145, v145, v177
    v_mfma_f32_16x16x32_bf16 v[200:203], v[28:31], a[172:175], v[200:203]
    v_mul_f32 v146, v146, v178
    v_mul_f32 v147, v147, v179
    v_mfma_f32_16x16x32_bf16 v[204:207], v[16:19], a[224:227], v[204:207]
    v_cvt_pk_bf16_f32 v128, v128, v129
    v_cvt_pk_bf16_f32 v129, v130, v131
    v_mfma_f32_16x16x32_bf16 v[204:207], v[20:23], a[228:231], v[204:207]
    v_cvt_pk_bf16_f32 v130, v144, v145
    v_cvt_pk_bf16_f32 v131, v146, v147
    v_mfma_f32_16x16x32_bf16 v[204:207], v[24:27], a[232:235], v[204:207]
    s_add_u32 m0, s6, 108544
    buffer_store_dwordx4 v[128:131], v12, s[8:11], s76 offen sc1
    v_mfma_f32_16x16x32_bf16 v[204:207], v[28:31], a[236:239], v[204:207]
    s_waitcnt lgkmcnt(0)
    buffer_load_dwordx4 v50, s[12:15], s69 offen lds
    v_mfma_f32_16x16x32_bf16 v[208:211], v[32:35], a[32:35], v[208:211]
    v_xor_b32 v10, 0x10000, v10
    v_mul_f32 v56, 0x3fb8aa3b, v132
    v_mfma_f32_16x16x32_bf16 v[208:211], v[36:39], a[36:39], v[208:211]
    ds_read_b64_tr_b16 v[16:17], v10 offset:0
    v_mul_f32 v57, 0x3fb8aa3b, v133
    v_mfma_f32_16x16x32_bf16 v[208:211], v[40:43], a[40:43], v[208:211]
    ds_read_b64_tr_b16 v[18:19], v10 offset:512
    v_mul_f32 v58, 0x3fb8aa3b, v134
    v_mfma_f32_16x16x32_bf16 v[208:211], v[44:47], a[44:47], v[208:211]
    ds_read_b64_tr_b16 v[20:21], v10 offset:4096
    v_mul_f32 v59, 0x3fb8aa3b, v135
    v_mfma_f32_16x16x32_bf16 v[212:215], v[32:35], a[96:99], v[212:215]
    ds_read_b64_tr_b16 v[22:23], v10 offset:4608
    v_min_f32 v56, 0x41e6d4ca, v56
    v_mfma_f32_16x16x32_bf16 v[212:215], v[36:39], a[100:103], v[212:215]
    ds_read_b64_tr_b16 v[24:25], v10 offset:16384
    v_min_f32 v57, 0x41e6d4ca, v57
    v_mfma_f32_16x16x32_bf16 v[212:215], v[40:43], a[104:107], v[212:215]
    ds_read_b64_tr_b16 v[26:27], v10 offset:16896
    s_add_u32 m0, s6, 109568
    v_mfma_f32_16x16x32_bf16 v[212:215], v[44:47], a[108:111], v[212:215]
    ds_read_b64_tr_b16 v[28:29], v10 offset:20480
    buffer_load_dwordx4 v51, s[12:15], s69 offen lds
    v_mfma_f32_16x16x32_bf16 v[216:219], v[32:35], a[160:163], v[216:219]
    ds_read_b64_tr_b16 v[30:31], v10 offset:20992
    v_min_f32 v58, 0x41e6d4ca, v58
    v_mfma_f32_16x16x32_bf16 v[216:219], v[36:39], a[164:167], v[216:219]
    v_min_f32 v59, 0x41e6d4ca, v59
    v_mfma_f32_16x16x32_bf16 v[216:219], v[40:43], a[168:171], v[216:219]
    v_exp_f32 v56, v56
    v_mfma_f32_16x16x32_bf16 v[216:219], v[44:47], a[172:175], v[216:219]
    v_exp_f32 v57, v57
    v_mfma_f32_16x16x32_bf16 v[220:223], v[32:35], a[224:227], v[220:223]
    v_exp_f32 v58, v58
    v_mfma_f32_16x16x32_bf16 v[220:223], v[36:39], a[228:231], v[220:223]
    s_add_u32 s69, s4, 3145856
    s_add_u32 m0, s6, 8192
    v_mfma_f32_16x16x32_bf16 v[220:223], v[40:43], a[232:235], v[220:223]
    buffer_load_dwordx4 v48, s[12:15], s69 offen lds
    v_mfma_f32_16x16x32_bf16 v[220:223], v[44:47], a[236:239], v[220:223]
    s_waitcnt lgkmcnt(0)
    v_mfma_f32_16x16x32_bf16 v[224:227], v[16:19], a[32:35], v[224:227]
    v_xor_b32 v11, 0x10000, v11
    v_mfma_f32_16x16x32_bf16 v[224:227], v[20:23], a[36:39], v[224:227]
    ds_read_b64_tr_b16 v[32:33], v11 offset:0
    v_mfma_f32_16x16x32_bf16 v[224:227], v[24:27], a[40:43], v[224:227]
    ds_read_b64_tr_b16 v[34:35], v11 offset:512
    v_mfma_f32_16x16x32_bf16 v[224:227], v[28:31], a[44:47], v[224:227]
    ds_read_b64_tr_b16 v[36:37], v11 offset:4096
    v_mfma_f32_16x16x32_bf16 v[228:231], v[16:19], a[96:99], v[228:231]
    ds_read_b64_tr_b16 v[38:39], v11 offset:4608
    s_add_u32 m0, s6, 9216
    v_mfma_f32_16x16x32_bf16 v[228:231], v[20:23], a[100:103], v[228:231]
    ds_read_b64_tr_b16 v[40:41], v11 offset:16384
    buffer_load_dwordx4 v49, s[12:15], s69 offen lds
    v_mfma_f32_16x16x32_bf16 v[228:231], v[24:27], a[104:107], v[228:231]
    ds_read_b64_tr_b16 v[42:43], v11 offset:16896
    v_mfma_f32_16x16x32_bf16 v[228:231], v[28:31], a[108:111], v[228:231]
    ds_read_b64_tr_b16 v[44:45], v11 offset:20480
    v_mfma_f32_16x16x32_bf16 v[232:235], v[16:19], a[160:163], v[232:235]
    ds_read_b64_tr_b16 v[46:47], v11 offset:20992
    v_mfma_f32_16x16x32_bf16 v[232:235], v[20:23], a[164:167], v[232:235]
    v_exp_f32 v59, v59
    v_mfma_f32_16x16x32_bf16 v[232:235], v[24:27], a[168:171], v[232:235]
    v_add_f32 v176, 2.0, v56
    v_add_f32 v177, 2.0, v57
    v_mfma_f32_16x16x32_bf16 v[232:235], v[28:31], a[172:175], v[232:235]
    v_add_f32 v178, 2.0, v58
    v_add_f32 v179, 2.0, v59
    v_mfma_f32_16x16x32_bf16 v[236:239], v[16:19], a[224:227], v[236:239]
    s_add_u32 m0, s6, 10240
    v_mul_f32 v132, v132, v56
    v_mfma_f32_16x16x32_bf16 v[236:239], v[20:23], a[228:231], v[236:239]
    buffer_load_dwordx4 v50, s[12:15], s69 offen lds
    v_mul_f32 v133, v133, v57
    v_mfma_f32_16x16x32_bf16 v[236:239], v[24:27], a[232:235], v[236:239]
    v_mul_f32 v134, v134, v58
    v_mul_f32 v135, v135, v59
    v_mfma_f32_16x16x32_bf16 v[236:239], v[28:31], a[236:239], v[236:239]
    s_waitcnt vmcnt(25) lgkmcnt(0)
    s_barrier
    v_mfma_f32_16x16x32_bf16 v[240:243], v[32:35], a[32:35], v[240:243]
    ds_read_b64_tr_b16 v[16:17], v8 offset:32768
    v_mul_f32 v132, v132, v176
    v_mfma_f32_16x16x32_bf16 v[240:243], v[36:39], a[36:39], v[240:243]
    ds_read_b64_tr_b16 v[18:19], v8 offset:33280
    v_mul_f32 v133, v133, v177
    v_mfma_f32_16x16x32_bf16 v[240:243], v[40:43], a[40:43], v[240:243]
    ds_read_b64_tr_b16 v[20:21], v8 offset:36864
    v_mul_f32 v134, v134, v178
    v_mfma_f32_16x16x32_bf16 v[240:243], v[44:47], a[44:47], v[240:243]
    ds_read_b64_tr_b16 v[22:23], v8 offset:37376
    s_add_u32 m0, s6, 11264
    v_mfma_f32_16x16x32_bf16 v[244:247], v[32:35], a[96:99], v[244:247]
    ds_read_b64_tr_b16 v[24:25], v8 offset:49152
    buffer_load_dwordx4 v51, s[12:15], s69 offen lds
    v_mfma_f32_16x16x32_bf16 v[244:247], v[36:39], a[100:103], v[244:247]
    ds_read_b64_tr_b16 v[26:27], v8 offset:49664
    v_mul_f32 v135, v135, v179
    v_mfma_f32_16x16x32_bf16 v[244:247], v[40:43], a[104:107], v[244:247]
    ds_read_b64_tr_b16 v[28:29], v8 offset:53248
    v_fma_f32 v176, v56, v176, 2.0
    v_mfma_f32_16x16x32_bf16 v[244:247], v[44:47], a[108:111], v[244:247]
    ds_read_b64_tr_b16 v[30:31], v8 offset:53760
    v_fma_f32 v177, v57, v177, 2.0
    v_mfma_f32_16x16x32_bf16 v[248:251], v[32:35], a[160:163], v[248:251]
    v_fma_f32 v178, v58, v178, 2.0
    v_fma_f32 v179, v59, v179, 2.0
    v_mfma_f32_16x16x32_bf16 v[248:251], v[36:39], a[164:167], v[248:251]
    v_rcp_f32 v176, v176
    v_mfma_f32_16x16x32_bf16 v[248:251], v[40:43], a[168:171], v[248:251]
    v_rcp_f32 v177, v177
    v_mfma_f32_16x16x32_bf16 v[248:251], v[44:47], a[172:175], v[248:251]
    v_rcp_f32 v178, v178
    v_mfma_f32_16x16x32_bf16 v[252:255], v[32:35], a[224:227], v[252:255]
    v_rcp_f32 v179, v179
    v_mfma_f32_16x16x32_bf16 v[252:255], v[36:39], a[228:231], v[252:255]
    v_mul_f32 v132, v132, v176
    v_mul_f32 v133, v133, v177
    v_mfma_f32_16x16x32_bf16 v[252:255], v[40:43], a[232:235], v[252:255]
    v_mul_f32 v134, v134, v178
    v_mul_f32 v135, v135, v179
    v_mfma_f32_16x16x32_bf16 v[252:255], v[44:47], a[236:239], v[252:255]
    v_mul_f32 v56, 0x3fb8aa3b, v148
    v_mul_f32 v57, 0x3fb8aa3b, v149
    s_waitcnt lgkmcnt(0)
    v_mfma_f32_16x16x32_bf16 v[192:195], v[16:19], a[48:51], v[192:195]
    ds_read_b64_tr_b16 v[32:33], v9 offset:32768
    v_mul_f32 v58, 0x3fb8aa3b, v150
    v_mfma_f32_16x16x32_bf16 v[192:195], v[20:23], a[52:55], v[192:195]
    ds_read_b64_tr_b16 v[34:35], v9 offset:33280
    s_waitcnt vmcnt(9)
    v_mfma_f32_16x16x32_bf16 v[192:195], v[24:27], a[56:59], v[192:195]
    ds_read_b64_tr_b16 v[36:37], v9 offset:36864
    v_mul_f32 v59, 0x3fb8aa3b, v151
    v_mfma_f32_16x16x32_bf16 v[192:195], v[28:31], a[60:63], v[192:195]
    ds_read_b64_tr_b16 v[38:39], v9 offset:37376
    v_min_f32 v56, 0x41e6d4ca, v56
    v_mfma_f32_16x16x32_bf16 v[196:199], v[16:19], a[112:115], v[196:199]
    ds_read_b64_tr_b16 v[40:41], v9 offset:49152
    v_min_f32 v57, 0x41e6d4ca, v57
    v_mfma_f32_16x16x32_bf16 v[196:199], v[20:23], a[116:119], v[196:199]
    ds_read_b64_tr_b16 v[42:43], v9 offset:49664
    v_min_f32 v58, 0x41e6d4ca, v58
    v_mfma_f32_16x16x32_bf16 v[196:199], v[24:27], a[120:123], v[196:199]
    ds_read_b64_tr_b16 v[44:45], v9 offset:53248
    v_min_f32 v59, 0x41e6d4ca, v59
    v_mfma_f32_16x16x32_bf16 v[196:199], v[28:31], a[124:127], v[196:199]
    ds_read_b64_tr_b16 v[46:47], v9 offset:53760
    v_mfma_f32_16x16x32_bf16 v[200:203], v[16:19], a[176:179], v[200:203]
    v_exp_f32 v56, v56
    v_mfma_f32_16x16x32_bf16 v[200:203], v[20:23], a[180:183], v[200:203]
    v_exp_f32 v57, v57
    v_mfma_f32_16x16x32_bf16 v[200:203], v[24:27], a[184:187], v[200:203]
    v_exp_f32 v58, v58
    v_mfma_f32_16x16x32_bf16 v[200:203], v[28:31], a[188:191], v[200:203]
    v_exp_f32 v59, v59
    v_mfma_f32_16x16x32_bf16 v[204:207], v[16:19], a[240:243], v[204:207]
    v_add_f32 v176, 2.0, v56
    v_add_f32 v177, 2.0, v57
    v_mfma_f32_16x16x32_bf16 v[204:207], v[20:23], a[244:247], v[204:207]
    v_add_f32 v178, 2.0, v58
    v_add_f32 v179, 2.0, v59
    v_mfma_f32_16x16x32_bf16 v[204:207], v[24:27], a[248:251], v[204:207]
    v_mul_f32 v148, v148, v56
    v_mul_f32 v149, v149, v57
    v_mfma_f32_16x16x32_bf16 v[204:207], v[28:31], a[252:255], v[204:207]
    s_waitcnt lgkmcnt(0)
    v_mul_f32 v150, v150, v58
    v_mfma_f32_16x16x32_bf16 v[208:211], v[32:35], a[48:51], v[208:211]
    ds_read_b64_tr_b16 v[16:17], v10 offset:32768
    v_mul_f32 v151, v151, v59
    v_mfma_f32_16x16x32_bf16 v[208:211], v[36:39], a[52:55], v[208:211]
    ds_read_b64_tr_b16 v[18:19], v10 offset:33280
    v_mul_f32 v148, v148, v176
    v_mfma_f32_16x16x32_bf16 v[208:211], v[40:43], a[56:59], v[208:211]
    ds_read_b64_tr_b16 v[20:21], v10 offset:36864
    v_mul_f32 v149, v149, v177
    v_mfma_f32_16x16x32_bf16 v[208:211], v[44:47], a[60:63], v[208:211]
    ds_read_b64_tr_b16 v[22:23], v10 offset:37376
    v_mul_f32 v150, v150, v178
    v_mfma_f32_16x16x32_bf16 v[212:215], v[32:35], a[112:115], v[212:215]
    ds_read_b64_tr_b16 v[24:25], v10 offset:49152
    buffer_store_dword v61, v60, s[8:11], s74 offen sc1
    v_mfma_f32_16x16x32_bf16 v[212:215], v[36:39], a[116:119], v[212:215]
    ds_read_b64_tr_b16 v[26:27], v10 offset:49664
    v_mul_f32 v151, v151, v179
    v_mfma_f32_16x16x32_bf16 v[212:215], v[40:43], a[120:123], v[212:215]
    ds_read_b64_tr_b16 v[28:29], v10 offset:53248
    v_fma_f32 v176, v56, v176, 2.0
    v_mfma_f32_16x16x32_bf16 v[212:215], v[44:47], a[124:127], v[212:215]
    ds_read_b64_tr_b16 v[30:31], v10 offset:53760
    v_fma_f32 v177, v57, v177, 2.0
    v_mfma_f32_16x16x32_bf16 v[216:219], v[32:35], a[176:179], v[216:219]
    v_fma_f32 v178, v58, v178, 2.0
    v_fma_f32 v179, v59, v179, 2.0
    v_mfma_f32_16x16x32_bf16 v[216:219], v[36:39], a[180:183], v[216:219]
    v_rcp_f32 v176, v176
    v_mfma_f32_16x16x32_bf16 v[216:219], v[40:43], a[184:187], v[216:219]
    v_rcp_f32 v177, v177
    v_mfma_f32_16x16x32_bf16 v[216:219], v[44:47], a[188:191], v[216:219]
    v_rcp_f32 v178, v178
    v_mfma_f32_16x16x32_bf16 v[220:223], v[32:35], a[240:243], v[220:223]
    v_rcp_f32 v179, v179
    v_mfma_f32_16x16x32_bf16 v[220:223], v[36:39], a[244:247], v[220:223]
    v_mul_f32 v148, v148, v176
    v_mul_f32 v149, v149, v177
    v_mfma_f32_16x16x32_bf16 v[220:223], v[40:43], a[248:251], v[220:223]
    v_mul_f32 v150, v150, v178
    v_mul_f32 v151, v151, v179
    v_mfma_f32_16x16x32_bf16 v[220:223], v[44:47], a[252:255], v[220:223]
    s_waitcnt lgkmcnt(0)
    v_cvt_pk_bf16_f32 v132, v132, v133
    v_mfma_f32_16x16x32_bf16 v[224:227], v[16:19], a[48:51], v[224:227]
    ds_read_b64_tr_b16 v[32:33], v11 offset:32768
    v_cvt_pk_bf16_f32 v133, v134, v135
    v_mfma_f32_16x16x32_bf16 v[224:227], v[20:23], a[52:55], v[224:227]
    ds_read_b64_tr_b16 v[34:35], v11 offset:33280
    v_cvt_pk_bf16_f32 v134, v148, v149
    v_mfma_f32_16x16x32_bf16 v[224:227], v[24:27], a[56:59], v[224:227]
    ds_read_b64_tr_b16 v[36:37], v11 offset:36864
    v_cvt_pk_bf16_f32 v135, v150, v151
    v_mfma_f32_16x16x32_bf16 v[224:227], v[28:31], a[60:63], v[224:227]
    ds_read_b64_tr_b16 v[38:39], v11 offset:37376
    buffer_store_dwordx4 v[132:135], v13, s[8:11], s76 offen sc1
    v_mfma_f32_16x16x32_bf16 v[228:231], v[16:19], a[112:115], v[228:231]
    ds_read_b64_tr_b16 v[40:41], v11 offset:49152
    v_mul_f32 v56, 0x3fb8aa3b, v136
    v_mfma_f32_16x16x32_bf16 v[228:231], v[20:23], a[116:119], v[228:231]
    ds_read_b64_tr_b16 v[42:43], v11 offset:49664
    v_mul_f32 v57, 0x3fb8aa3b, v137
    v_mfma_f32_16x16x32_bf16 v[228:231], v[24:27], a[120:123], v[228:231]
    ds_read_b64_tr_b16 v[44:45], v11 offset:53248
    v_mul_f32 v58, 0x3fb8aa3b, v138
    v_mfma_f32_16x16x32_bf16 v[228:231], v[28:31], a[124:127], v[228:231]
    ds_read_b64_tr_b16 v[46:47], v11 offset:53760
    v_mul_f32 v59, 0x3fb8aa3b, v139
    v_mfma_f32_16x16x32_bf16 v[232:235], v[16:19], a[176:179], v[232:235]
    buffer_load_dword v3, v62, s[8:11], s47 offen sc1
    v_min_f32 v56, 0x41e6d4ca, v56
    v_mfma_f32_16x16x32_bf16 v[232:235], v[20:23], a[180:183], v[232:235]
    v_min_f32 v57, 0x41e6d4ca, v57
    v_min_f32 v58, 0x41e6d4ca, v58
    v_mfma_f32_16x16x32_bf16 v[232:235], v[24:27], a[184:187], v[232:235]
    v_min_f32 v59, 0x41e6d4ca, v59
    v_mfma_f32_16x16x32_bf16 v[232:235], v[28:31], a[188:191], v[232:235]
    v_exp_f32 v56, v56
    v_mfma_f32_16x16x32_bf16 v[236:239], v[16:19], a[240:243], v[236:239]
    v_exp_f32 v57, v57
    v_mfma_f32_16x16x32_bf16 v[236:239], v[20:23], a[244:247], v[236:239]
    v_exp_f32 v58, v58
    v_mfma_f32_16x16x32_bf16 v[236:239], v[24:27], a[248:251], v[236:239]
    v_exp_f32 v59, v59
    v_mfma_f32_16x16x32_bf16 v[236:239], v[28:31], a[252:255], v[236:239]
    s_waitcnt vmcnt(21) lgkmcnt(0)
    s_barrier
    s_load_dwordx2 s[28:29], s[0:1], 40
    s_load_dwordx2 s[12:13], s[0:1], 72
    s_load_dwordx2 s[16:17], s[0:1], 0
    s_load_dwordx2 s[20:21], s[0:1], 80
    s_mov_b32 s30, 4194304
    s_mov_b32 s14, 1409024
    s_mov_b32 s18, 2097152
    s_mov_b32 s22, 2097152
    s_waitcnt lgkmcnt(0)
    v_mfma_f32_16x16x32_bf16 v[240:243], v[32:35], a[48:51], v[240:243]
    v_xor_b32 v8, 0x10000, v8
    v_add_f32 v176, 2.0, v56
    v_mfma_f32_16x16x32_bf16 v[240:243], v[36:39], a[52:55], v[240:243]
    ds_read_b64_tr_b16 v[16:17], v8 offset:40960
    v_add_f32 v177, 2.0, v57
    v_mfma_f32_16x16x32_bf16 v[240:243], v[40:43], a[56:59], v[240:243]
    ds_read_b64_tr_b16 v[18:19], v8 offset:41472
    v_add_f32 v178, 2.0, v58
    v_mfma_f32_16x16x32_bf16 v[240:243], v[44:47], a[60:63], v[240:243]
    ds_read_b64_tr_b16 v[20:21], v8 offset:45056
    v_add_f32 v179, 2.0, v59
    v_mfma_f32_16x16x32_bf16 v[244:247], v[32:35], a[112:115], v[244:247]
    ds_read_b64_tr_b16 v[22:23], v8 offset:45568
    v_mul_f32 v136, v136, v56
    v_mfma_f32_16x16x32_bf16 v[244:247], v[36:39], a[116:119], v[244:247]
    ds_read_b64_tr_b16 v[24:25], v8 offset:57344
    v_mul_f32 v137, v137, v57
    v_mfma_f32_16x16x32_bf16 v[244:247], v[40:43], a[120:123], v[244:247]
    ds_read_b64_tr_b16 v[26:27], v8 offset:57856
    v_mul_f32 v138, v138, v58
    v_mfma_f32_16x16x32_bf16 v[244:247], v[44:47], a[124:127], v[244:247]
    ds_read_b64_tr_b16 v[28:29], v8 offset:61440
    v_mul_f32 v139, v139, v59
    v_mfma_f32_16x16x32_bf16 v[248:251], v[32:35], a[176:179], v[248:251]
    ds_read_b64_tr_b16 v[30:31], v8 offset:61952
    v_mul_f32 v136, v136, v176
    v_mfma_f32_16x16x32_bf16 v[248:251], v[36:39], a[180:183], v[248:251]
    v_mul_f32 v137, v137, v177
    v_mul_f32 v138, v138, v178
    v_mfma_f32_16x16x32_bf16 v[248:251], v[40:43], a[184:187], v[248:251]
    v_mul_f32 v139, v139, v179
    v_fma_f32 v176, v56, v176, 2.0
    v_mfma_f32_16x16x32_bf16 v[248:251], v[44:47], a[188:191], v[248:251]
    v_fma_f32 v177, v57, v177, 2.0
    v_fma_f32 v178, v58, v178, 2.0
    v_mfma_f32_16x16x32_bf16 v[252:255], v[32:35], a[240:243], v[252:255]
    v_fma_f32 v179, v59, v179, 2.0
    v_mfma_f32_16x16x32_bf16 v[252:255], v[36:39], a[244:247], v[252:255]
    v_rcp_f32 v176, v176
    v_mfma_f32_16x16x32_bf16 v[252:255], v[40:43], a[248:251], v[252:255]
    v_rcp_f32 v177, v177
    v_mfma_f32_16x16x32_bf16 v[252:255], v[44:47], a[252:255], v[252:255]
    v_rcp_f32 v178, v178
    s_waitcnt lgkmcnt(0)
    v_mfma_f32_16x16x32_bf16 v[64:67], v[16:19], a[0:3], 0
    v_xor_b32 v9, 0x10000, v9
    v_mfma_f32_16x16x32_bf16 v[64:67], v[20:23], a[4:7], v[64:67]
    ds_read_b64_tr_b16 v[32:33], v9 offset:40960
    s_lshl_b32 s55, s2, 15
    v_mfma_f32_16x16x32_bf16 v[64:67], v[24:27], a[8:11], v[64:67]
    ds_read_b64_tr_b16 v[34:35], v9 offset:41472
    s_lshl_b32 s54, s40, 13
    v_mfma_f32_16x16x32_bf16 v[64:67], v[28:31], a[12:15], v[64:67]
    ds_read_b64_tr_b16 v[36:37], v9 offset:45056
    s_add_u32 s55, s55, s54
    v_mfma_f32_16x16x32_bf16 v[68:71], v[16:19], a[64:67], 0
    ds_read_b64_tr_b16 v[38:39], v9 offset:45568
    s_add_u32 s55, s55, 58110976
    v_mfma_f32_16x16x32_bf16 v[68:71], v[20:23], a[68:71], v[68:71]
    ds_read_b64_tr_b16 v[40:41], v9 offset:57344
    v_mov_b32 v180, -1
    v_mfma_f32_16x16x32_bf16 v[68:71], v[24:27], a[72:75], v[68:71]
    ds_read_b64_tr_b16 v[42:43], v9 offset:57856
    v_mov_b32 v181, -1
    v_mfma_f32_16x16x32_bf16 v[68:71], v[28:31], a[76:79], v[68:71]
    ds_read_b64_tr_b16 v[44:45], v9 offset:61440
    v_mov_b32 v182, -1
    v_mfma_f32_16x16x32_bf16 v[72:75], v[16:19], a[128:131], 0
    ds_read_b64_tr_b16 v[46:47], v9 offset:61952
    v_mov_b32 v183, -1
    v_mfma_f32_16x16x32_bf16 v[72:75], v[20:23], a[132:135], v[72:75]
    buffer_store_dwordx4 v[180:183], v7, s[8:11], s55 offen offset:0 sc1
    v_mfma_f32_16x16x32_bf16 v[72:75], v[24:27], a[136:139], v[72:75]
    v_cvt_pk_bf16_f32 v192, v192, v193
    v_cvt_pk_bf16_f32 v193, v194, v195
    v_mfma_f32_16x16x32_bf16 v[72:75], v[28:31], a[140:143], v[72:75]
    v_cvt_pk_bf16_f32 v194, v208, v209
    v_cvt_pk_bf16_f32 v195, v210, v211
    v_mfma_f32_16x16x32_bf16 v[76:79], v[16:19], a[192:195], 0
    v_cvt_pk_bf16_f32 v224, v224, v225
    v_cvt_pk_bf16_f32 v225, v226, v227
    v_mfma_f32_16x16x32_bf16 v[76:79], v[20:23], a[196:199], v[76:79]
    v_cvt_pk_bf16_f32 v226, v240, v241
    v_cvt_pk_bf16_f32 v227, v242, v243
    v_mfma_f32_16x16x32_bf16 v[76:79], v[24:27], a[200:203], v[76:79]
    v_cvt_pk_bf16_f32 v196, v196, v197
    v_cvt_pk_bf16_f32 v197, v198, v199
    v_mfma_f32_16x16x32_bf16 v[76:79], v[28:31], a[204:207], v[76:79]
    s_waitcnt lgkmcnt(0)
    buffer_store_dwordx4 v[180:183], v7, s[8:11], s55 offen offset:1024 sc1
    v_mfma_f32_16x16x32_bf16 v[80:83], v[32:35], a[0:3], 0
    v_xor_b32 v10, 0x10000, v10
    v_cvt_pk_bf16_f32 v198, v212, v213
    v_mfma_f32_16x16x32_bf16 v[80:83], v[36:39], a[4:7], v[80:83]
    ds_read_b64_tr_b16 v[16:17], v10 offset:40960
    v_cvt_pk_bf16_f32 v199, v214, v215
    v_mfma_f32_16x16x32_bf16 v[80:83], v[40:43], a[8:11], v[80:83]
    ds_read_b64_tr_b16 v[18:19], v10 offset:41472
    v_cvt_pk_bf16_f32 v228, v228, v229
    v_mfma_f32_16x16x32_bf16 v[80:83], v[44:47], a[12:15], v[80:83]
    ds_read_b64_tr_b16 v[20:21], v10 offset:45056
    v_cvt_pk_bf16_f32 v229, v230, v231
    v_mfma_f32_16x16x32_bf16 v[84:87], v[32:35], a[64:67], 0
    ds_read_b64_tr_b16 v[22:23], v10 offset:45568
    v_cvt_pk_bf16_f32 v230, v244, v245
    v_mfma_f32_16x16x32_bf16 v[84:87], v[36:39], a[68:71], v[84:87]
    ds_read_b64_tr_b16 v[24:25], v10 offset:57344
    v_cvt_pk_bf16_f32 v231, v246, v247
    v_mfma_f32_16x16x32_bf16 v[84:87], v[40:43], a[72:75], v[84:87]
    ds_read_b64_tr_b16 v[26:27], v10 offset:57856
    v_cvt_pk_bf16_f32 v200, v200, v201
    v_mfma_f32_16x16x32_bf16 v[84:87], v[44:47], a[76:79], v[84:87]
    ds_read_b64_tr_b16 v[28:29], v10 offset:61440
    v_cvt_pk_bf16_f32 v201, v202, v203
    v_mfma_f32_16x16x32_bf16 v[88:91], v[32:35], a[128:131], 0
    ds_read_b64_tr_b16 v[30:31], v10 offset:61952
    v_cvt_pk_bf16_f32 v202, v216, v217
    v_mfma_f32_16x16x32_bf16 v[88:91], v[36:39], a[132:135], v[88:91]
    v_cvt_pk_bf16_f32 v203, v218, v219
    v_cvt_pk_bf16_f32 v232, v232, v233
    v_mfma_f32_16x16x32_bf16 v[88:91], v[40:43], a[136:139], v[88:91]
    v_cvt_pk_bf16_f32 v233, v234, v235
    v_cvt_pk_bf16_f32 v234, v248, v249
    v_mfma_f32_16x16x32_bf16 v[88:91], v[44:47], a[140:143], v[88:91]
    v_cvt_pk_bf16_f32 v235, v250, v251
    v_cvt_pk_bf16_f32 v204, v204, v205
    v_mfma_f32_16x16x32_bf16 v[92:95], v[32:35], a[192:195], 0
    v_cvt_pk_bf16_f32 v205, v206, v207
    v_cvt_pk_bf16_f32 v206, v220, v221
    v_mfma_f32_16x16x32_bf16 v[92:95], v[36:39], a[196:199], v[92:95]
    v_cvt_pk_bf16_f32 v207, v222, v223
    v_cvt_pk_bf16_f32 v236, v236, v237
    v_mfma_f32_16x16x32_bf16 v[92:95], v[40:43], a[200:203], v[92:95]
    buffer_store_dwordx4 v[180:183], v7, s[8:11], s55 offen offset:2048 sc1
    v_cvt_pk_bf16_f32 v237, v238, v239
    v_mfma_f32_16x16x32_bf16 v[92:95], v[44:47], a[204:207], v[92:95]
    s_waitcnt lgkmcnt(0)
    v_cvt_pk_bf16_f32 v238, v252, v253
    v_mfma_f32_16x16x32_bf16 v[96:99], v[16:19], a[0:3], 0
    v_xor_b32 v11, 0x10000, v11
    v_cvt_pk_bf16_f32 v239, v254, v255
    v_mfma_f32_16x16x32_bf16 v[96:99], v[20:23], a[4:7], v[96:99]
    ds_read_b64_tr_b16 v[32:33], v11 offset:40960
    v_mfma_f32_16x16x32_bf16 v[96:99], v[24:27], a[8:11], v[96:99]
    ds_read_b64_tr_b16 v[34:35], v11 offset:41472
    v_mfma_f32_16x16x32_bf16 v[96:99], v[28:31], a[12:15], v[96:99]
    ds_read_b64_tr_b16 v[36:37], v11 offset:45056
    v_mfma_f32_16x16x32_bf16 v[100:103], v[16:19], a[64:67], 0
    ds_read_b64_tr_b16 v[38:39], v11 offset:45568
    v_mfma_f32_16x16x32_bf16 v[100:103], v[20:23], a[68:71], v[100:103]
    ds_read_b64_tr_b16 v[40:41], v11 offset:57344
    v_mfma_f32_16x16x32_bf16 v[100:103], v[24:27], a[72:75], v[100:103]
    ds_read_b64_tr_b16 v[42:43], v11 offset:57856
    v_mfma_f32_16x16x32_bf16 v[100:103], v[28:31], a[76:79], v[100:103]
    ds_read_b64_tr_b16 v[44:45], v11 offset:61440
    v_mfma_f32_16x16x32_bf16 v[104:107], v[16:19], a[128:131], 0
    ds_read_b64_tr_b16 v[46:47], v11 offset:61952
    v_mfma_f32_16x16x32_bf16 v[104:107], v[20:23], a[132:135], v[104:107]
    v_rcp_f32 v179, v179
    v_mfma_f32_16x16x32_bf16 v[104:107], v[24:27], a[136:139], v[104:107]
    v_mul_f32 v136, v136, v176
    v_mul_f32 v137, v137, v177
    v_mfma_f32_16x16x32_bf16 v[104:107], v[28:31], a[140:143], v[104:107]
    v_mul_f32 v138, v138, v178
    v_mul_f32 v139, v139, v179
    v_mfma_f32_16x16x32_bf16 v[108:111], v[16:19], a[192:195], 0
    v_mul_f32 v56, 0x3fb8aa3b, v152
    v_mul_f32 v57, 0x3fb8aa3b, v153
    v_mfma_f32_16x16x32_bf16 v[108:111], v[20:23], a[196:199], v[108:111]
    buffer_store_dwordx4 v[180:183], v7, s[8:11], s55 offen offset:3072 sc1
    v_mul_f32 v58, 0x3fb8aa3b, v154
    v_mfma_f32_16x16x32_bf16 v[108:111], v[24:27], a[200:203], v[108:111]
    v_mul_f32 v59, 0x3fb8aa3b, v155
    v_min_f32 v56, 0x41e6d4ca, v56
    v_mfma_f32_16x16x32_bf16 v[108:111], v[28:31], a[204:207], v[108:111]
    s_waitcnt vmcnt(17) lgkmcnt(0)
    s_barrier
    v_mfma_f32_16x16x32_bf16 v[112:115], v[32:35], a[0:3], 0
    v_xor_b32 v8, 0x10000, v8
    v_min_f32 v57, 0x41e6d4ca, v57
    v_mfma_f32_16x16x32_bf16 v[112:115], v[36:39], a[4:7], v[112:115]
    ds_read_b64_tr_b16 v[16:17], v8 offset:8192
    v_min_f32 v58, 0x41e6d4ca, v58
    v_mfma_f32_16x16x32_bf16 v[112:115], v[40:43], a[8:11], v[112:115]
    ds_read_b64_tr_b16 v[18:19], v8 offset:8704
    v_min_f32 v59, 0x41e6d4ca, v59
    v_mfma_f32_16x16x32_bf16 v[112:115], v[44:47], a[12:15], v[112:115]
    ds_read_b64_tr_b16 v[20:21], v8 offset:12288
    v_mfma_f32_16x16x32_bf16 v[116:119], v[32:35], a[64:67], 0
    ds_read_b64_tr_b16 v[22:23], v8 offset:12800
    v_mfma_f32_16x16x32_bf16 v[116:119], v[36:39], a[68:71], v[116:119]
    ds_read_b64_tr_b16 v[24:25], v8 offset:24576
    v_mfma_f32_16x16x32_bf16 v[116:119], v[40:43], a[72:75], v[116:119]
    ds_read_b64_tr_b16 v[26:27], v8 offset:25088
    v_mfma_f32_16x16x32_bf16 v[116:119], v[44:47], a[76:79], v[116:119]
    ds_read_b64_tr_b16 v[28:29], v8 offset:28672
    v_mfma_f32_16x16x32_bf16 v[120:123], v[32:35], a[128:131], 0
    ds_read_b64_tr_b16 v[30:31], v8 offset:29184
    v_mfma_f32_16x16x32_bf16 v[120:123], v[36:39], a[132:135], v[120:123]
    v_exp_f32 v56, v56
    v_mfma_f32_16x16x32_bf16 v[120:123], v[40:43], a[136:139], v[120:123]
    v_exp_f32 v57, v57
    v_mfma_f32_16x16x32_bf16 v[120:123], v[44:47], a[140:143], v[120:123]
    v_exp_f32 v58, v58
    v_mfma_f32_16x16x32_bf16 v[124:127], v[32:35], a[192:195], 0
    v_exp_f32 v59, v59
    v_mfma_f32_16x16x32_bf16 v[124:127], v[36:39], a[196:199], v[124:127]
    v_add_f32 v176, 2.0, v56
    v_add_f32 v177, 2.0, v57
    v_mfma_f32_16x16x32_bf16 v[124:127], v[40:43], a[200:203], v[124:127]
    v_add_f32 v178, 2.0, v58
    v_add_f32 v179, 2.0, v59
    v_mfma_f32_16x16x32_bf16 v[124:127], v[44:47], a[204:207], v[124:127]
    v_mul_f32 v152, v152, v56
    v_mul_f32 v153, v153, v57
    s_waitcnt lgkmcnt(0)
    v_mfma_f32_16x16x32_bf16 v[64:67], v[16:19], a[16:19], v[64:67]
    v_xor_b32 v9, 0x10000, v9
    v_accvgpr_write_b32 a0, v192
    v_mfma_f32_16x16x32_bf16 v[64:67], v[20:23], a[20:23], v[64:67]
    ds_read_b64_tr_b16 v[32:33], v9 offset:8192
    s_lshl_b32 s55, s2, 15
    v_mfma_f32_16x16x32_bf16 v[64:67], v[24:27], a[24:27], v[64:67]
    ds_read_b64_tr_b16 v[34:35], v9 offset:8704
    s_lshl_b32 s54, s40, 13
    v_mfma_f32_16x16x32_bf16 v[64:67], v[28:31], a[28:31], v[64:67]
    ds_read_b64_tr_b16 v[36:37], v9 offset:12288
    s_add_u32 s55, s55, s54
    v_mfma_f32_16x16x32_bf16 v[68:71], v[16:19], a[80:83], v[68:71]
    ds_read_b64_tr_b16 v[38:39], v9 offset:12800
    s_add_u32 s55, s55, 58115072
    v_mfma_f32_16x16x32_bf16 v[68:71], v[20:23], a[84:87], v[68:71]
    ds_read_b64_tr_b16 v[40:41], v9 offset:24576
    v_mov_b32 v180, -1
    v_mfma_f32_16x16x32_bf16 v[68:71], v[24:27], a[88:91], v[68:71]
    ds_read_b64_tr_b16 v[42:43], v9 offset:25088
    v_mov_b32 v181, -1
    v_mfma_f32_16x16x32_bf16 v[68:71], v[28:31], a[92:95], v[68:71]
    ds_read_b64_tr_b16 v[44:45], v9 offset:28672
    v_mov_b32 v182, -1
    v_mfma_f32_16x16x32_bf16 v[72:75], v[16:19], a[144:147], v[72:75]
    ds_read_b64_tr_b16 v[46:47], v9 offset:29184
    v_mov_b32 v183, -1
    v_mfma_f32_16x16x32_bf16 v[72:75], v[20:23], a[148:151], v[72:75]
    buffer_store_dwordx4 v[180:183], v7, s[8:11], s55 offen offset:0 sc1
    v_accvgpr_write_b32 a1, v193
    v_mfma_f32_16x16x32_bf16 v[72:75], v[24:27], a[152:155], v[72:75]
    v_accvgpr_write_b32 a2, v194
    v_accvgpr_write_b32 a3, v195
    v_mfma_f32_16x16x32_bf16 v[72:75], v[28:31], a[156:159], v[72:75]
    v_accvgpr_write_b32 a4, v224
    v_accvgpr_write_b32 a5, v225
    v_mfma_f32_16x16x32_bf16 v[76:79], v[16:19], a[208:211], v[76:79]
    buffer_store_dwordx4 v[180:183], v7, s[8:11], s55 offen offset:1024 sc1
    v_accvgpr_write_b32 a6, v226
    v_mfma_f32_16x16x32_bf16 v[76:79], v[20:23], a[212:215], v[76:79]
    v_accvgpr_write_b32 a7, v227
    v_accvgpr_write_b32 a64, v196
    v_mfma_f32_16x16x32_bf16 v[76:79], v[24:27], a[216:219], v[76:79]
    v_accvgpr_write_b32 a65, v197
    v_accvgpr_write_b32 a66, v198
    v_mfma_f32_16x16x32_bf16 v[76:79], v[28:31], a[220:223], v[76:79]
    s_waitcnt lgkmcnt(0)
    v_accvgpr_write_b32 a67, v199
    v_mfma_f32_16x16x32_bf16 v[80:83], v[32:35], a[16:19], v[80:83]
    v_xor_b32 v10, 0x10000, v10
    v_accvgpr_write_b32 a68, v228
    v_mfma_f32_16x16x32_bf16 v[80:83], v[36:39], a[20:23], v[80:83]
    ds_read_b64_tr_b16 v[16:17], v10 offset:8192
    v_accvgpr_write_b32 a69, v229
    v_mfma_f32_16x16x32_bf16 v[80:83], v[40:43], a[24:27], v[80:83]
    ds_read_b64_tr_b16 v[18:19], v10 offset:8704
    v_accvgpr_write_b32 a70, v230
    v_mfma_f32_16x16x32_bf16 v[80:83], v[44:47], a[28:31], v[80:83]
    ds_read_b64_tr_b16 v[20:21], v10 offset:12288
    v_accvgpr_write_b32 a71, v231
    v_mfma_f32_16x16x32_bf16 v[84:87], v[32:35], a[80:83], v[84:87]
    ds_read_b64_tr_b16 v[22:23], v10 offset:12800
    v_accvgpr_write_b32 a128, v200
    v_mfma_f32_16x16x32_bf16 v[84:87], v[36:39], a[84:87], v[84:87]
    ds_read_b64_tr_b16 v[24:25], v10 offset:24576
    v_accvgpr_write_b32 a129, v201
    v_mfma_f32_16x16x32_bf16 v[84:87], v[40:43], a[88:91], v[84:87]
    ds_read_b64_tr_b16 v[26:27], v10 offset:25088
    v_accvgpr_write_b32 a130, v202
    v_mfma_f32_16x16x32_bf16 v[84:87], v[44:47], a[92:95], v[84:87]
    ds_read_b64_tr_b16 v[28:29], v10 offset:28672
    v_accvgpr_write_b32 a131, v203
    v_mfma_f32_16x16x32_bf16 v[88:91], v[32:35], a[144:147], v[88:91]
    ds_read_b64_tr_b16 v[30:31], v10 offset:29184
    buffer_store_dwordx4 v[180:183], v7, s[8:11], s55 offen offset:2048 sc1
    v_mfma_f32_16x16x32_bf16 v[88:91], v[36:39], a[148:151], v[88:91]
    v_accvgpr_write_b32 a132, v232
    v_accvgpr_write_b32 a133, v233
    v_mfma_f32_16x16x32_bf16 v[88:91], v[40:43], a[152:155], v[88:91]
    v_accvgpr_write_b32 a134, v234
    v_accvgpr_write_b32 a135, v235
    v_mfma_f32_16x16x32_bf16 v[88:91], v[44:47], a[156:159], v[88:91]
    v_accvgpr_write_b32 a192, v204
    v_accvgpr_write_b32 a193, v205
    v_mfma_f32_16x16x32_bf16 v[92:95], v[32:35], a[208:211], v[92:95]
    v_accvgpr_write_b32 a194, v206
    v_accvgpr_write_b32 a195, v207
    v_mfma_f32_16x16x32_bf16 v[92:95], v[36:39], a[212:215], v[92:95]
    v_accvgpr_write_b32 a196, v236
    v_accvgpr_write_b32 a197, v237
    v_mfma_f32_16x16x32_bf16 v[92:95], v[40:43], a[216:219], v[92:95]
    v_accvgpr_write_b32 a198, v238
    v_accvgpr_write_b32 a199, v239
    v_mfma_f32_16x16x32_bf16 v[92:95], v[44:47], a[220:223], v[92:95]
    s_waitcnt lgkmcnt(0)
    v_mul_f32 v154, v154, v58
    v_mfma_f32_16x16x32_bf16 v[96:99], v[16:19], a[16:19], v[96:99]
    v_xor_b32 v11, 0x10000, v11
    v_mul_f32 v155, v155, v59
    v_mfma_f32_16x16x32_bf16 v[96:99], v[20:23], a[20:23], v[96:99]
    ds_read_b64_tr_b16 v[32:33], v11 offset:8192
    v_mul_f32 v152, v152, v176
    v_mfma_f32_16x16x32_bf16 v[96:99], v[24:27], a[24:27], v[96:99]
    ds_read_b64_tr_b16 v[34:35], v11 offset:8704
    v_mul_f32 v153, v153, v177
    v_mfma_f32_16x16x32_bf16 v[96:99], v[28:31], a[28:31], v[96:99]
    ds_read_b64_tr_b16 v[36:37], v11 offset:12288
    v_mul_f32 v154, v154, v178
    v_mfma_f32_16x16x32_bf16 v[100:103], v[16:19], a[80:83], v[100:103]
    ds_read_b64_tr_b16 v[38:39], v11 offset:12800
    buffer_store_dwordx4 v[180:183], v7, s[8:11], s55 offen offset:3072 sc1
    v_mfma_f32_16x16x32_bf16 v[100:103], v[20:23], a[84:87], v[100:103]
    ds_read_b64_tr_b16 v[40:41], v11 offset:24576
    v_mul_f32 v155, v155, v179
    v_mfma_f32_16x16x32_bf16 v[100:103], v[24:27], a[88:91], v[100:103]
    ds_read_b64_tr_b16 v[42:43], v11 offset:25088
    v_fma_f32 v176, v56, v176, 2.0
    v_mfma_f32_16x16x32_bf16 v[100:103], v[28:31], a[92:95], v[100:103]
    ds_read_b64_tr_b16 v[44:45], v11 offset:28672
    v_fma_f32 v177, v57, v177, 2.0
    v_mfma_f32_16x16x32_bf16 v[104:107], v[16:19], a[144:147], v[104:107]
    ds_read_b64_tr_b16 v[46:47], v11 offset:29184
    v_fma_f32 v178, v58, v178, 2.0
    v_mfma_f32_16x16x32_bf16 v[104:107], v[20:23], a[148:151], v[104:107]
    v_fma_f32 v179, v59, v179, 2.0
    v_mfma_f32_16x16x32_bf16 v[104:107], v[24:27], a[152:155], v[104:107]
    v_rcp_f32 v176, v176
    v_mfma_f32_16x16x32_bf16 v[104:107], v[28:31], a[156:159], v[104:107]
    v_rcp_f32 v177, v177
    v_mfma_f32_16x16x32_bf16 v[108:111], v[16:19], a[208:211], v[108:111]
    v_rcp_f32 v178, v178
    v_mfma_f32_16x16x32_bf16 v[108:111], v[20:23], a[212:215], v[108:111]
    v_rcp_f32 v179, v179
    v_mfma_f32_16x16x32_bf16 v[108:111], v[24:27], a[216:219], v[108:111]
    v_mul_f32 v152, v152, v176
    v_mul_f32 v153, v153, v177
    v_mfma_f32_16x16x32_bf16 v[108:111], v[28:31], a[220:223], v[108:111]
    s_waitcnt vmcnt(15) lgkmcnt(0)
    s_barrier
    v_mfma_f32_16x16x32_bf16 v[112:115], v[32:35], a[16:19], v[112:115]
    ds_read_b64_tr_b16 v[16:17], v8 offset:40960
    v_mul_f32 v154, v154, v178
    v_mfma_f32_16x16x32_bf16 v[112:115], v[36:39], a[20:23], v[112:115]
    ds_read_b64_tr_b16 v[18:19], v8 offset:41472
    v_mul_f32 v155, v155, v179
    v_mfma_f32_16x16x32_bf16 v[112:115], v[40:43], a[24:27], v[112:115]
    ds_read_b64_tr_b16 v[20:21], v8 offset:45056
    v_cvt_pk_bf16_f32 v136, v136, v137
    v_mfma_f32_16x16x32_bf16 v[112:115], v[44:47], a[28:31], v[112:115]
    ds_read_b64_tr_b16 v[22:23], v8 offset:45568
    v_cvt_pk_bf16_f32 v137, v138, v139
    v_mfma_f32_16x16x32_bf16 v[116:119], v[32:35], a[80:83], v[116:119]
    ds_read_b64_tr_b16 v[24:25], v8 offset:57344
    v_cvt_pk_bf16_f32 v138, v152, v153
    v_mfma_f32_16x16x32_bf16 v[116:119], v[36:39], a[84:87], v[116:119]
    ds_read_b64_tr_b16 v[26:27], v8 offset:57856
    v_cvt_pk_bf16_f32 v139, v154, v155
    v_mfma_f32_16x16x32_bf16 v[116:119], v[40:43], a[88:91], v[116:119]
    ds_read_b64_tr_b16 v[28:29], v8 offset:61440
    buffer_store_dwordx4 v[136:139], v14, s[8:11], s76 offen sc1
    v_mfma_f32_16x16x32_bf16 v[116:119], v[44:47], a[92:95], v[116:119]
    ds_read_b64_tr_b16 v[30:31], v8 offset:61952
    v_mul_f32 v56, 0x3fb8aa3b, v140
    v_mfma_f32_16x16x32_bf16 v[120:123], v[32:35], a[144:147], v[120:123]
    s_waitcnt vmcnt(9)
    v_cmp_eq_u32 vcc, 0, v3
    s_nop 0
    s_cbranch_vccnz mg_ps_11
mg_pb_12:
    v_mfma_f32_16x16x32_bf16 v[120:123], v[36:39], a[148:151], v[120:123]
    v_mul_f32 v57, 0x3fb8aa3b, v141
    v_mul_f32 v58, 0x3fb8aa3b, v142
    v_mfma_f32_16x16x32_bf16 v[120:123], v[40:43], a[152:155], v[120:123]
    v_mul_f32 v59, 0x3fb8aa3b, v143
    v_min_f32 v56, 0x41e6d4ca, v56
    v_mfma_f32_16x16x32_bf16 v[120:123], v[44:47], a[156:159], v[120:123]
    v_min_f32 v57, 0x41e6d4ca, v57
    v_min_f32 v58, 0x41e6d4ca, v58
    v_mfma_f32_16x16x32_bf16 v[124:127], v[32:35], a[208:211], v[124:127]
    v_min_f32 v59, 0x41e6d4ca, v59
    v_mfma_f32_16x16x32_bf16 v[124:127], v[36:39], a[212:215], v[124:127]
    v_exp_f32 v56, v56
    v_mfma_f32_16x16x32_bf16 v[124:127], v[40:43], a[216:219], v[124:127]
    v_exp_f32 v57, v57
    v_mfma_f32_16x16x32_bf16 v[124:127], v[44:47], a[220:223], v[124:127]
    v_exp_f32 v58, v58
    s_waitcnt lgkmcnt(0)
    v_mfma_f32_16x16x32_bf16 v[64:67], v[16:19], a[32:35], v[64:67]
    ds_read_b64_tr_b16 v[32:33], v9 offset:40960
    v_mfma_f32_16x16x32_bf16 v[64:67], v[20:23], a[36:39], v[64:67]
    ds_read_b64_tr_b16 v[34:35], v9 offset:41472
    v_mfma_f32_16x16x32_bf16 v[64:67], v[24:27], a[40:43], v[64:67]
    ds_read_b64_tr_b16 v[36:37], v9 offset:45056
    v_mfma_f32_16x16x32_bf16 v[64:67], v[28:31], a[44:47], v[64:67]
    ds_read_b64_tr_b16 v[38:39], v9 offset:45568
    v_mfma_f32_16x16x32_bf16 v[68:71], v[16:19], a[96:99], v[68:71]
    ds_read_b64_tr_b16 v[40:41], v9 offset:57344
    v_mfma_f32_16x16x32_bf16 v[68:71], v[20:23], a[100:103], v[68:71]
    ds_read_b64_tr_b16 v[42:43], v9 offset:57856
    v_mfma_f32_16x16x32_bf16 v[68:71], v[24:27], a[104:107], v[68:71]
    ds_read_b64_tr_b16 v[44:45], v9 offset:61440
    v_mfma_f32_16x16x32_bf16 v[68:71], v[28:31], a[108:111], v[68:71]
    ds_read_b64_tr_b16 v[46:47], v9 offset:61952
    v_mfma_f32_16x16x32_bf16 v[72:75], v[16:19], a[160:163], v[72:75]
    s_cmp_lg_u32 s44, 0
    s_cbranch_scc1 mg_fs_13
    s_add_u32 m0, s48, 0
    s_mov_b32 s71, 0
    buffer_load_dwordx4 v4, s[24:27], s71 offen offset:0 sc1 lds
    buffer_load_dwordx4 v4, s[24:27], s71 offen offset:1024 sc1 lds
    buffer_load_dwordx4 v4, s[24:27], s71 offen offset:2048 sc1 lds
    buffer_load_dwordx4 v4, s[24:27], s71 offen offset:3072 sc1 lds
mg_fs_13:
    v_mfma_f32_16x16x32_bf16 v[72:75], v[20:23], a[164:167], v[72:75]
    s_cmp_lg_u32 s44, 0
    s_cbranch_scc1 mg_fs_14
    s_add_u32 m0, s48, 16384
    s_mov_b32 s71, 8192
    buffer_load_dwordx4 v4, s[24:27], s71 offen offset:0 sc1 lds
    buffer_load_dwordx4 v4, s[24:27], s71 offen offset:1024 sc1 lds
    buffer_load_dwordx4 v4, s[24:27], s71 offen offset:2048 sc1 lds
    buffer_load_dwordx4 v4, s[24:27], s71 offen offset:3072 sc1 lds
mg_fs_14:
    v_mfma_f32_16x16x32_bf16 v[72:75], v[24:27], a[168:171], v[72:75]
    v_exp_f32 v59, v59
    v_mfma_f32_16x16x32_bf16 v[72:75], v[28:31], a[172:175], v[72:75]
    v_add_f32 v176, 2.0, v56
    v_add_f32 v177, 2.0, v57
    v_mfma_f32_16x16x32_bf16 v[76:79], v[16:19], a[224:227], v[76:79]
    s_cmp_lg_u32 s44, 0
    s_cbranch_scc1 mg_fs_15
    s_add_u32 m0, s48, 32768
    s_mov_b32 s71, 16384
    buffer_load_dwordx4 v4, s[24:27], s71 offen offset:0 sc1 lds
    buffer_load_dwordx4 v4, s[24:27], s71 offen offset:1024 sc1 lds
    buffer_load_dwordx4 v4, s[24:27], s71 offen offset:2048 sc1 lds
    buffer_load_dwordx4 v4, s[24:27], s71 offen offset:3072 sc1 lds
mg_fs_15:
    v_mfma_f32_16x16x32_bf16 v[76:79], v[20:23], a[228:231], v[76:79]
    v_add_f32 v178, 2.0, v58
    v_add_f32 v179, 2.0, v59
    v_mfma_f32_16x16x32_bf16 v[76:79], v[24:27], a[232:235], v[76:79]
    v_mul_f32 v140, v140, v56
    v_mul_f32 v141, v141, v57
    v_mfma_f32_16x16x32_bf16 v[76:79], v[28:31], a[236:239], v[76:79]
    s_waitcnt lgkmcnt(0)
    v_mul_f32 v142, v142, v58
    v_mfma_f32_16x16x32_bf16 v[80:83], v[32:35], a[32:35], v[80:83]
    ds_read_b64_tr_b16 v[16:17], v10 offset:40960
    v_mul_f32 v143, v143, v59
    v_mfma_f32_16x16x32_bf16 v[80:83], v[36:39], a[36:39], v[80:83]
    ds_read_b64_tr_b16 v[18:19], v10 offset:41472
    v_mul_f32 v140, v140, v176
    v_mfma_f32_16x16x32_bf16 v[80:83], v[40:43], a[40:43], v[80:83]
    ds_read_b64_tr_b16 v[20:21], v10 offset:45056
    v_mul_f32 v141, v141, v177
    v_mfma_f32_16x16x32_bf16 v[80:83], v[44:47], a[44:47], v[80:83]
    ds_read_b64_tr_b16 v[22:23], v10 offset:45568
    v_mul_f32 v142, v142, v178
    v_mfma_f32_16x16x32_bf16 v[84:87], v[32:35], a[96:99], v[84:87]
    ds_read_b64_tr_b16 v[24:25], v10 offset:57344
    v_mul_f32 v143, v143, v179
    v_mfma_f32_16x16x32_bf16 v[84:87], v[36:39], a[100:103], v[84:87]
    ds_read_b64_tr_b16 v[26:27], v10 offset:57856
    v_fma_f32 v176, v56, v176, 2.0
    v_mfma_f32_16x16x32_bf16 v[84:87], v[40:43], a[104:107], v[84:87]
    ds_read_b64_tr_b16 v[28:29], v10 offset:61440
    v_fma_f32 v177, v57, v177, 2.0
    v_mfma_f32_16x16x32_bf16 v[84:87], v[44:47], a[108:111], v[84:87]
    ds_read_b64_tr_b16 v[30:31], v10 offset:61952
    v_fma_f32 v178, v58, v178, 2.0
    v_mfma_f32_16x16x32_bf16 v[88:91], v[32:35], a[160:163], v[88:91]
    s_cmp_lg_u32 s44, 0
    s_cbranch_scc1 mg_fs_16
    s_add_u32 m0, s48, 49152
    s_mov_b32 s71, 24576
    buffer_load_dwordx4 v4, s[24:27], s71 offen offset:0 sc1 lds
    buffer_load_dwordx4 v4, s[24:27], s71 offen offset:1024 sc1 lds
    buffer_load_dwordx4 v4, s[24:27], s71 offen offset:2048 sc1 lds
    buffer_load_dwordx4 v4, s[24:27], s71 offen offset:3072 sc1 lds
mg_fs_16:
    v_mfma_f32_16x16x32_bf16 v[88:91], v[36:39], a[164:167], v[88:91]
    s_cmp_lg_u32 s44, 1
    s_cbranch_scc1 mg_fs_17
    s_add_u32 m0, s48, 32768
    s_mov_b32 s71, 16384
    buffer_load_dwordx4 v4, s[24:27], s71 offen offset:0 sc1 lds
    buffer_load_dwordx4 v4, s[24:27], s71 offen offset:1024 sc1 lds
    buffer_load_dwordx4 v4, s[24:27], s71 offen offset:2048 sc1 lds
    buffer_load_dwordx4 v4, s[24:27], s71 offen offset:3072 sc1 lds
mg_fs_17:
    v_mfma_f32_16x16x32_bf16 v[88:91], v[40:43], a[168:171], v[88:91]
    v_fma_f32 v179, v59, v179, 2.0
    v_mfma_f32_16x16x32_bf16 v[88:91], v[44:47], a[172:175], v[88:91]
    v_rcp_f32 v176, v176
    v_mfma_f32_16x16x32_bf16 v[92:95], v[32:35], a[224:227], v[92:95]
    s_cmp_lg_u32 s44, 1
    s_cbranch_scc1 mg_fs_18
    s_add_u32 m0, s48, 49152
    s_mov_b32 s71, 24576
    buffer_load_dwordx4 v4, s[24:27], s71 offen offset:0 sc1 lds
    buffer_load_dwordx4 v4, s[24:27], s71 offen offset:1024 sc1 lds
    buffer_load_dwordx4 v4, s[24:27], s71 offen offset:2048 sc1 lds
    buffer_load_dwordx4 v4, s[24:27], s71 offen offset:3072 sc1 lds
mg_fs_18:
    v_mfma_f32_16x16x32_bf16 v[92:95], v[36:39], a[228:231], v[92:95]
    v_rcp_f32 v177, v177
    v_mfma_f32_16x16x32_bf16 v[92:95], v[40:43], a[232:235], v[92:95]
    v_rcp_f32 v178, v178
    v_mfma_f32_16x16x32_bf16 v[92:95], v[44:47], a[236:239], v[92:95]
    s_waitcnt lgkmcnt(0)
    v_mfma_f32_16x16x32_bf16 v[96:99], v[16:19], a[32:35], v[96:99]
    ds_read_b64_tr_b16 v[32:33], v11 offset:40960
    v_mfma_f32_16x16x32_bf16 v[96:99], v[20:23], a[36:39], v[96:99]
    ds_read_b64_tr_b16 v[34:35], v11 offset:41472
    v_mfma_f32_16x16x32_bf16 v[96:99], v[24:27], a[40:43], v[96:99]
    ds_read_b64_tr_b16 v[36:37], v11 offset:45056
    v_mfma_f32_16x16x32_bf16 v[96:99], v[28:31], a[44:47], v[96:99]
    ds_read_b64_tr_b16 v[38:39], v11 offset:45568
    v_mfma_f32_16x16x32_bf16 v[100:103], v[16:19], a[96:99], v[100:103]
    ds_read_b64_tr_b16 v[40:41], v11 offset:57344
    v_mfma_f32_16x16x32_bf16 v[100:103], v[20:23], a[100:103], v[100:103]
    ds_read_b64_tr_b16 v[42:43], v11 offset:57856
    v_mfma_f32_16x16x32_bf16 v[100:103], v[24:27], a[104:107], v[100:103]
    ds_read_b64_tr_b16 v[44:45], v11 offset:61440
    v_mfma_f32_16x16x32_bf16 v[100:103], v[28:31], a[108:111], v[100:103]
    ds_read_b64_tr_b16 v[46:47], v11 offset:61952
    v_mfma_f32_16x16x32_bf16 v[104:107], v[16:19], a[160:163], v[104:107]
    s_cmp_lg_u32 s44, 1
    s_cbranch_scc1 mg_fs_19
    s_add_u32 m0, s48, 65536
    s_mov_b32 s71, 32768
    buffer_load_dwordx4 v4, s[24:27], s71 offen offset:0 sc1 lds
    buffer_load_dwordx4 v4, s[24:27], s71 offen offset:1024 sc1 lds
    buffer_load_dwordx4 v4, s[24:27], s71 offen offset:2048 sc1 lds
    buffer_load_dwordx4 v4, s[24:27], s71 offen offset:3072 sc1 lds
mg_fs_19:
    v_mfma_f32_16x16x32_bf16 v[104:107], v[20:23], a[164:167], v[104:107]
    s_cmp_lg_u32 s44, 1
    s_cbranch_scc1 mg_fs_20
    s_add_u32 m0, s48, 81920
    s_mov_b32 s71, 40960
    buffer_load_dwordx4 v4, s[24:27], s71 offen offset:0 sc1 lds
    buffer_load_dwordx4 v4, s[24:27], s71 offen offset:1024 sc1 lds
    buffer_load_dwordx4 v4, s[24:27], s71 offen offset:2048 sc1 lds
    buffer_load_dwordx4 v4, s[24:27], s71 offen offset:3072 sc1 lds
mg_fs_20:
    v_mfma_f32_16x16x32_bf16 v[104:107], v[24:27], a[168:171], v[104:107]
    v_rcp_f32 v179, v179
    v_mfma_f32_16x16x32_bf16 v[104:107], v[28:31], a[172:175], v[104:107]
    v_mul_f32 v140, v140, v176
    v_mul_f32 v141, v141, v177
    v_mfma_f32_16x16x32_bf16 v[108:111], v[16:19], a[224:227], v[108:111]
    v_mul_f32 v142, v142, v178
    v_mul_f32 v143, v143, v179
    v_mfma_f32_16x16x32_bf16 v[108:111], v[20:23], a[228:231], v[108:111]
    v_mul_f32 v56, 0x3fb8aa3b, v156
    v_mul_f32 v57, 0x3fb8aa3b, v157
    v_mfma_f32_16x16x32_bf16 v[108:111], v[24:27], a[232:235], v[108:111]
    v_mul_f32 v58, 0x3fb8aa3b, v158
    v_mul_f32 v59, 0x3fb8aa3b, v159
    v_mfma_f32_16x16x32_bf16 v[108:111], v[28:31], a[236:239], v[108:111]
    s_waitcnt vmcnt(12) lgkmcnt(0)
    s_barrier
    v_mfma_f32_16x16x32_bf16 v[112:115], v[32:35], a[32:35], v[112:115]
    v_xor_b32 v8, 0x10000, v8
    v_min_f32 v56, 0x41e6d4ca, v56
    v_mfma_f32_16x16x32_bf16 v[112:115], v[36:39], a[36:39], v[112:115]
    ds_read_b64_tr_b16 v[16:17], v8 offset:8192
    v_min_f32 v57, 0x41e6d4ca, v57
    v_mfma_f32_16x16x32_bf16 v[112:115], v[40:43], a[40:43], v[112:115]
    ds_read_b64_tr_b16 v[18:19], v8 offset:8704
    v_min_f32 v58, 0x41e6d4ca, v58
    v_mfma_f32_16x16x32_bf16 v[112:115], v[44:47], a[44:47], v[112:115]
    ds_read_b64_tr_b16 v[20:21], v8 offset:12288
    v_min_f32 v59, 0x41e6d4ca, v59
    v_mfma_f32_16x16x32_bf16 v[116:119], v[32:35], a[96:99], v[116:119]
    ds_read_b64_tr_b16 v[22:23], v8 offset:12800
    v_mfma_f32_16x16x32_bf16 v[116:119], v[36:39], a[100:103], v[116:119]
    ds_read_b64_tr_b16 v[24:25], v8 offset:24576
    v_mfma_f32_16x16x32_bf16 v[116:119], v[40:43], a[104:107], v[116:119]
    ds_read_b64_tr_b16 v[26:27], v8 offset:25088
    v_mfma_f32_16x16x32_bf16 v[116:119], v[44:47], a[108:111], v[116:119]
    ds_read_b64_tr_b16 v[28:29], v8 offset:28672
    v_mfma_f32_16x16x32_bf16 v[120:123], v[32:35], a[160:163], v[120:123]
    ds_read_b64_tr_b16 v[30:31], v8 offset:29184
    v_mfma_f32_16x16x32_bf16 v[120:123], v[36:39], a[164:167], v[120:123]
    v_exp_f32 v56, v56
    v_mfma_f32_16x16x32_bf16 v[120:123], v[40:43], a[168:171], v[120:123]
    v_exp_f32 v57, v57
    v_mfma_f32_16x16x32_bf16 v[120:123], v[44:47], a[172:175], v[120:123]
    v_exp_f32 v58, v58
    v_mfma_f32_16x16x32_bf16 v[124:127], v[32:35], a[224:227], v[124:127]
    v_exp_f32 v59, v59
    v_mfma_f32_16x16x32_bf16 v[124:127], v[36:39], a[228:231], v[124:127]
    v_add_f32 v176, 2.0, v56
    v_add_f32 v177, 2.0, v57
    v_mfma_f32_16x16x32_bf16 v[124:127], v[40:43], a[232:235], v[124:127]
    v_add_f32 v178, 2.0, v58
    v_add_f32 v179, 2.0, v59
    v_mfma_f32_16x16x32_bf16 v[124:127], v[44:47], a[236:239], v[124:127]
    v_mul_f32 v156, v156, v56
    v_mul_f32 v157, v157, v57
    s_waitcnt lgkmcnt(0)
    v_mfma_f32_16x16x32_bf16 v[64:67], v[16:19], a[48:51], v[64:67]
    v_xor_b32 v9, 0x10000, v9
    v_accvgpr_write_b32 a164, 0
    v_mfma_f32_16x16x32_bf16 v[64:67], v[20:23], a[52:55], v[64:67]
    ds_read_b64_tr_b16 v[32:33], v9 offset:8192
    v_accvgpr_write_b32 a165, 0
    v_mfma_f32_16x16x32_bf16 v[64:67], v[24:27], a[56:59], v[64:67]
    ds_read_b64_tr_b16 v[34:35], v9 offset:8704
    v_accvgpr_write_b32 a166, 0
    v_mfma_f32_16x16x32_bf16 v[64:67], v[28:31], a[60:63], v[64:67]
    ds_read_b64_tr_b16 v[36:37], v9 offset:12288
    v_accvgpr_write_b32 a167, 0
    v_mfma_f32_16x16x32_bf16 v[68:71], v[16:19], a[112:115], v[68:71]
    ds_read_b64_tr_b16 v[38:39], v9 offset:12800
    v_mov_b32 v63, 0x3f803f80
    v_mfma_f32_16x16x32_bf16 v[68:71], v[20:23], a[116:119], v[68:71]
    ds_read_b64_tr_b16 v[40:41], v9 offset:24576
    v_accvgpr_write_b32 a160, v63
    v_mfma_f32_16x16x32_bf16 v[68:71], v[24:27], a[120:123], v[68:71]
    ds_read_b64_tr_b16 v[42:43], v9 offset:25088
    v_accvgpr_write_b32 a161, v63
    v_mfma_f32_16x16x32_bf16 v[68:71], v[28:31], a[124:127], v[68:71]
    ds_read_b64_tr_b16 v[44:45], v9 offset:28672
    v_accvgpr_write_b32 a162, v63
    v_mfma_f32_16x16x32_bf16 v[72:75], v[16:19], a[176:179], v[72:75]
    ds_read_b64_tr_b16 v[46:47], v9 offset:29184
    v_accvgpr_write_b32 a163, v63
    v_mfma_f32_16x16x32_bf16 v[72:75], v[20:23], a[180:183], v[72:75]
    s_cmp_lg_u32 s44, 0
    s_cbranch_scc1 mg_fs_21
    s_add_u32 m0, s48, 65536
    s_mov_b32 s71, 32768
    buffer_load_dwordx4 v4, s[24:27], s71 offen offset:0 sc1 lds
    buffer_load_dwordx4 v4, s[24:27], s71 offen offset:1024 sc1 lds
    buffer_load_dwordx4 v4, s[24:27], s71 offen offset:2048 sc1 lds
    buffer_load_dwordx4 v4, s[24:27], s71 offen offset:3072 sc1 lds
mg_fs_21:
    v_mfma_f32_16x16x32_bf16 v[72:75], v[24:27], a[184:187], v[72:75]
    s_cmp_lg_u32 s44, 0
    s_cbranch_scc1 mg_fs_22
    s_add_u32 m0, s48, 81920
    s_mov_b32 s71, 40960
    buffer_load_dwordx4 v4, s[24:27], s71 offen offset:0 sc1 lds
    buffer_load_dwordx4 v4, s[24:27], s71 offen offset:1024 sc1 lds
    buffer_load_dwordx4 v4, s[24:27], s71 offen offset:2048 sc1 lds
    buffer_load_dwordx4 v4, s[24:27], s71 offen offset:3072 sc1 lds
mg_fs_22:
    v_mfma_f32_16x16x32_bf16 v[72:75], v[28:31], a[188:191], v[72:75]
    v_mul_f32 v158, v158, v58
    v_mul_f32 v159, v159, v59
    v_mfma_f32_16x16x32_bf16 v[76:79], v[16:19], a[240:243], v[76:79]
    v_mul_f32 v156, v156, v176
    v_mul_f32 v157, v157, v177
    v_mfma_f32_16x16x32_bf16 v[76:79], v[20:23], a[244:247], v[76:79]
    v_mul_f32 v158, v158, v178
    v_mul_f32 v159, v159, v179
    v_mfma_f32_16x16x32_bf16 v[76:79], v[24:27], a[248:251], v[76:79]
    v_fma_f32 v176, v56, v176, 2.0
    v_fma_f32 v177, v57, v177, 2.0
    v_mfma_f32_16x16x32_bf16 v[76:79], v[28:31], a[252:255], v[76:79]
    s_waitcnt lgkmcnt(0)
    v_fma_f32 v178, v58, v178, 2.0
    v_mfma_f32_16x16x32_bf16 v[80:83], v[32:35], a[48:51], v[80:83]
    v_xor_b32 v10, 0x10000, v10
    v_fma_f32 v179, v59, v179, 2.0
    v_mfma_f32_16x16x32_bf16 v[80:83], v[36:39], a[52:55], v[80:83]
    ds_read_b64_tr_b16 v[16:17], v10 offset:8192
    v_mfma_f32_16x16x32_bf16 v[80:83], v[40:43], a[56:59], v[80:83]
    ds_read_b64_tr_b16 v[18:19], v10 offset:8704
    v_mfma_f32_16x16x32_bf16 v[80:83], v[44:47], a[60:63], v[80:83]
    ds_read_b64_tr_b16 v[20:21], v10 offset:12288
    v_mfma_f32_16x16x32_bf16 v[84:87], v[32:35], a[112:115], v[84:87]
    ds_read_b64_tr_b16 v[22:23], v10 offset:12800
    v_mfma_f32_16x16x32_bf16 v[84:87], v[36:39], a[116:119], v[84:87]
    ds_read_b64_tr_b16 v[24:25], v10 offset:24576
    v_mfma_f32_16x16x32_bf16 v[84:87], v[40:43], a[120:123], v[84:87]
    ds_read_b64_tr_b16 v[26:27], v10 offset:25088
    v_mfma_f32_16x16x32_bf16 v[84:87], v[44:47], a[124:127], v[84:87]
    ds_read_b64_tr_b16 v[28:29], v10 offset:28672
    v_mfma_f32_16x16x32_bf16 v[88:91], v[32:35], a[176:179], v[88:91]
    ds_read_b64_tr_b16 v[30:31], v10 offset:29184
    v_mfma_f32_16x16x32_bf16 v[88:91], v[36:39], a[180:183], v[88:91]
    s_cmp_lg_u32 s44, 0
    s_cbranch_scc1 mg_fs_23
    s_add_u32 m0, s48, 98304
    s_mov_b32 s71, 49152
    buffer_load_dwordx4 v4, s[24:27], s71 offen offset:0 sc1 lds
    buffer_load_dwordx4 v4, s[24:27], s71 offen offset:1024 sc1 lds
    buffer_load_dwordx4 v4, s[24:27], s71 offen offset:2048 sc1 lds
    buffer_load_dwordx4 v4, s[24:27], s71 offen offset:3072 sc1 lds
mg_fs_23:
    v_mfma_f32_16x16x32_bf16 v[88:91], v[40:43], a[184:187], v[88:91]
    s_cmp_lg_u32 s44, 0
    s_cbranch_scc1 mg_fs_24
    s_add_u32 m0, s48, 114688
    s_mov_b32 s71, 57344
    buffer_load_dwordx4 v4, s[24:27], s71 offen offset:0 sc1 lds
    buffer_load_dwordx4 v4, s[24:27], s71 offen offset:1024 sc1 lds
    buffer_load_dwordx4 v4, s[24:27], s71 offen offset:2048 sc1 lds
    buffer_load_dwordx4 v4, s[24:27], s71 offen offset:3072 sc1 lds
mg_fs_24:
    v_mfma_f32_16x16x32_bf16 v[88:91], v[44:47], a[188:191], v[88:91]
    v_rcp_f32 v176, v176
    v_mfma_f32_16x16x32_bf16 v[92:95], v[32:35], a[240:243], v[92:95]
    v_rcp_f32 v177, v177
    v_mfma_f32_16x16x32_bf16 v[92:95], v[36:39], a[244:247], v[92:95]
    v_rcp_f32 v178, v178
    v_mfma_f32_16x16x32_bf16 v[92:95], v[40:43], a[248:251], v[92:95]
    s_cmp_lg_u32 s44, 1
    s_cbranch_scc1 mg_fs_25
    s_add_u32 m0, s48, 98304
    s_mov_b32 s71, 49152
    buffer_load_dwordx4 v4, s[24:27], s71 offen offset:0 sc1 lds
    buffer_load_dwordx4 v4, s[24:27], s71 offen offset:1024 sc1 lds
    buffer_load_dwordx4 v4, s[24:27], s71 offen offset:2048 sc1 lds
    buffer_load_dwordx4 v4, s[24:27], s71 offen offset:3072 sc1 lds
mg_fs_25:
    v_mfma_f32_16x16x32_bf16 v[92:95], v[44:47], a[252:255], v[92:95]
    s_waitcnt lgkmcnt(0)
    v_mfma_f32_16x16x32_bf16 v[96:99], v[16:19], a[48:51], v[96:99]
    v_xor_b32 v11, 0x10000, v11
    v_mfma_f32_16x16x32_bf16 v[96:99], v[20:23], a[52:55], v[96:99]
    ds_read_b64_tr_b16 v[32:33], v11 offset:8192
    v_mfma_f32_16x16x32_bf16 v[96:99], v[24:27], a[56:59], v[96:99]
    ds_read_b64_tr_b16 v[34:35], v11 offset:8704
    v_mfma_f32_16x16x32_bf16 v[96:99], v[28:31], a[60:63], v[96:99]
    ds_read_b64_tr_b16 v[36:37], v11 offset:12288
    v_mfma_f32_16x16x32_bf16 v[100:103], v[16:19], a[112:115], v[100:103]
    ds_read_b64_tr_b16 v[38:39], v11 offset:12800
    v_mfma_f32_16x16x32_bf16 v[100:103], v[20:23], a[116:119], v[100:103]
    ds_read_b64_tr_b16 v[40:41], v11 offset:24576
    v_mfma_f32_16x16x32_bf16 v[100:103], v[24:27], a[120:123], v[100:103]
    ds_read_b64_tr_b16 v[42:43], v11 offset:25088
    v_mfma_f32_16x16x32_bf16 v[100:103], v[28:31], a[124:127], v[100:103]
    ds_read_b64_tr_b16 v[44:45], v11 offset:28672
    v_mfma_f32_16x16x32_bf16 v[104:107], v[16:19], a[176:179], v[104:107]
    ds_read_b64_tr_b16 v[46:47], v11 offset:29184
    v_mfma_f32_16x16x32_bf16 v[104:107], v[20:23], a[180:183], v[104:107]
    s_cmp_lg_u32 s44, 1
    s_cbranch_scc1 mg_fs_26
    s_add_u32 m0, s48, 114688
    s_mov_b32 s71, 57344
    buffer_load_dwordx4 v4, s[24:27], s71 offen offset:0 sc1 lds
    buffer_load_dwordx4 v4, s[24:27], s71 offen offset:1024 sc1 lds
    buffer_load_dwordx4 v4, s[24:27], s71 offen offset:2048 sc1 lds
    buffer_load_dwordx4 v4, s[24:27], s71 offen offset:3072 sc1 lds
mg_fs_26:
    v_mfma_f32_16x16x32_bf16 v[104:107], v[24:27], a[184:187], v[104:107]
    v_rcp_f32 v179, v179
    v_mfma_f32_16x16x32_bf16 v[104:107], v[28:31], a[188:191], v[104:107]
    v_mul_f32 v156, v156, v176
    v_mul_f32 v157, v157, v177
    v_mfma_f32_16x16x32_bf16 v[108:111], v[16:19], a[240:243], v[108:111]
    v_mul_f32 v158, v158, v178
    v_mul_f32 v159, v159, v179
    v_mfma_f32_16x16x32_bf16 v[108:111], v[20:23], a[244:247], v[108:111]
    v_cvt_pk_bf16_f32 v140, v140, v141
    v_cvt_pk_bf16_f32 v141, v142, v143
    v_mfma_f32_16x16x32_bf16 v[108:111], v[24:27], a[248:251], v[108:111]
    v_mov_b32 v2, v7
    v_cvt_pk_bf16_f32 v142, v156, v157
    v_mfma_f32_16x16x32_bf16 v[108:111], v[28:31], a[252:255], v[108:111]
    s_waitcnt vmcnt(24) lgkmcnt(0)
    s_barrier
    v_mfma_f32_16x16x32_bf16 v[112:115], v[32:35], a[48:51], v[112:115]
    ds_read_b128 a[16:19], v2 offset:0
    v_cvt_pk_bf16_f32 v143, v158, v159
    v_mfma_f32_16x16x32_bf16 v[112:115], v[36:39], a[52:55], v[112:115]
    ds_read_b128 a[20:23], v2 offset:1024
    buffer_store_dwordx4 v[140:143], v15, s[8:11], s76 offen sc1
    v_mfma_f32_16x16x32_bf16 v[112:115], v[40:43], a[56:59], v[112:115]
    ds_read_b128 a[24:27], v2 offset:2048
    v_mul_f32 v56, 0x3fb8aa3b, v160
    v_mfma_f32_16x16x32_bf16 v[112:115], v[44:47], a[60:63], v[112:115]
    ds_read_b128 a[28:31], v2 offset:3072
    v_mul_f32 v57, 0x3fb8aa3b, v161
    v_mfma_f32_16x16x32_bf16 v[116:119], v[32:35], a[112:115], v[116:119]
    ds_read_b128 a[32:35], v2 offset:4096
    v_mul_f32 v58, 0x3fb8aa3b, v162
    v_mfma_f32_16x16x32_bf16 v[116:119], v[36:39], a[116:119], v[116:119]
    ds_read_b128 a[36:39], v2 offset:5120
    v_mul_f32 v59, 0x3fb8aa3b, v163
    v_mfma_f32_16x16x32_bf16 v[116:119], v[40:43], a[120:123], v[116:119]
    ds_read_b128 a[40:43], v2 offset:6144
    v_min_f32 v56, 0x41e6d4ca, v56
    v_mfma_f32_16x16x32_bf16 v[116:119], v[44:47], a[124:127], v[116:119]
    ds_read_b128 a[44:47], v2 offset:7168
    v_min_f32 v57, 0x41e6d4ca, v57
    v_mfma_f32_16x16x32_bf16 v[120:123], v[32:35], a[176:179], v[120:123]
    v_min_f32 v58, 0x41e6d4ca, v58
    v_min_f32 v59, 0x41e6d4ca, v59
    v_mfma_f32_16x16x32_bf16 v[120:123], v[36:39], a[180:183], v[120:123]
    v_exp_f32 v56, v56
    v_mfma_f32_16x16x32_bf16 v[120:123], v[40:43], a[184:187], v[120:123]
    v_exp_f32 v57, v57
    v_mfma_f32_16x16x32_bf16 v[120:123], v[44:47], a[188:191], v[120:123]
    v_exp_f32 v58, v58
    v_mfma_f32_16x16x32_bf16 v[124:127], v[32:35], a[240:243], v[124:127]
    v_exp_f32 v59, v59
    v_mfma_f32_16x16x32_bf16 v[124:127], v[36:39], a[244:247], v[124:127]
    v_add_f32 v176, 2.0, v56
    v_add_f32 v177, 2.0, v57
    v_mfma_f32_16x16x32_bf16 v[124:127], v[40:43], a[248:251], v[124:127]
    v_add_f32 v178, 2.0, v58
    v_add_f32 v179, 2.0, v59
    v_mfma_f32_16x16x32_bf16 v[124:127], v[44:47], a[252:255], v[124:127]
    v_mul_f32 v160, v160, v56
    v_mul_f32 v161, v161, v57
    v_mul_f32 v162, v162, v58
    v_mul_f32 v163, v163, v59
    v_mul_f32 v160, v160, v176
    v_mul_f32 v161, v161, v177
    v_mul_f32 v162, v162, v178
    v_mul_f32 v163, v163, v179
    v_fma_f32 v176, v56, v176, 2.0
    v_fma_f32 v177, v57, v177, 2.0
    v_fma_f32 v178, v58, v178, 2.0
    v_fma_f32 v179, v59, v179, 2.0
    v_rcp_f32 v176, v176
    v_rcp_f32 v177, v177
    v_rcp_f32 v178, v178
    v_rcp_f32 v179, v179
    v_mul_f32 v160, v160, v176
    v_mul_f32 v161, v161, v177
    v_mul_f32 v162, v162, v178
    v_mul_f32 v163, v163, v179
    v_mul_f32 v56, 0x3fb8aa3b, v168
    v_mul_f32 v57, 0x3fb8aa3b, v169
    v_mul_f32 v58, 0x3fb8aa3b, v170
    v_mul_f32 v59, 0x3fb8aa3b, v171
    v_min_f32 v56, 0x41e6d4ca, v56
    v_min_f32 v57, 0x41e6d4ca, v57
    v_min_f32 v58, 0x41e6d4ca, v58
    v_min_f32 v59, 0x41e6d4ca, v59
    v_exp_f32 v56, v56
    v_exp_f32 v57, v57
    v_exp_f32 v58, v58
    v_exp_f32 v59, v59
    v_add_f32 v176, 2.0, v56
    v_add_f32 v177, 2.0, v57
    v_add_f32 v178, 2.0, v58
    v_add_f32 v179, 2.0, v59
    v_mul_f32 v168, v168, v56
    v_mul_f32 v169, v169, v57
    v_mul_f32 v170, v170, v58
    v_mul_f32 v171, v171, v59
    v_mul_f32 v168, v168, v176
    v_mul_f32 v169, v169, v177
    v_mul_f32 v170, v170, v178
    v_mul_f32 v171, v171, v179
    v_fma_f32 v176, v56, v176, 2.0
    v_fma_f32 v177, v57, v177, 2.0
    v_fma_f32 v178, v58, v178, 2.0
    v_fma_f32 v179, v59, v179, 2.0
    v_rcp_f32 v176, v176
    v_rcp_f32 v177, v177
    v_rcp_f32 v178, v178
    v_rcp_f32 v179, v179
    v_mul_f32 v168, v168, v176
    v_mul_f32 v169, v169, v177
    v_mul_f32 v170, v170, v178
    v_mul_f32 v171, v171, v179
    v_cvt_pk_bf16_f32 v160, v160, v161
    v_cvt_pk_bf16_f32 v161, v162, v163
    v_cvt_pk_bf16_f32 v162, v168, v169
    v_cvt_pk_bf16_f32 v163, v170, v171
    buffer_store_dwordx4 v[160:163], v12, s[8:11], s77 offen sc1
    v_mul_f32 v56, 0x3fb8aa3b, v164
    v_mul_f32 v57, 0x3fb8aa3b, v165
    v_mul_f32 v58, 0x3fb8aa3b, v166
    v_mul_f32 v59, 0x3fb8aa3b, v167
    v_min_f32 v56, 0x41e6d4ca, v56
    v_min_f32 v57, 0x41e6d4ca, v57
    v_min_f32 v58, 0x41e6d4ca, v58
    v_min_f32 v59, 0x41e6d4ca, v59
    v_exp_f32 v56, v56
    v_exp_f32 v57, v57
    v_exp_f32 v58, v58
    v_exp_f32 v59, v59
    v_add_f32 v176, 2.0, v56
    v_add_f32 v177, 2.0, v57
    v_add_f32 v178, 2.0, v58
    v_add_f32 v179, 2.0, v59
    v_mul_f32 v164, v164, v56
    v_mul_f32 v165, v165, v57
    v_mul_f32 v166, v166, v58
    v_mul_f32 v167, v167, v59
    v_mul_f32 v164, v164, v176
    v_mul_f32 v165, v165, v177
    v_mul_f32 v166, v166, v178
    v_mul_f32 v167, v167, v179
    v_fma_f32 v176, v56, v176, 2.0
    v_fma_f32 v177, v57, v177, 2.0
    v_fma_f32 v178, v58, v178, 2.0
    v_fma_f32 v179, v59, v179, 2.0
    v_rcp_f32 v176, v176
    v_rcp_f32 v177, v177
    v_rcp_f32 v178, v178
    v_rcp_f32 v179, v179
    v_mul_f32 v164, v164, v176
    v_mul_f32 v165, v165, v177
    v_mul_f32 v166, v166, v178
    v_mul_f32 v167, v167, v179
    v_mul_f32 v56, 0x3fb8aa3b, v172
    v_mul_f32 v57, 0x3fb8aa3b, v173
    v_mul_f32 v58, 0x3fb8aa3b, v174
    v_mul_f32 v59, 0x3fb8aa3b, v175
    v_min_f32 v56, 0x41e6d4ca, v56
    v_min_f32 v57, 0x41e6d4ca, v57
    v_min_f32 v58, 0x41e6d4ca, v58
    v_min_f32 v59, 0x41e6d4ca, v59
    v_exp_f32 v56, v56
    v_exp_f32 v57, v57
    v_exp_f32 v58, v58
    v_exp_f32 v59, v59
    v_add_f32 v176, 2.0, v56
    v_add_f32 v177, 2.0, v57
    v_add_f32 v178, 2.0, v58
    v_add_f32 v179, 2.0, v59
    v_mul_f32 v172, v172, v56
    v_mul_f32 v173, v173, v57
    v_mul_f32 v174, v174, v58
    v_mul_f32 v175, v175, v59
    v_mul_f32 v172, v172, v176
    v_mul_f32 v173, v173, v177
    v_mul_f32 v174, v174, v178
    v_mul_f32 v175, v175, v179
    v_fma_f32 v176, v56, v176, 2.0
    v_fma_f32 v177, v57, v177, 2.0
    v_fma_f32 v178, v58, v178, 2.0
    v_fma_f32 v179, v59, v179, 2.0
    v_rcp_f32 v176, v176
    v_rcp_f32 v177, v177
    v_rcp_f32 v178, v178
    v_rcp_f32 v179, v179
    v_mul_f32 v172, v172, v176
    v_mul_f32 v173, v173, v177
    v_mul_f32 v174, v174, v178
    v_mul_f32 v175, v175, v179
    v_cvt_pk_bf16_f32 v164, v164, v165
    v_cvt_pk_bf16_f32 v165, v166, v167
    v_cvt_pk_bf16_f32 v166, v172, v173
    v_cvt_pk_bf16_f32 v167, v174, v175
    buffer_store_dwordx4 v[164:167], v13, s[8:11], s77 offen sc1
    s_nop 7
    v_cvt_pk_bf16_f32 v64, v64, v65
    v_cvt_pk_bf16_f32 v65, v66, v67
    v_cvt_pk_bf16_f32 v66, v80, v81
    v_cvt_pk_bf16_f32 v67, v82, v83
    v_cvt_pk_bf16_f32 v96, v96, v97
    v_cvt_pk_bf16_f32 v97, v98, v99
    v_cvt_pk_bf16_f32 v98, v112, v113
    v_cvt_pk_bf16_f32 v99, v114, v115
    v_cvt_pk_bf16_f32 v68, v68, v69
    v_cvt_pk_bf16_f32 v69, v70, v71
    v_cvt_pk_bf16_f32 v70, v84, v85
    v_cvt_pk_bf16_f32 v71, v86, v87
    v_cvt_pk_bf16_f32 v100, v100, v101
    v_cvt_pk_bf16_f32 v101, v102, v103
    v_cvt_pk_bf16_f32 v102, v116, v117
    v_cvt_pk_bf16_f32 v103, v118, v119
    v_cvt_pk_bf16_f32 v72, v72, v73
    v_cvt_pk_bf16_f32 v73, v74, v75
    v_cvt_pk_bf16_f32 v74, v88, v89
    v_cvt_pk_bf16_f32 v75, v90, v91
    v_cvt_pk_bf16_f32 v104, v104, v105
    v_cvt_pk_bf16_f32 v105, v106, v107
    v_cvt_pk_bf16_f32 v106, v120, v121
    v_cvt_pk_bf16_f32 v107, v122, v123
    v_cvt_pk_bf16_f32 v76, v76, v77
    v_cvt_pk_bf16_f32 v77, v78, v79
    v_cvt_pk_bf16_f32 v78, v92, v93
    v_cvt_pk_bf16_f32 v79, v94, v95
    v_cvt_pk_bf16_f32 v108, v108, v109
    v_cvt_pk_bf16_f32 v109, v110, v111
    v_cvt_pk_bf16_f32 v110, v124, v125
    v_cvt_pk_bf16_f32 v111, v126, v127
    v_accvgpr_write_b32 a8, v64
    v_accvgpr_write_b32 a9, v65
    v_accvgpr_write_b32 a10, v66
    v_accvgpr_write_b32 a11, v67
    v_accvgpr_write_b32 a12, v96
    v_accvgpr_write_b32 a13, v97
    v_accvgpr_write_b32 a14, v98
    v_accvgpr_write_b32 a15, v99
    v_accvgpr_write_b32 a72, v68
    v_accvgpr_write_b32 a73, v69
    v_accvgpr_write_b32 a74, v70
    v_accvgpr_write_b32 a75, v71
    v_accvgpr_write_b32 a76, v100
    v_accvgpr_write_b32 a77, v101
    v_accvgpr_write_b32 a78, v102
    v_accvgpr_write_b32 a79, v103
    v_accvgpr_write_b32 a136, v72
    v_accvgpr_write_b32 a137, v73
    v_accvgpr_write_b32 a138, v74
    v_accvgpr_write_b32 a139, v75
    v_accvgpr_write_b32 a140, v104
    v_accvgpr_write_b32 a141, v105
    v_accvgpr_write_b32 a142, v106
    v_accvgpr_write_b32 a143, v107
    v_accvgpr_write_b32 a200, v76
    v_accvgpr_write_b32 a201, v77
    v_accvgpr_write_b32 a202, v78
    v_accvgpr_write_b32 a203, v79
    v_accvgpr_write_b32 a204, v108
    v_accvgpr_write_b32 a205, v109
    v_accvgpr_write_b32 a206, v110
    v_accvgpr_write_b32 a207, v111
    v_mov_b32 v8, 0xff800000
    v_mov_b32 v15, v6
    v_mov_b32 v0, v60
    s_lshl_b32 s65, s43, 14
    s_add_u32 s65, s65, 131072
    v_add_u32 v6, s65, v7
    s_cmp_eq_u32 s43, 0
    s_mov_b32 s66, 0x6000
    s_cselect_b32 s65, 146432, s66
    v_add_u32 v14, s65, v7
    s_cmp_lg_u32 s44, 0
    s_cbranch_scc1 k2_nopub
    ds_write_b128 v14, a[204:207]
k2_nopub:
    s_mov_b32 s50, s45
    s_mov_b32 s45, 4
    s_mov_b32 s47, 65536
    s_mov_b32 s74, 0
    s_mov_b32 s7, 0x4000
    s_mov_b32 s73, 0
    s_mov_b32 m0, s48
    s_mov_b32 s48, s53
    v_add_u32 v2, 0x4000, v7
    v_add_u32 v3, 0x8000, v7
    v_lshlrev_b32 v9, 2, v1
    v_add_u32 v9, 163584, v9
    v_mov_b32 v10, 1
    s_cmp_eq_u32 s44, 0
    s_cselect_b32 s72, s46, 0x7fffff00
    s_getpc_b64 s[4:5]
mg_pc2:
    s_mov_b32 s36, s79
    s_lshl_b32 s65, s42, 2
    s_add_u32 s65, s65, s40
    s_cmp_eq_u32 s65, 2
    s_cbranch_scc1 k2_proA
    s_waitcnt vmcnt(0) lgkmcnt(0)
    ds_add_u32 v9, v10
    v_mfma_f32_16x16x32_bf16 v[16:19], a[16:19], a[0:3], 0
    s_cmp_lg_u32 s44, 0
    s_cbranch_scc1 k2_np_29
    ds_write_b128 v6, a[0:3] offset:0
    ds_write_b128 v6, a[4:7] offset:1024
    ds_write_b128 v6, a[8:11] offset:2048
    ds_write_b128 v6, a[12:15] offset:3072
k2_np_29:
    v_mfma_f32_16x16x32_bf16 v[16:19], a[20:23], a[4:7], v[16:19]
    s_lshl_b32 s65, s2, 2
    s_add_u32 s65, s65, s40
    s_lshl_b32 s38, s65, 12
    v_mfma_f32_16x16x32_bf16 v[16:19], a[24:27], a[8:11], v[16:19]
    s_lshl_b32 s37, s65, 11
    s_and_b32 s65, s2, 1
    s_lshl_b32 s65, s65, 3
    v_mfma_f32_16x16x32_bf16 v[16:19], a[28:31], a[12:15], v[16:19]
    s_lshr_b32 s66, s2, 5
    s_add_u32 s65, s65, s66
    s_sub_u32 s66, 15, s65
    v_mfma_f32_16x16x32_bf16 v[20:23], a[32:35], a[0:3], 0
    s_min_u32 s65, s65, s66
    s_lshl_b32 s65, s65, 7
    s_add_u32 s65, s65, 58077184
    v_mfma_f32_16x16x32_bf16 v[20:23], a[36:39], a[4:7], v[20:23]
    s_cmp_lg_u32 s44, 0
    s_cbranch_scc1 k2_np_30
    ds_write_b128 v6, a[64:67] offset:4096
    ds_write_b128 v6, a[68:71] offset:5120
    ds_write_b128 v6, a[72:75] offset:6144
    ds_write_b128 v6, a[76:79] offset:7168
k2_np_30:
    v_mfma_f32_16x16x32_bf16 v[20:23], a[40:43], a[8:11], v[20:23]
    v_and_b32 v117, 31, v1
    v_lshlrev_b32 v117, 2, v117
    v_add_u32 v117, s65, v117
    v_mfma_f32_16x16x32_bf16 v[20:23], a[44:47], a[12:15], v[20:23]
    s_lshr_b32 s65, s2, 3
    s_lshl_b32 s65, s65, 2
    s_add_u32 s65, s65, s40
    v_mfma_f32_16x16x32_bf16 v[24:27], a[16:19], a[64:67], 0
    s_and_b32 s66, s2, 7
    s_lshr_b32 s66, s66, 1
    s_lshl_b32 s67, s66, 20
    v_mfma_f32_16x16x32_bf16 v[24:27], a[20:23], a[68:71], v[24:27]
    s_lshl_b32 s68, s65, 13
    s_add_u32 s67, s67, s68
    v_add_u32 v114, s67, v7
    v_mfma_f32_16x16x32_bf16 v[24:27], a[24:27], a[72:75], v[24:27]
    s_cmp_lg_u32 s44, 0
    s_cbranch_scc1 k2_np_31
    ds_write_b128 v6, a[128:131] offset:8192
    ds_write_b128 v6, a[132:135] offset:9216
    ds_write_b128 v6, a[136:139] offset:10240
    ds_write_b128 v6, a[140:143] offset:11264
k2_np_31:
    v_mfma_f32_16x16x32_bf16 v[24:27], a[28:31], a[76:79], v[24:27]
    v_add_u32 v113, 0x1000, v114
    s_lshl_b32 s3, s65, 10
    s_mul_i32 s65, s65, 2816
    v_mfma_f32_16x16x32_bf16 v[28:31], a[32:35], a[64:67], 0
    ds_read_b32 v11, v9
    s_mul_i32 s66, s66, 0x58000
    s_add_u32 s65, s65, s66
    v_mfma_f32_16x16x32_bf16 v[28:31], a[36:39], a[68:71], v[28:31]
    v_add_u32 v115, s65, v7
    s_add_u32 s65, s3, k2_merge-mg_pc2
    v_add_u32 v116, s65, v7
    v_mfma_f32_16x16x32_bf16 v[28:31], a[40:43], a[72:75], v[28:31]
    v_min_u32 v116, mg_exit-mg_pc2-16, v116
    v_mov_b32 v13, 0
    v_mfma_f32_16x16x32_bf16 v[28:31], a[44:47], a[76:79], v[28:31]
    s_cmp_lg_u32 s44, 0
    s_cbranch_scc1 k2_np_32
    ds_write_b128 v6, a[192:195] offset:12288
    ds_write_b128 v6, a[196:199] offset:13312
    ds_write_b128 v6, a[200:203] offset:14336
k2_np_32:
    v_mfma_f32_16x16x32_bf16 v[32:35], a[16:19], a[128:131], 0
    s_waitcnt lgkmcnt(0)
    v_cmp_gt_u32 vcc, s45, v11
    v_max3_f32 v88, v16, v17, v18
    v_mfma_f32_16x16x32_bf16 v[32:35], a[20:23], a[132:135], v[32:35]
    s_cbranch_vccnz k2_st_27
k2_bk_28:
    v_max3_f32 v89, v19, v20, v21
    v_max3_f32 v88, v88, v22, v23
    v_mfma_f32_16x16x32_bf16 v[32:35], a[24:27], a[136:139], v[32:35]
    ds_read_b128 a[80:83], v3 offset:8192
    v_max_f32 v88, v88, v89
    v_mov_b32 v89, v88
    v_mfma_f32_16x16x32_bf16 v[32:35], a[28:31], a[140:143], v[32:35]
    ds_read_b128 a[84:87], v3 offset:9216
    buffer_store_dword v10, v15, s[8:11], s50 offen sc1
    v_mfma_f32_16x16x32_bf16 v[36:39], a[32:35], a[128:131], 0
    s_nop 1
    ds_read_b128 a[88:91], v3 offset:10240
    v_mfma_f32_16x16x32_bf16 v[36:39], a[36:39], a[132:135], v[36:39]
    ds_read_b128 a[92:95], v3 offset:11264
    v_permlane16_swap_b32 v88, v89
    v_max_f32 v88, v88, v89
    v_mfma_f32_16x16x32_bf16 v[36:39], a[40:43], a[136:139], v[36:39]
    ds_read_b128 a[96:99], v3 offset:12288
    v_mov_b32 v89, v88
    v_mfma_f32_16x16x32_bf16 v[36:39], a[44:47], a[140:143], v[36:39]
    ds_read_b128 a[100:103], v3 offset:13312
    s_nop 1
    v_mfma_f32_16x16x32_bf16 v[40:43], a[16:19], a[192:195], 0
    ds_read_b128 a[104:107], v3 offset:14336
    v_permlane32_swap_b32 v88, v89
    v_max_f32 v88, v88, v89
    v_mfma_f32_16x16x32_bf16 v[40:43], a[20:23], a[196:199], v[40:43]
    ds_read_b128 a[108:111], v3 offset:15360
    v_max_f32 v88, 0xf149f2ca, v88
    v_add_f32 v88, 0x42000000, v88
    v_mfma_f32_16x16x32_bf16 v[40:43], a[24:27], a[200:203], v[40:43]
    ds_read_b128 a[16:19], v2 offset:0
    v_sub_f32 v16, v16, v88
    v_sub_f32 v17, v17, v88
    v_mfma_f32_16x16x32_bf16 v[40:43], a[28:31], a[204:207], v[40:43]
    ds_read_b128 a[20:23], v2 offset:1024
    v_sub_f32 v18, v18, v88
    v_sub_f32 v19, v19, v88
    v_mfma_f32_16x16x32_bf16 v[44:47], a[32:35], a[192:195], 0
    ds_read_b128 a[24:27], v2 offset:2048
    v_sub_f32 v20, v20, v88
    v_sub_f32 v21, v21, v88
    v_mfma_f32_16x16x32_bf16 v[44:47], a[36:39], a[196:199], v[44:47]
    ds_read_b128 a[28:31], v2 offset:3072
    v_sub_f32 v22, v22, v88
    v_sub_f32 v23, v23, v88
    v_mfma_f32_16x16x32_bf16 v[44:47], a[40:43], a[200:203], v[44:47]
    ds_read_b128 a[32:35], v2 offset:4096
    v_exp_f32 v48, v16
    v_mfma_f32_16x16x32_bf16 v[44:47], a[44:47], a[204:207], v[44:47]
    ds_read_b128 a[36:39], v2 offset:5120
    v_exp_f32 v49, v17
    v_mfma_f32_16x16x32_bf16 v[160:163], a[164:167], a[164:167], 0
    ds_read_b128 a[40:43], v2 offset:6144
    v_exp_f32 v50, v18
    v_mfma_f32_16x16x32_bf16 v[164:167], a[164:167], a[164:167], 0
    ds_read_b128 a[44:47], v2 offset:7168
    v_exp_f32 v51, v19
    v_mfma_f32_16x16x32_bf16 v[168:171], a[164:167], a[164:167], 0
    v_exp_f32 v52, v20
    s_add_i32 s66, s45, 8
    v_mfma_f32_16x16x32_bf16 v[172:175], a[164:167], a[164:167], 0
    v_exp_f32 v53, v21
    buffer_load_dwordx4 a[208:211], v7, s[28:31], s38 offen offset:0
    v_mfma_f32_16x16x32_bf16 v[176:179], a[164:167], a[164:167], 0
    v_exp_f32 v54, v22
    buffer_load_dwordx4 a[208:211], v7, s[28:31], s38 offen offset:1024
    v_mfma_f32_16x16x32_bf16 v[180:183], a[164:167], a[164:167], 0
    v_exp_f32 v55, v23
    s_nop 0
    v_mfma_f32_16x16x32_bf16 v[184:187], a[164:167], a[164:167], 0
    v_cvt_pk_bf16_f32 v56, v48, v49
    v_cvt_pk_bf16_f32 v57, v50, v51
    v_cvt_pk_bf16_f32 v58, v52, v53
    v_mfma_f32_16x16x32_bf16 v[188:191], a[164:167], a[164:167], 0
    v_cvt_pk_bf16_f32 v59, v54, v55
    s_cmp_ge_i32 s66, s72
    s_cselect_b32 s51, 0x8000, s7
    v_mfma_f32_16x16x32_bf16 a[148:151], a[164:167], a[164:167], 0
    s_cmp_gt_i32 s66, s72
    s_cselect_b32 s52, 0x8000, s7
    buffer_load_dwordx4 a[208:211], v7, s[28:31], s38 offen offset:2048
    v_mfma_f32_16x16x32_bf16 v[192:195], a[164:167], a[164:167], 0
    v_add_u32 v2, s51, v2
    v_and_b32 v2, 0x1ffff, v2
    v_add_u32 v3, s52, v3
    v_mfma_f32_16x16x32_bf16 v[196:199], a[164:167], a[164:167], 0
    buffer_load_dwordx4 a[208:211], v7, s[28:31], s38 offen offset:3072
    v_and_b32 v3, 0x1ffff, v3
    s_add_u32 s45, s45, 4
    v_mfma_f32_16x16x32_bf16 v[200:203], a[164:167], a[164:167], 0
    v_sub_f32 v72, 0, v88
    v_sub_f32 v73, 0, v88
    v_sub_f32 v74, 0, v88
    v_mfma_f32_16x16x32_bf16 v[204:207], a[164:167], a[164:167], 0
    v_sub_f32 v75, 0, v88
    v_max3_f32 v90, v24, v25, v26
    v_max3_f32 v91, v27, v28, v29
    v_mfma_f32_16x16x32_bf16 v[208:211], a[164:167], a[164:167], 0
    v_max3_f32 v90, v90, v30, v31
    v_max_f32 v90, v90, v91
    v_mov_b32 v91, v90
    v_mfma_f32_16x16x32_bf16 v[212:215], a[164:167], a[164:167], 0
    s_nop 1
    buffer_load_dwordx4 a[208:211], v7, s[12:15], s37 offen offset:0
    v_mfma_f32_16x16x32_bf16 v[216:219], a[164:167], a[164:167], 0
    v_permlane16_swap_b32 v90, v91
    v_max_f32 v90, v90, v91
    v_mov_b32 v91, v90
    v_mfma_f32_16x16x32_bf16 v[220:223], a[164:167], a[164:167], 0
    s_nop 1
    v_permlane32_swap_b32 v90, v91
    v_mfma_f32_16x16x32_bf16 a[152:155], a[164:167], a[164:167], 0
    v_max_f32 v90, v90, v91
    v_max_f32 v90, 0xf149f2ca, v90
    v_add_f32 v90, 0x42000000, v90
    v_mfma_f32_16x16x32_bf16 v[224:227], a[164:167], a[164:167], 0
    buffer_load_dwordx4 a[208:211], v7, s[12:15], s37 offen offset:1024
    v_sub_f32 v24, v24, v90
    v_sub_f32 v25, v25, v90
    v_mfma_f32_16x16x32_bf16 v[228:231], a[164:167], a[164:167], 0
    v_sub_f32 v26, v26, v90
    v_sub_f32 v27, v27, v90
    v_sub_f32 v28, v28, v90
    v_mfma_f32_16x16x32_bf16 v[232:235], a[164:167], a[164:167], 0
    v_sub_f32 v29, v29, v90
    v_sub_f32 v30, v30, v90
    v_sub_f32 v31, v31, v90
    v_mfma_f32_16x16x32_bf16 v[236:239], a[164:167], a[164:167], 0
    v_exp_f32 v120, v24
    v_max3_f32 v92, v32, v33, v34
    v_mfma_f32_16x16x32_bf16 v[240:243], a[164:167], a[164:167], 0
    v_exp_f32 v121, v25
    v_max3_f32 v93, v35, v36, v37
    v_mfma_f32_16x16x32_bf16 v[244:247], a[164:167], a[164:167], 0
    v_exp_f32 v122, v26
    v_max3_f32 v92, v92, v38, v39
    v_mfma_f32_16x16x32_bf16 v[248:251], a[164:167], a[164:167], 0
    v_exp_f32 v123, v27
    v_max_f32 v92, v92, v93
    v_mfma_f32_16x16x32_bf16 v[252:255], a[164:167], a[164:167], 0
    v_exp_f32 v124, v28
    v_mov_b32 v93, v92
    v_mfma_f32_16x16x32_bf16 a[156:159], a[164:167], a[164:167], 0
    s_waitcnt lgkmcnt(8)
    v_exp_f32 v125, v29
    v_mfma_f32_16x16x32_bf16 v[128:131], a[80:83], v[56:59], 0
    v_exp_f32 v126, v30
    v_max3_f32 v94, v40, v41, v42
    v_mfma_f32_16x16x32_bf16 v[132:135], a[84:87], v[56:59], 0
    v_exp_f32 v127, v31
    s_nop 0
    v_mfma_f32_16x16x32_bf16 v[136:139], a[88:91], v[56:59], 0
    s_nop 1
    v_cvt_pk_bf16_f32 v60, v120, v121
    v_mfma_f32_16x16x32_bf16 v[140:143], a[92:95], v[56:59], 0
    v_cvt_pk_bf16_f32 v61, v122, v123
    v_cvt_pk_bf16_f32 v62, v124, v125
    v_cvt_pk_bf16_f32 v63, v126, v127
    v_mfma_f32_16x16x32_bf16 v[144:147], a[96:99], v[56:59], 0
    v_sub_f32 v76, 0, v90
    v_sub_f32 v77, 0, v90
    v_sub_f32 v78, 0, v90
    v_mfma_f32_16x16x32_bf16 v[148:151], a[100:103], v[56:59], 0
    v_sub_f32 v79, 0, v90
    v_permlane16_swap_b32 v92, v93
    v_max_f32 v92, v92, v93
    v_mfma_f32_16x16x32_bf16 v[152:155], a[104:107], v[56:59], 0
    v_mov_b32 v93, v92
    s_nop 1
    v_mfma_f32_16x16x32_bf16 v[156:159], a[108:111], v[56:59], 0
    v_permlane32_swap_b32 v92, v93
    v_max_f32 v92, v92, v93
    v_max_f32 v92, 0xf149f2ca, v92
    v_mfma_f32_16x16x32_bf16 a[144:147], a[160:163], v[56:59], 0
    v_add_f32 v92, 0x42000000, v92
    v_sub_f32 v32, v32, v92
    v_sub_f32 v33, v33, v92
    v_sub_f32 v34, v34, v92
    v_sub_f32 v35, v35, v92
    v_sub_f32 v36, v36, v92
    v_sub_f32 v37, v37, v92
    v_sub_f32 v38, v38, v92
    v_sub_f32 v39, v39, v92
    v_exp_f32 v48, v32
    v_exp_f32 v49, v33
    v_exp_f32 v50, v34
    v_exp_f32 v51, v35
    v_exp_f32 v52, v36
    v_exp_f32 v53, v37
    v_exp_f32 v54, v38
    v_exp_f32 v55, v39
    s_nop 0
    v_cvt_pk_bf16_f32 v64, v48, v49
    v_cvt_pk_bf16_f32 v65, v50, v51
    v_cvt_pk_bf16_f32 v66, v52, v53
    v_cvt_pk_bf16_f32 v67, v54, v55
    v_sub_f32 v80, 0, v92
    v_sub_f32 v81, 0, v92
    v_sub_f32 v82, 0, v92
    v_sub_f32 v83, 0, v92
    v_max3_f32 v95, v43, v44, v45
    v_max3_f32 v94, v94, v46, v47
    v_max_f32 v94, v94, v95
    v_mov_b32 v95, v94
    s_nop 1
    v_permlane16_swap_b32 v94, v95
    v_max_f32 v94, v94, v95
    v_mov_b32 v95, v94
    s_nop 1
    v_permlane32_swap_b32 v94, v95
    v_max_f32 v94, v94, v95
    v_max_f32 v94, 0xf149f2ca, v94
    v_add_f32 v94, 0x42000000, v94
    v_sub_f32 v40, v40, v94
    v_sub_f32 v41, v41, v94
    v_sub_f32 v42, v42, v94
    v_sub_f32 v43, v43, v94
    v_sub_f32 v44, v44, v94
    v_sub_f32 v45, v45, v94
    v_sub_f32 v46, v46, v94
    v_sub_f32 v47, v47, v94
    v_sub_f32 v84, 0, v94
    v_sub_f32 v85, 0, v94
    v_sub_f32 v86, 0, v94
    v_sub_f32 v87, 0, v94
    s_nop 1
    ds_read_b128 a[48:51], v14
    s_lshl_b32 s66, s43, 2
    s_add_u32 s73, s66, 136
    s_lshl_b32 s65, s42, 1
    s_add_u32 s65, s65, s43
    s_cmp_eq_u32 s65, 14
    s_cselect_b32 s73, 132, s73
    s_lshl_b32 s65, s43, 3
    s_add_u32 s65, s65, s46
    s_sub_u32 s65, s65, 28
    s_cmp_eq_u32 s44, 0
    s_cselect_b32 s73, s73, s65
    s_sub_u32 s65, s46, 8
    s_min_u32 s53, s73, s65
    s_cmp_ge_u32 s45, s53
    s_cbranch_scc1 k2_sdone
    .p2align 3
k2_sloop:
    s_waitcnt lgkmcnt(4)
    v_mfma_f32_16x16x32_bf16 v[16:19], a[16:19], a[0:3], v[72:75]
    v_exp_f32 v120, v40
    v_mfma_f32_16x16x32_bf16 v[16:19], a[20:23], a[4:7], v[16:19]
    v_exp_f32 v121, v41
    v_mfma_f32_16x16x32_bf16 v[16:19], a[24:27], a[8:11], v[16:19]
    v_exp_f32 v122, v42
    v_mfma_f32_16x16x32_bf16 v[16:19], a[28:31], a[12:15], v[16:19]
    s_waitcnt vmcnt(8) lgkmcnt(0)
    ds_add_u32 v9, v10
    v_mfma_f32_16x16x32_bf16 v[20:23], a[32:35], a[0:3], v[72:75]
    v_exp_f32 v123, v43
    v_mfma_f32_16x16x32_bf16 v[20:23], a[36:39], a[4:7], v[20:23]
    v_exp_f32 v124, v44
    v_mfma_f32_16x16x32_bf16 v[20:23], a[40:43], a[8:11], v[20:23]
    v_exp_f32 v125, v45
    v_mfma_f32_16x16x32_bf16 v[20:23], a[44:47], a[12:15], v[20:23]
    v_exp_f32 v126, v46
    v_mfma_f32_16x16x32_bf16 v[160:163], a[80:83], v[60:63], v[160:163]
    v_exp_f32 v127, v47
    v_mfma_f32_16x16x32_bf16 v[164:167], a[84:87], v[60:63], v[164:167]
    v_cvt_pk_bf16_f32 v68, v120, v121
    v_cvt_pk_bf16_f32 v69, v122, v123
    v_mfma_f32_16x16x32_bf16 v[168:171], a[88:91], v[60:63], v[168:171]
    v_cvt_pk_bf16_f32 v70, v124, v125
    v_cvt_pk_bf16_f32 v71, v126, v127
    v_mfma_f32_16x16x32_bf16 v[172:175], a[92:95], v[60:63], v[172:175]
    v_or3_b32 v13, v13, v68, v69
    v_or3_b32 v13, v13, v70, v71
    v_mfma_f32_16x16x32_bf16 v[176:179], a[96:99], v[60:63], v[176:179]
    v_and_b32 v13, 0x40004000, v13
    v_cmp_ne_u32 vcc, 0, v13
    v_mfma_f32_16x16x32_bf16 v[180:183], a[100:103], v[60:63], v[180:183]
    s_cbranch_vccnz k2_st_33
k2_bk_34:
    buffer_load_dwordx4 v4, s[24:27], s47 offen offset:0 sc1 lds
    v_mfma_f32_16x16x32_bf16 v[184:187], a[104:107], v[60:63], v[184:187]
    v_exp_f32 v48, v16
    v_mfma_f32_16x16x32_bf16 v[188:191], a[108:111], v[60:63], v[188:191]
    v_exp_f32 v49, v17
    v_mfma_f32_16x16x32_bf16 a[148:151], a[160:163], v[60:63], a[148:151]
    buffer_load_dwordx4 v4, s[24:27], s47 offen offset:1024 sc1 lds
    buffer_load_dwordx4 v4, s[24:27], s47 offen offset:2048 sc1 lds
    v_mfma_f32_16x16x32_bf16 v[24:27], a[16:19], a[64:67], v[76:79]
    buffer_load_dwordx4 v4, s[24:27], s47 offen offset:3072 sc1 lds
    v_cvt_pk_bf16_f32 v56, v48, v49
    v_mfma_f32_16x16x32_bf16 v[24:27], a[20:23], a[68:71], v[24:27]
    v_exp_f32 v50, v18
    v_mfma_f32_16x16x32_bf16 v[24:27], a[24:27], a[72:75], v[24:27]
    v_exp_f32 v51, v19
    v_mfma_f32_16x16x32_bf16 v[24:27], a[28:31], a[76:79], v[24:27]
    v_exp_f32 v52, v20
    v_mfma_f32_16x16x32_bf16 v[28:31], a[32:35], a[64:67], v[76:79]
    v_exp_f32 v53, v21
    v_mfma_f32_16x16x32_bf16 v[28:31], a[36:39], a[68:71], v[28:31]
    v_exp_f32 v54, v22
    v_mfma_f32_16x16x32_bf16 v[28:31], a[40:43], a[72:75], v[28:31]
    v_exp_f32 v55, v23
    v_mfma_f32_16x16x32_bf16 v[28:31], a[44:47], a[76:79], v[28:31]
    v_cvt_pk_bf16_f32 v57, v50, v51
    v_cvt_pk_bf16_f32 v58, v52, v53
    v_mfma_f32_16x16x32_bf16 v[192:195], a[80:83], v[64:67], v[192:195]
    v_cvt_pk_bf16_f32 v59, v54, v55
    v_or3_b32 v12, v56, v57, v58
    v_mfma_f32_16x16x32_bf16 v[196:199], a[84:87], v[64:67], v[196:199]
    v_or_b32 v12, v12, v59
    s_add_u32 m0, m0, 0x4000
    v_mfma_f32_16x16x32_bf16 v[200:203], a[88:91], v[64:67], v[200:203]
    s_and_b32 m0, m0, 0x1ffff
    s_add_u32 s47, s47, 0x2000
    v_mfma_f32_16x16x32_bf16 v[204:207], a[92:95], v[64:67], v[204:207]
    v_exp_f32 v120, v24
    v_mfma_f32_16x16x32_bf16 v[208:211], a[96:99], v[64:67], v[208:211]
    v_exp_f32 v121, v25
    v_mfma_f32_16x16x32_bf16 v[212:215], a[100:103], v[64:67], v[212:215]
    v_exp_f32 v122, v26
    v_mfma_f32_16x16x32_bf16 v[216:219], a[104:107], v[64:67], v[216:219]
    v_exp_f32 v123, v27
    v_mfma_f32_16x16x32_bf16 v[220:223], a[108:111], v[64:67], v[220:223]
    v_exp_f32 v124, v28
    v_mfma_f32_16x16x32_bf16 a[152:155], a[160:163], v[64:67], a[152:155]
    ds_read_b32 v11, v9
    v_cvt_pk_bf16_f32 v60, v120, v121
    v_mfma_f32_16x16x32_bf16 v[32:35], a[16:19], a[128:131], v[80:83]
    v_exp_f32 v125, v29
    v_mfma_f32_16x16x32_bf16 v[32:35], a[20:23], a[132:135], v[32:35]
    v_exp_f32 v126, v30
    v_mfma_f32_16x16x32_bf16 v[32:35], a[24:27], a[136:139], v[32:35]
    s_waitcnt lgkmcnt(0)
    v_cmp_gt_u32 vcc, s45, v11
    v_mfma_f32_16x16x32_bf16 v[32:35], a[28:31], a[140:143], v[32:35]
    s_cbranch_vccnz k2_st_35
k2_bk_36:
    v_cvt_pk_bf16_f32 v61, v122, v123
    v_mfma_f32_16x16x32_bf16 v[36:39], a[32:35], a[128:131], v[80:83]
    v_exp_f32 v127, v31
    v_mfma_f32_16x16x32_bf16 v[36:39], a[36:39], a[132:135], v[36:39]
    v_cvt_pk_bf16_f32 v62, v124, v125
    v_cvt_pk_bf16_f32 v63, v126, v127
    v_mfma_f32_16x16x32_bf16 v[36:39], a[40:43], a[136:139], v[36:39]
    v_or3_b32 v12, v12, v60, v61
    v_or3_b32 v12, v12, v62, v63
    v_mfma_f32_16x16x32_bf16 v[36:39], a[44:47], a[140:143], v[36:39]
    v_and_b32 v12, 0x40004000, v12
    v_cmp_ne_u32 vcc, 0, v12
    v_mfma_f32_16x16x32_bf16 v[224:227], a[80:83], v[68:71], v[224:227]
    ds_read_b128 a[80:83], v3 offset:8192
    s_cbranch_vccnz k2_st_37
k2_bk_38:
    v_mfma_f32_16x16x32_bf16 v[228:231], a[84:87], v[68:71], v[228:231]
    ds_read_b128 a[84:87], v3 offset:9216
    s_add_u32 s45, s45, 4
    v_mfma_f32_16x16x32_bf16 v[232:235], a[88:91], v[68:71], v[232:235]
    ds_read_b128 a[88:91], v3 offset:10240
    v_mfma_f32_16x16x32_bf16 v[236:239], a[92:95], v[68:71], v[236:239]
    v_exp_f32 v48, v32
    v_mfma_f32_16x16x32_bf16 v[240:243], a[96:99], v[68:71], v[240:243]
    v_exp_f32 v49, v33
    v_mfma_f32_16x16x32_bf16 v[244:247], a[100:103], v[68:71], v[244:247]
    ds_read_b128 a[92:95], v3 offset:11264
    v_cvt_pk_bf16_f32 v64, v48, v49
    v_mfma_f32_16x16x32_bf16 v[248:251], a[104:107], v[68:71], v[248:251]
    v_exp_f32 v50, v34
    v_mfma_f32_16x16x32_bf16 v[252:255], a[108:111], v[68:71], v[252:255]
    v_exp_f32 v51, v35
    v_mfma_f32_16x16x32_bf16 a[156:159], a[160:163], v[68:71], a[156:159]
    ds_read_b128 a[96:99], v3 offset:12288
    v_cvt_pk_bf16_f32 v65, v50, v51
    v_mfma_f32_16x16x32_bf16 v[40:43], a[16:19], a[192:195], v[84:87]
    v_exp_f32 v52, v36
    v_mfma_f32_16x16x32_bf16 v[40:43], a[20:23], a[196:199], v[40:43]
    v_exp_f32 v53, v37
    v_mfma_f32_16x16x32_bf16 v[40:43], a[24:27], a[200:203], v[40:43]
    ds_read_b128 a[100:103], v3 offset:13312
    v_cvt_pk_bf16_f32 v66, v52, v53
    v_mfma_f32_16x16x32_bf16 v[40:43], a[28:31], a[204:207], v[40:43]
    ds_read_b128 a[104:107], v3 offset:14336
    v_or3_b32 v13, v64, v65, v66
    v_mfma_f32_16x16x32_bf16 v[44:47], a[32:35], a[192:195], v[84:87]
    v_exp_f32 v54, v38
    v_mfma_f32_16x16x32_bf16 v[44:47], a[36:39], a[196:199], v[44:47]
    v_exp_f32 v55, v39
    v_mfma_f32_16x16x32_bf16 v[44:47], a[40:43], a[200:203], v[44:47]
    ds_read_b128 a[108:111], v3 offset:15360
    v_cvt_pk_bf16_f32 v67, v54, v55
    v_mfma_f32_16x16x32_bf16 v[44:47], a[44:47], a[204:207], v[44:47]
    ds_read_b128 a[16:19], v2 offset:0
    s_waitcnt lgkmcnt(5)
    v_mfma_f32_16x16x32_bf16 v[128:131], a[80:83], v[56:59], v[128:131]
    ds_read_b128 a[20:23], v2 offset:1024
    v_or_b32 v13, v13, v67
    v_mfma_f32_16x16x32_bf16 v[132:135], a[84:87], v[56:59], v[132:135]
    ds_read_b128 a[24:27], v2 offset:2048
    v_mfma_f32_16x16x32_bf16 v[136:139], a[88:91], v[56:59], v[136:139]
    ds_read_b128 a[28:31], v2 offset:3072
    v_mfma_f32_16x16x32_bf16 v[140:143], a[92:95], v[56:59], v[140:143]
    ds_read_b128 a[32:35], v2 offset:4096
    s_waitcnt lgkmcnt(5)
    v_mfma_f32_16x16x32_bf16 v[144:147], a[96:99], v[56:59], v[144:147]
    ds_read_b128 a[36:39], v2 offset:5120
    v_mfma_f32_16x16x32_bf16 v[148:151], a[100:103], v[56:59], v[148:151]
    ds_read_b128 a[40:43], v2 offset:6144
    v_mfma_f32_16x16x32_bf16 v[152:155], a[104:107], v[56:59], v[152:155]
    ds_read_b128 a[44:47], v2 offset:7168
    v_mov_b32 v2, v3
    v_mfma_f32_16x16x32_bf16 v[156:159], a[108:111], v[56:59], v[156:159]
    v_add_u32 v3, 0x4000, v3
    v_and_b32 v3, 0x1ffff, v3
    v_mfma_f32_16x16x32_bf16 a[144:147], a[160:163], v[56:59], a[144:147]
    s_cmp_lt_u32 s45, s53
    s_cbranch_scc1 k2_sloop
k2_sdone:
    s_min_u32 s53, s73, s46
    s_cmp_ge_u32 s45, s53
    s_cbranch_scc1 k2_gdone
k2_gloop:
    s_waitcnt lgkmcnt(4)
    v_mfma_f32_16x16x32_bf16 v[16:19], a[16:19], a[0:3], v[72:75]
    v_exp_f32 v120, v40
    v_mfma_f32_16x16x32_bf16 v[16:19], a[20:23], a[4:7], v[16:19]
    v_exp_f32 v121, v41
    v_mfma_f32_16x16x32_bf16 v[16:19], a[24:27], a[8:11], v[16:19]
    v_exp_f32 v122, v42
    v_mfma_f32_16x16x32_bf16 v[16:19], a[28:31], a[12:15], v[16:19]
    s_waitcnt vmcnt(8) lgkmcnt(0)
    s_cmp_lt_u32 s47, s26
    s_cbranch_scc1 k2_ag_45
    s_waitcnt vmcnt(0)
k2_ag_45:
    ds_add_u32 v9, v10
    v_mfma_f32_16x16x32_bf16 v[20:23], a[32:35], a[0:3], v[72:75]
    v_exp_f32 v123, v43
    v_mfma_f32_16x16x32_bf16 v[20:23], a[36:39], a[4:7], v[20:23]
    v_exp_f32 v124, v44
    v_mfma_f32_16x16x32_bf16 v[20:23], a[40:43], a[8:11], v[20:23]
    v_exp_f32 v125, v45
    v_mfma_f32_16x16x32_bf16 v[20:23], a[44:47], a[12:15], v[20:23]
    v_exp_f32 v126, v46
    v_mfma_f32_16x16x32_bf16 v[160:163], a[80:83], v[60:63], v[160:163]
    v_exp_f32 v127, v47
    v_mfma_f32_16x16x32_bf16 v[164:167], a[84:87], v[60:63], v[164:167]
    v_cvt_pk_bf16_f32 v68, v120, v121
    v_cvt_pk_bf16_f32 v69, v122, v123
    v_mfma_f32_16x16x32_bf16 v[168:171], a[88:91], v[60:63], v[168:171]
    v_cvt_pk_bf16_f32 v70, v124, v125
    v_cvt_pk_bf16_f32 v71, v126, v127
    v_mfma_f32_16x16x32_bf16 v[172:175], a[92:95], v[60:63], v[172:175]
    s_cmp_ge_u32 s47, s26
    s_cbranch_scc1 k2_dsk_46
    buffer_load_dwordx4 v4, s[24:27], s47 offen offset:0 sc1 lds
    buffer_load_dwordx4 v4, s[24:27], s47 offen offset:1024 sc1 lds
    buffer_load_dwordx4 v4, s[24:27], s47 offen offset:2048 sc1 lds
    buffer_load_dwordx4 v4, s[24:27], s47 offen offset:3072 sc1 lds
    s_add_u32 m0, m0, 0x4000
    s_and_b32 m0, m0, 0x1ffff
    s_add_u32 s47, s47, 0x2000
    s_cmp_lt_u32 s45, s46
    s_cbranch_scc1 k2_dsk_46
    buffer_load_dwordx4 v4, s[24:27], s47 offen offset:0 sc1 lds
    buffer_load_dwordx4 v4, s[24:27], s47 offen offset:1024 sc1 lds
    buffer_load_dwordx4 v4, s[24:27], s47 offen offset:2048 sc1 lds
    buffer_load_dwordx4 v4, s[24:27], s47 offen offset:3072 sc1 lds
    s_add_u32 m0, m0, 0x4000
    s_and_b32 m0, m0, 0x1ffff
    s_add_u32 s47, s47, 0x2000
k2_dsk_46:
    v_mfma_f32_16x16x32_bf16 v[176:179], a[96:99], v[60:63], v[176:179]
    v_exp_f32 v48, v16
    v_mfma_f32_16x16x32_bf16 v[180:183], a[100:103], v[60:63], v[180:183]
    v_exp_f32 v49, v17
    v_mfma_f32_16x16x32_bf16 v[184:187], a[104:107], v[60:63], v[184:187]
    v_or3_b32 v13, v13, v68, v69
    v_or3_b32 v13, v13, v70, v71
    v_mfma_f32_16x16x32_bf16 v[188:191], a[108:111], v[60:63], v[188:191]
    v_and_b32 v13, 0x40004000, v13
    v_cmp_ne_u32 vcc, 0, v13
    v_mfma_f32_16x16x32_bf16 a[148:151], a[160:163], v[60:63], a[148:151]
    s_cbranch_vccnz k2_st_39
k2_bk_40:
    v_cvt_pk_bf16_f32 v56, v48, v49
    v_mfma_f32_16x16x32_bf16 v[24:27], a[16:19], a[64:67], v[76:79]
    v_exp_f32 v50, v18
    v_mfma_f32_16x16x32_bf16 v[24:27], a[20:23], a[68:71], v[24:27]
    v_exp_f32 v51, v19
    v_mfma_f32_16x16x32_bf16 v[24:27], a[24:27], a[72:75], v[24:27]
    v_exp_f32 v52, v20
    v_mfma_f32_16x16x32_bf16 v[24:27], a[28:31], a[76:79], v[24:27]
    v_exp_f32 v53, v21
    v_mfma_f32_16x16x32_bf16 v[28:31], a[32:35], a[64:67], v[76:79]
    v_exp_f32 v54, v22
    v_mfma_f32_16x16x32_bf16 v[28:31], a[36:39], a[68:71], v[28:31]
    v_exp_f32 v55, v23
    v_mfma_f32_16x16x32_bf16 v[28:31], a[40:43], a[72:75], v[28:31]
    v_cvt_pk_bf16_f32 v57, v50, v51
    v_cvt_pk_bf16_f32 v58, v52, v53
    v_mfma_f32_16x16x32_bf16 v[28:31], a[44:47], a[76:79], v[28:31]
    v_cvt_pk_bf16_f32 v59, v54, v55
    v_or3_b32 v12, v56, v57, v58
    v_mfma_f32_16x16x32_bf16 v[192:195], a[80:83], v[64:67], v[192:195]
    v_or_b32 v12, v12, v59
    v_mfma_f32_16x16x32_bf16 v[196:199], a[84:87], v[64:67], v[196:199]
    v_mfma_f32_16x16x32_bf16 v[200:203], a[88:91], v[64:67], v[200:203]
    v_mfma_f32_16x16x32_bf16 v[204:207], a[92:95], v[64:67], v[204:207]
    v_exp_f32 v120, v24
    v_mfma_f32_16x16x32_bf16 v[208:211], a[96:99], v[64:67], v[208:211]
    v_exp_f32 v121, v25
    v_mfma_f32_16x16x32_bf16 v[212:215], a[100:103], v[64:67], v[212:215]
    v_exp_f32 v122, v26
    v_mfma_f32_16x16x32_bf16 v[216:219], a[104:107], v[64:67], v[216:219]
    v_exp_f32 v123, v27
    v_mfma_f32_16x16x32_bf16 v[220:223], a[108:111], v[64:67], v[220:223]
    v_exp_f32 v124, v28
    v_mfma_f32_16x16x32_bf16 a[152:155], a[160:163], v[64:67], a[152:155]
    ds_read_b32 v11, v9
    v_cvt_pk_bf16_f32 v60, v120, v121
    v_mfma_f32_16x16x32_bf16 v[32:35], a[16:19], a[128:131], v[80:83]
    v_exp_f32 v125, v29
    v_mfma_f32_16x16x32_bf16 v[32:35], a[20:23], a[132:135], v[32:35]
    v_exp_f32 v126, v30
    v_mfma_f32_16x16x32_bf16 v[32:35], a[24:27], a[136:139], v[32:35]
    s_waitcnt lgkmcnt(0)
    v_cmp_gt_u32 vcc, s45, v11
    v_mfma_f32_16x16x32_bf16 v[32:35], a[28:31], a[140:143], v[32:35]
    s_cbranch_vccnz k2_st_41
k2_bk_42:
    v_cvt_pk_bf16_f32 v61, v122, v123
    v_mfma_f32_16x16x32_bf16 v[36:39], a[32:35], a[128:131], v[80:83]
    v_exp_f32 v127, v31
    v_mfma_f32_16x16x32_bf16 v[36:39], a[36:39], a[132:135], v[36:39]
    v_cvt_pk_bf16_f32 v62, v124, v125
    v_cvt_pk_bf16_f32 v63, v126, v127
    v_mfma_f32_16x16x32_bf16 v[36:39], a[40:43], a[136:139], v[36:39]
    v_or3_b32 v12, v12, v60, v61
    v_or3_b32 v12, v12, v62, v63
    v_mfma_f32_16x16x32_bf16 v[36:39], a[44:47], a[140:143], v[36:39]
    v_and_b32 v12, 0x40004000, v12
    v_cmp_ne_u32 vcc, 0, v12
    v_mfma_f32_16x16x32_bf16 v[224:227], a[80:83], v[68:71], v[224:227]
    ds_read_b128 a[80:83], v3 offset:8192
    s_cbranch_vccnz k2_st_43
k2_bk_44:
    v_mfma_f32_16x16x32_bf16 v[228:231], a[84:87], v[68:71], v[228:231]
    ds_read_b128 a[84:87], v3 offset:9216
    v_mfma_f32_16x16x32_bf16 v[232:235], a[88:91], v[68:71], v[232:235]
    ds_read_b128 a[88:91], v3 offset:10240
    s_add_i32 s66, s45, 8
    v_mfma_f32_16x16x32_bf16 v[236:239], a[92:95], v[68:71], v[236:239]
    s_cmp_ge_i32 s66, s72
    s_cselect_b32 s51, 0x8000, s7
    v_mfma_f32_16x16x32_bf16 v[240:243], a[96:99], v[68:71], v[240:243]
    s_cmp_gt_i32 s66, s72
    s_cselect_b32 s52, 0x8000, s7
    v_mfma_f32_16x16x32_bf16 v[244:247], a[100:103], v[68:71], v[244:247]
    ds_read_b128 a[92:95], v3 offset:11264
    s_add_u32 s45, s45, 4
    v_mfma_f32_16x16x32_bf16 v[248:251], a[104:107], v[68:71], v[248:251]
    v_exp_f32 v48, v32
    v_mfma_f32_16x16x32_bf16 v[252:255], a[108:111], v[68:71], v[252:255]
    v_exp_f32 v49, v33
    v_mfma_f32_16x16x32_bf16 a[156:159], a[160:163], v[68:71], a[156:159]
    ds_read_b128 a[96:99], v3 offset:12288
    v_cvt_pk_bf16_f32 v64, v48, v49
    v_mfma_f32_16x16x32_bf16 v[40:43], a[16:19], a[192:195], v[84:87]
    v_exp_f32 v50, v34
    v_mfma_f32_16x16x32_bf16 v[40:43], a[20:23], a[196:199], v[40:43]
    v_exp_f32 v51, v35
    v_mfma_f32_16x16x32_bf16 v[40:43], a[24:27], a[200:203], v[40:43]
    ds_read_b128 a[100:103], v3 offset:13312
    v_cvt_pk_bf16_f32 v65, v50, v51
    v_mfma_f32_16x16x32_bf16 v[40:43], a[28:31], a[204:207], v[40:43]
    v_exp_f32 v52, v36
    v_mfma_f32_16x16x32_bf16 v[44:47], a[32:35], a[192:195], v[84:87]
    v_exp_f32 v53, v37
    v_mfma_f32_16x16x32_bf16 v[44:47], a[36:39], a[196:199], v[44:47]
    ds_read_b128 a[104:107], v3 offset:14336
    v_cvt_pk_bf16_f32 v66, v52, v53
    v_mfma_f32_16x16x32_bf16 v[44:47], a[40:43], a[200:203], v[44:47]
    ds_read_b128 a[108:111], v3 offset:15360
    v_or3_b32 v13, v64, v65, v66
    v_mfma_f32_16x16x32_bf16 v[44:47], a[44:47], a[204:207], v[44:47]
    ds_read_b128 a[16:19], v2 offset:0
    s_waitcnt lgkmcnt(5)
    v_mfma_f32_16x16x32_bf16 v[128:131], a[80:83], v[56:59], v[128:131]
    ds_read_b128 a[20:23], v2 offset:1024
    v_add_u32 v3, s52, v3
    v_mfma_f32_16x16x32_bf16 v[132:135], a[84:87], v[56:59], v[132:135]
    ds_read_b128 a[24:27], v2 offset:2048
    v_and_b32 v3, 0x1ffff, v3
    v_mfma_f32_16x16x32_bf16 v[136:139], a[88:91], v[56:59], v[136:139]
    ds_read_b128 a[28:31], v2 offset:3072
    v_mfma_f32_16x16x32_bf16 v[140:143], a[92:95], v[56:59], v[140:143]
    ds_read_b128 a[32:35], v2 offset:4096
    s_waitcnt lgkmcnt(5)
    v_mfma_f32_16x16x32_bf16 v[144:147], a[96:99], v[56:59], v[144:147]
    ds_read_b128 a[36:39], v2 offset:5120
    v_mfma_f32_16x16x32_bf16 v[148:151], a[100:103], v[56:59], v[148:151]
    ds_read_b128 a[40:43], v2 offset:6144
    v_mfma_f32_16x16x32_bf16 v[152:155], a[104:107], v[56:59], v[152:155]
    ds_read_b128 a[44:47], v2 offset:7168
    v_add_u32 v2, s51, v2
    v_mfma_f32_16x16x32_bf16 v[156:159], a[108:111], v[56:59], v[156:159]
    v_exp_f32 v54, v38
    v_exp_f32 v55, v39
    v_mfma_f32_16x16x32_bf16 a[144:147], a[160:163], v[56:59], a[144:147]
    v_cvt_pk_bf16_f32 v67, v54, v55
    v_or_b32 v13, v13, v67
    v_and_b32 v2, 0x1ffff, v2
    s_cmp_lt_u32 s45, s53
    s_cbranch_scc1 k2_gloop
k2_gdone:
k2_dentry:
    s_cmp_ge_u32 s45, s73
    s_cbranch_scc1 k2_ddone
    .p2align 3
k2_dloop:
    s_waitcnt lgkmcnt(4)
    v_mfma_f32_16x16x32_bf16 v[16:19], a[16:19], a[0:3], v[72:75]
    v_exp_f32 v120, v40
    v_mfma_f32_16x16x32_bf16 v[16:19], a[20:23], a[4:7], v[16:19]
    v_exp_f32 v121, v41
    v_mfma_f32_16x16x32_bf16 v[16:19], a[24:27], a[8:11], v[16:19]
    v_exp_f32 v122, v42
    v_mfma_f32_16x16x32_bf16 v[16:19], a[28:31], a[12:15], v[16:19]
    s_waitcnt vmcnt(8) lgkmcnt(0)
    ds_add_u32 v9, v10
    v_mfma_f32_16x16x32_bf16 v[20:23], a[32:35], a[0:3], v[72:75]
    v_exp_f32 v123, v43
    v_mfma_f32_16x16x32_bf16 v[20:23], a[36:39], a[4:7], v[20:23]
    v_exp_f32 v124, v44
    v_mfma_f32_16x16x32_bf16 v[20:23], a[40:43], a[8:11], v[20:23]
    v_exp_f32 v125, v45
    v_mfma_f32_16x16x32_bf16 v[20:23], a[44:47], a[12:15], v[20:23]
    v_exp_f32 v126, v46
    v_mfma_f32_16x16x32_bf16 v[160:163], a[80:83], v[60:63], v[160:163]
    v_exp_f32 v127, v47
    v_mfma_f32_16x16x32_bf16 v[164:167], a[84:87], v[60:63], v[164:167]
    v_cvt_pk_bf16_f32 v68, v120, v121
    v_cvt_pk_bf16_f32 v69, v122, v123
    v_mfma_f32_16x16x32_bf16 v[168:171], a[88:91], v[60:63], v[168:171]
    v_cvt_pk_bf16_f32 v70, v124, v125
    v_cvt_pk_bf16_f32 v71, v126, v127
    v_mfma_f32_16x16x32_bf16 v[172:175], a[92:95], v[60:63], v[172:175]
    v_or3_b32 v13, v13, v68, v69
    v_or3_b32 v13, v13, v70, v71
    v_mfma_f32_16x16x32_bf16 v[176:179], a[96:99], v[60:63], v[176:179]
    v_and_b32 v13, 0x40004000, v13
    v_cmp_ne_u32 vcc, 0, v13
    v_mfma_f32_16x16x32_bf16 v[180:183], a[100:103], v[60:63], v[180:183]
    s_cbranch_vccnz k2_st_47
k2_bk_48:
    buffer_load_dwordx4 v4, s[24:27], s47 offen offset:0 sc1 lds
    v_mfma_f32_16x16x32_bf16 v[184:187], a[104:107], v[60:63], v[184:187]
    v_exp_f32 v48, v16
    v_mfma_f32_16x16x32_bf16 v[188:191], a[108:111], v[60:63], v[188:191]
    v_exp_f32 v49, v17
    v_mfma_f32_16x16x32_bf16 a[148:151], a[160:163], v[60:63], a[148:151]
    buffer_load_dwordx4 v4, s[24:27], s47 offen offset:1024 sc1 lds
    buffer_load_dwordx4 v4, s[24:27], s47 offen offset:2048 sc1 lds
    v_mfma_f32_16x16x32_bf16 v[24:27], a[16:19], a[64:67], v[76:79]
    buffer_load_dwordx4 v4, s[24:27], s47 offen offset:3072 sc1 lds
    s_add_u32 m0, m0, 0x4000
    v_mfma_f32_16x16x32_bf16 v[24:27], a[20:23], a[68:71], v[24:27]
    buffer_load_dwordx4 v5, s[24:27], s47 offen offset:0 sc1 lds
    buffer_load_dwordx4 v5, s[24:27], s47 offen offset:1024 sc1 lds
    v_mfma_f32_16x16x32_bf16 v[24:27], a[24:27], a[72:75], v[24:27]
    buffer_load_dwordx4 v5, s[24:27], s47 offen offset:2048 sc1 lds
    buffer_load_dwordx4 v5, s[24:27], s47 offen offset:3072 sc1 lds
    v_mfma_f32_16x16x32_bf16 v[24:27], a[28:31], a[76:79], v[24:27]
    v_exp_f32 v50, v18
    v_mfma_f32_16x16x32_bf16 v[28:31], a[32:35], a[64:67], v[76:79]
    v_exp_f32 v51, v19
    v_mfma_f32_16x16x32_bf16 v[28:31], a[36:39], a[68:71], v[28:31]
    v_exp_f32 v52, v20
    v_mfma_f32_16x16x32_bf16 v[28:31], a[40:43], a[72:75], v[28:31]
    v_exp_f32 v53, v21
    v_mfma_f32_16x16x32_bf16 v[28:31], a[44:47], a[76:79], v[28:31]
    v_exp_f32 v54, v22
    v_mfma_f32_16x16x32_bf16 v[192:195], a[80:83], v[64:67], v[192:195]
    v_exp_f32 v55, v23
    v_mfma_f32_16x16x32_bf16 v[196:199], a[84:87], v[64:67], v[196:199]
    v_cvt_pk_bf16_f32 v56, v48, v49
    v_cvt_pk_bf16_f32 v57, v50, v51
    v_mfma_f32_16x16x32_bf16 v[200:203], a[88:91], v[64:67], v[200:203]
    v_cvt_pk_bf16_f32 v58, v52, v53
    v_cvt_pk_bf16_f32 v59, v54, v55
    v_mfma_f32_16x16x32_bf16 v[204:207], a[92:95], v[64:67], v[204:207]
    v_exp_f32 v120, v24
    v_mfma_f32_16x16x32_bf16 v[208:211], a[96:99], v[64:67], v[208:211]
    v_exp_f32 v121, v25
    v_mfma_f32_16x16x32_bf16 v[212:215], a[100:103], v[64:67], v[212:215]
    v_exp_f32 v122, v26
    v_mfma_f32_16x16x32_bf16 v[216:219], a[104:107], v[64:67], v[216:219]
    v_exp_f32 v123, v27
    v_mfma_f32_16x16x32_bf16 v[220:223], a[108:111], v[64:67], v[220:223]
    v_exp_f32 v124, v28
    v_mfma_f32_16x16x32_bf16 a[152:155], a[160:163], v[64:67], a[152:155]
    ds_read_b32 v11, v9
    v_or3_b32 v12, v56, v57, v58
    v_mfma_f32_16x16x32_bf16 v[32:35], a[16:19], a[128:131], v[80:83]
    v_exp_f32 v125, v29
    v_mfma_f32_16x16x32_bf16 v[32:35], a[20:23], a[132:135], v[32:35]
    v_exp_f32 v126, v30
    v_mfma_f32_16x16x32_bf16 v[32:35], a[24:27], a[136:139], v[32:35]
    s_waitcnt lgkmcnt(0)
    v_cmp_gt_u32 vcc, s45, v11
    v_mfma_f32_16x16x32_bf16 v[32:35], a[28:31], a[140:143], v[32:35]
    s_cbranch_vccnz k2_st_49
k2_bk_50:
    v_or_b32 v12, v12, v59
    v_mfma_f32_16x16x32_bf16 v[36:39], a[32:35], a[128:131], v[80:83]
    v_exp_f32 v127, v31
    v_mfma_f32_16x16x32_bf16 v[36:39], a[36:39], a[132:135], v[36:39]
    v_cvt_pk_bf16_f32 v60, v120, v121
    v_cvt_pk_bf16_f32 v61, v122, v123
    v_mfma_f32_16x16x32_bf16 v[36:39], a[40:43], a[136:139], v[36:39]
    v_cvt_pk_bf16_f32 v62, v124, v125
    v_cvt_pk_bf16_f32 v63, v126, v127
    v_mfma_f32_16x16x32_bf16 v[36:39], a[44:47], a[140:143], v[36:39]
    v_or3_b32 v12, v12, v60, v61
    v_or3_b32 v12, v12, v62, v63
    v_mfma_f32_16x16x32_bf16 v[224:227], a[80:83], v[68:71], v[224:227]
    ds_read_b128 a[80:83], v2 offset:8192
    v_and_b32 v12, 0x40004000, v12
    v_mfma_f32_16x16x32_bf16 v[228:231], a[84:87], v[68:71], v[228:231]
    ds_read_b128 a[84:87], v2 offset:9216
    v_cmp_ne_u32 vcc, 0, v12
    v_mfma_f32_16x16x32_bf16 v[232:235], a[88:91], v[68:71], v[232:235]
    ds_read_b128 a[88:91], v2 offset:10240
    s_cbranch_vccnz k2_st_51
k2_bk_52:
    v_mfma_f32_16x16x32_bf16 v[236:239], a[92:95], v[68:71], v[236:239]
    ds_read_b128 a[92:95], v2 offset:11264
    s_add_u32 m0, m0, 0x4000
    v_mfma_f32_16x16x32_bf16 v[240:243], a[96:99], v[68:71], v[240:243]
    ds_read_b128 a[96:99], v2 offset:12288
    s_and_b32 m0, m0, 0x1ffff
    v_mfma_f32_16x16x32_bf16 v[244:247], a[100:103], v[68:71], v[244:247]
    ds_read_b128 a[100:103], v2 offset:13312
    s_add_u32 s47, s47, 0x4000
    v_mfma_f32_16x16x32_bf16 v[248:251], a[104:107], v[68:71], v[248:251]
    ds_read_b128 a[104:107], v2 offset:14336
    s_add_u32 s45, s45, 4
    v_mfma_f32_16x16x32_bf16 v[252:255], a[108:111], v[68:71], v[252:255]
    v_exp_f32 v48, v32
    v_mfma_f32_16x16x32_bf16 a[156:159], a[160:163], v[68:71], a[156:159]
    v_exp_f32 v49, v33
    v_mfma_f32_16x16x32_bf16 v[40:43], a[16:19], a[192:195], v[84:87]
    ds_read_b128 a[108:111], v2 offset:15360
    v_cvt_pk_bf16_f32 v64, v48, v49
    v_mfma_f32_16x16x32_bf16 v[40:43], a[20:23], a[196:199], v[40:43]
    v_exp_f32 v50, v34
    v_mfma_f32_16x16x32_bf16 v[40:43], a[24:27], a[200:203], v[40:43]
    v_exp_f32 v51, v35
    v_mfma_f32_16x16x32_bf16 v[40:43], a[28:31], a[204:207], v[40:43]
    ds_read_b128 a[16:19], v2 offset:0
    v_cvt_pk_bf16_f32 v65, v50, v51
    v_mfma_f32_16x16x32_bf16 v[44:47], a[32:35], a[192:195], v[84:87]
    v_exp_f32 v52, v36
    v_mfma_f32_16x16x32_bf16 v[44:47], a[36:39], a[196:199], v[44:47]
    v_exp_f32 v53, v37
    v_mfma_f32_16x16x32_bf16 v[44:47], a[40:43], a[200:203], v[44:47]
    ds_read_b128 a[20:23], v2 offset:1024
    v_cvt_pk_bf16_f32 v66, v52, v53
    v_mfma_f32_16x16x32_bf16 v[44:47], a[44:47], a[204:207], v[44:47]
    s_waitcnt lgkmcnt(6)
    ds_read_b128 a[24:27], v2 offset:2048
    v_mfma_f32_16x16x32_bf16 v[128:131], a[80:83], v[56:59], v[128:131]
    ds_read_b128 a[28:31], v2 offset:3072
    v_or3_b32 v13, v64, v65, v66
    v_mfma_f32_16x16x32_bf16 v[132:135], a[84:87], v[56:59], v[132:135]
    v_exp_f32 v54, v38
    v_mfma_f32_16x16x32_bf16 v[136:139], a[88:91], v[56:59], v[136:139]
    v_exp_f32 v55, v39
    v_mfma_f32_16x16x32_bf16 v[140:143], a[92:95], v[56:59], v[140:143]
    ds_read_b128 a[32:35], v2 offset:4096
    s_waitcnt lgkmcnt(5)
    v_mfma_f32_16x16x32_bf16 v[144:147], a[96:99], v[56:59], v[144:147]
    ds_read_b128 a[36:39], v2 offset:5120
    v_cvt_pk_bf16_f32 v67, v54, v55
    v_mfma_f32_16x16x32_bf16 v[148:151], a[100:103], v[56:59], v[148:151]
    ds_read_b128 a[40:43], v2 offset:6144
    v_or_b32 v13, v13, v67
    v_mfma_f32_16x16x32_bf16 v[152:155], a[104:107], v[56:59], v[152:155]
    ds_read_b128 a[44:47], v2 offset:7168
    v_add_u32 v2, 0x8000, v2
    v_mfma_f32_16x16x32_bf16 v[156:159], a[108:111], v[56:59], v[156:159]
    v_and_b32 v2, 0x1ffff, v2
    s_cmp_lt_u32 s45, s73
    v_mfma_f32_16x16x32_bf16 a[144:147], a[160:163], v[56:59], a[144:147]
    s_cbranch_scc1 k2_dloop
    v_mov_b32 v3, v2
k2_ddone:
    s_cmp_eq_u32 s74, 1
    s_cbranch_scc1 k2_perB
    s_waitcnt lgkmcnt(4)
    v_mfma_f32_16x16x32_bf16 v[16:19], a[16:19], a[0:3], v[72:75]
    v_exp_f32 v120, v40
    v_mfma_f32_16x16x32_bf16 v[16:19], a[20:23], a[4:7], v[16:19]
    v_exp_f32 v121, v41
    v_mfma_f32_16x16x32_bf16 v[16:19], a[24:27], a[8:11], v[16:19]
    v_exp_f32 v122, v42
    v_mfma_f32_16x16x32_bf16 v[16:19], a[28:31], a[12:15], v[16:19]
    s_waitcnt vmcnt(8) lgkmcnt(0)
    s_cmp_lt_u32 s47, s26
    s_cbranch_scc1 k2_ag_59
    s_waitcnt vmcnt(0)
k2_ag_59:
    ds_add_u32 v9, v10
    v_mfma_f32_16x16x32_bf16 v[20:23], a[32:35], a[0:3], v[72:75]
    v_exp_f32 v123, v43
    v_mfma_f32_16x16x32_bf16 v[20:23], a[36:39], a[4:7], v[20:23]
    v_exp_f32 v124, v44
    v_mfma_f32_16x16x32_bf16 v[20:23], a[40:43], a[8:11], v[20:23]
    v_exp_f32 v125, v45
    v_mfma_f32_16x16x32_bf16 v[20:23], a[44:47], a[12:15], v[20:23]
    v_exp_f32 v126, v46
    v_mfma_f32_16x16x32_bf16 v[160:163], a[80:83], v[60:63], v[160:163]
    v_exp_f32 v127, v47
    v_mfma_f32_16x16x32_bf16 v[164:167], a[84:87], v[60:63], v[164:167]
    v_cvt_pk_bf16_f32 v68, v120, v121
    v_cvt_pk_bf16_f32 v69, v122, v123
    v_mfma_f32_16x16x32_bf16 v[168:171], a[88:91], v[60:63], v[168:171]
    v_cvt_pk_bf16_f32 v70, v124, v125
    v_cvt_pk_bf16_f32 v71, v126, v127
    v_mfma_f32_16x16x32_bf16 v[172:175], a[92:95], v[60:63], v[172:175]
    v_or3_b32 v13, v13, v68, v69
    v_or3_b32 v13, v13, v70, v71
    v_mfma_f32_16x16x32_bf16 v[176:179], a[96:99], v[60:63], v[176:179]
    v_and_b32 v13, 0x40004000, v13
    v_cmp_ne_u32 vcc, 0, v13
    v_mfma_f32_16x16x32_bf16 v[180:183], a[100:103], v[60:63], v[180:183]
    s_cbranch_vccnz k2_st_53
k2_bk_54:
    v_cndmask_b32 v16, v16, v8, s[56:57]
    v_mfma_f32_16x16x32_bf16 v[184:187], a[104:107], v[60:63], v[184:187]
    s_cmp_ge_u32 s47, s26
    s_cbranch_scc1 k2_dsk_60
    buffer_load_dwordx4 v4, s[24:27], s47 offen offset:0 sc1 lds
    buffer_load_dwordx4 v4, s[24:27], s47 offen offset:1024 sc1 lds
    buffer_load_dwordx4 v4, s[24:27], s47 offen offset:2048 sc1 lds
    buffer_load_dwordx4 v4, s[24:27], s47 offen offset:3072 sc1 lds
    s_add_u32 m0, m0, 0x4000
    s_and_b32 m0, m0, 0x1ffff
    s_add_u32 s47, s47, 0x2000
    s_cmp_lt_u32 s45, s46
    s_cbranch_scc1 k2_dsk_60
    buffer_load_dwordx4 v4, s[24:27], s47 offen offset:0 sc1 lds
    buffer_load_dwordx4 v4, s[24:27], s47 offen offset:1024 sc1 lds
    buffer_load_dwordx4 v4, s[24:27], s47 offen offset:2048 sc1 lds
    buffer_load_dwordx4 v4, s[24:27], s47 offen offset:3072 sc1 lds
    s_add_u32 m0, m0, 0x4000
    s_and_b32 m0, m0, 0x1ffff
    s_add_u32 s47, s47, 0x2000
k2_dsk_60:
    v_mfma_f32_16x16x32_bf16 v[188:191], a[108:111], v[60:63], v[188:191]
    v_exp_f32 v48, v16
    v_mfma_f32_16x16x32_bf16 a[148:151], a[160:163], v[60:63], a[148:151]
    v_cndmask_b32 v17, v17, v8, s[58:59]
    v_cndmask_b32 v18, v18, v8, s[60:61]
    v_mfma_f32_16x16x32_bf16 v[24:27], a[16:19], a[64:67], v[76:79]
    v_exp_f32 v49, v17
    v_mfma_f32_16x16x32_bf16 v[24:27], a[20:23], a[68:71], v[24:27]
    v_exp_f32 v50, v18
    v_mfma_f32_16x16x32_bf16 v[24:27], a[24:27], a[72:75], v[24:27]
    v_cndmask_b32 v19, v19, v8, s[62:63]
    v_mov_b32 v20, v8
    v_mfma_f32_16x16x32_bf16 v[24:27], a[28:31], a[76:79], v[24:27]
    v_exp_f32 v51, v19
    v_mfma_f32_16x16x32_bf16 v[28:31], a[32:35], a[64:67], v[76:79]
    v_exp_f32 v52, v20
    v_mfma_f32_16x16x32_bf16 v[28:31], a[36:39], a[68:71], v[28:31]
    v_mov_b32 v21, v8
    v_mov_b32 v22, v8
    v_mfma_f32_16x16x32_bf16 v[28:31], a[40:43], a[72:75], v[28:31]
    v_exp_f32 v53, v21
    v_mfma_f32_16x16x32_bf16 v[28:31], a[44:47], a[76:79], v[28:31]
    v_exp_f32 v54, v22
    v_mfma_f32_16x16x32_bf16 v[192:195], a[80:83], v[64:67], v[192:195]
    v_mov_b32 v23, v8
    v_cvt_pk_bf16_f32 v56, v48, v49
    v_mfma_f32_16x16x32_bf16 v[196:199], a[84:87], v[64:67], v[196:199]
    v_exp_f32 v55, v23
    v_mfma_f32_16x16x32_bf16 v[200:203], a[88:91], v[64:67], v[200:203]
    v_cvt_pk_bf16_f32 v57, v50, v51
    v_cvt_pk_bf16_f32 v58, v52, v53
    v_mfma_f32_16x16x32_bf16 v[204:207], a[92:95], v[64:67], v[204:207]
    v_exp_f32 v120, v24
    v_mfma_f32_16x16x32_bf16 v[208:211], a[96:99], v[64:67], v[208:211]
    v_exp_f32 v121, v25
    v_mfma_f32_16x16x32_bf16 v[212:215], a[100:103], v[64:67], v[212:215]
    v_exp_f32 v122, v26
    v_mfma_f32_16x16x32_bf16 v[216:219], a[104:107], v[64:67], v[216:219]
    v_exp_f32 v123, v27
    v_mfma_f32_16x16x32_bf16 v[220:223], a[108:111], v[64:67], v[220:223]
    v_cndmask_b32 v28, v28, v8, s[56:57]
    v_cndmask_b32 v29, v29, v8, s[58:59]
    v_mfma_f32_16x16x32_bf16 a[152:155], a[160:163], v[64:67], a[152:155]
    ds_read_b32 v11, v9
    v_cndmask_b32 v30, v30, v8, s[60:61]
    v_mfma_f32_16x16x32_bf16 v[32:35], a[16:19], a[128:131], v[80:83]
    v_exp_f32 v124, v28
    v_mfma_f32_16x16x32_bf16 v[32:35], a[20:23], a[132:135], v[32:35]
    v_exp_f32 v125, v29
    v_mfma_f32_16x16x32_bf16 v[32:35], a[24:27], a[136:139], v[32:35]
    s_waitcnt lgkmcnt(0)
    v_cmp_gt_u32 vcc, s45, v11
    v_mfma_f32_16x16x32_bf16 v[32:35], a[28:31], a[140:143], v[32:35]
    s_cbranch_vccnz k2_st_55
k2_bk_56:
    v_cndmask_b32 v31, v31, v8, s[62:63]
    v_mfma_f32_16x16x32_bf16 v[36:39], a[32:35], a[128:131], v[80:83]
    v_exp_f32 v126, v30
    v_mfma_f32_16x16x32_bf16 v[36:39], a[36:39], a[132:135], v[36:39]
    v_exp_f32 v127, v31
    v_mfma_f32_16x16x32_bf16 v[36:39], a[40:43], a[136:139], v[36:39]
    v_cvt_pk_bf16_f32 v59, v54, v55
    v_or3_b32 v12, v56, v57, v58
    v_mfma_f32_16x16x32_bf16 v[36:39], a[44:47], a[140:143], v[36:39]
    v_or_b32 v12, v12, v59
    v_cvt_pk_bf16_f32 v60, v120, v121
    v_mfma_f32_16x16x32_bf16 v[224:227], a[80:83], v[68:71], v[224:227]
    ds_read_b128 a[80:83], v3 offset:8192
    v_cvt_pk_bf16_f32 v61, v122, v123
    v_mfma_f32_16x16x32_bf16 v[228:231], a[84:87], v[68:71], v[228:231]
    ds_read_b128 a[84:87], v3 offset:9216
    v_cvt_pk_bf16_f32 v62, v124, v125
    v_mfma_f32_16x16x32_bf16 v[232:235], a[88:91], v[68:71], v[232:235]
    ds_read_b128 a[88:91], v3 offset:10240
    v_cvt_pk_bf16_f32 v63, v126, v127
    v_mfma_f32_16x16x32_bf16 v[236:239], a[92:95], v[68:71], v[236:239]
    ds_read_b128 a[92:95], v3 offset:11264
    v_or3_b32 v12, v12, v60, v61
    v_mfma_f32_16x16x32_bf16 v[240:243], a[96:99], v[68:71], v[240:243]
    ds_read_b128 a[96:99], v3 offset:12288
    v_or3_b32 v12, v12, v62, v63
    v_mfma_f32_16x16x32_bf16 v[244:247], a[100:103], v[68:71], v[244:247]
    ds_read_b128 a[100:103], v3 offset:13312
    v_and_b32 v12, 0x40004000, v12
    v_mfma_f32_16x16x32_bf16 v[248:251], a[104:107], v[68:71], v[248:251]
    ds_read_b128 a[104:107], v3 offset:14336
    v_cmp_ne_u32 vcc, 0, v12
    v_mfma_f32_16x16x32_bf16 v[252:255], a[108:111], v[68:71], v[252:255]
    ds_read_b128 a[108:111], v3 offset:15360
    s_cbranch_vccnz k2_st_57
k2_bk_58:
    v_mfma_f32_16x16x32_bf16 a[156:159], a[160:163], v[68:71], a[156:159]
    v_exp_f32 v48, v32
    v_mfma_f32_16x16x32_bf16 v[40:43], a[16:19], a[192:195], v[84:87]
    ds_read_b128 a[16:19], v2 offset:0
    s_add_i32 s66, s45, 8
    v_mfma_f32_16x16x32_bf16 v[40:43], a[20:23], a[196:199], v[40:43]
    s_cmp_ge_i32 s66, s72
    s_cselect_b32 s51, 0x8000, s7
    v_mfma_f32_16x16x32_bf16 v[40:43], a[24:27], a[200:203], v[40:43]
    s_cmp_gt_i32 s66, s72
    s_cselect_b32 s52, 0x8000, s7
    v_mfma_f32_16x16x32_bf16 v[40:43], a[28:31], a[204:207], v[40:43]
    ds_read_b128 a[20:23], v2 offset:1024
    v_add_u32 v3, s52, v3
    v_mfma_f32_16x16x32_bf16 v[44:47], a[32:35], a[192:195], v[84:87]
    ds_read_b128 a[24:27], v2 offset:2048
    v_and_b32 v3, 0x1ffff, v3
    v_mfma_f32_16x16x32_bf16 v[44:47], a[36:39], a[196:199], v[44:47]
    ds_read_b128 a[28:31], v2 offset:3072
    s_add_u32 s45, s45, 4
    v_mfma_f32_16x16x32_bf16 v[44:47], a[40:43], a[200:203], v[44:47]
    v_exp_f32 v49, v33
    v_mfma_f32_16x16x32_bf16 v[44:47], a[44:47], a[204:207], v[44:47]
    s_waitcnt lgkmcnt(8)
    ds_read_b128 a[32:35], v2 offset:4096
    v_mfma_f32_16x16x32_bf16 v[128:131], a[80:83], v[56:59], v[128:131]
    v_exp_f32 v50, v34
    v_mfma_f32_16x16x32_bf16 v[132:135], a[84:87], v[56:59], v[132:135]
    v_exp_f32 v51, v35
    v_mfma_f32_16x16x32_bf16 v[136:139], a[88:91], v[56:59], v[136:139]
    v_exp_f32 v52, v36
    v_mfma_f32_16x16x32_bf16 v[140:143], a[92:95], v[56:59], v[140:143]
    s_waitcnt lgkmcnt(5)
    ds_read_b128 a[36:39], v2 offset:5120
    v_mfma_f32_16x16x32_bf16 v[144:147], a[96:99], v[56:59], v[144:147]
    v_exp_f32 v53, v37
    v_mfma_f32_16x16x32_bf16 v[148:151], a[100:103], v[56:59], v[148:151]
    ds_read_b128 a[40:43], v2 offset:6144
    v_cvt_pk_bf16_f32 v64, v48, v49
    v_mfma_f32_16x16x32_bf16 v[152:155], a[104:107], v[56:59], v[152:155]
    ds_read_b128 a[44:47], v2 offset:7168
    v_cvt_pk_bf16_f32 v65, v50, v51
    v_mfma_f32_16x16x32_bf16 v[156:159], a[108:111], v[56:59], v[156:159]
    v_exp_f32 v54, v38
    v_exp_f32 v55, v39
    v_mfma_f32_16x16x32_bf16 a[144:147], a[160:163], v[56:59], a[144:147]
    v_cvt_pk_bf16_f32 v66, v52, v53
    v_cvt_pk_bf16_f32 v67, v54, v55
    v_or3_b32 v13, v64, v65, v66
    v_or_b32 v13, v13, v67
    v_add_u32 v2, s51, v2
    v_and_b32 v2, 0x1ffff, v2
    s_cmp_eq_u32 s73, 132
    s_cbranch_scc1 k2_perB
    s_cmp_eq_u32 s44, 1
    s_cbranch_scc1 k2_perB
    v_exp_f32 v120, v40
    v_mfma_f32_16x16x32_bf16 v[160:163], a[80:83], v[60:63], v[160:163]
    s_waitcnt vmcnt(8) lgkmcnt(0)
    s_cmp_lt_u32 s47, s26
    s_cbranch_scc1 k2_ag_65
    s_waitcnt vmcnt(0)
k2_ag_65:
    ds_add_u32 v9, v10
    v_mfma_f32_16x16x32_bf16 v[164:167], a[84:87], v[60:63], v[164:167]
    v_exp_f32 v121, v41
    v_mfma_f32_16x16x32_bf16 v[168:171], a[88:91], v[60:63], v[168:171]
    v_exp_f32 v122, v42
    v_mfma_f32_16x16x32_bf16 v[172:175], a[92:95], v[60:63], v[172:175]
    v_exp_f32 v123, v43
    v_mfma_f32_16x16x32_bf16 v[176:179], a[96:99], v[60:63], v[176:179]
    v_exp_f32 v124, v44
    v_mfma_f32_16x16x32_bf16 v[180:183], a[100:103], v[60:63], v[180:183]
    v_exp_f32 v125, v45
    v_mfma_f32_16x16x32_bf16 v[184:187], a[104:107], v[60:63], v[184:187]
    v_exp_f32 v126, v46
    v_exp_f32 v127, v47
    v_mfma_f32_16x16x32_bf16 v[188:191], a[108:111], v[60:63], v[188:191]
    v_cvt_pk_bf16_f32 v68, v120, v121
    v_cvt_pk_bf16_f32 v69, v122, v123
    v_cvt_pk_bf16_f32 v70, v124, v125
    v_cvt_pk_bf16_f32 v71, v126, v127
    v_or3_b32 v13, v13, v68, v69
    v_or3_b32 v13, v13, v70, v71
    v_and_b32 v13, 0x40004000, v13
    v_cmp_ne_u32 vcc, 0, v13
    v_mfma_f32_16x16x32_bf16 a[148:151], a[160:163], v[60:63], a[148:151]
    s_cbranch_vccnz k2_st_61
k2_bk_62:
    v_mfma_f32_16x16x32_bf16 v[192:195], a[80:83], v[64:67], v[192:195]
    s_cmp_ge_u32 s47, s26
    s_cbranch_scc1 k2_dsk_66
    buffer_load_dwordx4 v4, s[24:27], s47 offen offset:0 sc1 lds
    buffer_load_dwordx4 v4, s[24:27], s47 offen offset:1024 sc1 lds
    buffer_load_dwordx4 v4, s[24:27], s47 offen offset:2048 sc1 lds
    buffer_load_dwordx4 v4, s[24:27], s47 offen offset:3072 sc1 lds
    s_add_u32 m0, m0, 0x4000
    s_and_b32 m0, m0, 0x1ffff
    s_add_u32 s47, s47, 0x2000
    s_cmp_lt_u32 s45, s46
    s_cbranch_scc1 k2_dsk_66
    buffer_load_dwordx4 v4, s[24:27], s47 offen offset:0 sc1 lds
    buffer_load_dwordx4 v4, s[24:27], s47 offen offset:1024 sc1 lds
    buffer_load_dwordx4 v4, s[24:27], s47 offen offset:2048 sc1 lds
    buffer_load_dwordx4 v4, s[24:27], s47 offen offset:3072 sc1 lds
    s_add_u32 m0, m0, 0x4000
    s_and_b32 m0, m0, 0x1ffff
    s_add_u32 s47, s47, 0x2000
k2_dsk_66:
    v_mfma_f32_16x16x32_bf16 v[196:199], a[84:87], v[64:67], v[196:199]
    buffer_load_dword v14, v117, s[8:11], 0 offen sc1
    global_load_dwordx4 a[208:211], v116, s[4:5]
    v_mfma_f32_16x16x32_bf16 v[200:203], a[88:91], v[64:67], v[200:203]
    buffer_load_dwordx4 a[208:211], v115, s[12:15], 0 offen offset:0
    v_mfma_f32_16x16x32_bf16 v[204:207], a[92:95], v[64:67], v[204:207]
    buffer_load_dwordx4 a[208:211], v115, s[12:15], 0 offen offset:1024
    v_mfma_f32_16x16x32_bf16 v[208:211], a[96:99], v[64:67], v[208:211]
    buffer_load_dwordx4 a[208:211], v115, s[12:15], 0 offen offset:2048
    v_mfma_f32_16x16x32_bf16 v[212:215], a[100:103], v[64:67], v[212:215]
    buffer_load_dwordx4 a[208:211], v114, s[28:31], 0 offen offset:0
    v_mfma_f32_16x16x32_bf16 v[216:219], a[104:107], v[64:67], v[216:219]
    buffer_load_dwordx4 a[208:211], v114, s[28:31], 0 offen offset:1024
    v_mfma_f32_16x16x32_bf16 v[220:223], a[108:111], v[64:67], v[220:223]
    ds_read_b32 v11, v9
    buffer_load_dwordx4 a[208:211], v114, s[28:31], 0 offen offset:2048
    v_mfma_f32_16x16x32_bf16 a[152:155], a[160:163], v[64:67], a[152:155]
    buffer_load_dwordx4 a[208:211], v114, s[28:31], 0 offen offset:3072
    v_mfma_f32_16x16x32_bf16 v[224:227], a[80:83], v[68:71], v[224:227]
    buffer_load_dwordx4 a[208:211], v113, s[28:31], 0 offen offset:0
    v_mfma_f32_16x16x32_bf16 v[228:231], a[84:87], v[68:71], v[228:231]
    buffer_load_dwordx4 a[208:211], v113, s[28:31], 0 offen offset:1024
    v_mfma_f32_16x16x32_bf16 v[232:235], a[88:91], v[68:71], v[232:235]
    s_waitcnt lgkmcnt(0)
    v_cmp_gt_u32 vcc, s45, v11
    v_mfma_f32_16x16x32_bf16 v[236:239], a[92:95], v[68:71], v[236:239]
    s_cbranch_vccnz k2_st_63
k2_bk_64:
    s_add_u32 s45, s45, 4
    v_mfma_f32_16x16x32_bf16 v[240:243], a[96:99], v[68:71], v[240:243]
    buffer_load_dwordx4 a[208:211], v113, s[28:31], 0 offen offset:2048
    buffer_load_dwordx4 a[208:211], v113, s[28:31], 0 offen offset:3072
    v_mfma_f32_16x16x32_bf16 v[244:247], a[100:103], v[68:71], v[244:247]
    v_mfma_f32_16x16x32_bf16 v[248:251], a[104:107], v[68:71], v[248:251]
    v_mfma_f32_16x16x32_bf16 v[252:255], a[108:111], v[68:71], v[252:255]
    v_mfma_f32_16x16x32_bf16 a[156:159], a[160:163], v[68:71], a[156:159]
    s_branch k2_tail
k2_proA:
    s_waitcnt vmcnt(0) lgkmcnt(0)
    ds_add_u32 v9, v10
    v_mfma_f32_16x16x32_bf16 v[16:19], a[16:19], a[0:3], 0
    s_cmp_lg_u32 s44, 0
    s_cbranch_scc1 k2_np_69
    ds_write_b128 v6, a[0:3] offset:0
    ds_write_b128 v6, a[4:7] offset:1024
    ds_write_b128 v6, a[8:11] offset:2048
    ds_write_b128 v6, a[12:15] offset:3072
k2_np_69:
    v_mfma_f32_16x16x32_bf16 v[16:19], a[20:23], a[4:7], v[16:19]
    s_lshl_b32 s65, s2, 2
    s_add_u32 s65, s65, s40
    s_lshl_b32 s38, s65, 12
    v_mfma_f32_16x16x32_bf16 v[16:19], a[24:27], a[8:11], v[16:19]
    s_lshl_b32 s37, s65, 11
    s_and_b32 s65, s2, 1
    s_lshl_b32 s65, s65, 3
    v_mfma_f32_16x16x32_bf16 v[16:19], a[28:31], a[12:15], v[16:19]
    s_lshr_b32 s66, s2, 5
    s_add_u32 s65, s65, s66
    s_sub_u32 s66, 15, s65
    v_mfma_f32_16x16x32_bf16 v[20:23], a[32:35], a[0:3], 0
    s_min_u32 s65, s65, s66
    s_lshl_b32 s65, s65, 7
    s_add_u32 s65, s65, 58077184
    v_mfma_f32_16x16x32_bf16 v[20:23], a[36:39], a[4:7], v[20:23]
    s_cmp_lg_u32 s44, 0
    s_cbranch_scc1 k2_np_70
    ds_write_b128 v6, a[64:67] offset:4096
    ds_write_b128 v6, a[68:71] offset:5120
    ds_write_b128 v6, a[72:75] offset:6144
    ds_write_b128 v6, a[76:79] offset:7168
k2_np_70:
    v_mfma_f32_16x16x32_bf16 v[20:23], a[40:43], a[8:11], v[20:23]
    v_and_b32 v117, 31, v1
    v_lshlrev_b32 v117, 2, v117
    v_add_u32 v117, s65, v117
    v_mfma_f32_16x16x32_bf16 v[20:23], a[44:47], a[12:15], v[20:23]
    s_lshr_b32 s65, s2, 3
    s_lshl_b32 s65, s65, 2
    s_add_u32 s65, s65, s40
    v_mfma_f32_16x16x32_bf16 v[24:27], a[16:19], a[64:67], 0
    s_and_b32 s66, s2, 7
    s_lshr_b32 s66, s66, 1
    s_lshl_b32 s67, s66, 20
    v_mfma_f32_16x16x32_bf16 v[24:27], a[20:23], a[68:71], v[24:27]
    s_lshl_b32 s68, s65, 13
    s_add_u32 s67, s67, s68
    v_add_u32 v114, s67, v7
    v_mfma_f32_16x16x32_bf16 v[24:27], a[24:27], a[72:75], v[24:27]
    s_cmp_lg_u32 s44, 0
    s_cbranch_scc1 k2_np_71
    ds_write_b128 v6, a[128:131] offset:8192
    ds_write_b128 v6, a[132:135] offset:9216
    ds_write_b128 v6, a[136:139] offset:10240
    ds_write_b128 v6, a[140:143] offset:11264
k2_np_71:
    v_mfma_f32_16x16x32_bf16 v[24:27], a[28:31], a[76:79], v[24:27]
    v_add_u32 v113, 0x1000, v114
    s_lshl_b32 s3, s65, 10
    s_mul_i32 s65, s65, 2816
    v_mfma_f32_16x16x32_bf16 v[28:31], a[32:35], a[64:67], 0
    ds_read_b32 v11, v9
    s_mul_i32 s66, s66, 0x58000
    s_add_u32 s65, s65, s66
    v_mfma_f32_16x16x32_bf16 v[28:31], a[36:39], a[68:71], v[28:31]
    v_add_u32 v115, s65, v7
    s_add_u32 s65, s3, k2_merge-mg_pc2
    v_add_u32 v116, s65, v7
    v_mfma_f32_16x16x32_bf16 v[28:31], a[40:43], a[72:75], v[28:31]
    v_min_u32 v116, mg_exit-mg_pc2-16, v116
    v_mov_b32 v13, 0
    v_mfma_f32_16x16x32_bf16 v[28:31], a[44:47], a[76:79], v[28:31]
    s_cmp_lg_u32 s44, 0
    s_cbranch_scc1 k2_np_72
    ds_write_b128 v6, a[192:195] offset:12288
    ds_write_b128 v6, a[196:199] offset:13312
    ds_write_b128 v6, a[200:203] offset:14336
k2_np_72:
    v_mfma_f32_16x16x32_bf16 v[32:35], a[16:19], a[128:131], 0
    s_waitcnt lgkmcnt(0)
    v_cmp_gt_u32 vcc, s45, v11
    v_cndmask_b32 v16, v16, v8, s[56:57]
    v_mfma_f32_16x16x32_bf16 v[32:35], a[20:23], a[132:135], v[32:35]
    s_cbranch_vccnz k2_st_67
k2_bk_68:
    v_cndmask_b32 v17, v17, v8, s[58:59]
    v_cndmask_b32 v18, v18, v8, s[60:61]
    v_mfma_f32_16x16x32_bf16 v[32:35], a[24:27], a[136:139], v[32:35]
    ds_read_b128 a[80:83], v3 offset:8192
    v_cndmask_b32 v19, v19, v8, s[62:63]
    v_mov_b32 v20, v8
    v_mfma_f32_16x16x32_bf16 v[32:35], a[28:31], a[140:143], v[32:35]
    ds_read_b128 a[84:87], v3 offset:9216
    buffer_store_dword v10, v15, s[8:11], s50 offen sc1
    v_mov_b32 v21, v8
    v_mfma_f32_16x16x32_bf16 v[36:39], a[32:35], a[128:131], 0
    ds_read_b128 a[88:91], v3 offset:10240
    v_mov_b32 v22, v8
    v_mov_b32 v23, v8
    v_mfma_f32_16x16x32_bf16 v[36:39], a[36:39], a[132:135], v[36:39]
    ds_read_b128 a[92:95], v3 offset:11264
    v_max3_f32 v88, v16, v17, v18
    v_max3_f32 v89, v19, v20, v21
    v_mfma_f32_16x16x32_bf16 v[36:39], a[40:43], a[136:139], v[36:39]
    ds_read_b128 a[96:99], v3 offset:12288
    v_max3_f32 v88, v88, v22, v23
    v_max_f32 v88, v88, v89
    v_mfma_f32_16x16x32_bf16 v[36:39], a[44:47], a[140:143], v[36:39]
    ds_read_b128 a[100:103], v3 offset:13312
    v_mov_b32 v89, v88
    v_cndmask_b32 v28, v28, v8, s[56:57]
    v_mfma_f32_16x16x32_bf16 v[40:43], a[16:19], a[192:195], 0
    ds_read_b128 a[104:107], v3 offset:14336
    s_nop 1
    v_mfma_f32_16x16x32_bf16 v[40:43], a[20:23], a[196:199], v[40:43]
    ds_read_b128 a[108:111], v3 offset:15360
    v_permlane16_swap_b32 v88, v89
    v_max_f32 v88, v88, v89
    v_mfma_f32_16x16x32_bf16 v[40:43], a[24:27], a[200:203], v[40:43]
    ds_read_b128 a[16:19], v2 offset:0
    v_mov_b32 v89, v88
    v_cndmask_b32 v29, v29, v8, s[58:59]
    v_mfma_f32_16x16x32_bf16 v[40:43], a[28:31], a[204:207], v[40:43]
    ds_read_b128 a[20:23], v2 offset:1024
    s_nop 1
    v_mfma_f32_16x16x32_bf16 v[44:47], a[32:35], a[192:195], 0
    ds_read_b128 a[24:27], v2 offset:2048
    v_permlane32_swap_b32 v88, v89
    v_max_f32 v88, v88, v89
    v_mfma_f32_16x16x32_bf16 v[44:47], a[36:39], a[196:199], v[44:47]
    ds_read_b128 a[28:31], v2 offset:3072
    v_max_f32 v88, 0xf149f2ca, v88
    v_add_f32 v88, 0x42000000, v88
    v_mfma_f32_16x16x32_bf16 v[44:47], a[40:43], a[200:203], v[44:47]
    ds_read_b128 a[32:35], v2 offset:4096
    v_sub_f32 v16, v16, v88
    v_sub_f32 v17, v17, v88
    v_mfma_f32_16x16x32_bf16 v[44:47], a[44:47], a[204:207], v[44:47]
    ds_read_b128 a[36:39], v2 offset:5120
    v_sub_f32 v18, v18, v88
    v_sub_f32 v19, v19, v88
    v_mfma_f32_16x16x32_bf16 v[160:163], a[164:167], a[164:167], 0
    ds_read_b128 a[40:43], v2 offset:6144
    v_sub_f32 v20, v20, v88
    v_sub_f32 v21, v21, v88
    v_mfma_f32_16x16x32_bf16 v[164:167], a[164:167], a[164:167], 0
    ds_read_b128 a[44:47], v2 offset:7168
    v_sub_f32 v22, v22, v88
    v_sub_f32 v23, v23, v88
    v_mfma_f32_16x16x32_bf16 v[168:171], a[164:167], a[164:167], 0
    v_exp_f32 v48, v16
    s_add_i32 s66, s45, 8
    v_mfma_f32_16x16x32_bf16 v[172:175], a[164:167], a[164:167], 0
    v_exp_f32 v49, v17
    buffer_load_dwordx4 a[208:211], v7, s[28:31], s38 offen offset:0
    v_mfma_f32_16x16x32_bf16 v[176:179], a[164:167], a[164:167], 0
    v_exp_f32 v50, v18
    buffer_load_dwordx4 a[208:211], v7, s[28:31], s38 offen offset:1024
    v_mfma_f32_16x16x32_bf16 v[180:183], a[164:167], a[164:167], 0
    v_exp_f32 v51, v19
    v_cndmask_b32 v30, v30, v8, s[60:61]
    v_mfma_f32_16x16x32_bf16 v[184:187], a[164:167], a[164:167], 0
    v_exp_f32 v52, v20
    buffer_load_dwordx4 a[208:211], v7, s[28:31], s38 offen offset:2048
    v_mfma_f32_16x16x32_bf16 v[188:191], a[164:167], a[164:167], 0
    v_exp_f32 v53, v21
    v_cndmask_b32 v31, v31, v8, s[62:63]
    v_mfma_f32_16x16x32_bf16 a[148:151], a[164:167], a[164:167], 0
    v_exp_f32 v54, v22
    v_max3_f32 v90, v24, v25, v26
    v_mfma_f32_16x16x32_bf16 v[192:195], a[164:167], a[164:167], 0
    v_exp_f32 v55, v23
    s_nop 0
    v_mfma_f32_16x16x32_bf16 v[196:199], a[164:167], a[164:167], 0
    v_cvt_pk_bf16_f32 v56, v48, v49
    v_cvt_pk_bf16_f32 v57, v50, v51
    v_cvt_pk_bf16_f32 v58, v52, v53
    v_mfma_f32_16x16x32_bf16 v[200:203], a[164:167], a[164:167], 0
    v_cvt_pk_bf16_f32 v59, v54, v55
    s_cmp_ge_i32 s66, s72
    s_cselect_b32 s51, 0x8000, s7
    v_mfma_f32_16x16x32_bf16 v[204:207], a[164:167], a[164:167], 0
    s_cmp_gt_i32 s66, s72
    s_cselect_b32 s52, 0x8000, s7
    buffer_load_dwordx4 a[208:211], v7, s[28:31], s38 offen offset:3072
    v_mfma_f32_16x16x32_bf16 v[208:211], a[164:167], a[164:167], 0
    v_add_u32 v2, s51, v2
    v_and_b32 v2, 0x1ffff, v2
    v_add_u32 v3, s52, v3
    v_mfma_f32_16x16x32_bf16 v[212:215], a[164:167], a[164:167], 0
    buffer_load_dwordx4 a[208:211], v7, s[12:15], s37 offen offset:0
    v_and_b32 v3, 0x1ffff, v3
    s_add_u32 s45, s45, 4
    v_mfma_f32_16x16x32_bf16 v[216:219], a[164:167], a[164:167], 0
    v_sub_f32 v72, 0, v88
    v_sub_f32 v73, 0, v88
    v_sub_f32 v74, 0, v88
    v_mfma_f32_16x16x32_bf16 v[220:223], a[164:167], a[164:167], 0
    v_sub_f32 v75, 0, v88
    v_max3_f32 v91, v27, v28, v29
    v_max3_f32 v90, v90, v30, v31
    v_mfma_f32_16x16x32_bf16 a[152:155], a[164:167], a[164:167], 0
    v_max_f32 v90, v90, v91
    v_mov_b32 v91, v90
    v_max3_f32 v92, v32, v33, v34
    v_mfma_f32_16x16x32_bf16 v[224:227], a[164:167], a[164:167], 0
    s_nop 1
    buffer_load_dwordx4 a[208:211], v7, s[12:15], s37 offen offset:1024
    v_mfma_f32_16x16x32_bf16 v[228:231], a[164:167], a[164:167], 0
    v_permlane16_swap_b32 v90, v91
    v_max_f32 v90, v90, v91
    v_mov_b32 v91, v90
    v_mfma_f32_16x16x32_bf16 v[232:235], a[164:167], a[164:167], 0
    s_nop 1
    v_permlane32_swap_b32 v90, v91
    v_mfma_f32_16x16x32_bf16 v[236:239], a[164:167], a[164:167], 0
    v_max_f32 v90, v90, v91
    v_max_f32 v90, 0xf149f2ca, v90
    v_add_f32 v90, 0x42000000, v90
    v_mfma_f32_16x16x32_bf16 v[240:243], a[164:167], a[164:167], 0
    v_sub_f32 v24, v24, v90
    v_sub_f32 v25, v25, v90
    v_sub_f32 v26, v26, v90
    v_mfma_f32_16x16x32_bf16 v[244:247], a[164:167], a[164:167], 0
    v_sub_f32 v27, v27, v90
    v_sub_f32 v28, v28, v90
    v_sub_f32 v29, v29, v90
    v_mfma_f32_16x16x32_bf16 v[248:251], a[164:167], a[164:167], 0
    v_sub_f32 v30, v30, v90
    v_sub_f32 v31, v31, v90
    v_max3_f32 v93, v35, v36, v37
    v_mfma_f32_16x16x32_bf16 v[252:255], a[164:167], a[164:167], 0
    v_exp_f32 v120, v24
    v_max3_f32 v92, v92, v38, v39
    v_mfma_f32_16x16x32_bf16 a[156:159], a[164:167], a[164:167], 0
    s_waitcnt lgkmcnt(8)
    v_exp_f32 v121, v25
    v_mfma_f32_16x16x32_bf16 v[128:131], a[80:83], v[56:59], 0
    v_exp_f32 v122, v26
    v_max_f32 v92, v92, v93
    v_mfma_f32_16x16x32_bf16 v[132:135], a[84:87], v[56:59], 0
    v_exp_f32 v123, v27
    v_mov_b32 v93, v92
    v_mfma_f32_16x16x32_bf16 v[136:139], a[88:91], v[56:59], 0
    v_exp_f32 v124, v28
    v_max3_f32 v94, v40, v41, v42
    v_mfma_f32_16x16x32_bf16 v[140:143], a[92:95], v[56:59], 0
    v_exp_f32 v125, v29
    v_max3_f32 v95, v43, v44, v45
    v_mfma_f32_16x16x32_bf16 v[144:147], a[96:99], v[56:59], 0
    v_exp_f32 v126, v30
    v_max3_f32 v94, v94, v46, v47
    v_mfma_f32_16x16x32_bf16 v[148:151], a[100:103], v[56:59], 0
    v_exp_f32 v127, v31
    s_nop 0
    v_mfma_f32_16x16x32_bf16 v[152:155], a[104:107], v[56:59], 0
    s_nop 1
    v_cvt_pk_bf16_f32 v60, v120, v121
    v_mfma_f32_16x16x32_bf16 v[156:159], a[108:111], v[56:59], 0
    v_cvt_pk_bf16_f32 v61, v122, v123
    v_cvt_pk_bf16_f32 v62, v124, v125
    v_cvt_pk_bf16_f32 v63, v126, v127
    v_mfma_f32_16x16x32_bf16 a[144:147], a[160:163], v[56:59], 0
    v_sub_f32 v76, 0, v90
    v_sub_f32 v77, 0, v90
    v_sub_f32 v78, 0, v90
    v_sub_f32 v79, 0, v90
    v_permlane16_swap_b32 v92, v93
    v_max_f32 v92, v92, v93
    v_mov_b32 v93, v92
    s_nop 1
    v_permlane32_swap_b32 v92, v93
    v_max_f32 v92, v92, v93
    v_max_f32 v92, 0xf149f2ca, v92
    v_add_f32 v92, 0x42000000, v92
    v_sub_f32 v32, v32, v92
    v_sub_f32 v33, v33, v92
    v_sub_f32 v34, v34, v92
    v_sub_f32 v35, v35, v92
    v_sub_f32 v36, v36, v92
    v_sub_f32 v37, v37, v92
    v_sub_f32 v38, v38, v92
    v_sub_f32 v39, v39, v92
    v_exp_f32 v48, v32
    v_exp_f32 v49, v33
    v_exp_f32 v50, v34
    v_exp_f32 v51, v35
    v_exp_f32 v52, v36
    v_exp_f32 v53, v37
    v_exp_f32 v54, v38
    v_exp_f32 v55, v39
    s_nop 0
    v_cvt_pk_bf16_f32 v64, v48, v49
    v_cvt_pk_bf16_f32 v65, v50, v51
    v_cvt_pk_bf16_f32 v66, v52, v53
    v_cvt_pk_bf16_f32 v67, v54, v55
    v_sub_f32 v80, 0, v92
    v_sub_f32 v81, 0, v92
    v_sub_f32 v82, 0, v92
    v_sub_f32 v83, 0, v92
    v_max_f32 v94, v94, v95
    v_mov_b32 v95, v94
    s_nop 1
    v_permlane16_swap_b32 v94, v95
    v_max_f32 v94, v94, v95
    v_mov_b32 v95, v94
    s_nop 1
    v_permlane32_swap_b32 v94, v95
    v_max_f32 v94, v94, v95
    v_max_f32 v94, 0xf149f2ca, v94
    v_add_f32 v94, 0x42000000, v94
    v_sub_f32 v40, v40, v94
    v_sub_f32 v41, v41, v94
    v_sub_f32 v42, v42, v94
    v_sub_f32 v43, v43, v94
    v_sub_f32 v44, v44, v94
    v_sub_f32 v45, v45, v94
    v_sub_f32 v46, v46, v94
    v_sub_f32 v47, v47, v94
    v_sub_f32 v84, 0, v94
    v_sub_f32 v85, 0, v94
    v_sub_f32 v86, 0, v94
    v_sub_f32 v87, 0, v94
    s_nop 1
    ds_read_b128 a[48:51], v14
k2_perB:
    s_waitcnt lgkmcnt(4)
    v_mfma_f32_16x16x32_bf16 v[16:19], a[16:19], a[0:3], v[72:75]
    v_exp_f32 v120, v40
    v_mfma_f32_16x16x32_bf16 v[16:19], a[20:23], a[4:7], v[16:19]
    v_exp_f32 v121, v41
    v_mfma_f32_16x16x32_bf16 v[16:19], a[24:27], a[8:11], v[16:19]
    v_exp_f32 v122, v42
    v_mfma_f32_16x16x32_bf16 v[16:19], a[28:31], a[12:15], v[16:19]
    s_waitcnt vmcnt(8) lgkmcnt(0)
    s_cmp_lt_u32 s47, s26
    s_cbranch_scc1 k2_ag_79
    s_waitcnt vmcnt(0)
k2_ag_79:
    ds_add_u32 v9, v10
    v_mfma_f32_16x16x32_bf16 v[20:23], a[32:35], a[0:3], v[72:75]
    v_exp_f32 v123, v43
    v_mfma_f32_16x16x32_bf16 v[20:23], a[36:39], a[4:7], v[20:23]
    v_exp_f32 v124, v44
    v_mfma_f32_16x16x32_bf16 v[20:23], a[40:43], a[8:11], v[20:23]
    v_exp_f32 v125, v45
    v_mfma_f32_16x16x32_bf16 v[20:23], a[44:47], a[12:15], v[20:23]
    v_exp_f32 v126, v46
    v_mfma_f32_16x16x32_bf16 v[160:163], a[80:83], v[60:63], v[160:163]
    v_exp_f32 v127, v47
    v_mfma_f32_16x16x32_bf16 v[164:167], a[84:87], v[60:63], v[164:167]
    v_cvt_pk_bf16_f32 v68, v120, v121
    v_cvt_pk_bf16_f32 v69, v122, v123
    v_mfma_f32_16x16x32_bf16 v[168:171], a[88:91], v[60:63], v[168:171]
    v_cvt_pk_bf16_f32 v70, v124, v125
    v_cvt_pk_bf16_f32 v71, v126, v127
    v_mfma_f32_16x16x32_bf16 v[172:175], a[92:95], v[60:63], v[172:175]
    v_or3_b32 v13, v13, v68, v69
    v_or3_b32 v13, v13, v70, v71
    v_mfma_f32_16x16x32_bf16 v[176:179], a[96:99], v[60:63], v[176:179]
    v_and_b32 v13, 0x40004000, v13
    v_cmp_ne_u32 vcc, 0, v13
    v_mfma_f32_16x16x32_bf16 v[180:183], a[100:103], v[60:63], v[180:183]
    s_cbranch_vccnz k2_st_73
k2_bk_74:
    v_mov_b32 v16, v8
    v_mfma_f32_16x16x32_bf16 v[184:187], a[104:107], v[60:63], v[184:187]
    s_cmp_ge_u32 s47, s26
    s_cbranch_scc1 k2_dsk_80
    buffer_load_dwordx4 v4, s[24:27], s47 offen offset:0 sc1 lds
    buffer_load_dwordx4 v4, s[24:27], s47 offen offset:1024 sc1 lds
    buffer_load_dwordx4 v4, s[24:27], s47 offen offset:2048 sc1 lds
    buffer_load_dwordx4 v4, s[24:27], s47 offen offset:3072 sc1 lds
    s_add_u32 m0, m0, 0x4000
    s_and_b32 m0, m0, 0x1ffff
    s_add_u32 s47, s47, 0x2000
    s_cmp_lt_u32 s45, s46
    s_cbranch_scc1 k2_dsk_80
    buffer_load_dwordx4 v4, s[24:27], s47 offen offset:0 sc1 lds
    buffer_load_dwordx4 v4, s[24:27], s47 offen offset:1024 sc1 lds
    buffer_load_dwordx4 v4, s[24:27], s47 offen offset:2048 sc1 lds
    buffer_load_dwordx4 v4, s[24:27], s47 offen offset:3072 sc1 lds
    s_add_u32 m0, m0, 0x4000
    s_and_b32 m0, m0, 0x1ffff
    s_add_u32 s47, s47, 0x2000
k2_dsk_80:
    v_mfma_f32_16x16x32_bf16 v[188:191], a[108:111], v[60:63], v[188:191]
    v_exp_f32 v48, v16
    v_mfma_f32_16x16x32_bf16 a[148:151], a[160:163], v[60:63], a[148:151]
    v_mov_b32 v17, v8
    v_mov_b32 v18, v8
    v_mfma_f32_16x16x32_bf16 v[24:27], a[16:19], a[64:67], v[76:79]
    v_exp_f32 v49, v17
    v_mfma_f32_16x16x32_bf16 v[24:27], a[20:23], a[68:71], v[24:27]
    v_exp_f32 v50, v18
    v_mfma_f32_16x16x32_bf16 v[24:27], a[24:27], a[72:75], v[24:27]
    v_mov_b32 v19, v8
    v_mov_b32 v20, v8
    v_mfma_f32_16x16x32_bf16 v[24:27], a[28:31], a[76:79], v[24:27]
    v_exp_f32 v51, v19
    v_mfma_f32_16x16x32_bf16 v[28:31], a[32:35], a[64:67], v[76:79]
    v_exp_f32 v52, v20
    v_mfma_f32_16x16x32_bf16 v[28:31], a[36:39], a[68:71], v[28:31]
    v_mov_b32 v21, v8
    v_mov_b32 v22, v8
    v_mfma_f32_16x16x32_bf16 v[28:31], a[40:43], a[72:75], v[28:31]
    v_exp_f32 v53, v21
    v_mfma_f32_16x16x32_bf16 v[28:31], a[44:47], a[76:79], v[28:31]
    v_exp_f32 v54, v22
    v_mfma_f32_16x16x32_bf16 v[192:195], a[80:83], v[64:67], v[192:195]
    v_mov_b32 v23, v8
    v_cvt_pk_bf16_f32 v56, v48, v49
    v_mfma_f32_16x16x32_bf16 v[196:199], a[84:87], v[64:67], v[196:199]
    v_exp_f32 v55, v23
    v_mfma_f32_16x16x32_bf16 v[200:203], a[88:91], v[64:67], v[200:203]
    v_cvt_pk_bf16_f32 v57, v50, v51
    v_cvt_pk_bf16_f32 v58, v52, v53
    v_mfma_f32_16x16x32_bf16 v[204:207], a[92:95], v[64:67], v[204:207]
    v_mov_b32 v24, v8
    v_mov_b32 v25, v8
    v_mfma_f32_16x16x32_bf16 v[208:211], a[96:99], v[64:67], v[208:211]
    v_exp_f32 v120, v24
    v_mfma_f32_16x16x32_bf16 v[212:215], a[100:103], v[64:67], v[212:215]
    v_exp_f32 v121, v25
    v_mfma_f32_16x16x32_bf16 v[216:219], a[104:107], v[64:67], v[216:219]
    v_mov_b32 v26, v8
    v_mov_b32 v27, v8
    v_mfma_f32_16x16x32_bf16 v[220:223], a[108:111], v[64:67], v[220:223]
    v_exp_f32 v122, v26
    v_mfma_f32_16x16x32_bf16 a[152:155], a[160:163], v[64:67], a[152:155]
    ds_read_b32 v11, v9
    v_mov_b32 v28, v8
    v_mfma_f32_16x16x32_bf16 v[32:35], a[16:19], a[128:131], v[80:83]
    v_exp_f32 v123, v27
    v_mfma_f32_16x16x32_bf16 v[32:35], a[20:23], a[132:135], v[32:35]
    v_exp_f32 v124, v28
    v_mfma_f32_16x16x32_bf16 v[32:35], a[24:27], a[136:139], v[32:35]
    s_waitcnt lgkmcnt(0)
    v_cmp_gt_u32 vcc, s45, v11
    v_mfma_f32_16x16x32_bf16 v[32:35], a[28:31], a[140:143], v[32:35]
    s_cbranch_vccnz k2_st_75
k2_bk_76:
    v_mov_b32 v29, v8
    v_mfma_f32_16x16x32_bf16 v[36:39], a[32:35], a[128:131], v[80:83]
    v_exp_f32 v125, v29
    v_mfma_f32_16x16x32_bf16 v[36:39], a[36:39], a[132:135], v[36:39]
    v_mov_b32 v30, v8
    v_mov_b32 v31, v8
    v_mfma_f32_16x16x32_bf16 v[36:39], a[40:43], a[136:139], v[36:39]
    v_exp_f32 v126, v30
    v_mfma_f32_16x16x32_bf16 v[36:39], a[44:47], a[140:143], v[36:39]
    v_exp_f32 v127, v31
    v_mfma_f32_16x16x32_bf16 v[224:227], a[80:83], v[68:71], v[224:227]
    ds_read_b128 a[80:83], v3 offset:8192
    v_cvt_pk_bf16_f32 v59, v54, v55
    v_mfma_f32_16x16x32_bf16 v[228:231], a[84:87], v[68:71], v[228:231]
    ds_read_b128 a[84:87], v3 offset:9216
    v_or3_b32 v12, v56, v57, v58
    v_mfma_f32_16x16x32_bf16 v[232:235], a[88:91], v[68:71], v[232:235]
    ds_read_b128 a[88:91], v3 offset:10240
    v_or_b32 v12, v12, v59
    v_mfma_f32_16x16x32_bf16 v[236:239], a[92:95], v[68:71], v[236:239]
    ds_read_b128 a[92:95], v3 offset:11264
    v_cvt_pk_bf16_f32 v60, v120, v121
    v_mfma_f32_16x16x32_bf16 v[240:243], a[96:99], v[68:71], v[240:243]
    ds_read_b128 a[96:99], v3 offset:12288
    v_cvt_pk_bf16_f32 v61, v122, v123
    v_mfma_f32_16x16x32_bf16 v[244:247], a[100:103], v[68:71], v[244:247]
    ds_read_b128 a[100:103], v3 offset:13312
    v_cvt_pk_bf16_f32 v62, v124, v125
    v_mfma_f32_16x16x32_bf16 v[248:251], a[104:107], v[68:71], v[248:251]
    ds_read_b128 a[104:107], v3 offset:14336
    v_cvt_pk_bf16_f32 v63, v126, v127
    v_mfma_f32_16x16x32_bf16 v[252:255], a[108:111], v[68:71], v[252:255]
    v_or3_b32 v12, v12, v60, v61
    v_or3_b32 v12, v12, v62, v63
    v_mfma_f32_16x16x32_bf16 a[156:159], a[160:163], v[68:71], a[156:159]
    v_and_b32 v12, 0x40004000, v12
    v_cmp_ne_u32 vcc, 0, v12
    v_mfma_f32_16x16x32_bf16 v[40:43], a[16:19], a[192:195], v[84:87]
    ds_read_b128 a[108:111], v3 offset:15360
    s_cbranch_vccnz k2_st_77
k2_bk_78:
    v_mfma_f32_16x16x32_bf16 v[40:43], a[20:23], a[196:199], v[40:43]
    ds_read_b128 a[16:19], v2 offset:0
    s_add_i32 s66, s45, 8
    v_mfma_f32_16x16x32_bf16 v[40:43], a[24:27], a[200:203], v[40:43]
    ds_read_b128 a[20:23], v2 offset:1024
    v_cndmask_b32 v32, v32, v8, s[56:57]
    v_mfma_f32_16x16x32_bf16 v[40:43], a[28:31], a[204:207], v[40:43]
    ds_read_b128 a[24:27], v2 offset:2048
    v_cndmask_b32 v33, v33, v8, s[58:59]
    v_mfma_f32_16x16x32_bf16 v[44:47], a[32:35], a[192:195], v[84:87]
    s_cmp_ge_i32 s66, s72
    s_cselect_b32 s51, 0x8000, s7
    v_mfma_f32_16x16x32_bf16 v[44:47], a[36:39], a[196:199], v[44:47]
    s_cmp_gt_i32 s66, s72
    s_cselect_b32 s52, 0x8000, s7
    v_mfma_f32_16x16x32_bf16 v[44:47], a[40:43], a[200:203], v[44:47]
    ds_read_b128 a[28:31], v2 offset:3072
    v_cndmask_b32 v34, v34, v8, s[60:61]
    v_mfma_f32_16x16x32_bf16 v[44:47], a[44:47], a[204:207], v[44:47]
    s_waitcnt lgkmcnt(8)
    ds_read_b128 a[32:35], v2 offset:4096
    v_mfma_f32_16x16x32_bf16 v[128:131], a[80:83], v[56:59], v[128:131]
    v_exp_f32 v48, v32
    v_mfma_f32_16x16x32_bf16 v[132:135], a[84:87], v[56:59], v[132:135]
    v_exp_f32 v49, v33
    v_mfma_f32_16x16x32_bf16 v[136:139], a[88:91], v[56:59], v[136:139]
    v_exp_f32 v50, v34
    v_mfma_f32_16x16x32_bf16 v[140:143], a[92:95], v[56:59], v[140:143]
    s_waitcnt lgkmcnt(5)
    ds_read_b128 a[36:39], v2 offset:5120
    v_mfma_f32_16x16x32_bf16 v[144:147], a[96:99], v[56:59], v[144:147]
    ds_read_b128 a[40:43], v2 offset:6144
    v_cndmask_b32 v35, v35, v8, s[62:63]
    v_mfma_f32_16x16x32_bf16 v[148:151], a[100:103], v[56:59], v[148:151]
    v_exp_f32 v51, v35
    v_mfma_f32_16x16x32_bf16 v[152:155], a[104:107], v[56:59], v[152:155]
    ds_read_b128 a[44:47], v2 offset:7168
    v_mov_b32 v36, v8
    v_mfma_f32_16x16x32_bf16 v[156:159], a[108:111], v[56:59], v[156:159]
    v_exp_f32 v52, v36
    v_mov_b32 v37, v8
    v_exp_f32 v53, v37
    v_mov_b32 v38, v8
    v_exp_f32 v54, v38
    v_mov_b32 v39, v8
    v_exp_f32 v55, v39
    v_mfma_f32_16x16x32_bf16 a[144:147], a[160:163], v[56:59], a[144:147]
    v_cvt_pk_bf16_f32 v64, v48, v49
    v_cvt_pk_bf16_f32 v65, v50, v51
    v_cvt_pk_bf16_f32 v66, v52, v53
    v_cvt_pk_bf16_f32 v67, v54, v55
    v_or3_b32 v13, v64, v65, v66
    v_or_b32 v13, v13, v67
    v_add_u32 v2, s51, v2
    v_and_b32 v2, 0x1ffff, v2
    v_add_u32 v3, s52, v3
    v_and_b32 v3, 0x1ffff, v3
    s_add_u32 s45, s45, 4
k2_drnB:
    v_exp_f32 v120, v40
    v_mfma_f32_16x16x32_bf16 v[160:163], a[80:83], v[60:63], v[160:163]
    s_waitcnt vmcnt(8) lgkmcnt(0)
    s_cmp_lt_u32 s47, s26
    s_cbranch_scc1 k2_ag_85
    s_waitcnt vmcnt(0)
k2_ag_85:
    v_cndmask_b32 v44, v44, v8, s[56:57]
    v_mfma_f32_16x16x32_bf16 v[164:167], a[84:87], v[60:63], v[164:167]
    v_exp_f32 v121, v41
    v_mfma_f32_16x16x32_bf16 v[168:171], a[88:91], v[60:63], v[168:171]
    v_exp_f32 v122, v42
    v_mfma_f32_16x16x32_bf16 v[172:175], a[92:95], v[60:63], v[172:175]
    v_exp_f32 v123, v43
    v_mfma_f32_16x16x32_bf16 v[176:179], a[96:99], v[60:63], v[176:179]
    v_exp_f32 v124, v44
    v_mfma_f32_16x16x32_bf16 v[180:183], a[100:103], v[60:63], v[180:183]
    v_cndmask_b32 v45, v45, v8, s[58:59]
    v_cndmask_b32 v46, v46, v8, s[60:61]
    v_mfma_f32_16x16x32_bf16 v[184:187], a[104:107], v[60:63], v[184:187]
    v_exp_f32 v125, v45
    v_exp_f32 v126, v46
    v_cndmask_b32 v47, v47, v8, s[62:63]
    v_exp_f32 v127, v47
    v_mfma_f32_16x16x32_bf16 v[188:191], a[108:111], v[60:63], v[188:191]
    v_cvt_pk_bf16_f32 v68, v120, v121
    v_cvt_pk_bf16_f32 v69, v122, v123
    v_cvt_pk_bf16_f32 v70, v124, v125
    v_cvt_pk_bf16_f32 v71, v126, v127
    v_or3_b32 v13, v13, v68, v69
    v_or3_b32 v13, v13, v70, v71
    v_and_b32 v13, 0x40004000, v13
    v_cmp_ne_u32 vcc, 0, v13
    v_mfma_f32_16x16x32_bf16 a[148:151], a[160:163], v[60:63], a[148:151]
    s_cbranch_vccnz k2_st_81
k2_bk_82:
    ds_add_u32 v9, v10
    v_mfma_f32_16x16x32_bf16 v[192:195], a[80:83], v[64:67], v[192:195]
    s_cmp_ge_u32 s47, s26
    s_cbranch_scc1 k2_dsk_86
    buffer_load_dwordx4 v4, s[24:27], s47 offen offset:0 sc1 lds
    buffer_load_dwordx4 v4, s[24:27], s47 offen offset:1024 sc1 lds
    buffer_load_dwordx4 v4, s[24:27], s47 offen offset:2048 sc1 lds
    buffer_load_dwordx4 v4, s[24:27], s47 offen offset:3072 sc1 lds
    s_add_u32 m0, m0, 0x4000
    s_and_b32 m0, m0, 0x1ffff
    s_add_u32 s47, s47, 0x2000
    s_cmp_lt_u32 s45, s46
    s_cbranch_scc1 k2_dsk_86
    buffer_load_dwordx4 v4, s[24:27], s47 offen offset:0 sc1 lds
    buffer_load_dwordx4 v4, s[24:27], s47 offen offset:1024 sc1 lds
    buffer_load_dwordx4 v4, s[24:27], s47 offen offset:2048 sc1 lds
    buffer_load_dwordx4 v4, s[24:27], s47 offen offset:3072 sc1 lds
    s_add_u32 m0, m0, 0x4000
    s_and_b32 m0, m0, 0x1ffff
    s_add_u32 s47, s47, 0x2000
k2_dsk_86:
    v_mfma_f32_16x16x32_bf16 v[196:199], a[84:87], v[64:67], v[196:199]
    buffer_load_dword v14, v117, s[8:11], 0 offen sc1
    global_load_dwordx4 a[208:211], v116, s[4:5]
    v_mfma_f32_16x16x32_bf16 v[200:203], a[88:91], v[64:67], v[200:203]
    buffer_load_dwordx4 a[208:211], v115, s[12:15], 0 offen offset:0
    v_mfma_f32_16x16x32_bf16 v[204:207], a[92:95], v[64:67], v[204:207]
    buffer_load_dwordx4 a[208:211], v115, s[12:15], 0 offen offset:1024
    v_mfma_f32_16x16x32_bf16 v[208:211], a[96:99], v[64:67], v[208:211]
    buffer_load_dwordx4 a[208:211], v115, s[12:15], 0 offen offset:2048
    v_mfma_f32_16x16x32_bf16 v[212:215], a[100:103], v[64:67], v[212:215]
    buffer_load_dwordx4 a[208:211], v114, s[28:31], 0 offen offset:0
    v_mfma_f32_16x16x32_bf16 v[216:219], a[104:107], v[64:67], v[216:219]
    buffer_load_dwordx4 a[208:211], v114, s[28:31], 0 offen offset:1024
    v_mfma_f32_16x16x32_bf16 v[220:223], a[108:111], v[64:67], v[220:223]
    ds_read_b32 v11, v9
    buffer_load_dwordx4 a[208:211], v114, s[28:31], 0 offen offset:2048
    v_mfma_f32_16x16x32_bf16 a[152:155], a[160:163], v[64:67], a[152:155]
    buffer_load_dwordx4 a[208:211], v114, s[28:31], 0 offen offset:3072
    v_mfma_f32_16x16x32_bf16 v[224:227], a[80:83], v[68:71], v[224:227]
    buffer_load_dwordx4 a[208:211], v113, s[28:31], 0 offen offset:0
    v_mfma_f32_16x16x32_bf16 v[228:231], a[84:87], v[68:71], v[228:231]
    buffer_load_dwordx4 a[208:211], v113, s[28:31], 0 offen offset:1024
    v_mfma_f32_16x16x32_bf16 v[232:235], a[88:91], v[68:71], v[232:235]
    s_waitcnt lgkmcnt(0)
    v_cmp_gt_u32 vcc, s45, v11
    v_mfma_f32_16x16x32_bf16 v[236:239], a[92:95], v[68:71], v[236:239]
    s_cbranch_vccnz k2_st_83
k2_bk_84:
    s_add_u32 s45, s45, 4
    v_mfma_f32_16x16x32_bf16 v[240:243], a[96:99], v[68:71], v[240:243]
    buffer_load_dwordx4 a[208:211], v113, s[28:31], 0 offen offset:2048
    buffer_load_dwordx4 a[208:211], v113, s[28:31], 0 offen offset:3072
    v_mfma_f32_16x16x32_bf16 v[244:247], a[100:103], v[68:71], v[244:247]
    v_mfma_f32_16x16x32_bf16 v[248:251], a[104:107], v[68:71], v[248:251]
    v_mfma_f32_16x16x32_bf16 v[252:255], a[108:111], v[68:71], v[252:255]
    v_mfma_f32_16x16x32_bf16 a[156:159], a[160:163], v[68:71], a[156:159]
    s_cmp_eq_u32 s44, 0
    s_cbranch_scc1 k2_tail
    s_cmp_eq_u32 s74, 1
    s_cbranch_scc1 k2_tail
    s_waitcnt vmcnt(8) lgkmcnt(0)
    s_cmp_lt_u32 s47, s26
    s_cbranch_scc1 k2_ag_87
    s_waitcnt vmcnt(0)
k2_ag_87:
    ds_add_u32 v9, v10
    s_cmp_ge_u32 s47, s26
    s_cbranch_scc1 k2_dsk_88
    buffer_load_dwordx4 v4, s[24:27], s47 offen offset:0 sc1 lds
    buffer_load_dwordx4 v4, s[24:27], s47 offen offset:1024 sc1 lds
    buffer_load_dwordx4 v4, s[24:27], s47 offen offset:2048 sc1 lds
    buffer_load_dwordx4 v4, s[24:27], s47 offen offset:3072 sc1 lds
    s_add_u32 m0, m0, 0x4000
    s_and_b32 m0, m0, 0x1ffff
    s_add_u32 s47, s47, 0x2000
    s_cmp_lt_u32 s45, s46
    s_cbranch_scc1 k2_dsk_88
    buffer_load_dwordx4 v4, s[24:27], s47 offen offset:0 sc1 lds
    buffer_load_dwordx4 v4, s[24:27], s47 offen offset:1024 sc1 lds
    buffer_load_dwordx4 v4, s[24:27], s47 offen offset:2048 sc1 lds
    buffer_load_dwordx4 v4, s[24:27], s47 offen offset:3072 sc1 lds
    s_add_u32 m0, m0, 0x4000
    s_and_b32 m0, m0, 0x1ffff
    s_add_u32 s47, s47, 0x2000
k2_dsk_88:
    ds_read_b128 a[0:3], v6 offset:0
    ds_read_b128 a[4:7], v6 offset:1024
    ds_read_b128 a[8:11], v6 offset:2048
    ds_read_b128 a[12:15], v6 offset:3072
    ds_read_b128 a[64:67], v6 offset:4096
    ds_read_b128 a[68:71], v6 offset:5120
    ds_read_b128 a[72:75], v6 offset:6144
    ds_read_b128 a[76:79], v6 offset:7168
    ds_read_b128 a[128:131], v6 offset:8192
    ds_read_b128 a[132:135], v6 offset:9216
    ds_read_b128 a[136:139], v6 offset:10240
    ds_read_b128 a[140:143], v6 offset:11264
    ds_read_b128 a[192:195], v6 offset:12288
    ds_read_b128 a[196:199], v6 offset:13312
    ds_read_b128 a[200:203], v6 offset:14336
    v_accvgpr_read_b32 v88, a144
    s_add_u32 s67, s64, 0
    v_rcp_f32 v88, v88
    s_nop 0
    v_mul_f32 v128, v128, v88
    v_mul_f32 v129, v129, v88
    v_mul_f32 v130, v130, v88
    v_mul_f32 v131, v131, v88
    v_cvt_pk_bf16_f32 v92, v128, v129
    v_cvt_pk_bf16_f32 v93, v130, v131
    v_mul_f32 v132, v132, v88
    v_mul_f32 v133, v133, v88
    v_mul_f32 v134, v134, v88
    v_mul_f32 v135, v135, v88
    v_cvt_pk_bf16_f32 v94, v132, v133
    v_cvt_pk_bf16_f32 v95, v134, v135
    buffer_store_dwordx4 v[92:95], v7, s[8:11], s67 offen offset:0 sc1
    v_mul_f32 v136, v136, v88
    v_mul_f32 v137, v137, v88
    v_mul_f32 v138, v138, v88
    v_mul_f32 v139, v139, v88
    v_cvt_pk_bf16_f32 v96, v136, v137
    v_cvt_pk_bf16_f32 v97, v138, v139
    v_mul_f32 v140, v140, v88
    v_mul_f32 v141, v141, v88
    v_mul_f32 v142, v142, v88
    v_mul_f32 v143, v143, v88
    v_cvt_pk_bf16_f32 v98, v140, v141
    v_cvt_pk_bf16_f32 v99, v142, v143
    buffer_store_dwordx4 v[96:99], v7, s[8:11], s67 offen offset:1024 sc1
    v_mul_f32 v144, v144, v88
    v_mul_f32 v145, v145, v88
    v_mul_f32 v146, v146, v88
    v_mul_f32 v147, v147, v88
    v_cvt_pk_bf16_f32 v92, v144, v145
    v_cvt_pk_bf16_f32 v93, v146, v147
    v_mul_f32 v148, v148, v88
    v_mul_f32 v149, v149, v88
    v_mul_f32 v150, v150, v88
    v_mul_f32 v151, v151, v88
    v_cvt_pk_bf16_f32 v94, v148, v149
    v_cvt_pk_bf16_f32 v95, v150, v151
    buffer_store_dwordx4 v[92:95], v7, s[8:11], s67 offen offset:2048 sc1
    v_mul_f32 v152, v152, v88
    v_mul_f32 v153, v153, v88
    v_mul_f32 v154, v154, v88
    v_mul_f32 v155, v155, v88
    v_cvt_pk_bf16_f32 v96, v152, v153
    v_cvt_pk_bf16_f32 v97, v154, v155
    v_mul_f32 v156, v156, v88
    v_mul_f32 v157, v157, v88
    v_mul_f32 v158, v158, v88
    v_mul_f32 v159, v159, v88
    v_cvt_pk_bf16_f32 v98, v156, v157
    v_cvt_pk_bf16_f32 v99, v158, v159
    buffer_store_dwordx4 v[96:99], v7, s[8:11], s67 offen offset:3072 sc1
    v_accvgpr_read_b32 v88, a148
    s_add_u32 s67, s64, 175104
    v_rcp_f32 v88, v88
    s_nop 0
    v_mul_f32 v160, v160, v88
    v_mul_f32 v161, v161, v88
    v_mul_f32 v162, v162, v88
    v_mul_f32 v163, v163, v88
    v_cvt_pk_bf16_f32 v100, v160, v161
    v_cvt_pk_bf16_f32 v101, v162, v163
    v_mul_f32 v164, v164, v88
    v_mul_f32 v165, v165, v88
    v_mul_f32 v166, v166, v88
    v_mul_f32 v167, v167, v88
    v_cvt_pk_bf16_f32 v102, v164, v165
    v_cvt_pk_bf16_f32 v103, v166, v167
    buffer_store_dwordx4 v[100:103], v7, s[8:11], s67 offen offset:0 sc1
    v_mul_f32 v168, v168, v88
    v_mul_f32 v169, v169, v88
    v_mul_f32 v170, v170, v88
    v_mul_f32 v171, v171, v88
    v_cvt_pk_bf16_f32 v104, v168, v169
    v_cvt_pk_bf16_f32 v105, v170, v171
    v_mul_f32 v172, v172, v88
    v_mul_f32 v173, v173, v88
    v_mul_f32 v174, v174, v88
    v_mul_f32 v175, v175, v88
    v_cvt_pk_bf16_f32 v106, v172, v173
    v_cvt_pk_bf16_f32 v107, v174, v175
    buffer_store_dwordx4 v[104:107], v7, s[8:11], s67 offen offset:1024 sc1
    v_mul_f32 v176, v176, v88
    v_mul_f32 v177, v177, v88
    v_mul_f32 v178, v178, v88
    v_mul_f32 v179, v179, v88
    v_cvt_pk_bf16_f32 v100, v176, v177
    v_cvt_pk_bf16_f32 v101, v178, v179
    v_mul_f32 v180, v180, v88
    v_mul_f32 v181, v181, v88
    v_mul_f32 v182, v182, v88
    v_mul_f32 v183, v183, v88
    v_cvt_pk_bf16_f32 v102, v180, v181
    v_cvt_pk_bf16_f32 v103, v182, v183
    buffer_store_dwordx4 v[100:103], v7, s[8:11], s67 offen offset:2048 sc1
    v_mul_f32 v184, v184, v88
    v_mul_f32 v185, v185, v88
    v_mul_f32 v186, v186, v88
    v_mul_f32 v187, v187, v88
    v_cvt_pk_bf16_f32 v104, v184, v185
    v_cvt_pk_bf16_f32 v105, v186, v187
    v_mul_f32 v188, v188, v88
    v_mul_f32 v189, v189, v88
    v_mul_f32 v190, v190, v88
    v_mul_f32 v191, v191, v88
    v_cvt_pk_bf16_f32 v106, v188, v189
    v_cvt_pk_bf16_f32 v107, v190, v191
    buffer_store_dwordx4 v[104:107], v7, s[8:11], s67 offen offset:3072 sc1
    v_accvgpr_read_b32 v88, a152
    s_add_u32 s67, s64, 350208
    v_rcp_f32 v88, v88
    s_nop 0
    v_mul_f32 v192, v192, v88
    v_mul_f32 v193, v193, v88
    v_mul_f32 v194, v194, v88
    v_mul_f32 v195, v195, v88
    v_cvt_pk_bf16_f32 v92, v192, v193
    v_cvt_pk_bf16_f32 v93, v194, v195
    v_mul_f32 v196, v196, v88
    v_mul_f32 v197, v197, v88
    v_mul_f32 v198, v198, v88
    v_mul_f32 v199, v199, v88
    v_cvt_pk_bf16_f32 v94, v196, v197
    v_cvt_pk_bf16_f32 v95, v198, v199
    buffer_store_dwordx4 v[92:95], v7, s[8:11], s67 offen offset:0 sc1
    v_mul_f32 v200, v200, v88
    v_mul_f32 v201, v201, v88
    v_mul_f32 v202, v202, v88
    v_mul_f32 v203, v203, v88
    v_cvt_pk_bf16_f32 v96, v200, v201
    v_cvt_pk_bf16_f32 v97, v202, v203
    v_mul_f32 v204, v204, v88
    v_mul_f32 v205, v205, v88
    v_mul_f32 v206, v206, v88
    v_mul_f32 v207, v207, v88
    v_cvt_pk_bf16_f32 v98, v204, v205
    v_cvt_pk_bf16_f32 v99, v206, v207
    buffer_store_dwordx4 v[96:99], v7, s[8:11], s67 offen offset:1024 sc1
    v_mul_f32 v208, v208, v88
    v_mul_f32 v209, v209, v88
    v_mul_f32 v210, v210, v88
    v_mul_f32 v211, v211, v88
    v_cvt_pk_bf16_f32 v92, v208, v209
    v_cvt_pk_bf16_f32 v93, v210, v211
    v_mul_f32 v212, v212, v88
    v_mul_f32 v213, v213, v88
    v_mul_f32 v214, v214, v88
    v_mul_f32 v215, v215, v88
    v_cvt_pk_bf16_f32 v94, v212, v213
    v_cvt_pk_bf16_f32 v95, v214, v215
    buffer_store_dwordx4 v[92:95], v7, s[8:11], s67 offen offset:2048 sc1
    v_mul_f32 v216, v216, v88
    v_mul_f32 v217, v217, v88
    v_mul_f32 v218, v218, v88
    v_mul_f32 v219, v219, v88
    v_cvt_pk_bf16_f32 v96, v216, v217
    v_cvt_pk_bf16_f32 v97, v218, v219
    v_mul_f32 v220, v220, v88
    v_mul_f32 v221, v221, v88
    v_mul_f32 v222, v222, v88
    v_mul_f32 v223, v223, v88
    v_cvt_pk_bf16_f32 v98, v220, v221
    v_cvt_pk_bf16_f32 v99, v222, v223
    buffer_store_dwordx4 v[96:99], v7, s[8:11], s67 offen offset:3072 sc1
    v_accvgpr_read_b32 v88, a156
    s_add_u32 s67, s64, 525312
    v_rcp_f32 v88, v88
    s_nop 0
    v_mul_f32 v224, v224, v88
    v_mul_f32 v225, v225, v88
    v_mul_f32 v226, v226, v88
    v_mul_f32 v227, v227, v88
    v_cvt_pk_bf16_f32 v100, v224, v225
    v_cvt_pk_bf16_f32 v101, v226, v227
    v_mul_f32 v228, v228, v88
    v_mul_f32 v229, v229, v88
    v_mul_f32 v230, v230, v88
    v_mul_f32 v231, v231, v88
    v_cvt_pk_bf16_f32 v102, v228, v229
    v_cvt_pk_bf16_f32 v103, v230, v231
    buffer_store_dwordx4 v[100:103], v7, s[8:11], s67 offen offset:0 sc1
    v_mul_f32 v232, v232, v88
    v_mul_f32 v233, v233, v88
    v_mul_f32 v234, v234, v88
    v_mul_f32 v235, v235, v88
    v_cvt_pk_bf16_f32 v104, v232, v233
    v_cvt_pk_bf16_f32 v105, v234, v235
    v_mul_f32 v236, v236, v88
    v_mul_f32 v237, v237, v88
    v_mul_f32 v238, v238, v88
    v_mul_f32 v239, v239, v88
    v_cvt_pk_bf16_f32 v106, v236, v237
    v_cvt_pk_bf16_f32 v107, v238, v239
    buffer_store_dwordx4 v[104:107], v7, s[8:11], s67 offen offset:1024 sc1
    v_mul_f32 v240, v240, v88
    v_mul_f32 v241, v241, v88
    v_mul_f32 v242, v242, v88
    v_mul_f32 v243, v243, v88
    v_cvt_pk_bf16_f32 v100, v240, v241
    v_cvt_pk_bf16_f32 v101, v242, v243
    v_mul_f32 v244, v244, v88
    v_mul_f32 v245, v245, v88
    v_mul_f32 v246, v246, v88
    v_mul_f32 v247, v247, v88
    v_cvt_pk_bf16_f32 v102, v244, v245
    v_cvt_pk_bf16_f32 v103, v246, v247
    buffer_store_dwordx4 v[100:103], v7, s[8:11], s67 offen offset:2048 sc1
    v_mul_f32 v248, v248, v88
    v_mul_f32 v249, v249, v88
    v_mul_f32 v250, v250, v88
    v_mul_f32 v251, v251, v88
    v_cvt_pk_bf16_f32 v104, v248, v249
    v_cvt_pk_bf16_f32 v105, v250, v251
    v_mul_f32 v252, v252, v88
    v_mul_f32 v253, v253, v88
    v_mul_f32 v254, v254, v88
    v_mul_f32 v255, v255, v88
    v_cvt_pk_bf16_f32 v106, v252, v253
    v_cvt_pk_bf16_f32 v107, v254, v255
    buffer_store_dwordx4 v[104:107], v7, s[8:11], s67 offen offset:3072 sc1
    v_accvgpr_mov_b32 a204, a48
    v_accvgpr_mov_b32 a205, a49
    v_accvgpr_mov_b32 a206, a50
    v_accvgpr_mov_b32 a207, a51
    v_mov_b32 v72, 0x7149f2ca
    v_mov_b32 v73, 0x7149f2ca
    v_mov_b32 v74, 0x7149f2ca
    v_mov_b32 v75, 0x7149f2ca
    v_mov_b32 v76, 0x7149f2ca
    v_mov_b32 v77, 0x7149f2ca
    v_mov_b32 v78, 0x7149f2ca
    v_mov_b32 v79, 0x7149f2ca
    v_mov_b32 v80, 0x7149f2ca
    v_mov_b32 v81, 0x7149f2ca
    v_mov_b32 v82, 0x7149f2ca
    v_mov_b32 v83, 0x7149f2ca
    v_mov_b32 v84, 0x7149f2ca
    v_mov_b32 v85, 0x7149f2ca
    v_mov_b32 v86, 0x7149f2ca
    v_mov_b32 v87, 0x7149f2ca
    ds_read_b32 v11, v9
    s_waitcnt lgkmcnt(0)
    v_cmp_gt_u32 vcc, s45, v11
    s_cbranch_vccnz k2_st_89
k2_bk_90:
    s_add_u32 s45, s45, 4
    s_mov_b32 s74, 1
    s_mov_b32 s64, s75
k2_hidle:
    s_add_u32 s65, s45, 4
    s_cmp_ge_u32 s65, s46
    s_cbranch_scc1 k2_hset
    s_waitcnt vmcnt(8) lgkmcnt(0)
    s_cmp_lt_u32 s47, s26
    s_cbranch_scc1 k2_ag_91
    s_waitcnt vmcnt(0)
k2_ag_91:
    ds_add_u32 v9, v10
    s_cmp_ge_u32 s47, s26
    s_cbranch_scc1 k2_dsk_92
    buffer_load_dwordx4 v4, s[24:27], s47 offen offset:0 sc1 lds
    buffer_load_dwordx4 v4, s[24:27], s47 offen offset:1024 sc1 lds
    buffer_load_dwordx4 v4, s[24:27], s47 offen offset:2048 sc1 lds
    buffer_load_dwordx4 v4, s[24:27], s47 offen offset:3072 sc1 lds
    s_add_u32 m0, m0, 0x4000
    s_and_b32 m0, m0, 0x1ffff
    s_add_u32 s47, s47, 0x2000
    s_cmp_lt_u32 s45, s46
    s_cbranch_scc1 k2_dsk_92
    buffer_load_dwordx4 v4, s[24:27], s47 offen offset:0 sc1 lds
    buffer_load_dwordx4 v4, s[24:27], s47 offen offset:1024 sc1 lds
    buffer_load_dwordx4 v4, s[24:27], s47 offen offset:2048 sc1 lds
    buffer_load_dwordx4 v4, s[24:27], s47 offen offset:3072 sc1 lds
    s_add_u32 m0, m0, 0x4000
    s_and_b32 m0, m0, 0x1ffff
    s_add_u32 s47, s47, 0x2000
k2_dsk_92:
    ds_read_b32 v11, v9
    s_waitcnt lgkmcnt(0)
    v_cmp_gt_u32 vcc, s45, v11
    s_cbranch_vccnz k2_st_93
k2_bk_94:
    s_add_u32 s45, s45, 4
    s_branch k2_hidle
k2_hset:
    s_lshl_b32 s65, s42, 1
    s_add_u32 s65, s65, s43
    s_cmp_eq_u32 s65, 14
    s_cbranch_scc0 k2_hgo
    v_mfma_f32_16x16x32_bf16 v[128:131], a[164:167], a[164:167], 0
    v_mfma_f32_16x16x32_bf16 v[132:135], a[164:167], a[164:167], 0
    v_mfma_f32_16x16x32_bf16 v[136:139], a[164:167], a[164:167], 0
    v_mfma_f32_16x16x32_bf16 v[140:143], a[164:167], a[164:167], 0
    v_mfma_f32_16x16x32_bf16 v[144:147], a[164:167], a[164:167], 0
    v_mfma_f32_16x16x32_bf16 v[148:151], a[164:167], a[164:167], 0
    v_mfma_f32_16x16x32_bf16 v[152:155], a[164:167], a[164:167], 0
    v_mfma_f32_16x16x32_bf16 v[156:159], a[164:167], a[164:167], 0
    v_mfma_f32_16x16x32_bf16 a[144:147], a[164:167], a[164:167], 0
    v_mfma_f32_16x16x32_bf16 v[160:163], a[164:167], a[164:167], 0
    v_mfma_f32_16x16x32_bf16 v[164:167], a[164:167], a[164:167], 0
    v_mfma_f32_16x16x32_bf16 v[168:171], a[164:167], a[164:167], 0
    v_mfma_f32_16x16x32_bf16 v[172:175], a[164:167], a[164:167], 0
    v_mfma_f32_16x16x32_bf16 v[176:179], a[164:167], a[164:167], 0
    v_mfma_f32_16x16x32_bf16 v[180:183], a[164:167], a[164:167], 0
    v_mfma_f32_16x16x32_bf16 v[184:187], a[164:167], a[164:167], 0
    v_mfma_f32_16x16x32_bf16 v[188:191], a[164:167], a[164:167], 0
    v_mfma_f32_16x16x32_bf16 a[148:151], a[164:167], a[164:167], 0
    v_mfma_f32_16x16x32_bf16 v[192:195], a[164:167], a[164:167], 0
    v_mfma_f32_16x16x32_bf16 v[196:199], a[164:167], a[164:167], 0
    v_mfma_f32_16x16x32_bf16 v[200:203], a[164:167], a[164:167], 0
    v_mfma_f32_16x16x32_bf16 v[204:207], a[164:167], a[164:167], 0
    v_mfma_f32_16x16x32_bf16 v[208:211], a[164:167], a[164:167], 0
    v_mfma_f32_16x16x32_bf16 v[212:215], a[164:167], a[164:167], 0
    v_mfma_f32_16x16x32_bf16 v[216:219], a[164:167], a[164:167], 0
    v_mfma_f32_16x16x32_bf16 v[220:223], a[164:167], a[164:167], 0
    v_mfma_f32_16x16x32_bf16 a[152:155], a[164:167], a[164:167], 0
    v_mfma_f32_16x16x32_bf16 v[224:227], a[164:167], a[164:167], 0
    v_mfma_f32_16x16x32_bf16 v[228:231], a[164:167], a[164:167], 0
    v_mfma_f32_16x16x32_bf16 v[232:235], a[164:167], a[164:167], 0
    v_mfma_f32_16x16x32_bf16 v[236:239], a[164:167], a[164:167], 0
    v_mfma_f32_16x16x32_bf16 v[240:243], a[164:167], a[164:167], 0
    v_mfma_f32_16x16x32_bf16 v[244:247], a[164:167], a[164:167], 0
    v_mfma_f32_16x16x32_bf16 v[248:251], a[164:167], a[164:167], 0
    v_mfma_f32_16x16x32_bf16 v[252:255], a[164:167], a[164:167], 0
    v_mfma_f32_16x16x32_bf16 a[156:159], a[164:167], a[164:167], 0
    s_waitcnt vmcnt(0)
    buffer_load_dword v14, v117, s[8:11], 0 offen sc1
    global_load_dwordx4 a[208:211], v116, s[4:5]
    buffer_load_dwordx4 a[208:211], v115, s[12:15], 0 offen offset:0
    buffer_load_dwordx4 a[208:211], v115, s[12:15], 0 offen offset:1024
    buffer_load_dwordx4 a[208:211], v115, s[12:15], 0 offen offset:2048
    buffer_load_dwordx4 a[208:211], v114, s[28:31], 0 offen offset:0
    buffer_load_dwordx4 a[208:211], v114, s[28:31], 0 offen offset:1024
    buffer_load_dwordx4 a[208:211], v114, s[28:31], 0 offen offset:2048
    buffer_load_dwordx4 a[208:211], v114, s[28:31], 0 offen offset:3072
    buffer_load_dwordx4 a[208:211], v113, s[28:31], 0 offen offset:0
    buffer_load_dwordx4 a[208:211], v113, s[28:31], 0 offen offset:1024
    buffer_load_dwordx4 a[208:211], v113, s[28:31], 0 offen offset:2048
    buffer_load_dwordx4 a[208:211], v113, s[28:31], 0 offen offset:3072
    s_branch k2_tail
k2_hgo:
    s_lshl_b32 s65, s46, 12
    s_add_u32 s65, s65, 0x1c000
    s_and_b32 s65, s65, 0x1ffff
    v_add_u32 v2, s65, v7
    ds_read_b128 a[16:19], v2 offset:0
    ds_read_b128 a[20:23], v2 offset:1024
    ds_read_b128 a[24:27], v2 offset:2048
    ds_read_b128 a[28:31], v2 offset:3072
    ds_read_b128 a[32:35], v2 offset:4096
    ds_read_b128 a[36:39], v2 offset:5120
    ds_read_b128 a[40:43], v2 offset:6144
    ds_read_b128 a[44:47], v2 offset:7168
    v_add_u32 v2, 0x8000, v2
    v_and_b32 v2, 0x1ffff, v2
    v_mov_b32 v3, v2
    s_mov_b32 s72, -1000
    s_lshl_b32 s66, s43, 2
    s_add_u32 s73, s66, 136
    s_cmp_eq_u32 s42, 7
    s_cbranch_scc1 k2_proB
    s_waitcnt vmcnt(8) lgkmcnt(0)
    s_cmp_lt_u32 s47, s26
    s_cbranch_scc1 k2_ag_97
    s_waitcnt vmcnt(0)
k2_ag_97:
    ds_add_u32 v9, v10
    v_mfma_f32_16x16x32_bf16 v[16:19], a[16:19], a[0:3], 0
    s_cmp_ge_u32 s47, s26
    s_cbranch_scc1 k2_dsk_98
    buffer_load_dwordx4 v4, s[24:27], s47 offen offset:0 sc1 lds
    buffer_load_dwordx4 v4, s[24:27], s47 offen offset:1024 sc1 lds
    buffer_load_dwordx4 v4, s[24:27], s47 offen offset:2048 sc1 lds
    buffer_load_dwordx4 v4, s[24:27], s47 offen offset:3072 sc1 lds
    s_add_u32 m0, m0, 0x4000
    s_and_b32 m0, m0, 0x1ffff
    s_add_u32 s47, s47, 0x2000
    s_cmp_lt_u32 s45, s46
    s_cbranch_scc1 k2_dsk_98
    buffer_load_dwordx4 v4, s[24:27], s47 offen offset:0 sc1 lds
    buffer_load_dwordx4 v4, s[24:27], s47 offen offset:1024 sc1 lds
    buffer_load_dwordx4 v4, s[24:27], s47 offen offset:2048 sc1 lds
    buffer_load_dwordx4 v4, s[24:27], s47 offen offset:3072 sc1 lds
    s_add_u32 m0, m0, 0x4000
    s_and_b32 m0, m0, 0x1ffff
    s_add_u32 s47, s47, 0x2000
k2_dsk_98:
    v_mov_b32 v13, 0
    v_mfma_f32_16x16x32_bf16 v[16:19], a[20:23], a[4:7], v[16:19]
    v_mfma_f32_16x16x32_bf16 v[16:19], a[24:27], a[8:11], v[16:19]
    v_mfma_f32_16x16x32_bf16 v[16:19], a[28:31], a[12:15], v[16:19]
    v_mfma_f32_16x16x32_bf16 v[20:23], a[32:35], a[0:3], 0
    v_mfma_f32_16x16x32_bf16 v[20:23], a[36:39], a[4:7], v[20:23]
    v_mfma_f32_16x16x32_bf16 v[20:23], a[40:43], a[8:11], v[20:23]
    v_mfma_f32_16x16x32_bf16 v[20:23], a[44:47], a[12:15], v[20:23]
    v_mfma_f32_16x16x32_bf16 v[24:27], a[16:19], a[64:67], 0
    v_mfma_f32_16x16x32_bf16 v[24:27], a[20:23], a[68:71], v[24:27]
    v_mfma_f32_16x16x32_bf16 v[24:27], a[24:27], a[72:75], v[24:27]
    v_mfma_f32_16x16x32_bf16 v[24:27], a[28:31], a[76:79], v[24:27]
    v_mfma_f32_16x16x32_bf16 v[28:31], a[32:35], a[64:67], 0
    ds_read_b32 v11, v9
    v_mfma_f32_16x16x32_bf16 v[28:31], a[36:39], a[68:71], v[28:31]
    v_mfma_f32_16x16x32_bf16 v[28:31], a[40:43], a[72:75], v[28:31]
    v_mfma_f32_16x16x32_bf16 v[28:31], a[44:47], a[76:79], v[28:31]
    v_max3_f32 v88, v16, v17, v18
    v_max3_f32 v89, v19, v20, v21
    v_max3_f32 v88, v88, v22, v23
    v_mfma_f32_16x16x32_bf16 v[32:35], a[16:19], a[128:131], 0
    s_waitcnt lgkmcnt(0)
    v_cmp_gt_u32 vcc, s45, v11
    v_max_f32 v88, v88, v89
    v_mfma_f32_16x16x32_bf16 v[32:35], a[20:23], a[132:135], v[32:35]
    s_cbranch_vccnz k2_st_95
k2_bk_96:
    v_mov_b32 v89, v88
    v_mfma_f32_16x16x32_bf16 v[32:35], a[24:27], a[136:139], v[32:35]
    s_nop 1
    ds_read_b128 a[80:83], v3 offset:8192
    v_mfma_f32_16x16x32_bf16 v[32:35], a[28:31], a[140:143], v[32:35]
    ds_read_b128 a[84:87], v3 offset:9216
    v_permlane16_swap_b32 v88, v89
    v_max_f32 v88, v88, v89
    v_mfma_f32_16x16x32_bf16 v[36:39], a[32:35], a[128:131], 0
    ds_read_b128 a[88:91], v3 offset:10240
    v_mov_b32 v89, v88
    v_mfma_f32_16x16x32_bf16 v[36:39], a[36:39], a[132:135], v[36:39]
    s_nop 1
    ds_read_b128 a[92:95], v3 offset:11264
    v_mfma_f32_16x16x32_bf16 v[36:39], a[40:43], a[136:139], v[36:39]
    ds_read_b128 a[96:99], v3 offset:12288
    v_permlane32_swap_b32 v88, v89
    v_max_f32 v88, v88, v89
    v_mfma_f32_16x16x32_bf16 v[36:39], a[44:47], a[140:143], v[36:39]
    ds_read_b128 a[100:103], v3 offset:13312
    v_max_f32 v88, 0xf149f2ca, v88
    v_add_f32 v88, 0x42000000, v88
    v_mfma_f32_16x16x32_bf16 v[40:43], a[16:19], a[192:195], 0
    ds_read_b128 a[104:107], v3 offset:14336
    v_sub_f32 v16, v16, v88
    v_sub_f32 v17, v17, v88
    v_mfma_f32_16x16x32_bf16 v[40:43], a[20:23], a[196:199], v[40:43]
    ds_read_b128 a[108:111], v3 offset:15360
    v_sub_f32 v18, v18, v88
    v_sub_f32 v19, v19, v88
    v_mfma_f32_16x16x32_bf16 v[40:43], a[24:27], a[200:203], v[40:43]
    ds_read_b128 a[16:19], v2 offset:0
    v_sub_f32 v20, v20, v88
    v_sub_f32 v21, v21, v88
    v_mfma_f32_16x16x32_bf16 v[40:43], a[28:31], a[204:207], v[40:43]
    ds_read_b128 a[20:23], v2 offset:1024
    v_sub_f32 v22, v22, v88
    v_sub_f32 v23, v23, v88
    v_mfma_f32_16x16x32_bf16 v[44:47], a[32:35], a[192:195], 0
    ds_read_b128 a[24:27], v2 offset:2048
    v_exp_f32 v48, v16
    v_mfma_f32_16x16x32_bf16 v[44:47], a[36:39], a[196:199], v[44:47]
    ds_read_b128 a[28:31], v2 offset:3072
    v_exp_f32 v49, v17
    v_mfma_f32_16x16x32_bf16 v[44:47], a[40:43], a[200:203], v[44:47]
    ds_read_b128 a[32:35], v2 offset:4096
    v_exp_f32 v50, v18
    v_mfma_f32_16x16x32_bf16 v[44:47], a[44:47], a[204:207], v[44:47]
    ds_read_b128 a[36:39], v2 offset:5120
    v_exp_f32 v51, v19
    v_mfma_f32_16x16x32_bf16 v[160:163], a[164:167], a[164:167], 0
    ds_read_b128 a[40:43], v2 offset:6144
    v_exp_f32 v52, v20
    v_mfma_f32_16x16x32_bf16 v[164:167], a[164:167], a[164:167], 0
    ds_read_b128 a[44:47], v2 offset:7168
    v_exp_f32 v53, v21
    v_mfma_f32_16x16x32_bf16 v[168:171], a[164:167], a[164:167], 0
    v_exp_f32 v54, v22
    s_add_i32 s66, s45, 8
    v_mfma_f32_16x16x32_bf16 v[172:175], a[164:167], a[164:167], 0
    v_exp_f32 v55, v23
    s_nop 0
    v_mfma_f32_16x16x32_bf16 v[176:179], a[164:167], a[164:167], 0
    v_cvt_pk_bf16_f32 v56, v48, v49
    v_cvt_pk_bf16_f32 v57, v50, v51
    v_cvt_pk_bf16_f32 v58, v52, v53
    v_mfma_f32_16x16x32_bf16 v[180:183], a[164:167], a[164:167], 0
    v_cvt_pk_bf16_f32 v59, v54, v55
    s_cmp_ge_i32 s66, s72
    s_cselect_b32 s51, 0x8000, s7
    v_mfma_f32_16x16x32_bf16 v[184:187], a[164:167], a[164:167], 0
    s_cmp_gt_i32 s66, s72
    s_cselect_b32 s52, 0x8000, s7
    v_add_u32 v2, s51, v2
    v_mfma_f32_16x16x32_bf16 v[188:191], a[164:167], a[164:167], 0
    v_and_b32 v2, 0x1ffff, v2
    v_add_u32 v3, s52, v3
    v_and_b32 v3, 0x1ffff, v3
    v_mfma_f32_16x16x32_bf16 a[148:151], a[164:167], a[164:167], 0
    s_add_u32 s45, s45, 4
    v_sub_f32 v72, 0, v88
    v_sub_f32 v73, 0, v88
    v_mfma_f32_16x16x32_bf16 v[192:195], a[164:167], a[164:167], 0
    v_sub_f32 v74, 0, v88
    v_sub_f32 v75, 0, v88
    v_max3_f32 v90, v24, v25, v26
    v_mfma_f32_16x16x32_bf16 v[196:199], a[164:167], a[164:167], 0
    v_max3_f32 v91, v27, v28, v29
    v_max3_f32 v90, v90, v30, v31
    v_max_f32 v90, v90, v91
    v_mfma_f32_16x16x32_bf16 v[200:203], a[164:167], a[164:167], 0
    v_mov_b32 v91, v90
    s_nop 1
    v_mfma_f32_16x16x32_bf16 v[204:207], a[164:167], a[164:167], 0
    v_permlane16_swap_b32 v90, v91
    v_max_f32 v90, v90, v91
    v_mov_b32 v91, v90
    v_mfma_f32_16x16x32_bf16 v[208:211], a[164:167], a[164:167], 0
    s_nop 1
    v_permlane32_swap_b32 v90, v91
    v_mfma_f32_16x16x32_bf16 v[212:215], a[164:167], a[164:167], 0
    v_max_f32 v90, v90, v91
    v_max_f32 v90, 0xf149f2ca, v90
    v_add_f32 v90, 0x42000000, v90
    v_mfma_f32_16x16x32_bf16 v[216:219], a[164:167], a[164:167], 0
    v_sub_f32 v24, v24, v90
    v_sub_f32 v25, v25, v90
    v_sub_f32 v26, v26, v90
    v_mfma_f32_16x16x32_bf16 v[220:223], a[164:167], a[164:167], 0
    v_sub_f32 v27, v27, v90
    v_sub_f32 v28, v28, v90
    v_sub_f32 v29, v29, v90
    v_mfma_f32_16x16x32_bf16 a[152:155], a[164:167], a[164:167], 0
    v_sub_f32 v30, v30, v90
    v_sub_f32 v31, v31, v90
    v_max3_f32 v92, v32, v33, v34
    v_mfma_f32_16x16x32_bf16 v[224:227], a[164:167], a[164:167], 0
    v_exp_f32 v120, v24
    v_max3_f32 v93, v35, v36, v37
    v_mfma_f32_16x16x32_bf16 v[228:231], a[164:167], a[164:167], 0
    v_exp_f32 v121, v25
    v_max3_f32 v92, v92, v38, v39
    v_mfma_f32_16x16x32_bf16 v[232:235], a[164:167], a[164:167], 0
    v_exp_f32 v122, v26
    v_max_f32 v92, v92, v93
    v_mfma_f32_16x16x32_bf16 v[236:239], a[164:167], a[164:167], 0
    v_exp_f32 v123, v27
    v_mov_b32 v93, v92
    v_mfma_f32_16x16x32_bf16 v[240:243], a[164:167], a[164:167], 0
    v_exp_f32 v124, v28
    v_max3_f32 v94, v40, v41, v42
    v_mfma_f32_16x16x32_bf16 v[244:247], a[164:167], a[164:167], 0
    v_exp_f32 v125, v29
    v_max3_f32 v95, v43, v44, v45
    v_mfma_f32_16x16x32_bf16 v[248:251], a[164:167], a[164:167], 0
    v_exp_f32 v126, v30
    v_max3_f32 v94, v94, v46, v47
    v_mfma_f32_16x16x32_bf16 v[252:255], a[164:167], a[164:167], 0
    v_exp_f32 v127, v31
    s_nop 0
    v_mfma_f32_16x16x32_bf16 a[156:159], a[164:167], a[164:167], 0
    s_waitcnt lgkmcnt(8)
    s_nop 1
    v_mfma_f32_16x16x32_bf16 v[128:131], a[80:83], v[56:59], 0
    v_cvt_pk_bf16_f32 v60, v120, v121
    v_cvt_pk_bf16_f32 v61, v122, v123
    v_cvt_pk_bf16_f32 v62, v124, v125
    v_mfma_f32_16x16x32_bf16 v[132:135], a[84:87], v[56:59], 0
    v_cvt_pk_bf16_f32 v63, v126, v127
    v_sub_f32 v76, 0, v90
    v_sub_f32 v77, 0, v90
    v_mfma_f32_16x16x32_bf16 v[136:139], a[88:91], v[56:59], 0
    v_sub_f32 v78, 0, v90
    v_sub_f32 v79, 0, v90
    v_permlane16_swap_b32 v92, v93
    v_mfma_f32_16x16x32_bf16 v[140:143], a[92:95], v[56:59], 0
    v_max_f32 v92, v92, v93
    v_mov_b32 v93, v92
    v_max_f32 v94, v94, v95
    v_mfma_f32_16x16x32_bf16 v[144:147], a[96:99], v[56:59], 0
    s_nop 1
    v_permlane32_swap_b32 v92, v93
    v_mfma_f32_16x16x32_bf16 v[148:151], a[100:103], v[56:59], 0
    v_max_f32 v92, v92, v93
    v_max_f32 v92, 0xf149f2ca, v92
    v_add_f32 v92, 0x42000000, v92
    v_mfma_f32_16x16x32_bf16 v[152:155], a[104:107], v[56:59], 0
    v_sub_f32 v32, v32, v92
    v_sub_f32 v33, v33, v92
    v_sub_f32 v34, v34, v92
    v_mfma_f32_16x16x32_bf16 v[156:159], a[108:111], v[56:59], 0
    v_sub_f32 v35, v35, v92
    v_sub_f32 v36, v36, v92
    v_sub_f32 v37, v37, v92
    v_mfma_f32_16x16x32_bf16 a[144:147], a[160:163], v[56:59], 0
    v_sub_f32 v38, v38, v92
    v_sub_f32 v39, v39, v92
    v_exp_f32 v48, v32
    v_exp_f32 v49, v33
    v_exp_f32 v50, v34
    v_exp_f32 v51, v35
    v_exp_f32 v52, v36
    v_exp_f32 v53, v37
    v_exp_f32 v54, v38
    v_exp_f32 v55, v39
    s_nop 0
    v_cvt_pk_bf16_f32 v64, v48, v49
    v_cvt_pk_bf16_f32 v65, v50, v51
    v_cvt_pk_bf16_f32 v66, v52, v53
    v_cvt_pk_bf16_f32 v67, v54, v55
    v_sub_f32 v80, 0, v92
    v_sub_f32 v81, 0, v92
    v_sub_f32 v82, 0, v92
    v_sub_f32 v83, 0, v92
    v_mov_b32 v95, v94
    s_nop 1
    v_permlane16_swap_b32 v94, v95
    v_max_f32 v94, v94, v95
    v_mov_b32 v95, v94
    s_nop 1
    v_permlane32_swap_b32 v94, v95
    v_max_f32 v94, v94, v95
    v_max_f32 v94, 0xf149f2ca, v94
    v_add_f32 v94, 0x42000000, v94
    v_sub_f32 v40, v40, v94
    v_sub_f32 v41, v41, v94
    v_sub_f32 v42, v42, v94
    v_sub_f32 v43, v43, v94
    v_sub_f32 v44, v44, v94
    v_sub_f32 v45, v45, v94
    v_sub_f32 v46, v46, v94
    v_sub_f32 v47, v47, v94
    v_sub_f32 v84, 0, v94
    v_sub_f32 v85, 0, v94
    v_sub_f32 v86, 0, v94
    v_sub_f32 v87, 0, v94
    s_nop 1
    s_branch k2_dentry
k2_proB:
    s_waitcnt vmcnt(8) lgkmcnt(0)
    s_cmp_lt_u32 s47, s26
    s_cbranch_scc1 k2_ag_101
    s_waitcnt vmcnt(0)
k2_ag_101:
    ds_add_u32 v9, v10
    v_mfma_f32_16x16x32_bf16 v[16:19], a[16:19], a[0:3], 0
    s_cmp_ge_u32 s47, s26
    s_cbranch_scc1 k2_dsk_102
    buffer_load_dwordx4 v4, s[24:27], s47 offen offset:0 sc1 lds
    buffer_load_dwordx4 v4, s[24:27], s47 offen offset:1024 sc1 lds
    buffer_load_dwordx4 v4, s[24:27], s47 offen offset:2048 sc1 lds
    buffer_load_dwordx4 v4, s[24:27], s47 offen offset:3072 sc1 lds
    s_add_u32 m0, m0, 0x4000
    s_and_b32 m0, m0, 0x1ffff
    s_add_u32 s47, s47, 0x2000
    s_cmp_lt_u32 s45, s46
    s_cbranch_scc1 k2_dsk_102
    buffer_load_dwordx4 v4, s[24:27], s47 offen offset:0 sc1 lds
    buffer_load_dwordx4 v4, s[24:27], s47 offen offset:1024 sc1 lds
    buffer_load_dwordx4 v4, s[24:27], s47 offen offset:2048 sc1 lds
    buffer_load_dwordx4 v4, s[24:27], s47 offen offset:3072 sc1 lds
    s_add_u32 m0, m0, 0x4000
    s_and_b32 m0, m0, 0x1ffff
    s_add_u32 s47, s47, 0x2000
k2_dsk_102:
    v_mov_b32 v13, 0
    v_mfma_f32_16x16x32_bf16 v[16:19], a[20:23], a[4:7], v[16:19]
    v_mfma_f32_16x16x32_bf16 v[16:19], a[24:27], a[8:11], v[16:19]
    v_mfma_f32_16x16x32_bf16 v[16:19], a[28:31], a[12:15], v[16:19]
    v_mfma_f32_16x16x32_bf16 v[20:23], a[32:35], a[0:3], 0
    v_mfma_f32_16x16x32_bf16 v[20:23], a[36:39], a[4:7], v[20:23]
    v_mfma_f32_16x16x32_bf16 v[20:23], a[40:43], a[8:11], v[20:23]
    v_mfma_f32_16x16x32_bf16 v[20:23], a[44:47], a[12:15], v[20:23]
    v_mfma_f32_16x16x32_bf16 v[24:27], a[16:19], a[64:67], 0
    v_mfma_f32_16x16x32_bf16 v[24:27], a[20:23], a[68:71], v[24:27]
    v_mfma_f32_16x16x32_bf16 v[24:27], a[24:27], a[72:75], v[24:27]
    v_mfma_f32_16x16x32_bf16 v[24:27], a[28:31], a[76:79], v[24:27]
    v_mfma_f32_16x16x32_bf16 v[28:31], a[32:35], a[64:67], 0
    ds_read_b32 v11, v9
    v_mfma_f32_16x16x32_bf16 v[28:31], a[36:39], a[68:71], v[28:31]
    v_mfma_f32_16x16x32_bf16 v[28:31], a[40:43], a[72:75], v[28:31]
    v_mfma_f32_16x16x32_bf16 v[28:31], a[44:47], a[76:79], v[28:31]
    v_mov_b32 v16, v8
    v_mov_b32 v17, v8
    v_mov_b32 v18, v8
    v_mfma_f32_16x16x32_bf16 v[32:35], a[16:19], a[128:131], 0
    s_waitcnt lgkmcnt(0)
    v_cmp_gt_u32 vcc, s45, v11
    v_mov_b32 v19, v8
    v_mfma_f32_16x16x32_bf16 v[32:35], a[20:23], a[132:135], v[32:35]
    s_cbranch_vccnz k2_st_99
k2_bk_100:
    v_mov_b32 v20, v8
    v_mov_b32 v21, v8
    v_mfma_f32_16x16x32_bf16 v[32:35], a[24:27], a[136:139], v[32:35]
    ds_read_b128 a[80:83], v3 offset:8192
    v_mov_b32 v22, v8
    v_mov_b32 v23, v8
    v_mfma_f32_16x16x32_bf16 v[32:35], a[28:31], a[140:143], v[32:35]
    ds_read_b128 a[84:87], v3 offset:9216
    v_max3_f32 v88, v16, v17, v18
    v_max3_f32 v89, v19, v20, v21
    v_mfma_f32_16x16x32_bf16 v[36:39], a[32:35], a[128:131], 0
    ds_read_b128 a[88:91], v3 offset:10240
    v_max3_f32 v88, v88, v22, v23
    v_max_f32 v88, v88, v89
    v_mfma_f32_16x16x32_bf16 v[36:39], a[36:39], a[132:135], v[36:39]
    ds_read_b128 a[92:95], v3 offset:11264
    v_mov_b32 v89, v88
    v_mfma_f32_16x16x32_bf16 v[36:39], a[40:43], a[136:139], v[36:39]
    s_nop 1
    ds_read_b128 a[96:99], v3 offset:12288
    v_mfma_f32_16x16x32_bf16 v[36:39], a[44:47], a[140:143], v[36:39]
    ds_read_b128 a[100:103], v3 offset:13312
    v_permlane16_swap_b32 v88, v89
    v_max_f32 v88, v88, v89
    v_mfma_f32_16x16x32_bf16 v[40:43], a[16:19], a[192:195], 0
    ds_read_b128 a[104:107], v3 offset:14336
    v_mov_b32 v89, v88
    v_mov_b32 v24, v8
    v_mfma_f32_16x16x32_bf16 v[40:43], a[20:23], a[196:199], v[40:43]
    ds_read_b128 a[108:111], v3 offset:15360
    s_nop 1
    v_mfma_f32_16x16x32_bf16 v[40:43], a[24:27], a[200:203], v[40:43]
    ds_read_b128 a[16:19], v2 offset:0
    v_permlane32_swap_b32 v88, v89
    v_max_f32 v88, v88, v89
    v_mfma_f32_16x16x32_bf16 v[40:43], a[28:31], a[204:207], v[40:43]
    ds_read_b128 a[20:23], v2 offset:1024
    v_max_f32 v88, 0xf149f2ca, v88
    v_add_f32 v88, 0x42000000, v88
    v_mfma_f32_16x16x32_bf16 v[44:47], a[32:35], a[192:195], 0
    ds_read_b128 a[24:27], v2 offset:2048
    v_sub_f32 v16, v16, v88
    v_sub_f32 v17, v17, v88
    v_mfma_f32_16x16x32_bf16 v[44:47], a[36:39], a[196:199], v[44:47]
    ds_read_b128 a[28:31], v2 offset:3072
    v_sub_f32 v18, v18, v88
    v_sub_f32 v19, v19, v88
    v_mfma_f32_16x16x32_bf16 v[44:47], a[40:43], a[200:203], v[44:47]
    ds_read_b128 a[32:35], v2 offset:4096
    v_sub_f32 v20, v20, v88
    v_sub_f32 v21, v21, v88
    v_mfma_f32_16x16x32_bf16 v[44:47], a[44:47], a[204:207], v[44:47]
    ds_read_b128 a[36:39], v2 offset:5120
    v_sub_f32 v22, v22, v88
    v_sub_f32 v23, v23, v88
    v_mfma_f32_16x16x32_bf16 v[160:163], a[164:167], a[164:167], 0
    ds_read_b128 a[40:43], v2 offset:6144
    v_exp_f32 v48, v16
    v_mfma_f32_16x16x32_bf16 v[164:167], a[164:167], a[164:167], 0
    ds_read_b128 a[44:47], v2 offset:7168
    v_exp_f32 v49, v17
    v_mfma_f32_16x16x32_bf16 v[168:171], a[164:167], a[164:167], 0
    v_exp_f32 v50, v18
    s_add_i32 s66, s45, 8
    v_mfma_f32_16x16x32_bf16 v[172:175], a[164:167], a[164:167], 0
    v_exp_f32 v51, v19
    v_mov_b32 v25, v8
    v_mfma_f32_16x16x32_bf16 v[176:179], a[164:167], a[164:167], 0
    v_exp_f32 v52, v20
    v_mov_b32 v26, v8
    v_mfma_f32_16x16x32_bf16 v[180:183], a[164:167], a[164:167], 0
    v_exp_f32 v53, v21
    v_mov_b32 v27, v8
    v_mfma_f32_16x16x32_bf16 v[184:187], a[164:167], a[164:167], 0
    v_exp_f32 v54, v22
    v_mov_b32 v28, v8
    v_mfma_f32_16x16x32_bf16 v[188:191], a[164:167], a[164:167], 0
    v_exp_f32 v55, v23
    s_nop 0
    v_mfma_f32_16x16x32_bf16 a[148:151], a[164:167], a[164:167], 0
    v_cvt_pk_bf16_f32 v56, v48, v49
    v_cvt_pk_bf16_f32 v57, v50, v51
    v_cvt_pk_bf16_f32 v58, v52, v53
    v_mfma_f32_16x16x32_bf16 v[192:195], a[164:167], a[164:167], 0
    v_cvt_pk_bf16_f32 v59, v54, v55
    s_cmp_ge_i32 s66, s72
    s_cselect_b32 s51, 0x8000, s7
    v_mfma_f32_16x16x32_bf16 v[196:199], a[164:167], a[164:167], 0
    s_cmp_gt_i32 s66, s72
    s_cselect_b32 s52, 0x8000, s7
    v_add_u32 v2, s51, v2
    v_mfma_f32_16x16x32_bf16 v[200:203], a[164:167], a[164:167], 0
    v_and_b32 v2, 0x1ffff, v2
    v_add_u32 v3, s52, v3
    v_and_b32 v3, 0x1ffff, v3
    v_mfma_f32_16x16x32_bf16 v[204:207], a[164:167], a[164:167], 0
    s_add_u32 s45, s45, 4
    v_sub_f32 v72, 0, v88
    v_sub_f32 v73, 0, v88
    v_mfma_f32_16x16x32_bf16 v[208:211], a[164:167], a[164:167], 0
    v_sub_f32 v74, 0, v88
    v_sub_f32 v75, 0, v88
    v_mov_b32 v29, v8
    v_mfma_f32_16x16x32_bf16 v[212:215], a[164:167], a[164:167], 0
    v_mov_b32 v30, v8
    v_mov_b32 v31, v8
    v_max3_f32 v90, v24, v25, v26
    v_mfma_f32_16x16x32_bf16 v[216:219], a[164:167], a[164:167], 0
    v_max3_f32 v91, v27, v28, v29
    v_max3_f32 v90, v90, v30, v31
    v_max_f32 v90, v90, v91
    v_mfma_f32_16x16x32_bf16 v[220:223], a[164:167], a[164:167], 0
    v_mov_b32 v91, v90
    s_nop 1
    v_mfma_f32_16x16x32_bf16 a[152:155], a[164:167], a[164:167], 0
    v_permlane16_swap_b32 v90, v91
    v_max_f32 v90, v90, v91
    v_mov_b32 v91, v90
    v_mfma_f32_16x16x32_bf16 v[224:227], a[164:167], a[164:167], 0
    s_nop 1
    v_permlane32_swap_b32 v90, v91
    v_mfma_f32_16x16x32_bf16 v[228:231], a[164:167], a[164:167], 0
    v_max_f32 v90, v90, v91
    v_max_f32 v90, 0xf149f2ca, v90
    v_add_f32 v90, 0x42000000, v90
    v_mfma_f32_16x16x32_bf16 v[232:235], a[164:167], a[164:167], 0
    v_sub_f32 v24, v24, v90
    v_sub_f32 v25, v25, v90
    v_sub_f32 v26, v26, v90
    v_mfma_f32_16x16x32_bf16 v[236:239], a[164:167], a[164:167], 0
    v_sub_f32 v27, v27, v90
    v_sub_f32 v28, v28, v90
    v_sub_f32 v29, v29, v90
    v_mfma_f32_16x16x32_bf16 v[240:243], a[164:167], a[164:167], 0
    v_sub_f32 v30, v30, v90
    v_sub_f32 v31, v31, v90
    v_cndmask_b32 v32, v32, v8, s[56:57]
    v_mfma_f32_16x16x32_bf16 v[244:247], a[164:167], a[164:167], 0
    v_exp_f32 v120, v24
    v_cndmask_b32 v33, v33, v8, s[58:59]
    v_mfma_f32_16x16x32_bf16 v[248:251], a[164:167], a[164:167], 0
    v_exp_f32 v121, v25
    v_cndmask_b32 v34, v34, v8, s[60:61]
    v_mfma_f32_16x16x32_bf16 v[252:255], a[164:167], a[164:167], 0
    v_exp_f32 v122, v26
    v_cndmask_b32 v35, v35, v8, s[62:63]
    v_mfma_f32_16x16x32_bf16 a[156:159], a[164:167], a[164:167], 0
    s_waitcnt lgkmcnt(8)
    v_exp_f32 v123, v27
    v_mfma_f32_16x16x32_bf16 v[128:131], a[80:83], v[56:59], 0
    v_exp_f32 v124, v28
    v_mov_b32 v36, v8
    v_mfma_f32_16x16x32_bf16 v[132:135], a[84:87], v[56:59], 0
    v_exp_f32 v125, v29
    v_mov_b32 v37, v8
    v_mfma_f32_16x16x32_bf16 v[136:139], a[88:91], v[56:59], 0
    v_exp_f32 v126, v30
    v_mov_b32 v38, v8
    v_mfma_f32_16x16x32_bf16 v[140:143], a[92:95], v[56:59], 0
    v_exp_f32 v127, v31
    s_nop 0
    v_mfma_f32_16x16x32_bf16 v[144:147], a[96:99], v[56:59], 0
    v_cvt_pk_bf16_f32 v60, v120, v121
    v_cvt_pk_bf16_f32 v61, v122, v123
    v_cvt_pk_bf16_f32 v62, v124, v125
    v_mfma_f32_16x16x32_bf16 v[148:151], a[100:103], v[56:59], 0
    v_cvt_pk_bf16_f32 v63, v126, v127
    v_sub_f32 v76, 0, v90
    v_sub_f32 v77, 0, v90
    v_mfma_f32_16x16x32_bf16 v[152:155], a[104:107], v[56:59], 0
    v_sub_f32 v78, 0, v90
    v_sub_f32 v79, 0, v90
    v_mov_b32 v39, v8
    v_mfma_f32_16x16x32_bf16 v[156:159], a[108:111], v[56:59], 0
    v_max3_f32 v92, v32, v33, v34
    v_max3_f32 v93, v35, v36, v37
    v_max3_f32 v92, v92, v38, v39
    v_mfma_f32_16x16x32_bf16 a[144:147], a[160:163], v[56:59], 0
    v_max_f32 v92, v92, v93
    v_mov_b32 v93, v92
    s_nop 1
    v_permlane16_swap_b32 v92, v93
    v_max_f32 v92, v92, v93
    v_mov_b32 v93, v92
    s_nop 1
    v_permlane32_swap_b32 v92, v93
    v_max_f32 v92, v92, v93
    v_max_f32 v92, 0xf149f2ca, v92
    v_add_f32 v92, 0x42000000, v92
    v_sub_f32 v32, v32, v92
    v_sub_f32 v33, v33, v92
    v_sub_f32 v34, v34, v92
    v_sub_f32 v35, v35, v92
    v_sub_f32 v36, v36, v92
    v_sub_f32 v37, v37, v92
    v_sub_f32 v38, v38, v92
    v_sub_f32 v39, v39, v92
    v_exp_f32 v48, v32
    v_exp_f32 v49, v33
    v_exp_f32 v50, v34
    v_exp_f32 v51, v35
    v_exp_f32 v52, v36
    v_exp_f32 v53, v37
    v_exp_f32 v54, v38
    v_exp_f32 v55, v39
    s_nop 0
    v_cvt_pk_bf16_f32 v64, v48, v49
    v_cvt_pk_bf16_f32 v65, v50, v51
    v_cvt_pk_bf16_f32 v66, v52, v53
    v_cvt_pk_bf16_f32 v67, v54, v55
    v_sub_f32 v80, 0, v92
    v_sub_f32 v81, 0, v92
    v_sub_f32 v82, 0, v92
    v_sub_f32 v83, 0, v92
    v_cndmask_b32 v44, v44, v8, s[56:57]
    v_cndmask_b32 v45, v45, v8, s[58:59]
    v_cndmask_b32 v46, v46, v8, s[60:61]
    v_cndmask_b32 v47, v47, v8, s[62:63]
    v_max3_f32 v94, v40, v41, v42
    v_max3_f32 v95, v43, v44, v45
    v_max3_f32 v94, v94, v46, v47
    v_max_f32 v94, v94, v95
    v_mov_b32 v95, v94
    s_nop 1
    v_permlane16_swap_b32 v94, v95
    v_max_f32 v94, v94, v95
    v_mov_b32 v95, v94
    s_nop 1
    v_permlane32_swap_b32 v94, v95
    v_max_f32 v94, v94, v95
    v_max_f32 v94, 0xf149f2ca, v94
    v_add_f32 v94, 0x42000000, v94
    v_sub_f32 v40, v40, v94
    v_sub_f32 v41, v41, v94
    v_sub_f32 v42, v42, v94
    v_sub_f32 v43, v43, v94
    v_sub_f32 v44, v44, v94
    v_sub_f32 v45, v45, v94
    v_sub_f32 v46, v46, v94
    v_sub_f32 v47, v47, v94
    v_sub_f32 v84, 0, v94
    v_sub_f32 v85, 0, v94
    v_sub_f32 v86, 0, v94
    v_sub_f32 v87, 0, v94
    s_nop 1
    s_branch k2_drnB
k2_tail:
    s_cmp_gt_u32 s45, 144
    s_cbranch_scc1 k2_merge
    s_waitcnt lgkmcnt(0)
    ds_add_u32 v9, v10
    ds_read_b32 v11, v9
    s_waitcnt lgkmcnt(0)
    v_cmp_gt_u32 vcc, s45, v11
    s_cbranch_vccnz k2_st_103
k2_bk_104:
    s_add_u32 s45, s45, 4
    s_branch k2_tail
k2_merge:
    s_mul_i32 s65, s40, 0x5000
    s_xor_b32 s66, s40, 2
    s_mul_i32 s66, s66, 0x5000
    v_add_u32 v2, s65, v7
    v_add_u32 v3, s66, v7
    s_cmp_eq_u32 s44, 0
    s_cselect_b32 s65, 0x7f000000, s48
    s_cselect_b32 s48, s48, s36
    v_mov_b32 v11, 1
    v_mov_b32 v88, v72
    v_mov_b32 v89, v76
    v_mov_b32 v90, v80
    v_mov_b32 v91, v84
    v_accvgpr_read_b32 v92, a144
    v_accvgpr_read_b32 v93, a148
    v_accvgpr_read_b32 v94, a152
    v_accvgpr_read_b32 v95, a156
    buffer_store_dwordx2 v[10:11], v0, s[8:11], s65 offen sc1
    ds_write_b128 v2, v[88:91] offset:16384
    ds_write_b128 v2, v[92:95] offset:17408
    s_cmp_eq_u32 s44, 0
    s_cbranch_scc0 k2_mg_h
    ds_write_b128 v2, v[144:147] offset:0
    s_and_b32 s5, s2, 7
    s_lshr_b32 s5, s5, 1
    s_and_b32 s6, s2, 1
    s_lshl_b32 s6, s6, 3
    s_lshr_b32 s4, s2, 5
    s_add_u32 s6, s6, s4
    s_lshr_b32 s4, s2, 3
    s_and_b32 s4, s4, 3
    s_lshl_b32 s47, s6, 3
    ds_write_b128 v2, v[148:151] offset:1024
    s_lshl_b32 s53, s40, 1
    s_add_u32 s47, s47, s53
    s_mul_i32 s47, s47, 175104
    s_add_u32 s47, s47, 35651584
    s_lshl_b32 s52, s40, 13
    s_lshl_b32 s53, s4, 8
    s_add_u32 s52, s52, s53
    s_mul_i32 s53, s5, 11
    s_lshl_b32 s55, s53, 10
    ds_write_b128 v2, v[152:155] offset:2048
    s_add_u32 s55, s55, s47
    s_add_u32 s55, s55, 131072
    s_lshl_b32 s54, s53, 15
    s_add_u32 s54, s54, s52
    s_lshl_b32 s53, s40, 11
    v_mov_b32 v16, v7
    v_add_u32 v17, 175104, v7
    v_lshrrev_b32 v40, 4, v1
    v_and_b32 v41, 15, v1
    ds_write_b128 v2, v[156:159] offset:3072
    v_lshlrev_b32 v42, 1, v40
    v_xor_b32 v43, v41, v42
    v_lshlrev_b32 v42, 10, v40
    v_lshl_add_u32 v18, v43, 4, v42
    v_xor_b32 v43, 8, v43
    v_lshl_add_u32 v19, v43, 4, v42
    v_add_u32 v19, 0xc00, v19
    s_and_b32 s63, s2, 1
    s_lshl_b32 s50, s5, 1
    ds_write_b128 v2, v[176:179] offset:4096
    s_add_u32 s50, s50, s63
    s_lshl_b32 s51, s50, 14
    s_add_u32 s51, s51, s47
    s_lshl_b32 s50, s50, 19
    s_add_u32 s50, s50, s52
    s_mul_i32 s60, s63, 0xffff8000
    s_mul_i32 s61, s63, 0xfff00000
    s_lshl_b32 s39, s6, 9
    s_lshl_b32 s59, s5, 7
    ds_write_b128 v2, v[180:183] offset:5120
    s_add_u32 s39, s39, s59
    s_add_u32 s39, s39, 58064896
    s_lshl_b32 s63, s63, 6
    v_lshlrev_b32 v36, 2, v1
    v_add_u32 v36, s63, v36
    v_and_b32 v36, 0x7f, v36
    v_bfe_u32 v42, v1, 2, 2
    v_lshl_add_u32 v42, v40, 2, v42
    v_and_b32 v43, 3, v1
    ds_write_b128 v2, v[184:187] offset:6144
    v_lshlrev_b32 v44, 8, v42
    v_lshl_add_u32 v44, v43, 3, v44
    v_and_b32 v42, 7, v42
    v_xor_b32 v43, 0, v42
    v_lshl_add_u32 v20, v43, 5, v44
    v_add_u32 v28, 0x10000, v20
    v_xor_b32 v43, 1, v42
    v_lshl_add_u32 v21, v43, 5, v44
    v_add_u32 v29, 0x10000, v21
    ds_write_b128 v2, v[188:191] offset:7168
    v_xor_b32 v43, 2, v42
    v_lshl_add_u32 v22, v43, 5, v44
    v_add_u32 v30, 0x10000, v22
    v_xor_b32 v43, 3, v42
    v_lshl_add_u32 v23, v43, 5, v44
    v_add_u32 v31, 0x10000, v23
    v_xor_b32 v43, 4, v42
    v_lshl_add_u32 v24, v43, 5, v44
    v_add_u32 v32, 0x10000, v24
    ds_write_b128 v2, v[208:211] offset:8192
    v_xor_b32 v43, 5, v42
    v_lshl_add_u32 v25, v43, 5, v44
    v_add_u32 v33, 0x10000, v25
    v_xor_b32 v43, 6, v42
    v_lshl_add_u32 v26, v43, 5, v44
    v_add_u32 v34, 0x10000, v26
    v_xor_b32 v43, 7, v42
    v_lshl_add_u32 v27, v43, 5, v44
    v_add_u32 v35, 0x10000, v27
    ds_write_b128 v2, v[212:215] offset:9216
    v_lshlrev_b32 v41, 10, v41
    v_lshl_add_u32 v38, v40, 3, v41
    s_lshl_b32 s62, s6, 3
    s_lshl_b32 s63, s5, 1
    s_add_u32 s62, s62, s63
    s_and_b32 s63, s40, 1
    s_add_u32 s62, s62, s63
    s_lshl_b32 s62, s62, 14
    s_lshl_b32 s63, s4, 8
    ds_write_b128 v2, v[216:219] offset:10240
    s_add_u32 s62, s62, s63
    s_lshr_b32 s63, s40, 1
    s_lshl_b32 s63, s63, 7
    s_add_u32 s62, s62, s63
    s_andn2_b32 s56, s2, 6
    s_lshl_b32 s57, s40, 1
    s_or_b32 s56, s56, s57
    s_and_b32 s57, s56, 7
    s_lshl_b32 s57, s57, 4
    ds_write_b128 v2, v[220:223] offset:11264
    s_lshl_b32 s58, s4, 2
    s_add_u32 s57, s57, s58
    s_lshr_b32 s58, s2, 5
    s_lshl_b32 s58, s58, 7
    s_add_u32 s57, s57, s58
    s_add_u32 s57, s57, 58077184
    s_lshl_b32 s56, s56, 15
    s_lshl_b32 s58, s5, 13
    s_add_u32 s56, s56, s58
    ds_write_b128 v2, v[240:243] offset:12288
    s_add_u32 s56, s56, 58110976
    s_lshl_b32 s58, s2, 15
    s_lshl_b32 s59, s40, 11
    s_add_u32 s58, s58, s59
    s_add_u32 s58, s58, 58110976
    s_add_u32 s63, s58, 0
    s_cmp_eq_u32 s5, 0
    s_cselect_b32 s32, 0x7f000000, s63
    s_add_u32 s63, s58, 8192
    ds_write_b128 v2, v[244:247] offset:13312
    s_cmp_eq_u32 s5, 1
    s_cselect_b32 s33, 0x7f000000, s63
    s_add_u32 s63, s58, 16384
    s_cmp_eq_u32 s5, 2
    s_cselect_b32 s34, 0x7f000000, s63
    s_add_u32 s63, s58, 24576
    s_cmp_eq_u32 s5, 3
    s_cselect_b32 s35, 0x7f000000, s63
    v_subrev_u32 v45, 0x300, v9
    ds_write_b128 v2, v[248:251] offset:14336
    v_mov_b32 v43, 0
    ds_write_b32 v45, v43
    ds_write_b32 v45, v43 offset:256
    ds_write_b32 v45, v43 offset:512
    ds_write_b128 v2, v[252:255] offset:15360
    s_waitcnt vmcnt(13)
    v_cmp_eq_u32 vcc, 0, v14
    s_nop 0
    s_cbranch_vccnz mg_ps_105
mg_pb_106:
    buffer_load_dwordx4 a[0:3], v16, s[8:11], s55 offen sc1
    buffer_load_dwordx4 a[4:7], v17, s[8:11], s55 offen sc1
    s_add_u32 m0, s53, 81920
    s_add_u32 s55, s55, 1024
    buffer_load_dwordx4 v18, s[12:15], s54 offen lds
    buffer_load_dwordx4 v19, s[12:15], s54 offen offset:1024 lds
    s_add_u32 s54, s54, 32768
    buffer_load_dwordx4 a[8:11], v16, s[8:11], s55 offen sc1
    buffer_load_dwordx4 a[12:15], v17, s[8:11], s55 offen sc1
    s_add_u32 m0, s53, 90112
    s_add_u32 s55, s55, 1024
    buffer_load_dwordx4 v18, s[12:15], s54 offen lds
    buffer_load_dwordx4 v19, s[12:15], s54 offen offset:1024 lds
    s_add_u32 s54, s54, 32768
    s_waitcnt lgkmcnt(0)
    s_barrier
    ds_read_b128 v[96:99], v3 offset:16384
    ds_read_b128 v[100:103], v3 offset:17408
    ds_read_b128 v[144:147], v3 offset:0
    ds_read_b128 v[148:151], v3 offset:1024
    ds_read_b128 v[152:155], v3 offset:2048
    ds_read_b128 v[156:159], v3 offset:3072
    ds_read_b128 v[176:179], v3 offset:4096
    ds_read_b128 v[180:183], v3 offset:5120
    ds_read_b128 v[184:187], v3 offset:6144
    ds_read_b128 v[188:191], v3 offset:7168
    ds_read_b128 v[208:211], v3 offset:8192
    ds_read_b128 v[212:215], v3 offset:9216
    ds_read_b128 v[216:219], v3 offset:10240
    ds_read_b128 v[220:223], v3 offset:11264
    ds_read_b128 v[240:243], v3 offset:12288
    ds_read_b128 v[244:247], v3 offset:13312
    ds_read_b128 v[248:251], v3 offset:14336
    ds_read_b128 v[252:255], v3 offset:15360
    s_waitcnt lgkmcnt(14)
    v_min_f32 v112, v88, v96
    v_sub_f32 v104, v112, v88
    v_sub_f32 v108, v112, v96
    v_exp_f32 v104, v104
    v_exp_f32 v108, v108
    s_nop 0
    v_mul_f32 v112, v92, v104
    v_fmac_f32 v112, v100, v108
    v_rcp_f32 v112, v112
    s_nop 0
    v_mul_f32 v104, v104, v112
    v_mul_f32 v108, v108, v112
    v_min_f32 v112, v89, v97
    v_sub_f32 v105, v112, v89
    v_sub_f32 v109, v112, v97
    v_exp_f32 v105, v105
    v_exp_f32 v109, v109
    s_nop 0
    v_mul_f32 v112, v93, v105
    v_fmac_f32 v112, v101, v109
    v_rcp_f32 v112, v112
    s_nop 0
    v_mul_f32 v105, v105, v112
    v_mul_f32 v109, v109, v112
    v_min_f32 v112, v90, v98
    v_sub_f32 v106, v112, v90
    v_sub_f32 v110, v112, v98
    v_exp_f32 v106, v106
    v_exp_f32 v110, v110
    s_nop 0
    v_mul_f32 v112, v94, v106
    v_fmac_f32 v112, v102, v110
    v_rcp_f32 v112, v112
    s_nop 0
    v_mul_f32 v106, v106, v112
    v_mul_f32 v110, v110, v112
    v_min_f32 v112, v91, v99
    v_sub_f32 v107, v112, v91
    v_sub_f32 v111, v112, v99
    v_exp_f32 v107, v107
    v_exp_f32 v111, v111
    s_nop 0
    v_mul_f32 v112, v95, v107
    v_fmac_f32 v112, v103, v111
    v_rcp_f32 v112, v112
    s_nop 0
    v_mul_f32 v107, v107, v112
    v_mul_f32 v111, v111, v112
    s_waitcnt lgkmcnt(12)
    s_add_u32 s67, s64, 0
    v_mul_f32 v128, v128, v104
    v_fmac_f32 v128, v144, v108
    v_mul_f32 v129, v129, v104
    v_fmac_f32 v129, v145, v108
    v_mul_f32 v130, v130, v104
    v_fmac_f32 v130, v146, v108
    v_mul_f32 v131, v131, v104
    v_fmac_f32 v131, v147, v108
    v_cvt_pk_bf16_f32 v116, v128, v129
    v_cvt_pk_bf16_f32 v117, v130, v131
    v_mul_f32 v132, v132, v104
    v_fmac_f32 v132, v148, v108
    v_mul_f32 v133, v133, v104
    v_fmac_f32 v133, v149, v108
    v_mul_f32 v134, v134, v104
    v_fmac_f32 v134, v150, v108
    v_mul_f32 v135, v135, v104
    v_fmac_f32 v135, v151, v108
    v_cvt_pk_bf16_f32 v118, v132, v133
    v_cvt_pk_bf16_f32 v119, v134, v135
    buffer_store_dwordx4 v[116:119], v7, s[8:11], s67 offen offset:0 sc1
    s_nop 0
    v_mul_f32 v136, v136, v104
    v_fmac_f32 v136, v152, v108
    v_mul_f32 v137, v137, v104
    v_fmac_f32 v137, v153, v108
    v_mul_f32 v138, v138, v104
    v_fmac_f32 v138, v154, v108
    v_mul_f32 v139, v139, v104
    v_fmac_f32 v139, v155, v108
    v_cvt_pk_bf16_f32 v120, v136, v137
    v_cvt_pk_bf16_f32 v121, v138, v139
    v_mul_f32 v140, v140, v104
    v_fmac_f32 v140, v156, v108
    v_mul_f32 v141, v141, v104
    v_fmac_f32 v141, v157, v108
    v_mul_f32 v142, v142, v104
    v_fmac_f32 v142, v158, v108
    v_mul_f32 v143, v143, v104
    v_fmac_f32 v143, v159, v108
    v_cvt_pk_bf16_f32 v122, v140, v141
    v_cvt_pk_bf16_f32 v123, v142, v143
    buffer_store_dwordx4 v[120:123], v7, s[8:11], s67 offen offset:1024 sc1
    s_nop 0
    s_waitcnt lgkmcnt(8)
    s_add_u32 s67, s64, 175104
    v_mul_f32 v160, v160, v105
    v_fmac_f32 v160, v176, v109
    v_mul_f32 v161, v161, v105
    v_fmac_f32 v161, v177, v109
    v_mul_f32 v162, v162, v105
    v_fmac_f32 v162, v178, v109
    v_mul_f32 v163, v163, v105
    v_fmac_f32 v163, v179, v109
    v_cvt_pk_bf16_f32 v116, v160, v161
    v_cvt_pk_bf16_f32 v117, v162, v163
    v_mul_f32 v164, v164, v105
    v_fmac_f32 v164, v180, v109
    v_mul_f32 v165, v165, v105
    v_fmac_f32 v165, v181, v109
    v_mul_f32 v166, v166, v105
    v_fmac_f32 v166, v182, v109
    v_mul_f32 v167, v167, v105
    v_fmac_f32 v167, v183, v109
    v_cvt_pk_bf16_f32 v118, v164, v165
    v_cvt_pk_bf16_f32 v119, v166, v167
    buffer_store_dwordx4 v[116:119], v7, s[8:11], s67 offen offset:0 sc1
    s_nop 0
    v_mul_f32 v168, v168, v105
    v_fmac_f32 v168, v184, v109
    v_mul_f32 v169, v169, v105
    v_fmac_f32 v169, v185, v109
    v_mul_f32 v170, v170, v105
    v_fmac_f32 v170, v186, v109
    v_mul_f32 v171, v171, v105
    v_fmac_f32 v171, v187, v109
    v_cvt_pk_bf16_f32 v120, v168, v169
    v_cvt_pk_bf16_f32 v121, v170, v171
    v_mul_f32 v172, v172, v105
    v_fmac_f32 v172, v188, v109
    v_mul_f32 v173, v173, v105
    v_fmac_f32 v173, v189, v109
    v_mul_f32 v174, v174, v105
    v_fmac_f32 v174, v190, v109
    v_mul_f32 v175, v175, v105
    v_fmac_f32 v175, v191, v109
    v_cvt_pk_bf16_f32 v122, v172, v173
    v_cvt_pk_bf16_f32 v123, v174, v175
    buffer_store_dwordx4 v[120:123], v7, s[8:11], s67 offen offset:1024 sc1
    s_nop 0
    s_waitcnt lgkmcnt(4)
    s_add_u32 s67, s64, 350208
    v_mul_f32 v192, v192, v106
    v_fmac_f32 v192, v208, v110
    v_mul_f32 v193, v193, v106
    v_fmac_f32 v193, v209, v110
    v_mul_f32 v194, v194, v106
    v_fmac_f32 v194, v210, v110
    v_mul_f32 v195, v195, v106
    v_fmac_f32 v195, v211, v110
    v_cvt_pk_bf16_f32 v116, v192, v193
    v_cvt_pk_bf16_f32 v117, v194, v195
    v_mul_f32 v196, v196, v106
    v_fmac_f32 v196, v212, v110
    v_mul_f32 v197, v197, v106
    v_fmac_f32 v197, v213, v110
    v_mul_f32 v198, v198, v106
    v_fmac_f32 v198, v214, v110
    v_mul_f32 v199, v199, v106
    v_fmac_f32 v199, v215, v110
    v_cvt_pk_bf16_f32 v118, v196, v197
    v_cvt_pk_bf16_f32 v119, v198, v199
    buffer_store_dwordx4 v[116:119], v7, s[8:11], s67 offen offset:0 sc1
    s_nop 0
    v_mul_f32 v200, v200, v106
    v_fmac_f32 v200, v216, v110
    v_mul_f32 v201, v201, v106
    v_fmac_f32 v201, v217, v110
    v_mul_f32 v202, v202, v106
    v_fmac_f32 v202, v218, v110
    v_mul_f32 v203, v203, v106
    v_fmac_f32 v203, v219, v110
    v_cvt_pk_bf16_f32 v120, v200, v201
    v_cvt_pk_bf16_f32 v121, v202, v203
    v_mul_f32 v204, v204, v106
    v_fmac_f32 v204, v220, v110
    v_mul_f32 v205, v205, v106
    v_fmac_f32 v205, v221, v110
    v_mul_f32 v206, v206, v106
    v_fmac_f32 v206, v222, v110
    v_mul_f32 v207, v207, v106
    v_fmac_f32 v207, v223, v110
    v_cvt_pk_bf16_f32 v122, v204, v205
    v_cvt_pk_bf16_f32 v123, v206, v207
    buffer_store_dwordx4 v[120:123], v7, s[8:11], s67 offen offset:1024 sc1
    s_nop 0
    s_waitcnt lgkmcnt(0)
    s_add_u32 s67, s64, 525312
    v_mul_f32 v224, v224, v107
    v_fmac_f32 v224, v240, v111
    v_mul_f32 v225, v225, v107
    v_fmac_f32 v225, v241, v111
    v_mul_f32 v226, v226, v107
    v_fmac_f32 v226, v242, v111
    v_mul_f32 v227, v227, v107
    v_fmac_f32 v227, v243, v111
    v_cvt_pk_bf16_f32 v116, v224, v225
    v_cvt_pk_bf16_f32 v117, v226, v227
    v_mul_f32 v228, v228, v107
    v_fmac_f32 v228, v244, v111
    v_mul_f32 v229, v229, v107
    v_fmac_f32 v229, v245, v111
    v_mul_f32 v230, v230, v107
    v_fmac_f32 v230, v246, v111
    v_mul_f32 v231, v231, v107
    v_fmac_f32 v231, v247, v111
    v_cvt_pk_bf16_f32 v118, v228, v229
    v_cvt_pk_bf16_f32 v119, v230, v231
    buffer_store_dwordx4 v[116:119], v7, s[8:11], s67 offen offset:0 sc1
    s_nop 0
    v_mul_f32 v232, v232, v107
    v_fmac_f32 v232, v248, v111
    v_mul_f32 v233, v233, v107
    v_fmac_f32 v233, v249, v111
    v_mul_f32 v234, v234, v107
    v_fmac_f32 v234, v250, v111
    v_mul_f32 v235, v235, v107
    v_fmac_f32 v235, v251, v111
    v_cvt_pk_bf16_f32 v120, v232, v233
    v_cvt_pk_bf16_f32 v121, v234, v235
    v_mul_f32 v236, v236, v107
    v_fmac_f32 v236, v252, v111
    v_mul_f32 v237, v237, v107
    v_fmac_f32 v237, v253, v111
    v_mul_f32 v238, v238, v107
    v_fmac_f32 v238, v254, v111
    v_mul_f32 v239, v239, v107
    v_fmac_f32 v239, v255, v111
    v_cvt_pk_bf16_f32 v122, v236, v237
    v_cvt_pk_bf16_f32 v123, v238, v239
    buffer_store_dwordx4 v[120:123], v7, s[8:11], s67 offen offset:1024 sc1
    s_nop 0
    s_branch k2_done
k2_mg_h:
    ds_write_b128 v2, v[128:131] offset:0
    s_and_b32 s5, s2, 7
    s_lshr_b32 s5, s5, 1
    s_and_b32 s6, s2, 1
    s_lshl_b32 s6, s6, 3
    s_lshr_b32 s4, s2, 5
    s_add_u32 s6, s6, s4
    s_lshr_b32 s4, s2, 3
    s_and_b32 s4, s4, 3
    s_lshl_b32 s47, s6, 3
    ds_write_b128 v2, v[132:135] offset:1024
    s_lshl_b32 s53, s40, 1
    s_add_u32 s47, s47, s53
    s_mul_i32 s47, s47, 175104
    s_add_u32 s47, s47, 35651584
    s_lshl_b32 s52, s40, 13
    s_lshl_b32 s53, s4, 8
    s_add_u32 s52, s52, s53
    s_mul_i32 s53, s5, 11
    s_lshl_b32 s55, s53, 10
    ds_write_b128 v2, v[136:139] offset:2048
    s_add_u32 s55, s55, s47
    s_add_u32 s55, s55, 131072
    s_lshl_b32 s54, s53, 15
    s_add_u32 s54, s54, s52
    s_lshl_b32 s53, s40, 11
    v_mov_b32 v16, v7
    v_add_u32 v17, 175104, v7
    v_lshrrev_b32 v40, 4, v1
    v_and_b32 v41, 15, v1
    ds_write_b128 v2, v[140:143] offset:3072
    v_lshlrev_b32 v42, 1, v40
    v_xor_b32 v43, v41, v42
    v_lshlrev_b32 v42, 10, v40
    v_lshl_add_u32 v18, v43, 4, v42
    v_xor_b32 v43, 8, v43
    v_lshl_add_u32 v19, v43, 4, v42
    v_add_u32 v19, 0xc00, v19
    s_and_b32 s63, s2, 1
    s_lshl_b32 s50, s5, 1
    ds_write_b128 v2, v[160:163] offset:4096
    s_add_u32 s50, s50, s63
    s_lshl_b32 s51, s50, 14
    s_add_u32 s51, s51, s47
    s_lshl_b32 s50, s50, 19
    s_add_u32 s50, s50, s52
    s_mul_i32 s60, s63, 0xffff8000
    s_mul_i32 s61, s63, 0xfff00000
    s_lshl_b32 s39, s6, 9
    s_lshl_b32 s59, s5, 7
    ds_write_b128 v2, v[164:167] offset:5120
    s_add_u32 s39, s39, s59
    s_add_u32 s39, s39, 58064896
    s_lshl_b32 s63, s63, 6
    v_lshlrev_b32 v36, 2, v1
    v_add_u32 v36, s63, v36
    v_and_b32 v36, 0x7f, v36
    v_bfe_u32 v42, v1, 2, 2
    v_lshl_add_u32 v42, v40, 2, v42
    v_and_b32 v43, 3, v1
    ds_write_b128 v2, v[168:171] offset:6144
    v_lshlrev_b32 v44, 8, v42
    v_lshl_add_u32 v44, v43, 3, v44
    v_and_b32 v42, 7, v42
    v_xor_b32 v43, 0, v42
    v_lshl_add_u32 v20, v43, 5, v44
    v_add_u32 v28, 0x10000, v20
    v_xor_b32 v43, 1, v42
    v_lshl_add_u32 v21, v43, 5, v44
    v_add_u32 v29, 0x10000, v21
    ds_write_b128 v2, v[172:175] offset:7168
    v_xor_b32 v43, 2, v42
    v_lshl_add_u32 v22, v43, 5, v44
    v_add_u32 v30, 0x10000, v22
    v_xor_b32 v43, 3, v42
    v_lshl_add_u32 v23, v43, 5, v44
    v_add_u32 v31, 0x10000, v23
    v_xor_b32 v43, 4, v42
    v_lshl_add_u32 v24, v43, 5, v44
    v_add_u32 v32, 0x10000, v24
    ds_write_b128 v2, v[192:195] offset:8192
    v_xor_b32 v43, 5, v42
    v_lshl_add_u32 v25, v43, 5, v44
    v_add_u32 v33, 0x10000, v25
    v_xor_b32 v43, 6, v42
    v_lshl_add_u32 v26, v43, 5, v44
    v_add_u32 v34, 0x10000, v26
    v_xor_b32 v43, 7, v42
    v_lshl_add_u32 v27, v43, 5, v44
    v_add_u32 v35, 0x10000, v27
    ds_write_b128 v2, v[196:199] offset:9216
    v_lshlrev_b32 v41, 10, v41
    v_lshl_add_u32 v38, v40, 3, v41
    s_lshl_b32 s62, s6, 3
    s_lshl_b32 s63, s5, 1
    s_add_u32 s62, s62, s63
    s_and_b32 s63, s40, 1
    s_add_u32 s62, s62, s63
    s_lshl_b32 s62, s62, 14
    s_lshl_b32 s63, s4, 8
    ds_write_b128 v2, v[200:203] offset:10240
    s_add_u32 s62, s62, s63
    s_lshr_b32 s63, s40, 1
    s_lshl_b32 s63, s63, 7
    s_add_u32 s62, s62, s63
    s_andn2_b32 s56, s2, 6
    s_lshl_b32 s57, s40, 1
    s_or_b32 s56, s56, s57
    s_and_b32 s57, s56, 7
    s_lshl_b32 s57, s57, 4
    ds_write_b128 v2, v[204:207] offset:11264
    s_lshl_b32 s58, s4, 2
    s_add_u32 s57, s57, s58
    s_lshr_b32 s58, s2, 5
    s_lshl_b32 s58, s58, 7
    s_add_u32 s57, s57, s58
    s_add_u32 s57, s57, 58077184
    s_lshl_b32 s56, s56, 15
    s_lshl_b32 s58, s5, 13
    s_add_u32 s56, s56, s58
    ds_write_b128 v2, v[224:227] offset:12288
    s_add_u32 s56, s56, 58110976
    s_lshl_b32 s58, s2, 15
    s_lshl_b32 s59, s40, 11
    s_add_u32 s58, s58, s59
    s_add_u32 s58, s58, 58110976
    s_add_u32 s63, s58, 0
    s_cmp_eq_u32 s5, 0
    s_cselect_b32 s32, 0x7f000000, s63
    s_add_u32 s63, s58, 8192
    ds_write_b128 v2, v[228:231] offset:13312
    s_cmp_eq_u32 s5, 1
    s_cselect_b32 s33, 0x7f000000, s63
    s_add_u32 s63, s58, 16384
    s_cmp_eq_u32 s5, 2
    s_cselect_b32 s34, 0x7f000000, s63
    s_add_u32 s63, s58, 24576
    s_cmp_eq_u32 s5, 3
    s_cselect_b32 s35, 0x7f000000, s63
    v_subrev_u32 v45, 0x300, v9
    ds_write_b128 v2, v[232:235] offset:14336
    v_mov_b32 v43, 0
    ds_write_b32 v45, v43
    ds_write_b32 v45, v43 offset:256
    ds_write_b32 v45, v43 offset:512
    ds_write_b128 v2, v[236:239] offset:15360
    s_waitcnt vmcnt(13)
    v_cmp_eq_u32 vcc, 0, v14
    s_nop 0
    s_cbranch_vccnz mg_ps_107
mg_pb_108:
    buffer_load_dwordx4 a[0:3], v16, s[8:11], s55 offen sc1
    buffer_load_dwordx4 a[4:7], v17, s[8:11], s55 offen sc1
    s_add_u32 m0, s53, 81920
    s_add_u32 s55, s55, 1024
    buffer_load_dwordx4 v18, s[12:15], s54 offen lds
    buffer_load_dwordx4 v19, s[12:15], s54 offen offset:1024 lds
    s_add_u32 s54, s54, 32768
    buffer_load_dwordx4 a[8:11], v16, s[8:11], s55 offen sc1
    buffer_load_dwordx4 a[12:15], v17, s[8:11], s55 offen sc1
    s_add_u32 m0, s53, 90112
    s_add_u32 s55, s55, 1024
    buffer_load_dwordx4 v18, s[12:15], s54 offen lds
    buffer_load_dwordx4 v19, s[12:15], s54 offen offset:1024 lds
    s_add_u32 s54, s54, 32768
    s_waitcnt lgkmcnt(0)
    s_barrier
    ds_read_b128 v[96:99], v3 offset:16384
    ds_read_b128 v[100:103], v3 offset:17408
    ds_read_b128 v[128:131], v3 offset:0
    ds_read_b128 v[132:135], v3 offset:1024
    ds_read_b128 v[136:139], v3 offset:2048
    ds_read_b128 v[140:143], v3 offset:3072
    ds_read_b128 v[160:163], v3 offset:4096
    ds_read_b128 v[164:167], v3 offset:5120
    ds_read_b128 v[168:171], v3 offset:6144
    ds_read_b128 v[172:175], v3 offset:7168
    ds_read_b128 v[192:195], v3 offset:8192
    ds_read_b128 v[196:199], v3 offset:9216
    ds_read_b128 v[200:203], v3 offset:10240
    ds_read_b128 v[204:207], v3 offset:11264
    ds_read_b128 v[224:227], v3 offset:12288
    ds_read_b128 v[228:231], v3 offset:13312
    ds_read_b128 v[232:235], v3 offset:14336
    ds_read_b128 v[236:239], v3 offset:15360
    s_waitcnt lgkmcnt(14)
    v_min_f32 v112, v88, v96
    v_sub_f32 v104, v112, v88
    v_sub_f32 v108, v112, v96
    v_exp_f32 v104, v104
    v_exp_f32 v108, v108
    s_nop 0
    v_mul_f32 v112, v92, v104
    v_fmac_f32 v112, v100, v108
    v_rcp_f32 v112, v112
    s_nop 0
    v_mul_f32 v104, v104, v112
    v_mul_f32 v108, v108, v112
    v_min_f32 v112, v89, v97
    v_sub_f32 v105, v112, v89
    v_sub_f32 v109, v112, v97
    v_exp_f32 v105, v105
    v_exp_f32 v109, v109
    s_nop 0
    v_mul_f32 v112, v93, v105
    v_fmac_f32 v112, v101, v109
    v_rcp_f32 v112, v112
    s_nop 0
    v_mul_f32 v105, v105, v112
    v_mul_f32 v109, v109, v112
    v_min_f32 v112, v90, v98
    v_sub_f32 v106, v112, v90
    v_sub_f32 v110, v112, v98
    v_exp_f32 v106, v106
    v_exp_f32 v110, v110
    s_nop 0
    v_mul_f32 v112, v94, v106
    v_fmac_f32 v112, v102, v110
    v_rcp_f32 v112, v112
    s_nop 0
    v_mul_f32 v106, v106, v112
    v_mul_f32 v110, v110, v112
    v_min_f32 v112, v91, v99
    v_sub_f32 v107, v112, v91
    v_sub_f32 v111, v112, v99
    v_exp_f32 v107, v107
    v_exp_f32 v111, v111
    s_nop 0
    v_mul_f32 v112, v95, v107
    v_fmac_f32 v112, v103, v111
    v_rcp_f32 v112, v112
    s_nop 0
    v_mul_f32 v107, v107, v112
    v_mul_f32 v111, v111, v112
    s_waitcnt lgkmcnt(12)
    s_add_u32 s67, s64, 2048
    v_mul_f32 v144, v144, v104
    v_fmac_f32 v144, v128, v108
    v_mul_f32 v145, v145, v104
    v_fmac_f32 v145, v129, v108
    v_mul_f32 v146, v146, v104
    v_fmac_f32 v146, v130, v108
    v_mul_f32 v147, v147, v104
    v_fmac_f32 v147, v131, v108
    v_cvt_pk_bf16_f32 v116, v144, v145
    v_cvt_pk_bf16_f32 v117, v146, v147
    v_mul_f32 v148, v148, v104
    v_fmac_f32 v148, v132, v108
    v_mul_f32 v149, v149, v104
    v_fmac_f32 v149, v133, v108
    v_mul_f32 v150, v150, v104
    v_fmac_f32 v150, v134, v108
    v_mul_f32 v151, v151, v104
    v_fmac_f32 v151, v135, v108
    v_cvt_pk_bf16_f32 v118, v148, v149
    v_cvt_pk_bf16_f32 v119, v150, v151
    buffer_store_dwordx4 v[116:119], v7, s[8:11], s67 offen offset:0 sc1
    s_nop 0
    v_mul_f32 v152, v152, v104
    v_fmac_f32 v152, v136, v108
    v_mul_f32 v153, v153, v104
    v_fmac_f32 v153, v137, v108
    v_mul_f32 v154, v154, v104
    v_fmac_f32 v154, v138, v108
    v_mul_f32 v155, v155, v104
    v_fmac_f32 v155, v139, v108
    v_cvt_pk_bf16_f32 v120, v152, v153
    v_cvt_pk_bf16_f32 v121, v154, v155
    v_mul_f32 v156, v156, v104
    v_fmac_f32 v156, v140, v108
    v_mul_f32 v157, v157, v104
    v_fmac_f32 v157, v141, v108
    v_mul_f32 v158, v158, v104
    v_fmac_f32 v158, v142, v108
    v_mul_f32 v159, v159, v104
    v_fmac_f32 v159, v143, v108
    v_cvt_pk_bf16_f32 v122, v156, v157
    v_cvt_pk_bf16_f32 v123, v158, v159
    buffer_store_dwordx4 v[120:123], v7, s[8:11], s67 offen offset:1024 sc1
    s_nop 0
    s_waitcnt lgkmcnt(8)
    s_add_u32 s67, s64, 177152
    v_mul_f32 v176, v176, v105
    v_fmac_f32 v176, v160, v109
    v_mul_f32 v177, v177, v105
    v_fmac_f32 v177, v161, v109
    v_mul_f32 v178, v178, v105
    v_fmac_f32 v178, v162, v109
    v_mul_f32 v179, v179, v105
    v_fmac_f32 v179, v163, v109
    v_cvt_pk_bf16_f32 v116, v176, v177
    v_cvt_pk_bf16_f32 v117, v178, v179
    v_mul_f32 v180, v180, v105
    v_fmac_f32 v180, v164, v109
    v_mul_f32 v181, v181, v105
    v_fmac_f32 v181, v165, v109
    v_mul_f32 v182, v182, v105
    v_fmac_f32 v182, v166, v109
    v_mul_f32 v183, v183, v105
    v_fmac_f32 v183, v167, v109
    v_cvt_pk_bf16_f32 v118, v180, v181
    v_cvt_pk_bf16_f32 v119, v182, v183
    buffer_store_dwordx4 v[116:119], v7, s[8:11], s67 offen offset:0 sc1
    s_nop 0
    v_mul_f32 v184, v184, v105
    v_fmac_f32 v184, v168, v109
    v_mul_f32 v185, v185, v105
    v_fmac_f32 v185, v169, v109
    v_mul_f32 v186, v186, v105
    v_fmac_f32 v186, v170, v109
    v_mul_f32 v187, v187, v105
    v_fmac_f32 v187, v171, v109
    v_cvt_pk_bf16_f32 v120, v184, v185
    v_cvt_pk_bf16_f32 v121, v186, v187
    v_mul_f32 v188, v188, v105
    v_fmac_f32 v188, v172, v109
    v_mul_f32 v189, v189, v105
    v_fmac_f32 v189, v173, v109
    v_mul_f32 v190, v190, v105
    v_fmac_f32 v190, v174, v109
    v_mul_f32 v191, v191, v105
    v_fmac_f32 v191, v175, v109
    v_cvt_pk_bf16_f32 v122, v188, v189
    v_cvt_pk_bf16_f32 v123, v190, v191
    buffer_store_dwordx4 v[120:123], v7, s[8:11], s67 offen offset:1024 sc1
    s_nop 0
    s_waitcnt lgkmcnt(4)
    s_add_u32 s67, s64, 352256
    v_mul_f32 v208, v208, v106
    v_fmac_f32 v208, v192, v110
    v_mul_f32 v209, v209, v106
    v_fmac_f32 v209, v193, v110
    v_mul_f32 v210, v210, v106
    v_fmac_f32 v210, v194, v110
    v_mul_f32 v211, v211, v106
    v_fmac_f32 v211, v195, v110
    v_cvt_pk_bf16_f32 v116, v208, v209
    v_cvt_pk_bf16_f32 v117, v210, v211
    v_mul_f32 v212, v212, v106
    v_fmac_f32 v212, v196, v110
    v_mul_f32 v213, v213, v106
    v_fmac_f32 v213, v197, v110
    v_mul_f32 v214, v214, v106
    v_fmac_f32 v214, v198, v110
    v_mul_f32 v215, v215, v106
    v_fmac_f32 v215, v199, v110
    v_cvt_pk_bf16_f32 v118, v212, v213
    v_cvt_pk_bf16_f32 v119, v214, v215
    buffer_store_dwordx4 v[116:119], v7, s[8:11], s67 offen offset:0 sc1
    s_nop 0
    v_mul_f32 v216, v216, v106
    v_fmac_f32 v216, v200, v110
    v_mul_f32 v217, v217, v106
    v_fmac_f32 v217, v201, v110
    v_mul_f32 v218, v218, v106
    v_fmac_f32 v218, v202, v110
    v_mul_f32 v219, v219, v106
    v_fmac_f32 v219, v203, v110
    v_cvt_pk_bf16_f32 v120, v216, v217
    v_cvt_pk_bf16_f32 v121, v218, v219
    v_mul_f32 v220, v220, v106
    v_fmac_f32 v220, v204, v110
    v_mul_f32 v221, v221, v106
    v_fmac_f32 v221, v205, v110
    v_mul_f32 v222, v222, v106
    v_fmac_f32 v222, v206, v110
    v_mul_f32 v223, v223, v106
    v_fmac_f32 v223, v207, v110
    v_cvt_pk_bf16_f32 v122, v220, v221
    v_cvt_pk_bf16_f32 v123, v222, v223
    buffer_store_dwordx4 v[120:123], v7, s[8:11], s67 offen offset:1024 sc1
    s_nop 0
    s_waitcnt lgkmcnt(0)
    s_add_u32 s67, s64, 527360
    v_mul_f32 v240, v240, v107
    v_fmac_f32 v240, v224, v111
    v_mul_f32 v241, v241, v107
    v_fmac_f32 v241, v225, v111
    v_mul_f32 v242, v242, v107
    v_fmac_f32 v242, v226, v111
    v_mul_f32 v243, v243, v107
    v_fmac_f32 v243, v227, v111
    v_cvt_pk_bf16_f32 v116, v240, v241
    v_cvt_pk_bf16_f32 v117, v242, v243
    v_mul_f32 v244, v244, v107
    v_fmac_f32 v244, v228, v111
    v_mul_f32 v245, v245, v107
    v_fmac_f32 v245, v229, v111
    v_mul_f32 v246, v246, v107
    v_fmac_f32 v246, v230, v111
    v_mul_f32 v247, v247, v107
    v_fmac_f32 v247, v231, v111
    v_cvt_pk_bf16_f32 v118, v244, v245
    v_cvt_pk_bf16_f32 v119, v246, v247
    buffer_store_dwordx4 v[116:119], v7, s[8:11], s67 offen offset:0 sc1
    s_nop 0
    v_mul_f32 v248, v248, v107
    v_fmac_f32 v248, v232, v111
    v_mul_f32 v249, v249, v107
    v_fmac_f32 v249, v233, v111
    v_mul_f32 v250, v250, v107
    v_fmac_f32 v250, v234, v111
    v_mul_f32 v251, v251, v107
    v_fmac_f32 v251, v235, v111
    v_cvt_pk_bf16_f32 v120, v248, v249
    v_cvt_pk_bf16_f32 v121, v250, v251
    v_mul_f32 v252, v252, v107
    v_fmac_f32 v252, v236, v111
    v_mul_f32 v253, v253, v107
    v_fmac_f32 v253, v237, v111
    v_mul_f32 v254, v254, v107
    v_fmac_f32 v254, v238, v111
    v_mul_f32 v255, v255, v107
    v_fmac_f32 v255, v239, v111
    v_cvt_pk_bf16_f32 v122, v252, v253
    v_cvt_pk_bf16_f32 v123, v254, v255
    buffer_store_dwordx4 v[120:123], v7, s[8:11], s67 offen offset:1024 sc1
    s_nop 0
k2_done:
    buffer_load_dwordx4 a[16:19], v16, s[8:11], s55 offen sc1
    buffer_load_dwordx4 a[20:23], v17, s[8:11], s55 offen sc1
    s_add_u32 m0, s53, 98304
    s_add_u32 s55, s55, 1024
    buffer_load_dwordx4 v18, s[12:15], s54 offen lds
    buffer_load_dwordx4 v19, s[12:15], s54 offen offset:1024 lds
    s_add_u32 s54, s54, 32768
    buffer_load_dwordx4 a[24:27], v16, s[8:11], s55 offen sc1
    buffer_load_dwordx4 a[28:31], v17, s[8:11], s55 offen sc1
    s_add_u32 m0, s53, 106496
    s_add_u32 s55, s55, 1024
    buffer_load_dwordx4 v18, s[12:15], s54 offen lds
    buffer_load_dwordx4 v19, s[12:15], s54 offen offset:1024 lds
    s_add_u32 s54, s54, 32768
    buffer_load_dwordx4 a[32:35], v16, s[8:11], s55 offen sc1
    buffer_load_dwordx4 a[36:39], v17, s[8:11], s55 offen sc1
    s_add_u32 m0, s53, 114688
    s_add_u32 s55, s55, 1024
    buffer_load_dwordx4 v18, s[12:15], s54 offen lds
    buffer_load_dwordx4 v19, s[12:15], s54 offen offset:1024 lds
    s_add_u32 s54, s54, 32768
    buffer_load_dwordx4 a[40:43], v16, s[8:11], s55 offen sc1
    buffer_load_dwordx4 a[44:47], v17, s[8:11], s55 offen sc1
    s_add_u32 m0, s53, 122880
    s_add_u32 s55, s55, 1024
    buffer_load_dwordx4 v18, s[12:15], s54 offen lds
    buffer_load_dwordx4 v19, s[12:15], s54 offen offset:1024 lds
    s_add_u32 s54, s54, 32768
    buffer_load_dword v39, off, s[8:11], s57 sc1
    s_waitcnt vmcnt(13) lgkmcnt(0)
    buffer_store_dword v10, v0, s[8:11], s48 offen sc1
    ds_add_u32 v9, v10
    ds_read_b32 v11, v9
    s_waitcnt lgkmcnt(0)
    v_cmp_gt_u32 vcc, s45, v11
    s_nop 0
    s_cbranch_vccnz k2_st_109
k2_bk_110:
    ds_read_b64_tr_b16 v[192:193], v28 offset:16384
    ds_read_b64_tr_b16 v[194:195], v28 offset:20480
    ds_read_b64_tr_b16 v[196:197], v29 offset:16384
    ds_read_b64_tr_b16 v[198:199], v29 offset:20480
    ds_read_b64_tr_b16 v[200:201], v30 offset:16384
    ds_read_b64_tr_b16 v[202:203], v30 offset:20480
    ds_read_b64_tr_b16 v[204:205], v31 offset:16384
    ds_read_b64_tr_b16 v[206:207], v31 offset:20480
    ds_read_b64_tr_b16 v[208:209], v32 offset:16384
    ds_read_b64_tr_b16 v[210:211], v32 offset:20480
    ds_read_b64_tr_b16 v[212:213], v33 offset:16384
    ds_read_b64_tr_b16 v[214:215], v33 offset:20480
    ds_read_b64_tr_b16 v[216:217], v34 offset:16384
    ds_read_b64_tr_b16 v[218:219], v34 offset:20480
    ds_read_b64_tr_b16 v[220:221], v35 offset:16384
    ds_read_b64_tr_b16 v[222:223], v35 offset:20480
    buffer_load_dwordx4 a[48:51], v16, s[8:11], s55 offen sc1
    buffer_load_dwordx4 a[52:55], v17, s[8:11], s55 offen sc1
    s_add_u32 m0, s53, 0
    s_add_u32 s55, s55, 1024
    buffer_load_dwordx4 v18, s[12:15], s54 offen lds
    buffer_load_dwordx4 v19, s[12:15], s54 offen offset:1024 lds
    s_add_u32 s54, s54, 32768
    s_waitcnt vmcnt(14) lgkmcnt(12)
    ds_add_u32 v45, v10 offset:0
    v_mfma_f32_16x16x32_bf16 v[64:67], v[192:195], a[0:3], 0
    v_mfma_f32_16x16x32_bf16 v[68:71], v[192:195], a[4:7], 0
    buffer_load_dwordx4 a[56:59], v16, s[8:11], s55 offen sc1
    ds_read_b64_tr_b16 v[192:193], v28 offset:24576
    v_mfma_f32_16x16x32_bf16 v[72:75], v[196:199], a[0:3], 0
    ds_read_b64_tr_b16 v[194:195], v28 offset:28672
    v_mfma_f32_16x16x32_bf16 v[76:79], v[196:199], a[4:7], 0
    s_waitcnt lgkmcnt(11)
    ds_read_b64_tr_b16 v[196:197], v29 offset:24576
    v_mfma_f32_16x16x32_bf16 v[80:83], v[200:203], a[0:3], 0
    ds_read_b64_tr_b16 v[198:199], v29 offset:28672
    v_mfma_f32_16x16x32_bf16 v[84:87], v[200:203], a[4:7], 0
    buffer_load_dwordx4 a[60:63], v17, s[8:11], s55 offen sc1
    ds_read_b64_tr_b16 v[200:201], v30 offset:24576
    v_mfma_f32_16x16x32_bf16 v[88:91], v[204:207], a[0:3], 0
    ds_read_b64_tr_b16 v[202:203], v30 offset:28672
    s_add_u32 m0, s53, 8192
    v_mfma_f32_16x16x32_bf16 v[92:95], v[204:207], a[4:7], 0
    s_waitcnt lgkmcnt(11)
    ds_read_b64_tr_b16 v[204:205], v31 offset:24576
    v_mfma_f32_16x16x32_bf16 v[96:99], v[208:211], a[0:3], 0
    s_add_u32 s55, s55, 1024
    ds_read_b64_tr_b16 v[206:207], v31 offset:28672
    v_mfma_f32_16x16x32_bf16 v[100:103], v[208:211], a[4:7], 0
    buffer_load_dwordx4 v18, s[12:15], s54 offen lds
    ds_read_b64_tr_b16 v[208:209], v32 offset:24576
    v_mfma_f32_16x16x32_bf16 v[104:107], v[212:215], a[0:3], 0
    ds_read_b64_tr_b16 v[210:211], v32 offset:28672
    v_mfma_f32_16x16x32_bf16 v[108:111], v[212:215], a[4:7], 0
    s_waitcnt lgkmcnt(11)
    ds_read_b64_tr_b16 v[212:213], v33 offset:24576
    v_mfma_f32_16x16x32_bf16 v[112:115], v[216:219], a[0:3], 0
    ds_read_b64_tr_b16 v[214:215], v33 offset:28672
    v_mfma_f32_16x16x32_bf16 v[116:119], v[216:219], a[4:7], 0
    buffer_load_dwordx4 v19, s[12:15], s54 offen offset:1024 lds
    ds_read_b64_tr_b16 v[216:217], v34 offset:24576
    v_mfma_f32_16x16x32_bf16 v[120:123], v[220:223], a[0:3], 0
    ds_read_b64_tr_b16 v[218:219], v34 offset:28672
    s_add_u32 s54, s54, 32768
    v_mfma_f32_16x16x32_bf16 v[124:127], v[220:223], a[4:7], 0
    ds_read_b64_tr_b16 v[220:221], v35 offset:24576
    ds_read_b64_tr_b16 v[222:223], v35 offset:28672
    s_waitcnt vmcnt(14) lgkmcnt(12)
    ds_add_u32 v45, v10 offset:256
    v_mfma_f32_16x16x32_bf16 v[64:67], v[192:195], a[8:11], v[64:67]
    ds_read_b32 v11, v45 offset:0
    v_mfma_f32_16x16x32_bf16 v[68:71], v[192:195], a[12:15], v[68:71]
    buffer_load_dwordx4 a[0:3], v16, s[8:11], s55 offen sc1
    ds_read_b64_tr_b16 v[192:193], v28 offset:32768
    v_mfma_f32_16x16x32_bf16 v[72:75], v[196:199], a[8:11], v[72:75]
    ds_read_b64_tr_b16 v[194:195], v28 offset:36864
    v_mfma_f32_16x16x32_bf16 v[76:79], v[196:199], a[12:15], v[76:79]
    s_waitcnt lgkmcnt(12)
    ds_read_b64_tr_b16 v[196:197], v29 offset:32768
    v_mfma_f32_16x16x32_bf16 v[80:83], v[200:203], a[8:11], v[80:83]
    ds_read_b64_tr_b16 v[198:199], v29 offset:36864
    v_mfma_f32_16x16x32_bf16 v[84:87], v[200:203], a[12:15], v[84:87]
    buffer_load_dwordx4 a[4:7], v17, s[8:11], s55 offen sc1
    ds_read_b64_tr_b16 v[200:201], v30 offset:32768
    v_mfma_f32_16x16x32_bf16 v[88:91], v[204:207], a[8:11], v[88:91]
    ds_read_b64_tr_b16 v[202:203], v30 offset:36864
    s_add_u32 m0, s53, 16384
    v_mfma_f32_16x16x32_bf16 v[92:95], v[204:207], a[12:15], v[92:95]
    s_waitcnt lgkmcnt(12)
    ds_read_b64_tr_b16 v[204:205], v31 offset:32768
    v_mfma_f32_16x16x32_bf16 v[96:99], v[208:211], a[8:11], v[96:99]
    s_add_u32 s55, s55, 1024
    ds_read_b64_tr_b16 v[206:207], v31 offset:36864
    v_mfma_f32_16x16x32_bf16 v[100:103], v[208:211], a[12:15], v[100:103]
    buffer_load_dwordx4 v18, s[12:15], s54 offen lds
    ds_read_b64_tr_b16 v[208:209], v32 offset:32768
    v_mfma_f32_16x16x32_bf16 v[104:107], v[212:215], a[8:11], v[104:107]
    ds_read_b64_tr_b16 v[210:211], v32 offset:36864
    v_mfma_f32_16x16x32_bf16 v[108:111], v[212:215], a[12:15], v[108:111]
    s_waitcnt lgkmcnt(10)
    ds_read_b64_tr_b16 v[212:213], v33 offset:32768
    v_mfma_f32_16x16x32_bf16 v[112:115], v[216:219], a[8:11], v[112:115]
    ds_read_b64_tr_b16 v[214:215], v33 offset:36864
    v_cmp_gt_u32 vcc, 4, v11
    v_mfma_f32_16x16x32_bf16 v[116:119], v[216:219], a[12:15], v[116:119]
    buffer_load_dwordx4 v19, s[12:15], s54 offen offset:1024 lds
    ds_read_b64_tr_b16 v[216:217], v34 offset:32768
    v_mfma_f32_16x16x32_bf16 v[120:123], v[220:223], a[8:11], v[120:123]
    ds_read_b64_tr_b16 v[218:219], v34 offset:36864
    s_cbranch_vccnz k2_st_111
k2_bk_112:
    v_mfma_f32_16x16x32_bf16 v[124:127], v[220:223], a[12:15], v[124:127]
    ds_read_b64_tr_b16 v[220:221], v35 offset:32768
    ds_read_b64_tr_b16 v[222:223], v35 offset:36864
    s_add_u32 s54, s54, 32768
    s_waitcnt vmcnt(14) lgkmcnt(12)
    ds_add_u32 v45, v10 offset:512
    v_mfma_f32_16x16x32_bf16 v[64:67], v[192:195], a[16:19], v[64:67]
    ds_read_b32 v11, v45 offset:256
    v_mfma_f32_16x16x32_bf16 v[68:71], v[192:195], a[20:23], v[68:71]
    buffer_load_dwordx4 a[8:11], v16, s[8:11], s55 offen sc1
    ds_read_b64_tr_b16 v[192:193], v28 offset:40960
    v_mfma_f32_16x16x32_bf16 v[72:75], v[196:199], a[16:19], v[72:75]
    ds_read_b64_tr_b16 v[194:195], v28 offset:45056
    v_mfma_f32_16x16x32_bf16 v[76:79], v[196:199], a[20:23], v[76:79]
    s_waitcnt lgkmcnt(12)
    ds_read_b64_tr_b16 v[196:197], v29 offset:40960
    v_mfma_f32_16x16x32_bf16 v[80:83], v[200:203], a[16:19], v[80:83]
    ds_read_b64_tr_b16 v[198:199], v29 offset:45056
    v_mfma_f32_16x16x32_bf16 v[84:87], v[200:203], a[20:23], v[84:87]
    buffer_load_dwordx4 a[12:15], v17, s[8:11], s55 offen sc1
    ds_read_b64_tr_b16 v[200:201], v30 offset:40960
    v_mfma_f32_16x16x32_bf16 v[88:91], v[204:207], a[16:19], v[88:91]
    ds_read_b64_tr_b16 v[202:203], v30 offset:45056
    s_add_u32 m0, s53, 24576
    v_mfma_f32_16x16x32_bf16 v[92:95], v[204:207], a[20:23], v[92:95]
    s_waitcnt lgkmcnt(12)
    ds_read_b64_tr_b16 v[204:205], v31 offset:40960
    v_mfma_f32_16x16x32_bf16 v[96:99], v[208:211], a[16:19], v[96:99]
    s_add_u32 s55, s55, 1024
    ds_read_b64_tr_b16 v[206:207], v31 offset:45056
    v_mfma_f32_16x16x32_bf16 v[100:103], v[208:211], a[20:23], v[100:103]
    buffer_load_dwordx4 v18, s[12:15], s54 offen lds
    ds_read_b64_tr_b16 v[208:209], v32 offset:40960
    v_mfma_f32_16x16x32_bf16 v[104:107], v[212:215], a[16:19], v[104:107]
    ds_read_b64_tr_b16 v[210:211], v32 offset:45056
    v_mfma_f32_16x16x32_bf16 v[108:111], v[212:215], a[20:23], v[108:111]
    s_waitcnt lgkmcnt(10)
    ds_read_b64_tr_b16 v[212:213], v33 offset:40960
    v_mfma_f32_16x16x32_bf16 v[112:115], v[216:219], a[16:19], v[112:115]
    ds_read_b64_tr_b16 v[214:215], v33 offset:45056
    v_cmp_gt_u32 vcc, 4, v11
    v_mfma_f32_16x16x32_bf16 v[116:119], v[216:219], a[20:23], v[116:119]
    buffer_load_dwordx4 v19, s[12:15], s54 offen offset:1024 lds
    ds_read_b64_tr_b16 v[216:217], v34 offset:40960
    v_mfma_f32_16x16x32_bf16 v[120:123], v[220:223], a[16:19], v[120:123]
    ds_read_b64_tr_b16 v[218:219], v34 offset:45056
    s_cbranch_vccnz k2_st_113
k2_bk_114:
    v_mfma_f32_16x16x32_bf16 v[124:127], v[220:223], a[20:23], v[124:127]
    ds_read_b64_tr_b16 v[220:221], v35 offset:40960
    ds_read_b64_tr_b16 v[222:223], v35 offset:45056
    s_add_u32 s54, s54, 32768
    s_waitcnt vmcnt(12) lgkmcnt(12)
    ds_add_u32 v45, v10 offset:0
    v_mfma_f32_16x16x32_bf16 v[64:67], v[192:195], a[24:27], v[64:67]
    ds_read_b32 v11, v45 offset:512
    buffer_load_dword v37, v36, s[8:11], s39 offen sc1
    s_cmp_eq_u32 s5, 3
    s_cselect_b32 s55, 0x7f000000, s55
    v_mfma_f32_16x16x32_bf16 v[68:71], v[192:195], a[28:31], v[68:71]
    buffer_load_dwordx4 a[16:19], v16, s[8:11], s55 offen sc1
    ds_read_b64_tr_b16 v[192:193], v28 offset:49152
    v_mfma_f32_16x16x32_bf16 v[72:75], v[196:199], a[24:27], v[72:75]
    ds_read_b64_tr_b16 v[194:195], v28 offset:53248
    v_mfma_f32_16x16x32_bf16 v[76:79], v[196:199], a[28:31], v[76:79]
    s_waitcnt lgkmcnt(12)
    ds_read_b64_tr_b16 v[196:197], v29 offset:49152
    v_mfma_f32_16x16x32_bf16 v[80:83], v[200:203], a[24:27], v[80:83]
    ds_read_b64_tr_b16 v[198:199], v29 offset:53248
    v_mfma_f32_16x16x32_bf16 v[84:87], v[200:203], a[28:31], v[84:87]
    buffer_load_dwordx4 a[20:23], v17, s[8:11], s55 offen sc1
    ds_read_b64_tr_b16 v[200:201], v30 offset:49152
    v_mfma_f32_16x16x32_bf16 v[88:91], v[204:207], a[24:27], v[88:91]
    ds_read_b64_tr_b16 v[202:203], v30 offset:53248
    s_add_u32 m0, s53, 32768
    v_mfma_f32_16x16x32_bf16 v[92:95], v[204:207], a[28:31], v[92:95]
    s_waitcnt lgkmcnt(12)
    ds_read_b64_tr_b16 v[204:205], v31 offset:49152
    v_mfma_f32_16x16x32_bf16 v[96:99], v[208:211], a[24:27], v[96:99]
    s_add_u32 s55, s55, 1024
    ds_read_b64_tr_b16 v[206:207], v31 offset:53248
    v_mfma_f32_16x16x32_bf16 v[100:103], v[208:211], a[28:31], v[100:103]
    buffer_load_dwordx4 v18, s[12:15], s54 offen lds
    ds_read_b64_tr_b16 v[208:209], v32 offset:49152
    v_mfma_f32_16x16x32_bf16 v[104:107], v[212:215], a[24:27], v[104:107]
    ds_read_b64_tr_b16 v[210:211], v32 offset:53248
    v_mfma_f32_16x16x32_bf16 v[108:111], v[212:215], a[28:31], v[108:111]
    s_waitcnt lgkmcnt(10)
    ds_read_b64_tr_b16 v[212:213], v33 offset:49152
    v_mfma_f32_16x16x32_bf16 v[112:115], v[216:219], a[24:27], v[112:115]
    ds_read_b64_tr_b16 v[214:215], v33 offset:53248
    v_cmp_gt_u32 vcc, 4, v11
    v_mfma_f32_16x16x32_bf16 v[116:119], v[216:219], a[28:31], v[116:119]
    buffer_load_dwordx4 v19, s[12:15], s54 offen offset:1024 lds
    ds_read_b64_tr_b16 v[216:217], v34 offset:49152
    v_mfma_f32_16x16x32_bf16 v[120:123], v[220:223], a[24:27], v[120:123]
    ds_read_b64_tr_b16 v[218:219], v34 offset:53248
    s_cbranch_vccnz k2_st_115
k2_bk_116:
    v_mfma_f32_16x16x32_bf16 v[124:127], v[220:223], a[28:31], v[124:127]
    ds_read_b64_tr_b16 v[220:221], v35 offset:49152
    ds_read_b64_tr_b16 v[222:223], v35 offset:53248
    s_add_u32 s54, s54, 32768
    s_waitcnt vmcnt(13) lgkmcnt(12)
    ds_add_u32 v45, v10 offset:256
    v_mfma_f32_16x16x32_bf16 v[64:67], v[192:195], a[32:35], v[64:67]
    ds_read_b32 v11, v45 offset:0
    v_mfma_f32_16x16x32_bf16 v[68:71], v[192:195], a[36:39], v[68:71]
    ds_read_b64_tr_b16 v[192:193], v28 offset:57344
    v_mfma_f32_16x16x32_bf16 v[72:75], v[196:199], a[32:35], v[72:75]
    ds_read_b64_tr_b16 v[194:195], v28 offset:61440
    v_mfma_f32_16x16x32_bf16 v[76:79], v[196:199], a[36:39], v[76:79]
    s_waitcnt lgkmcnt(12)
    ds_read_b64_tr_b16 v[196:197], v29 offset:57344
    v_mfma_f32_16x16x32_bf16 v[80:83], v[200:203], a[32:35], v[80:83]
    ds_read_b64_tr_b16 v[198:199], v29 offset:61440
    v_mfma_f32_16x16x32_bf16 v[84:87], v[200:203], a[36:39], v[84:87]
    ds_read_b64_tr_b16 v[200:201], v30 offset:57344
    v_mfma_f32_16x16x32_bf16 v[88:91], v[204:207], a[32:35], v[88:91]
    ds_read_b64_tr_b16 v[202:203], v30 offset:61440
    v_mfma_f32_16x16x32_bf16 v[92:95], v[204:207], a[36:39], v[92:95]
    s_waitcnt lgkmcnt(12)
    ds_read_b64_tr_b16 v[204:205], v31 offset:57344
    v_mfma_f32_16x16x32_bf16 v[96:99], v[208:211], a[32:35], v[96:99]
    ds_read_b64_tr_b16 v[206:207], v31 offset:61440
    v_mfma_f32_16x16x32_bf16 v[100:103], v[208:211], a[36:39], v[100:103]
    ds_read_b64_tr_b16 v[208:209], v32 offset:57344
    v_mfma_f32_16x16x32_bf16 v[104:107], v[212:215], a[32:35], v[104:107]
    ds_read_b64_tr_b16 v[210:211], v32 offset:61440
    v_mfma_f32_16x16x32_bf16 v[108:111], v[212:215], a[36:39], v[108:111]
    s_waitcnt lgkmcnt(10)
    ds_read_b64_tr_b16 v[212:213], v33 offset:57344
    v_mfma_f32_16x16x32_bf16 v[112:115], v[216:219], a[32:35], v[112:115]
    ds_read_b64_tr_b16 v[214:215], v33 offset:61440
    v_cmp_gt_u32 vcc, 8, v11
    v_mfma_f32_16x16x32_bf16 v[116:119], v[216:219], a[36:39], v[116:119]
    ds_read_b64_tr_b16 v[216:217], v34 offset:57344
    s_cbranch_vccnz k2_st_117
k2_bk_118:
    v_mfma_f32_16x16x32_bf16 v[120:123], v[220:223], a[32:35], v[120:123]
    ds_read_b64_tr_b16 v[218:219], v34 offset:61440
    v_mfma_f32_16x16x32_bf16 v[124:127], v[220:223], a[36:39], v[124:127]
    ds_read_b64_tr_b16 v[220:221], v35 offset:57344
    ds_read_b64_tr_b16 v[222:223], v35 offset:61440
    s_waitcnt vmcnt(9) lgkmcnt(12)
    ds_add_u32 v45, v10 offset:512
    v_mfma_f32_16x16x32_bf16 v[64:67], v[192:195], a[40:43], v[64:67]
    ds_read_b32 v11, v45 offset:256
    buffer_load_dword v37, v36, s[8:11], s39 offen sc1
    v_mfma_f32_16x16x32_bf16 v[68:71], v[192:195], a[44:47], v[68:71]
    ds_read_b64_tr_b16 v[192:193], v20 offset:0
    v_mfma_f32_16x16x32_bf16 v[72:75], v[196:199], a[40:43], v[72:75]
    ds_read_b64_tr_b16 v[194:195], v20 offset:4096
    v_mfma_f32_16x16x32_bf16 v[76:79], v[196:199], a[44:47], v[76:79]
    s_waitcnt lgkmcnt(12)
    ds_read_b64_tr_b16 v[196:197], v21 offset:0
    v_mfma_f32_16x16x32_bf16 v[80:83], v[200:203], a[40:43], v[80:83]
    ds_read_b64_tr_b16 v[198:199], v21 offset:4096
    v_mfma_f32_16x16x32_bf16 v[84:87], v[200:203], a[44:47], v[84:87]
    ds_read_b64_tr_b16 v[200:201], v22 offset:0
    v_mfma_f32_16x16x32_bf16 v[88:91], v[204:207], a[40:43], v[88:91]
    ds_read_b64_tr_b16 v[202:203], v22 offset:4096
    v_mfma_f32_16x16x32_bf16 v[92:95], v[204:207], a[44:47], v[92:95]
    s_waitcnt lgkmcnt(12)
    ds_read_b64_tr_b16 v[204:205], v23 offset:0
    v_mfma_f32_16x16x32_bf16 v[96:99], v[208:211], a[40:43], v[96:99]
    ds_read_b64_tr_b16 v[206:207], v23 offset:4096
    v_mfma_f32_16x16x32_bf16 v[100:103], v[208:211], a[44:47], v[100:103]
    ds_read_b64_tr_b16 v[208:209], v24 offset:0
    v_mfma_f32_16x16x32_bf16 v[104:107], v[212:215], a[40:43], v[104:107]
    ds_read_b64_tr_b16 v[210:211], v24 offset:4096
    v_mfma_f32_16x16x32_bf16 v[108:111], v[212:215], a[44:47], v[108:111]
    s_waitcnt lgkmcnt(10)
    ds_read_b64_tr_b16 v[212:213], v25 offset:0
    v_mfma_f32_16x16x32_bf16 v[112:115], v[216:219], a[40:43], v[112:115]
    ds_read_b64_tr_b16 v[214:215], v25 offset:4096
    v_cmp_gt_u32 vcc, 8, v11
    v_mfma_f32_16x16x32_bf16 v[116:119], v[216:219], a[44:47], v[116:119]
    ds_read_b64_tr_b16 v[216:217], v26 offset:0
    s_cbranch_vccnz k2_st_119
k2_bk_120:
    v_mfma_f32_16x16x32_bf16 v[120:123], v[220:223], a[40:43], v[120:123]
    ds_read_b64_tr_b16 v[218:219], v26 offset:4096
    v_mfma_f32_16x16x32_bf16 v[124:127], v[220:223], a[44:47], v[124:127]
    ds_read_b64_tr_b16 v[220:221], v27 offset:0
    ds_read_b64_tr_b16 v[222:223], v27 offset:4096
    s_waitcnt vmcnt(0) lgkmcnt(12)
    v_cmp_eq_u32 vcc, 0, v37
    s_nop 1
    s_and_b32 s63, vcc_lo, 0xf
    s_cbranch_scc1 mg_ps_123
mg_pb_124:
    v_mfma_f32_16x16x32_bf16 v[64:67], v[192:195], a[48:51], v[64:67]
    ds_add_u32 v45, v10 offset:0
    ds_read_b32 v11, v45 offset:512
    s_mov_b32 s55, s51
    s_mov_b32 s54, s50
    s_mov_b32 s12, s28
    s_mov_b32 s13, s29
    s_mov_b32 s14, s30
    buffer_load_dwordx4 a[24:27], v16, s[8:11], s55 offen sc1
    v_mfma_f32_16x16x32_bf16 v[68:71], v[192:195], a[52:55], v[68:71]
    ds_read_b64_tr_b16 v[192:193], v20 offset:8192
    v_mfma_f32_16x16x32_bf16 v[72:75], v[196:199], a[48:51], v[72:75]
    buffer_load_dwordx4 a[28:31], v17, s[8:11], s55 offen sc1
    s_add_u32 m0, s53, 40960
    v_mfma_f32_16x16x32_bf16 v[76:79], v[196:199], a[52:55], v[76:79]
    ds_read_b64_tr_b16 v[194:195], v20 offset:12288
    s_waitcnt lgkmcnt(12)
    s_add_u32 s55, s55, 1024
    v_mfma_f32_16x16x32_bf16 v[80:83], v[200:203], a[48:51], v[80:83]
    ds_read_b64_tr_b16 v[196:197], v21 offset:8192
    buffer_load_dwordx4 v18, s[12:15], s54 offen lds
    v_mfma_f32_16x16x32_bf16 v[84:87], v[200:203], a[52:55], v[84:87]
    ds_read_b64_tr_b16 v[198:199], v21 offset:12288
    v_mfma_f32_16x16x32_bf16 v[88:91], v[204:207], a[48:51], v[88:91]
    ds_read_b64_tr_b16 v[200:201], v22 offset:8192
    buffer_load_dwordx4 v19, s[12:15], s54 offen offset:1024 lds
    v_mfma_f32_16x16x32_bf16 v[92:95], v[204:207], a[52:55], v[92:95]
    ds_read_b64_tr_b16 v[202:203], v22 offset:12288
    s_waitcnt lgkmcnt(12)
    s_add_u32 s54, s54, 32768
    v_mfma_f32_16x16x32_bf16 v[96:99], v[208:211], a[48:51], v[96:99]
    ds_read_b64_tr_b16 v[204:205], v23 offset:8192
    buffer_load_dwordx4 a[32:35], v16, s[8:11], s55 offen sc1
    v_mfma_f32_16x16x32_bf16 v[100:103], v[208:211], a[52:55], v[100:103]
    ds_read_b64_tr_b16 v[206:207], v23 offset:12288
    v_mfma_f32_16x16x32_bf16 v[104:107], v[212:215], a[48:51], v[104:107]
    ds_read_b64_tr_b16 v[208:209], v24 offset:8192
    buffer_load_dwordx4 a[36:39], v17, s[8:11], s55 offen sc1
    s_add_u32 m0, s53, 49152
    v_mfma_f32_16x16x32_bf16 v[108:111], v[212:215], a[52:55], v[108:111]
    ds_read_b64_tr_b16 v[210:211], v24 offset:12288
    s_waitcnt lgkmcnt(10)
    s_add_u32 s55, s55, 1024
    v_mfma_f32_16x16x32_bf16 v[112:115], v[216:219], a[48:51], v[112:115]
    ds_read_b64_tr_b16 v[212:213], v25 offset:8192
    buffer_load_dwordx4 v18, s[12:15], s54 offen lds
    v_mfma_f32_16x16x32_bf16 v[116:119], v[216:219], a[52:55], v[116:119]
    ds_read_b64_tr_b16 v[214:215], v25 offset:12288
    v_cmp_gt_u32 vcc, 8, v11
    v_mfma_f32_16x16x32_bf16 v[120:123], v[220:223], a[48:51], v[120:123]
    ds_read_b64_tr_b16 v[216:217], v26 offset:8192
    buffer_load_dwordx4 v19, s[12:15], s54 offen offset:1024 lds
    v_mfma_f32_16x16x32_bf16 v[124:127], v[220:223], a[52:55], v[124:127]
    ds_read_b64_tr_b16 v[218:219], v26 offset:12288
    ds_read_b64_tr_b16 v[220:221], v27 offset:8192
    ds_read_b64_tr_b16 v[222:223], v27 offset:12288
    s_cbranch_vccnz k2_st_121
k2_bk_122:
    s_add_u32 s54, s54, 32768
    s_waitcnt vmcnt(9) lgkmcnt(12)
    ds_add_u32 v45, v10 offset:256
    v_mfma_f32_16x16x32_bf16 v[64:67], v[192:195], a[56:59], v[64:67]
    ds_read_b32 v11, v45 offset:0
    buffer_load_dwordx4 a[40:43], v16, s[8:11], s55 offen sc1
    v_mfma_f32_16x16x32_bf16 v[68:71], v[192:195], a[60:63], v[68:71]
    ds_read_b64_tr_b16 v[192:193], v20 offset:16384
    v_mfma_f32_16x16x32_bf16 v[72:75], v[196:199], a[56:59], v[72:75]
    buffer_load_dwordx4 a[44:47], v17, s[8:11], s55 offen sc1
    s_add_u32 m0, s53, 57344
    v_mfma_f32_16x16x32_bf16 v[76:79], v[196:199], a[60:63], v[76:79]
    ds_read_b64_tr_b16 v[194:195], v20 offset:20480
    s_waitcnt lgkmcnt(12)
    s_add_u32 s55, s55, 1024
    v_mfma_f32_16x16x32_bf16 v[80:83], v[200:203], a[56:59], v[80:83]
    ds_read_b64_tr_b16 v[196:197], v21 offset:16384
    buffer_load_dwordx4 v18, s[12:15], s54 offen lds
    v_mfma_f32_16x16x32_bf16 v[84:87], v[200:203], a[60:63], v[84:87]
    ds_read_b64_tr_b16 v[198:199], v21 offset:20480
    v_mfma_f32_16x16x32_bf16 v[88:91], v[204:207], a[56:59], v[88:91]
    ds_read_b64_tr_b16 v[200:201], v22 offset:16384
    buffer_load_dwordx4 v19, s[12:15], s54 offen offset:1024 lds
    v_mfma_f32_16x16x32_bf16 v[92:95], v[204:207], a[60:63], v[92:95]
    ds_read_b64_tr_b16 v[202:203], v22 offset:20480
    s_waitcnt lgkmcnt(12)
    s_add_u32 s54, s54, 32768
    v_mfma_f32_16x16x32_bf16 v[96:99], v[208:211], a[56:59], v[96:99]
    ds_read_b64_tr_b16 v[204:205], v23 offset:16384
    buffer_load_dwordx4 a[48:51], v16, s[8:11], s55 offen sc1
    v_mfma_f32_16x16x32_bf16 v[100:103], v[208:211], a[60:63], v[100:103]
    ds_read_b64_tr_b16 v[206:207], v23 offset:20480
    v_mfma_f32_16x16x32_bf16 v[104:107], v[212:215], a[56:59], v[104:107]
    ds_read_b64_tr_b16 v[208:209], v24 offset:16384
    buffer_load_dwordx4 a[52:55], v17, s[8:11], s55 offen sc1
    s_add_u32 m0, s53, 65536
    v_mfma_f32_16x16x32_bf16 v[108:111], v[212:215], a[60:63], v[108:111]
    ds_read_b64_tr_b16 v[210:211], v24 offset:20480
    s_waitcnt lgkmcnt(10)
    s_add_u32 s55, s55, 1024
    v_mfma_f32_16x16x32_bf16 v[112:115], v[216:219], a[56:59], v[112:115]
    ds_read_b64_tr_b16 v[212:213], v25 offset:16384
    buffer_load_dwordx4 v18, s[12:15], s54 offen lds
    v_mfma_f32_16x16x32_bf16 v[116:119], v[216:219], a[60:63], v[116:119]
    ds_read_b64_tr_b16 v[214:215], v25 offset:20480
    v_cmp_gt_u32 vcc, 12, v11
    v_mfma_f32_16x16x32_bf16 v[120:123], v[220:223], a[56:59], v[120:123]
    ds_read_b64_tr_b16 v[216:217], v26 offset:16384
    buffer_load_dwordx4 v19, s[12:15], s54 offen offset:1024 lds
    v_mfma_f32_16x16x32_bf16 v[124:127], v[220:223], a[60:63], v[124:127]
    ds_read_b64_tr_b16 v[218:219], v26 offset:20480
    ds_read_b64_tr_b16 v[220:221], v27 offset:16384
    ds_read_b64_tr_b16 v[222:223], v27 offset:20480
    s_cbranch_vccnz k2_st_125
k2_bk_126:
    s_add_u32 s54, s54, 32768
    s_waitcnt vmcnt(12) lgkmcnt(12)
    v_cmp_eq_u32 vcc, 0, v37
    s_nop 1
    s_and_b32 s63, vcc_lo, 0xf0
    s_cbranch_scc1 mg_ps_129
mg_pb_130:
    v_mfma_f32_16x16x32_bf16 v[64:67], v[192:195], a[0:3], v[64:67]
    ds_add_u32 v45, v10 offset:512
    ds_read_b32 v11, v45 offset:256
    v_mfma_f32_16x16x32_bf16 v[68:71], v[192:195], a[4:7], v[68:71]
    buffer_load_dwordx4 a[56:59], v16, s[8:11], s55 offen sc1
    ds_read_b64_tr_b16 v[192:193], v20 offset:24576
    v_mfma_f32_16x16x32_bf16 v[72:75], v[196:199], a[0:3], v[72:75]
    ds_read_b64_tr_b16 v[194:195], v20 offset:28672
    v_mfma_f32_16x16x32_bf16 v[76:79], v[196:199], a[4:7], v[76:79]
    s_waitcnt lgkmcnt(12)
    ds_read_b64_tr_b16 v[196:197], v21 offset:24576
    v_mfma_f32_16x16x32_bf16 v[80:83], v[200:203], a[0:3], v[80:83]
    ds_read_b64_tr_b16 v[198:199], v21 offset:28672
    v_mfma_f32_16x16x32_bf16 v[84:87], v[200:203], a[4:7], v[84:87]
    buffer_load_dwordx4 a[60:63], v17, s[8:11], s55 offen sc1
    ds_read_b64_tr_b16 v[200:201], v22 offset:24576
    v_mfma_f32_16x16x32_bf16 v[88:91], v[204:207], a[0:3], v[88:91]
    ds_read_b64_tr_b16 v[202:203], v22 offset:28672
    s_add_u32 m0, s53, 73728
    v_mfma_f32_16x16x32_bf16 v[92:95], v[204:207], a[4:7], v[92:95]
    s_waitcnt lgkmcnt(12)
    ds_read_b64_tr_b16 v[204:205], v23 offset:24576
    v_mfma_f32_16x16x32_bf16 v[96:99], v[208:211], a[0:3], v[96:99]
    s_add_u32 s55, s55, 1024
    ds_read_b64_tr_b16 v[206:207], v23 offset:28672
    v_mfma_f32_16x16x32_bf16 v[100:103], v[208:211], a[4:7], v[100:103]
    buffer_load_dwordx4 v18, s[12:15], s54 offen lds
    ds_read_b64_tr_b16 v[208:209], v24 offset:24576
    v_mfma_f32_16x16x32_bf16 v[104:107], v[212:215], a[0:3], v[104:107]
    ds_read_b64_tr_b16 v[210:211], v24 offset:28672
    v_mfma_f32_16x16x32_bf16 v[108:111], v[212:215], a[4:7], v[108:111]
    s_waitcnt lgkmcnt(10)
    ds_read_b64_tr_b16 v[212:213], v25 offset:24576
    v_mfma_f32_16x16x32_bf16 v[112:115], v[216:219], a[0:3], v[112:115]
    ds_read_b64_tr_b16 v[214:215], v25 offset:28672
    v_cmp_gt_u32 vcc, 12, v11
    v_mfma_f32_16x16x32_bf16 v[116:119], v[216:219], a[4:7], v[116:119]
    buffer_load_dwordx4 v19, s[12:15], s54 offen offset:1024 lds
    ds_read_b64_tr_b16 v[216:217], v26 offset:24576
    v_mfma_f32_16x16x32_bf16 v[120:123], v[220:223], a[0:3], v[120:123]
    ds_read_b64_tr_b16 v[218:219], v26 offset:28672
    s_cbranch_vccnz k2_st_127
k2_bk_128:
    v_mfma_f32_16x16x32_bf16 v[124:127], v[220:223], a[4:7], v[124:127]
    ds_read_b64_tr_b16 v[220:221], v27 offset:24576
    ds_read_b64_tr_b16 v[222:223], v27 offset:28672
    s_add_u32 s54, s54, 32768
    s_waitcnt vmcnt(12) lgkmcnt(12)
    ds_add_u32 v45, v10 offset:0
    v_mfma_f32_16x16x32_bf16 v[64:67], v[192:195], a[8:11], v[64:67]
    ds_read_b32 v11, v45 offset:512
    buffer_load_dword v37, v36, s[8:11], s39 offen sc1
    v_mfma_f32_16x16x32_bf16 v[68:71], v[192:195], a[12:15], v[68:71]
    buffer_load_dwordx4 a[0:3], v16, s[8:11], s55 offen sc1
    ds_read_b64_tr_b16 v[192:193], v20 offset:32768
    v_mfma_f32_16x16x32_bf16 v[72:75], v[196:199], a[8:11], v[72:75]
    ds_read_b64_tr_b16 v[194:195], v20 offset:36864
    v_mfma_f32_16x16x32_bf16 v[76:79], v[196:199], a[12:15], v[76:79]
    s_waitcnt lgkmcnt(12)
    ds_read_b64_tr_b16 v[196:197], v21 offset:32768
    v_mfma_f32_16x16x32_bf16 v[80:83], v[200:203], a[8:11], v[80:83]
    ds_read_b64_tr_b16 v[198:199], v21 offset:36864
    v_mfma_f32_16x16x32_bf16 v[84:87], v[200:203], a[12:15], v[84:87]
    buffer_load_dwordx4 a[4:7], v17, s[8:11], s55 offen sc1
    ds_read_b64_tr_b16 v[200:201], v22 offset:32768
    v_mfma_f32_16x16x32_bf16 v[88:91], v[204:207], a[8:11], v[88:91]
    ds_read_b64_tr_b16 v[202:203], v22 offset:36864
    s_add_u32 m0, s53, 81920
    v_mfma_f32_16x16x32_bf16 v[92:95], v[204:207], a[12:15], v[92:95]
    s_waitcnt lgkmcnt(12)
    ds_read_b64_tr_b16 v[204:205], v23 offset:32768
    v_mfma_f32_16x16x32_bf16 v[96:99], v[208:211], a[8:11], v[96:99]
    s_add_u32 s55, s55, 1024
    ds_read_b64_tr_b16 v[206:207], v23 offset:36864
    v_mfma_f32_16x16x32_bf16 v[100:103], v[208:211], a[12:15], v[100:103]
    buffer_load_dwordx4 v18, s[12:15], s54 offen lds
    ds_read_b64_tr_b16 v[208:209], v24 offset:32768
    v_mfma_f32_16x16x32_bf16 v[104:107], v[212:215], a[8:11], v[104:107]
    ds_read_b64_tr_b16 v[210:211], v24 offset:36864
    v_mfma_f32_16x16x32_bf16 v[108:111], v[212:215], a[12:15], v[108:111]
    s_waitcnt lgkmcnt(10)
    ds_read_b64_tr_b16 v[212:213], v25 offset:32768
    v_mfma_f32_16x16x32_bf16 v[112:115], v[216:219], a[8:11], v[112:115]
    ds_read_b64_tr_b16 v[214:215], v25 offset:36864
    v_cmp_gt_u32 vcc, 12, v11
    v_mfma_f32_16x16x32_bf16 v[116:119], v[216:219], a[12:15], v[116:119]
    buffer_load_dwordx4 v19, s[12:15], s54 offen offset:1024 lds
    ds_read_b64_tr_b16 v[216:217], v26 offset:32768
    v_mfma_f32_16x16x32_bf16 v[120:123], v[220:223], a[8:11], v[120:123]
    ds_read_b64_tr_b16 v[218:219], v26 offset:36864
    s_cbranch_vccnz k2_st_131
k2_bk_132:
    v_mfma_f32_16x16x32_bf16 v[124:127], v[220:223], a[12:15], v[124:127]
    ds_read_b64_tr_b16 v[220:221], v27 offset:32768
    ds_read_b64_tr_b16 v[222:223], v27 offset:36864
    s_add_u32 s54, s54, 32768
    s_waitcnt vmcnt(13) lgkmcnt(12)
    ds_add_u32 v45, v10 offset:256
    v_mfma_f32_16x16x32_bf16 v[64:67], v[192:195], a[16:19], v[64:67]
    ds_read_b32 v11, v45 offset:0
    v_mfma_f32_16x16x32_bf16 v[68:71], v[192:195], a[20:23], v[68:71]
    buffer_load_dwordx4 a[8:11], v16, s[8:11], s55 offen sc1
    ds_read_b64_tr_b16 v[192:193], v20 offset:40960
    v_mfma_f32_16x16x32_bf16 v[72:75], v[196:199], a[16:19], v[72:75]
    ds_read_b64_tr_b16 v[194:195], v20 offset:45056
    v_mfma_f32_16x16x32_bf16 v[76:79], v[196:199], a[20:23], v[76:79]
    s_waitcnt lgkmcnt(12)
    ds_read_b64_tr_b16 v[196:197], v21 offset:40960
    v_mfma_f32_16x16x32_bf16 v[80:83], v[200:203], a[16:19], v[80:83]
    ds_read_b64_tr_b16 v[198:199], v21 offset:45056
    v_mfma_f32_16x16x32_bf16 v[84:87], v[200:203], a[20:23], v[84:87]
    buffer_load_dwordx4 a[12:15], v17, s[8:11], s55 offen sc1
    ds_read_b64_tr_b16 v[200:201], v22 offset:40960
    v_mfma_f32_16x16x32_bf16 v[88:91], v[204:207], a[16:19], v[88:91]
    ds_read_b64_tr_b16 v[202:203], v22 offset:45056
    s_add_u32 m0, s53, 90112
    v_mfma_f32_16x16x32_bf16 v[92:95], v[204:207], a[20:23], v[92:95]
    s_waitcnt lgkmcnt(12)
    ds_read_b64_tr_b16 v[204:205], v23 offset:40960
    v_mfma_f32_16x16x32_bf16 v[96:99], v[208:211], a[16:19], v[96:99]
    s_add_u32 s55, s55, 1024
    ds_read_b64_tr_b16 v[206:207], v23 offset:45056
    v_mfma_f32_16x16x32_bf16 v[100:103], v[208:211], a[20:23], v[100:103]
    buffer_load_dwordx4 v18, s[12:15], s54 offen lds
    ds_read_b64_tr_b16 v[208:209], v24 offset:40960
    v_mfma_f32_16x16x32_bf16 v[104:107], v[212:215], a[16:19], v[104:107]
    ds_read_b64_tr_b16 v[210:211], v24 offset:45056
    v_mfma_f32_16x16x32_bf16 v[108:111], v[212:215], a[20:23], v[108:111]
    s_waitcnt lgkmcnt(10)
    ds_read_b64_tr_b16 v[212:213], v25 offset:40960
    v_mfma_f32_16x16x32_bf16 v[112:115], v[216:219], a[16:19], v[112:115]
    ds_read_b64_tr_b16 v[214:215], v25 offset:45056
    v_cmp_gt_u32 vcc, 16, v11
    v_mfma_f32_16x16x32_bf16 v[116:119], v[216:219], a[20:23], v[116:119]
    buffer_load_dwordx4 v19, s[12:15], s54 offen offset:1024 lds
    ds_read_b64_tr_b16 v[216:217], v26 offset:40960
    v_mfma_f32_16x16x32_bf16 v[120:123], v[220:223], a[16:19], v[120:123]
    ds_read_b64_tr_b16 v[218:219], v26 offset:45056
    s_cbranch_vccnz k2_st_133
k2_bk_134:
    v_mfma_f32_16x16x32_bf16 v[124:127], v[220:223], a[20:23], v[124:127]
    ds_read_b64_tr_b16 v[220:221], v27 offset:40960
    ds_read_b64_tr_b16 v[222:223], v27 offset:45056
    s_add_u32 s54, s54, 32768
    s_waitcnt vmcnt(13) lgkmcnt(12)
    ds_add_u32 v45, v10 offset:512
    v_mfma_f32_16x16x32_bf16 v[64:67], v[192:195], a[24:27], v[64:67]
    ds_read_b32 v11, v45 offset:256
    v_mfma_f32_16x16x32_bf16 v[68:71], v[192:195], a[28:31], v[68:71]
    buffer_load_dwordx4 a[16:19], v16, s[8:11], s55 offen sc1
    ds_read_b64_tr_b16 v[192:193], v20 offset:49152
    v_mfma_f32_16x16x32_bf16 v[72:75], v[196:199], a[24:27], v[72:75]
    ds_read_b64_tr_b16 v[194:195], v20 offset:53248
    v_mfma_f32_16x16x32_bf16 v[76:79], v[196:199], a[28:31], v[76:79]
    s_waitcnt lgkmcnt(12)
    ds_read_b64_tr_b16 v[196:197], v21 offset:49152
    v_mfma_f32_16x16x32_bf16 v[80:83], v[200:203], a[24:27], v[80:83]
    ds_read_b64_tr_b16 v[198:199], v21 offset:53248
    v_mfma_f32_16x16x32_bf16 v[84:87], v[200:203], a[28:31], v[84:87]
    buffer_load_dwordx4 a[20:23], v17, s[8:11], s55 offen sc1
    ds_read_b64_tr_b16 v[200:201], v22 offset:49152
    v_mfma_f32_16x16x32_bf16 v[88:91], v[204:207], a[24:27], v[88:91]
    ds_read_b64_tr_b16 v[202:203], v22 offset:53248
    s_add_u32 m0, s53, 98304
    v_mfma_f32_16x16x32_bf16 v[92:95], v[204:207], a[28:31], v[92:95]
    s_waitcnt lgkmcnt(12)
    ds_read_b64_tr_b16 v[204:205], v23 offset:49152
    v_mfma_f32_16x16x32_bf16 v[96:99], v[208:211], a[24:27], v[96:99]
    s_add_u32 s55, s55, 1024
    ds_read_b64_tr_b16 v[206:207], v23 offset:53248
    v_mfma_f32_16x16x32_bf16 v[100:103], v[208:211], a[28:31], v[100:103]
    buffer_load_dwordx4 v18, s[12:15], s54 offen lds
    ds_read_b64_tr_b16 v[208:209], v24 offset:49152
    v_mfma_f32_16x16x32_bf16 v[104:107], v[212:215], a[24:27], v[104:107]
    ds_read_b64_tr_b16 v[210:211], v24 offset:53248
    v_mfma_f32_16x16x32_bf16 v[108:111], v[212:215], a[28:31], v[108:111]
    s_waitcnt lgkmcnt(10)
    ds_read_b64_tr_b16 v[212:213], v25 offset:49152
    v_mfma_f32_16x16x32_bf16 v[112:115], v[216:219], a[24:27], v[112:115]
    ds_read_b64_tr_b16 v[214:215], v25 offset:53248
    v_cmp_gt_u32 vcc, 16, v11
    v_mfma_f32_16x16x32_bf16 v[116:119], v[216:219], a[28:31], v[116:119]
    buffer_load_dwordx4 v19, s[12:15], s54 offen offset:1024 lds
    ds_read_b64_tr_b16 v[216:217], v26 offset:49152
    v_mfma_f32_16x16x32_bf16 v[120:123], v[220:223], a[24:27], v[120:123]
    ds_read_b64_tr_b16 v[218:219], v26 offset:53248
    s_cbranch_vccnz k2_st_135
k2_bk_136:
    v_mfma_f32_16x16x32_bf16 v[124:127], v[220:223], a[28:31], v[124:127]
    ds_read_b64_tr_b16 v[220:221], v27 offset:49152
    ds_read_b64_tr_b16 v[222:223], v27 offset:53248
    s_add_u32 s54, s54, 32768
    s_waitcnt vmcnt(12) lgkmcnt(12)
    v_cmp_eq_u32 vcc, 0, v37
    s_nop 1
    s_and_b32 s63, vcc_lo, 0xf00
    s_cbranch_scc1 mg_ps_139
mg_pb_140:
    v_mfma_f32_16x16x32_bf16 v[64:67], v[192:195], a[32:35], v[64:67]
    ds_add_u32 v45, v10 offset:0
    ds_read_b32 v11, v45 offset:512
    v_mfma_f32_16x16x32_bf16 v[68:71], v[192:195], a[36:39], v[68:71]
    buffer_load_dwordx4 a[24:27], v16, s[8:11], s55 offen sc1
    ds_read_b64_tr_b16 v[192:193], v20 offset:57344
    v_mfma_f32_16x16x32_bf16 v[72:75], v[196:199], a[32:35], v[72:75]
    ds_read_b64_tr_b16 v[194:195], v20 offset:61440
    v_mfma_f32_16x16x32_bf16 v[76:79], v[196:199], a[36:39], v[76:79]
    s_waitcnt lgkmcnt(12)
    ds_read_b64_tr_b16 v[196:197], v21 offset:57344
    v_mfma_f32_16x16x32_bf16 v[80:83], v[200:203], a[32:35], v[80:83]
    ds_read_b64_tr_b16 v[198:199], v21 offset:61440
    v_mfma_f32_16x16x32_bf16 v[84:87], v[200:203], a[36:39], v[84:87]
    buffer_load_dwordx4 a[28:31], v17, s[8:11], s55 offen sc1
    ds_read_b64_tr_b16 v[200:201], v22 offset:57344
    v_mfma_f32_16x16x32_bf16 v[88:91], v[204:207], a[32:35], v[88:91]
    ds_read_b64_tr_b16 v[202:203], v22 offset:61440
    s_add_u32 m0, s53, 106496
    v_mfma_f32_16x16x32_bf16 v[92:95], v[204:207], a[36:39], v[92:95]
    s_waitcnt lgkmcnt(12)
    ds_read_b64_tr_b16 v[204:205], v23 offset:57344
    v_mfma_f32_16x16x32_bf16 v[96:99], v[208:211], a[32:35], v[96:99]
    s_add_u32 s55, s55, 1024
    ds_read_b64_tr_b16 v[206:207], v23 offset:61440
    v_mfma_f32_16x16x32_bf16 v[100:103], v[208:211], a[36:39], v[100:103]
    buffer_load_dwordx4 v18, s[12:15], s54 offen lds
    ds_read_b64_tr_b16 v[208:209], v24 offset:57344
    v_mfma_f32_16x16x32_bf16 v[104:107], v[212:215], a[32:35], v[104:107]
    ds_read_b64_tr_b16 v[210:211], v24 offset:61440
    v_mfma_f32_16x16x32_bf16 v[108:111], v[212:215], a[36:39], v[108:111]
    s_waitcnt lgkmcnt(10)
    ds_read_b64_tr_b16 v[212:213], v25 offset:57344
    v_mfma_f32_16x16x32_bf16 v[112:115], v[216:219], a[32:35], v[112:115]
    ds_read_b64_tr_b16 v[214:215], v25 offset:61440
    v_cmp_gt_u32 vcc, 16, v11
    v_mfma_f32_16x16x32_bf16 v[116:119], v[216:219], a[36:39], v[116:119]
    buffer_load_dwordx4 v19, s[12:15], s54 offen offset:1024 lds
    ds_read_b64_tr_b16 v[216:217], v26 offset:57344
    v_mfma_f32_16x16x32_bf16 v[120:123], v[220:223], a[32:35], v[120:123]
    ds_read_b64_tr_b16 v[218:219], v26 offset:61440
    s_cbranch_vccnz k2_st_137
k2_bk_138:
    v_mfma_f32_16x16x32_bf16 v[124:127], v[220:223], a[36:39], v[124:127]
    ds_read_b64_tr_b16 v[220:221], v27 offset:57344
    ds_read_b64_tr_b16 v[222:223], v27 offset:61440
    s_add_u32 s54, s54, 32768
    s_waitcnt vmcnt(12) lgkmcnt(12)
    ds_add_u32 v45, v10 offset:256
    v_mfma_f32_16x16x32_bf16 v[64:67], v[192:195], a[40:43], v[64:67]
    ds_read_b32 v11, v45 offset:0
    buffer_load_dword v37, v36, s[8:11], s39 offen sc1
    v_mfma_f32_16x16x32_bf16 v[68:71], v[192:195], a[44:47], v[68:71]
    buffer_load_dwordx4 a[32:35], v16, s[8:11], s55 offen sc1
    ds_read_b64_tr_b16 v[192:193], v28 offset:0
    v_mfma_f32_16x16x32_bf16 v[72:75], v[196:199], a[40:43], v[72:75]
    ds_read_b64_tr_b16 v[194:195], v28 offset:4096
    v_mfma_f32_16x16x32_bf16 v[76:79], v[196:199], a[44:47], v[76:79]
    s_waitcnt lgkmcnt(12)
    ds_read_b64_tr_b16 v[196:197], v29 offset:0
    v_mfma_f32_16x16x32_bf16 v[80:83], v[200:203], a[40:43], v[80:83]
    ds_read_b64_tr_b16 v[198:199], v29 offset:4096
    v_mfma_f32_16x16x32_bf16 v[84:87], v[200:203], a[44:47], v[84:87]
    buffer_load_dwordx4 a[36:39], v17, s[8:11], s55 offen sc1
    ds_read_b64_tr_b16 v[200:201], v30 offset:0
    v_mfma_f32_16x16x32_bf16 v[88:91], v[204:207], a[40:43], v[88:91]
    ds_read_b64_tr_b16 v[202:203], v30 offset:4096
    s_add_u32 m0, s53, 114688
    v_mfma_f32_16x16x32_bf16 v[92:95], v[204:207], a[44:47], v[92:95]
    s_waitcnt lgkmcnt(12)
    ds_read_b64_tr_b16 v[204:205], v31 offset:0
    v_mfma_f32_16x16x32_bf16 v[96:99], v[208:211], a[40:43], v[96:99]
    s_add_u32 s55, s55, 1024
    ds_read_b64_tr_b16 v[206:207], v31 offset:4096
    v_mfma_f32_16x16x32_bf16 v[100:103], v[208:211], a[44:47], v[100:103]
    buffer_load_dwordx4 v18, s[12:15], s54 offen lds
    ds_read_b64_tr_b16 v[208:209], v32 offset:0
    v_mfma_f32_16x16x32_bf16 v[104:107], v[212:215], a[40:43], v[104:107]
    ds_read_b64_tr_b16 v[210:211], v32 offset:4096
    v_mfma_f32_16x16x32_bf16 v[108:111], v[212:215], a[44:47], v[108:111]
    s_waitcnt lgkmcnt(10)
    ds_read_b64_tr_b16 v[212:213], v33 offset:0
    v_mfma_f32_16x16x32_bf16 v[112:115], v[216:219], a[40:43], v[112:115]
    ds_read_b64_tr_b16 v[214:215], v33 offset:4096
    v_cmp_gt_u32 vcc, 20, v11
    v_mfma_f32_16x16x32_bf16 v[116:119], v[216:219], a[44:47], v[116:119]
    buffer_load_dwordx4 v19, s[12:15], s54 offen offset:1024 lds
    ds_read_b64_tr_b16 v[216:217], v34 offset:0
    v_mfma_f32_16x16x32_bf16 v[120:123], v[220:223], a[40:43], v[120:123]
    ds_read_b64_tr_b16 v[218:219], v34 offset:4096
    s_cbranch_vccnz k2_st_141
k2_bk_142:
    v_mfma_f32_16x16x32_bf16 v[124:127], v[220:223], a[44:47], v[124:127]
    ds_read_b64_tr_b16 v[220:221], v35 offset:0
    ds_read_b64_tr_b16 v[222:223], v35 offset:4096
    s_add_u32 s54, s54, 32768
    s_waitcnt vmcnt(13) lgkmcnt(12)
    ds_add_u32 v45, v10 offset:512
    v_mfma_f32_16x16x32_bf16 v[64:67], v[192:195], a[48:51], v[64:67]
    ds_read_b32 v11, v45 offset:256
    v_mfma_f32_16x16x32_bf16 v[68:71], v[192:195], a[52:55], v[68:71]
    buffer_load_dwordx4 a[40:43], v16, s[8:11], s55 offen sc1
    ds_read_b64_tr_b16 v[192:193], v28 offset:8192
    v_mfma_f32_16x16x32_bf16 v[72:75], v[196:199], a[48:51], v[72:75]
    ds_read_b64_tr_b16 v[194:195], v28 offset:12288
    v_mfma_f32_16x16x32_bf16 v[76:79], v[196:199], a[52:55], v[76:79]
    s_waitcnt lgkmcnt(12)
    ds_read_b64_tr_b16 v[196:197], v29 offset:8192
    v_mfma_f32_16x16x32_bf16 v[80:83], v[200:203], a[48:51], v[80:83]
    ds_read_b64_tr_b16 v[198:199], v29 offset:12288
    v_mfma_f32_16x16x32_bf16 v[84:87], v[200:203], a[52:55], v[84:87]
    buffer_load_dwordx4 a[44:47], v17, s[8:11], s55 offen sc1
    ds_read_b64_tr_b16 v[200:201], v30 offset:8192
    v_mfma_f32_16x16x32_bf16 v[88:91], v[204:207], a[48:51], v[88:91]
    ds_read_b64_tr_b16 v[202:203], v30 offset:12288
    s_add_u32 m0, s53, 122880
    v_mfma_f32_16x16x32_bf16 v[92:95], v[204:207], a[52:55], v[92:95]
    s_waitcnt lgkmcnt(12)
    ds_read_b64_tr_b16 v[204:205], v31 offset:8192
    v_mfma_f32_16x16x32_bf16 v[96:99], v[208:211], a[48:51], v[96:99]
    s_add_u32 s55, s55, 1024
    ds_read_b64_tr_b16 v[206:207], v31 offset:12288
    v_mfma_f32_16x16x32_bf16 v[100:103], v[208:211], a[52:55], v[100:103]
    buffer_load_dwordx4 v18, s[12:15], s54 offen lds
    ds_read_b64_tr_b16 v[208:209], v32 offset:8192
    v_mfma_f32_16x16x32_bf16 v[104:107], v[212:215], a[48:51], v[104:107]
    ds_read_b64_tr_b16 v[210:211], v32 offset:12288
    v_mfma_f32_16x16x32_bf16 v[108:111], v[212:215], a[52:55], v[108:111]
    s_waitcnt lgkmcnt(10)
    ds_read_b64_tr_b16 v[212:213], v33 offset:8192
    v_mfma_f32_16x16x32_bf16 v[112:115], v[216:219], a[48:51], v[112:115]
    ds_read_b64_tr_b16 v[214:215], v33 offset:12288
    v_cmp_gt_u32 vcc, 20, v11
    v_mfma_f32_16x16x32_bf16 v[116:119], v[216:219], a[52:55], v[116:119]
    buffer_load_dwordx4 v19, s[12:15], s54 offen offset:1024 lds
    ds_read_b64_tr_b16 v[216:217], v34 offset:8192
    v_mfma_f32_16x16x32_bf16 v[120:123], v[220:223], a[48:51], v[120:123]
    ds_read_b64_tr_b16 v[218:219], v34 offset:12288
    s_cbranch_vccnz k2_st_143
k2_bk_144:
    v_mfma_f32_16x16x32_bf16 v[124:127], v[220:223], a[52:55], v[124:127]
    ds_read_b64_tr_b16 v[220:221], v35 offset:8192
    ds_read_b64_tr_b16 v[222:223], v35 offset:12288
    s_add_u32 s54, s54, 32768
    s_waitcnt vmcnt(13) lgkmcnt(12)
    ds_add_u32 v45, v10 offset:0
    v_mfma_f32_16x16x32_bf16 v[64:67], v[192:195], a[56:59], v[64:67]
    ds_read_b32 v11, v45 offset:512
    v_mfma_f32_16x16x32_bf16 v[68:71], v[192:195], a[60:63], v[68:71]
    buffer_load_dwordx4 a[48:51], v16, s[8:11], s55 offen sc1
    ds_read_b64_tr_b16 v[192:193], v28 offset:16384
    v_mfma_f32_16x16x32_bf16 v[72:75], v[196:199], a[56:59], v[72:75]
    ds_read_b64_tr_b16 v[194:195], v28 offset:20480
    v_mfma_f32_16x16x32_bf16 v[76:79], v[196:199], a[60:63], v[76:79]
    s_waitcnt lgkmcnt(12)
    ds_read_b64_tr_b16 v[196:197], v29 offset:16384
    v_mfma_f32_16x16x32_bf16 v[80:83], v[200:203], a[56:59], v[80:83]
    ds_read_b64_tr_b16 v[198:199], v29 offset:20480
    v_mfma_f32_16x16x32_bf16 v[84:87], v[200:203], a[60:63], v[84:87]
    buffer_load_dwordx4 a[52:55], v17, s[8:11], s55 offen sc1
    ds_read_b64_tr_b16 v[200:201], v30 offset:16384
    v_mfma_f32_16x16x32_bf16 v[88:91], v[204:207], a[56:59], v[88:91]
    ds_read_b64_tr_b16 v[202:203], v30 offset:20480
    s_add_u32 m0, s53, 0
    v_mfma_f32_16x16x32_bf16 v[92:95], v[204:207], a[60:63], v[92:95]
    s_waitcnt lgkmcnt(12)
    ds_read_b64_tr_b16 v[204:205], v31 offset:16384
    v_mfma_f32_16x16x32_bf16 v[96:99], v[208:211], a[56:59], v[96:99]
    s_add_u32 s55, s55, 1024
    ds_read_b64_tr_b16 v[206:207], v31 offset:20480
    v_mfma_f32_16x16x32_bf16 v[100:103], v[208:211], a[60:63], v[100:103]
    buffer_load_dwordx4 v18, s[12:15], s54 offen lds
    ds_read_b64_tr_b16 v[208:209], v32 offset:16384
    v_mfma_f32_16x16x32_bf16 v[104:107], v[212:215], a[56:59], v[104:107]
    ds_read_b64_tr_b16 v[210:211], v32 offset:20480
    v_mfma_f32_16x16x32_bf16 v[108:111], v[212:215], a[60:63], v[108:111]
    s_waitcnt lgkmcnt(10)
    ds_read_b64_tr_b16 v[212:213], v33 offset:16384
    v_mfma_f32_16x16x32_bf16 v[112:115], v[216:219], a[56:59], v[112:115]
    ds_read_b64_tr_b16 v[214:215], v33 offset:20480
    v_cmp_gt_u32 vcc, 20, v11
    v_mfma_f32_16x16x32_bf16 v[116:119], v[216:219], a[60:63], v[116:119]
    buffer_load_dwordx4 v19, s[12:15], s54 offen offset:1024 lds
    ds_read_b64_tr_b16 v[216:217], v34 offset:16384
    v_mfma_f32_16x16x32_bf16 v[120:123], v[220:223], a[56:59], v[120:123]
    ds_read_b64_tr_b16 v[218:219], v34 offset:20480
    s_cbranch_vccnz k2_st_145
k2_bk_146:
    v_mfma_f32_16x16x32_bf16 v[124:127], v[220:223], a[60:63], v[124:127]
    ds_read_b64_tr_b16 v[220:221], v35 offset:16384
    ds_read_b64_tr_b16 v[222:223], v35 offset:20480
    s_add_u32 s54, s54, 32768
    s_waitcnt vmcnt(12) lgkmcnt(12)
    v_cmp_eq_u32 vcc, 0, v37
    s_nop 1
    s_and_b32 s63, vcc_lo, 0xf000
    s_cbranch_scc1 mg_ps_149
mg_pb_150:
    v_mfma_f32_16x16x32_bf16 v[64:67], v[192:195], a[0:3], v[64:67]
    ds_add_u32 v45, v10 offset:256
    ds_read_b32 v11, v45 offset:0
    v_mfma_f32_16x16x32_bf16 v[68:71], v[192:195], a[4:7], v[68:71]
    buffer_load_dwordx4 a[56:59], v16, s[8:11], s55 offen sc1
    ds_read_b64_tr_b16 v[192:193], v28 offset:24576
    v_mfma_f32_16x16x32_bf16 v[72:75], v[196:199], a[0:3], v[72:75]
    ds_read_b64_tr_b16 v[194:195], v28 offset:28672
    v_mfma_f32_16x16x32_bf16 v[76:79], v[196:199], a[4:7], v[76:79]
    s_waitcnt lgkmcnt(12)
    ds_read_b64_tr_b16 v[196:197], v29 offset:24576
    v_mfma_f32_16x16x32_bf16 v[80:83], v[200:203], a[0:3], v[80:83]
    ds_read_b64_tr_b16 v[198:199], v29 offset:28672
    v_mfma_f32_16x16x32_bf16 v[84:87], v[200:203], a[4:7], v[84:87]
    buffer_load_dwordx4 a[60:63], v17, s[8:11], s55 offen sc1
    ds_read_b64_tr_b16 v[200:201], v30 offset:24576
    v_mfma_f32_16x16x32_bf16 v[88:91], v[204:207], a[0:3], v[88:91]
    ds_read_b64_tr_b16 v[202:203], v30 offset:28672
    s_add_u32 m0, s53, 8192
    v_mfma_f32_16x16x32_bf16 v[92:95], v[204:207], a[4:7], v[92:95]
    s_waitcnt lgkmcnt(12)
    ds_read_b64_tr_b16 v[204:205], v31 offset:24576
    v_mfma_f32_16x16x32_bf16 v[96:99], v[208:211], a[0:3], v[96:99]
    s_add_u32 s55, s55, 1024
    ds_read_b64_tr_b16 v[206:207], v31 offset:28672
    v_mfma_f32_16x16x32_bf16 v[100:103], v[208:211], a[4:7], v[100:103]
    buffer_load_dwordx4 v18, s[12:15], s54 offen lds
    ds_read_b64_tr_b16 v[208:209], v32 offset:24576
    v_mfma_f32_16x16x32_bf16 v[104:107], v[212:215], a[0:3], v[104:107]
    ds_read_b64_tr_b16 v[210:211], v32 offset:28672
    v_mfma_f32_16x16x32_bf16 v[108:111], v[212:215], a[4:7], v[108:111]
    s_waitcnt lgkmcnt(10)
    ds_read_b64_tr_b16 v[212:213], v33 offset:24576
    v_mfma_f32_16x16x32_bf16 v[112:115], v[216:219], a[0:3], v[112:115]
    ds_read_b64_tr_b16 v[214:215], v33 offset:28672
    v_cmp_gt_u32 vcc, 24, v11
    v_mfma_f32_16x16x32_bf16 v[116:119], v[216:219], a[4:7], v[116:119]
    buffer_load_dwordx4 v19, s[12:15], s54 offen offset:1024 lds
    ds_read_b64_tr_b16 v[216:217], v34 offset:24576
    v_mfma_f32_16x16x32_bf16 v[120:123], v[220:223], a[0:3], v[120:123]
    ds_read_b64_tr_b16 v[218:219], v34 offset:28672
    s_cbranch_vccnz k2_st_147
k2_bk_148:
    v_mfma_f32_16x16x32_bf16 v[124:127], v[220:223], a[4:7], v[124:127]
    ds_read_b64_tr_b16 v[220:221], v35 offset:24576
    ds_read_b64_tr_b16 v[222:223], v35 offset:28672
    s_add_u32 s54, s54, 32768
    s_waitcnt vmcnt(12) lgkmcnt(12)
    ds_add_u32 v45, v10 offset:512
    v_mfma_f32_16x16x32_bf16 v[64:67], v[192:195], a[8:11], v[64:67]
    ds_read_b32 v11, v45 offset:256
    buffer_load_dword v37, v36, s[8:11], s39 offen sc1
    v_mfma_f32_16x16x32_bf16 v[68:71], v[192:195], a[12:15], v[68:71]
    buffer_load_dwordx4 a[0:3], v16, s[8:11], s55 offen sc1
    ds_read_b64_tr_b16 v[192:193], v28 offset:32768
    v_mfma_f32_16x16x32_bf16 v[72:75], v[196:199], a[8:11], v[72:75]
    ds_read_b64_tr_b16 v[194:195], v28 offset:36864
    v_mfma_f32_16x16x32_bf16 v[76:79], v[196:199], a[12:15], v[76:79]
    s_waitcnt lgkmcnt(12)
    ds_read_b64_tr_b16 v[196:197], v29 offset:32768
    v_mfma_f32_16x16x32_bf16 v[80:83], v[200:203], a[8:11], v[80:83]
    ds_read_b64_tr_b16 v[198:199], v29 offset:36864
    v_mfma_f32_16x16x32_bf16 v[84:87], v[200:203], a[12:15], v[84:87]
    buffer_load_dwordx4 a[4:7], v17, s[8:11], s55 offen sc1
    ds_read_b64_tr_b16 v[200:201], v30 offset:32768
    v_mfma_f32_16x16x32_bf16 v[88:91], v[204:207], a[8:11], v[88:91]
    ds_read_b64_tr_b16 v[202:203], v30 offset:36864
    s_add_u32 m0, s53, 16384
    v_mfma_f32_16x16x32_bf16 v[92:95], v[204:207], a[12:15], v[92:95]
    s_waitcnt lgkmcnt(12)
    ds_read_b64_tr_b16 v[204:205], v31 offset:32768
    v_mfma_f32_16x16x32_bf16 v[96:99], v[208:211], a[8:11], v[96:99]
    s_add_u32 s55, s55, 1024
    ds_read_b64_tr_b16 v[206:207], v31 offset:36864
    v_mfma_f32_16x16x32_bf16 v[100:103], v[208:211], a[12:15], v[100:103]
    buffer_load_dwordx4 v18, s[12:15], s54 offen lds
    ds_read_b64_tr_b16 v[208:209], v32 offset:32768
    v_mfma_f32_16x16x32_bf16 v[104:107], v[212:215], a[8:11], v[104:107]
    ds_read_b64_tr_b16 v[210:211], v32 offset:36864
    v_mfma_f32_16x16x32_bf16 v[108:111], v[212:215], a[12:15], v[108:111]
    s_waitcnt lgkmcnt(10)
    ds_read_b64_tr_b16 v[212:213], v33 offset:32768
    v_mfma_f32_16x16x32_bf16 v[112:115], v[216:219], a[8:11], v[112:115]
    ds_read_b64_tr_b16 v[214:215], v33 offset:36864
    v_cmp_gt_u32 vcc, 24, v11
    v_mfma_f32_16x16x32_bf16 v[116:119], v[216:219], a[12:15], v[116:119]
    buffer_load_dwordx4 v19, s[12:15], s54 offen offset:1024 lds
    ds_read_b64_tr_b16 v[216:217], v34 offset:32768
    v_mfma_f32_16x16x32_bf16 v[120:123], v[220:223], a[8:11], v[120:123]
    ds_read_b64_tr_b16 v[218:219], v34 offset:36864
    s_cbranch_vccnz k2_st_151
k2_bk_152:
    v_mfma_f32_16x16x32_bf16 v[124:127], v[220:223], a[12:15], v[124:127]
    ds_read_b64_tr_b16 v[220:221], v35 offset:32768
    ds_read_b64_tr_b16 v[222:223], v35 offset:36864
    s_add_u32 s54, s54, 32768
    s_waitcnt vmcnt(13) lgkmcnt(12)
    ds_add_u32 v45, v10 offset:0
    v_mfma_f32_16x16x32_bf16 v[64:67], v[192:195], a[16:19], v[64:67]
    ds_read_b32 v11, v45 offset:512
    v_mfma_f32_16x16x32_bf16 v[68:71], v[192:195], a[20:23], v[68:71]
    buffer_load_dwordx4 a[8:11], v16, s[8:11], s55 offen sc1
    ds_read_b64_tr_b16 v[192:193], v28 offset:40960
    v_mfma_f32_16x16x32_bf16 v[72:75], v[196:199], a[16:19], v[72:75]
    ds_read_b64_tr_b16 v[194:195], v28 offset:45056
    v_mfma_f32_16x16x32_bf16 v[76:79], v[196:199], a[20:23], v[76:79]
    s_waitcnt lgkmcnt(12)
    ds_read_b64_tr_b16 v[196:197], v29 offset:40960
    v_mfma_f32_16x16x32_bf16 v[80:83], v[200:203], a[16:19], v[80:83]
    ds_read_b64_tr_b16 v[198:199], v29 offset:45056
    v_mfma_f32_16x16x32_bf16 v[84:87], v[200:203], a[20:23], v[84:87]
    buffer_load_dwordx4 a[12:15], v17, s[8:11], s55 offen sc1
    ds_read_b64_tr_b16 v[200:201], v30 offset:40960
    v_mfma_f32_16x16x32_bf16 v[88:91], v[204:207], a[16:19], v[88:91]
    ds_read_b64_tr_b16 v[202:203], v30 offset:45056
    s_add_u32 m0, s53, 24576
    v_mfma_f32_16x16x32_bf16 v[92:95], v[204:207], a[20:23], v[92:95]
    s_waitcnt lgkmcnt(12)
    ds_read_b64_tr_b16 v[204:205], v31 offset:40960
    v_mfma_f32_16x16x32_bf16 v[96:99], v[208:211], a[16:19], v[96:99]
    s_add_u32 s55, s55, 1024
    ds_read_b64_tr_b16 v[206:207], v31 offset:45056
    v_mfma_f32_16x16x32_bf16 v[100:103], v[208:211], a[20:23], v[100:103]
    buffer_load_dwordx4 v18, s[12:15], s54 offen lds
    ds_read_b64_tr_b16 v[208:209], v32 offset:40960
    v_mfma_f32_16x16x32_bf16 v[104:107], v[212:215], a[16:19], v[104:107]
    ds_read_b64_tr_b16 v[210:211], v32 offset:45056
    v_mfma_f32_16x16x32_bf16 v[108:111], v[212:215], a[20:23], v[108:111]
    s_waitcnt lgkmcnt(10)
    ds_read_b64_tr_b16 v[212:213], v33 offset:40960
    v_mfma_f32_16x16x32_bf16 v[112:115], v[216:219], a[16:19], v[112:115]
    ds_read_b64_tr_b16 v[214:215], v33 offset:45056
    v_cmp_gt_u32 vcc, 24, v11
    v_mfma_f32_16x16x32_bf16 v[116:119], v[216:219], a[20:23], v[116:119]
    buffer_load_dwordx4 v19, s[12:15], s54 offen offset:1024 lds
    ds_read_b64_tr_b16 v[216:217], v34 offset:40960
    v_mfma_f32_16x16x32_bf16 v[120:123], v[220:223], a[16:19], v[120:123]
    ds_read_b64_tr_b16 v[218:219], v34 offset:45056
    s_cbranch_vccnz k2_st_153
k2_bk_154:
    v_mfma_f32_16x16x32_bf16 v[124:127], v[220:223], a[20:23], v[124:127]
    ds_read_b64_tr_b16 v[220:221], v35 offset:40960
    ds_read_b64_tr_b16 v[222:223], v35 offset:45056
    s_add_u32 s54, s54, 32768
    s_waitcnt vmcnt(13) lgkmcnt(12)
    ds_add_u32 v45, v10 offset:256
    v_mfma_f32_16x16x32_bf16 v[64:67], v[192:195], a[24:27], v[64:67]
    ds_read_b32 v11, v45 offset:0
    v_mfma_f32_16x16x32_bf16 v[68:71], v[192:195], a[28:31], v[68:71]
    buffer_load_dwordx4 a[16:19], v16, s[8:11], s55 offen sc1
    ds_read_b64_tr_b16 v[192:193], v28 offset:49152
    v_mfma_f32_16x16x32_bf16 v[72:75], v[196:199], a[24:27], v[72:75]
    ds_read_b64_tr_b16 v[194:195], v28 offset:53248
    v_mfma_f32_16x16x32_bf16 v[76:79], v[196:199], a[28:31], v[76:79]
    s_waitcnt lgkmcnt(12)
    ds_read_b64_tr_b16 v[196:197], v29 offset:49152
    v_mfma_f32_16x16x32_bf16 v[80:83], v[200:203], a[24:27], v[80:83]
    ds_read_b64_tr_b16 v[198:199], v29 offset:53248
    v_mfma_f32_16x16x32_bf16 v[84:87], v[200:203], a[28:31], v[84:87]
    buffer_load_dwordx4 a[20:23], v17, s[8:11], s55 offen sc1
    ds_read_b64_tr_b16 v[200:201], v30 offset:49152
    v_mfma_f32_16x16x32_bf16 v[88:91], v[204:207], a[24:27], v[88:91]
    ds_read_b64_tr_b16 v[202:203], v30 offset:53248
    s_add_u32 m0, s53, 32768
    v_mfma_f32_16x16x32_bf16 v[92:95], v[204:207], a[28:31], v[92:95]
    s_waitcnt lgkmcnt(12)
    ds_read_b64_tr_b16 v[204:205], v31 offset:49152
    v_mfma_f32_16x16x32_bf16 v[96:99], v[208:211], a[24:27], v[96:99]
    s_add_u32 s55, s55, 1024
    ds_read_b64_tr_b16 v[206:207], v31 offset:53248
    v_mfma_f32_16x16x32_bf16 v[100:103], v[208:211], a[28:31], v[100:103]
    buffer_load_dwordx4 v18, s[12:15], s54 offen lds
    ds_read_b64_tr_b16 v[208:209], v32 offset:49152
    v_mfma_f32_16x16x32_bf16 v[104:107], v[212:215], a[24:27], v[104:107]
    ds_read_b64_tr_b16 v[210:211], v32 offset:53248
    v_mfma_f32_16x16x32_bf16 v[108:111], v[212:215], a[28:31], v[108:111]
    s_waitcnt lgkmcnt(10)
    ds_read_b64_tr_b16 v[212:213], v33 offset:49152
    v_mfma_f32_16x16x32_bf16 v[112:115], v[216:219], a[24:27], v[112:115]
    ds_read_b64_tr_b16 v[214:215], v33 offset:53248
    v_cmp_gt_u32 vcc, 28, v11
    v_mfma_f32_16x16x32_bf16 v[116:119], v[216:219], a[28:31], v[116:119]
    buffer_load_dwordx4 v19, s[12:15], s54 offen offset:1024 lds
    ds_read_b64_tr_b16 v[216:217], v34 offset:49152
    v_mfma_f32_16x16x32_bf16 v[120:123], v[220:223], a[24:27], v[120:123]
    ds_read_b64_tr_b16 v[218:219], v34 offset:53248
    s_cbranch_vccnz k2_st_155
k2_bk_156:
    v_mfma_f32_16x16x32_bf16 v[124:127], v[220:223], a[28:31], v[124:127]
    ds_read_b64_tr_b16 v[220:221], v35 offset:49152
    ds_read_b64_tr_b16 v[222:223], v35 offset:53248
    s_add_u32 s54, s54, 32768
    s_waitcnt vmcnt(12) lgkmcnt(12)
    v_cmp_eq_u32 vcc, 0, v37
    s_nop 1
    s_and_b32 s63, vcc_lo, 0xf0000
    s_cbranch_scc1 mg_ps_159
mg_pb_160:
    v_mfma_f32_16x16x32_bf16 v[64:67], v[192:195], a[32:35], v[64:67]
    ds_add_u32 v45, v10 offset:512
    ds_read_b32 v11, v45 offset:256
    s_add_u32 s55, s55, s60
    s_add_u32 s54, s54, s61
    v_mfma_f32_16x16x32_bf16 v[68:71], v[192:195], a[36:39], v[68:71]
    buffer_load_dwordx4 a[24:27], v16, s[8:11], s55 offen sc1
    ds_read_b64_tr_b16 v[192:193], v28 offset:57344
    v_mfma_f32_16x16x32_bf16 v[72:75], v[196:199], a[32:35], v[72:75]
    ds_read_b64_tr_b16 v[194:195], v28 offset:61440
    v_mfma_f32_16x16x32_bf16 v[76:79], v[196:199], a[36:39], v[76:79]
    s_waitcnt lgkmcnt(12)
    ds_read_b64_tr_b16 v[196:197], v29 offset:57344
    v_mfma_f32_16x16x32_bf16 v[80:83], v[200:203], a[32:35], v[80:83]
    ds_read_b64_tr_b16 v[198:199], v29 offset:61440
    v_mfma_f32_16x16x32_bf16 v[84:87], v[200:203], a[36:39], v[84:87]
    buffer_load_dwordx4 a[28:31], v17, s[8:11], s55 offen sc1
    ds_read_b64_tr_b16 v[200:201], v30 offset:57344
    v_mfma_f32_16x16x32_bf16 v[88:91], v[204:207], a[32:35], v[88:91]
    ds_read_b64_tr_b16 v[202:203], v30 offset:61440
    s_add_u32 m0, s53, 40960
    v_mfma_f32_16x16x32_bf16 v[92:95], v[204:207], a[36:39], v[92:95]
    s_waitcnt lgkmcnt(12)
    ds_read_b64_tr_b16 v[204:205], v31 offset:57344
    v_mfma_f32_16x16x32_bf16 v[96:99], v[208:211], a[32:35], v[96:99]
    s_add_u32 s55, s55, 1024
    ds_read_b64_tr_b16 v[206:207], v31 offset:61440
    v_mfma_f32_16x16x32_bf16 v[100:103], v[208:211], a[36:39], v[100:103]
    buffer_load_dwordx4 v18, s[12:15], s54 offen lds
    ds_read_b64_tr_b16 v[208:209], v32 offset:57344
    v_mfma_f32_16x16x32_bf16 v[104:107], v[212:215], a[32:35], v[104:107]
    ds_read_b64_tr_b16 v[210:211], v32 offset:61440
    v_mfma_f32_16x16x32_bf16 v[108:111], v[212:215], a[36:39], v[108:111]
    s_waitcnt lgkmcnt(10)
    ds_read_b64_tr_b16 v[212:213], v33 offset:57344
    v_mfma_f32_16x16x32_bf16 v[112:115], v[216:219], a[32:35], v[112:115]
    ds_read_b64_tr_b16 v[214:215], v33 offset:61440
    v_cmp_gt_u32 vcc, 28, v11
    v_mfma_f32_16x16x32_bf16 v[116:119], v[216:219], a[36:39], v[116:119]
    buffer_load_dwordx4 v19, s[12:15], s54 offen offset:1024 lds
    ds_read_b64_tr_b16 v[216:217], v34 offset:57344
    v_mfma_f32_16x16x32_bf16 v[120:123], v[220:223], a[32:35], v[120:123]
    ds_read_b64_tr_b16 v[218:219], v34 offset:61440
    s_cbranch_vccnz k2_st_157
k2_bk_158:
    v_mfma_f32_16x16x32_bf16 v[124:127], v[220:223], a[36:39], v[124:127]
    ds_read_b64_tr_b16 v[220:221], v35 offset:57344
    ds_read_b64_tr_b16 v[222:223], v35 offset:61440
    s_add_u32 s54, s54, 32768
    s_waitcnt vmcnt(12) lgkmcnt(12)
    ds_add_u32 v45, v10 offset:0
    v_mfma_f32_16x16x32_bf16 v[64:67], v[192:195], a[40:43], v[64:67]
    ds_read_b32 v11, v45 offset:512
    buffer_load_dword v37, v36, s[8:11], s39 offen sc1
    v_mfma_f32_16x16x32_bf16 v[68:71], v[192:195], a[44:47], v[68:71]
    buffer_load_dwordx4 a[32:35], v16, s[8:11], s55 offen sc1
    ds_read_b64_tr_b16 v[192:193], v20 offset:0
    v_mfma_f32_16x16x32_bf16 v[72:75], v[196:199], a[40:43], v[72:75]
    ds_read_b64_tr_b16 v[194:195], v20 offset:4096
    v_mfma_f32_16x16x32_bf16 v[76:79], v[196:199], a[44:47], v[76:79]
    s_waitcnt lgkmcnt(12)
    ds_read_b64_tr_b16 v[196:197], v21 offset:0
    v_mfma_f32_16x16x32_bf16 v[80:83], v[200:203], a[40:43], v[80:83]
    ds_read_b64_tr_b16 v[198:199], v21 offset:4096
    v_mfma_f32_16x16x32_bf16 v[84:87], v[200:203], a[44:47], v[84:87]
    buffer_load_dwordx4 a[36:39], v17, s[8:11], s55 offen sc1
    ds_read_b64_tr_b16 v[200:201], v22 offset:0
    v_mfma_f32_16x16x32_bf16 v[88:91], v[204:207], a[40:43], v[88:91]
    ds_read_b64_tr_b16 v[202:203], v22 offset:4096
    s_add_u32 m0, s53, 49152
    v_mfma_f32_16x16x32_bf16 v[92:95], v[204:207], a[44:47], v[92:95]
    s_waitcnt lgkmcnt(12)
    ds_read_b64_tr_b16 v[204:205], v23 offset:0
    v_mfma_f32_16x16x32_bf16 v[96:99], v[208:211], a[40:43], v[96:99]
    s_add_u32 s55, s55, 1024
    ds_read_b64_tr_b16 v[206:207], v23 offset:4096
    v_mfma_f32_16x16x32_bf16 v[100:103], v[208:211], a[44:47], v[100:103]
    buffer_load_dwordx4 v18, s[12:15], s54 offen lds
    ds_read_b64_tr_b16 v[208:209], v24 offset:0
    v_mfma_f32_16x16x32_bf16 v[104:107], v[212:215], a[40:43], v[104:107]
    ds_read_b64_tr_b16 v[210:211], v24 offset:4096
    v_mfma_f32_16x16x32_bf16 v[108:111], v[212:215], a[44:47], v[108:111]
    s_waitcnt lgkmcnt(10)
    ds_read_b64_tr_b16 v[212:213], v25 offset:0
    v_mfma_f32_16x16x32_bf16 v[112:115], v[216:219], a[40:43], v[112:115]
    ds_read_b64_tr_b16 v[214:215], v25 offset:4096
    v_cmp_gt_u32 vcc, 28, v11
    v_mfma_f32_16x16x32_bf16 v[116:119], v[216:219], a[44:47], v[116:119]
    buffer_load_dwordx4 v19, s[12:15], s54 offen offset:1024 lds
    ds_read_b64_tr_b16 v[216:217], v26 offset:0
    v_mfma_f32_16x16x32_bf16 v[120:123], v[220:223], a[40:43], v[120:123]
    ds_read_b64_tr_b16 v[218:219], v26 offset:4096
    s_cbranch_vccnz k2_st_161
k2_bk_162:
    v_mfma_f32_16x16x32_bf16 v[124:127], v[220:223], a[44:47], v[124:127]
    ds_read_b64_tr_b16 v[220:221], v27 offset:0
    ds_read_b64_tr_b16 v[222:223], v27 offset:4096
    s_add_u32 s54, s54, 32768
    s_waitcnt vmcnt(13) lgkmcnt(12)
    ds_add_u32 v45, v10 offset:256
    v_mfma_f32_16x16x32_bf16 v[64:67], v[192:195], a[48:51], v[64:67]
    ds_read_b32 v11, v45 offset:0
    v_mfma_f32_16x16x32_bf16 v[68:71], v[192:195], a[52:55], v[68:71]
    buffer_load_dwordx4 a[40:43], v16, s[8:11], s55 offen sc1
    ds_read_b64_tr_b16 v[192:193], v20 offset:8192
    v_mfma_f32_16x16x32_bf16 v[72:75], v[196:199], a[48:51], v[72:75]
    ds_read_b64_tr_b16 v[194:195], v20 offset:12288
    v_mfma_f32_16x16x32_bf16 v[76:79], v[196:199], a[52:55], v[76:79]
    s_waitcnt lgkmcnt(12)
    ds_read_b64_tr_b16 v[196:197], v21 offset:8192
    v_mfma_f32_16x16x32_bf16 v[80:83], v[200:203], a[48:51], v[80:83]
    ds_read_b64_tr_b16 v[198:199], v21 offset:12288
    v_mfma_f32_16x16x32_bf16 v[84:87], v[200:203], a[52:55], v[84:87]
    buffer_load_dwordx4 a[44:47], v17, s[8:11], s55 offen sc1
    ds_read_b64_tr_b16 v[200:201], v22 offset:8192
    v_mfma_f32_16x16x32_bf16 v[88:91], v[204:207], a[48:51], v[88:91]
    ds_read_b64_tr_b16 v[202:203], v22 offset:12288
    s_add_u32 m0, s53, 57344
    v_mfma_f32_16x16x32_bf16 v[92:95], v[204:207], a[52:55], v[92:95]
    s_waitcnt lgkmcnt(12)
    ds_read_b64_tr_b16 v[204:205], v23 offset:8192
    v_mfma_f32_16x16x32_bf16 v[96:99], v[208:211], a[48:51], v[96:99]
    s_add_u32 s55, s55, 1024
    ds_read_b64_tr_b16 v[206:207], v23 offset:12288
    v_mfma_f32_16x16x32_bf16 v[100:103], v[208:211], a[52:55], v[100:103]
    buffer_load_dwordx4 v18, s[12:15], s54 offen lds
    ds_read_b64_tr_b16 v[208:209], v24 offset:8192
    v_mfma_f32_16x16x32_bf16 v[104:107], v[212:215], a[48:51], v[104:107]
    ds_read_b64_tr_b16 v[210:211], v24 offset:12288
    v_mfma_f32_16x16x32_bf16 v[108:111], v[212:215], a[52:55], v[108:111]
    s_waitcnt lgkmcnt(10)
    ds_read_b64_tr_b16 v[212:213], v25 offset:8192
    v_mfma_f32_16x16x32_bf16 v[112:115], v[216:219], a[48:51], v[112:115]
    ds_read_b64_tr_b16 v[214:215], v25 offset:12288
    v_cmp_gt_u32 vcc, 32, v11
    v_mfma_f32_16x16x32_bf16 v[116:119], v[216:219], a[52:55], v[116:119]
    buffer_load_dwordx4 v19, s[12:15], s54 offen offset:1024 lds
    ds_read_b64_tr_b16 v[216:217], v26 offset:8192
    v_mfma_f32_16x16x32_bf16 v[120:123], v[220:223], a[48:51], v[120:123]
    ds_read_b64_tr_b16 v[218:219], v26 offset:12288
    s_cbranch_vccnz k2_st_163
k2_bk_164:
    v_mfma_f32_16x16x32_bf16 v[124:127], v[220:223], a[52:55], v[124:127]
    ds_read_b64_tr_b16 v[220:221], v27 offset:8192
    ds_read_b64_tr_b16 v[222:223], v27 offset:12288
    s_add_u32 s54, s54, 32768
    s_waitcnt vmcnt(13) lgkmcnt(12)
    ds_add_u32 v45, v10 offset:512
    v_mfma_f32_16x16x32_bf16 v[64:67], v[192:195], a[56:59], v[64:67]
    ds_read_b32 v11, v45 offset:256
    v_mfma_f32_16x16x32_bf16 v[68:71], v[192:195], a[60:63], v[68:71]
    buffer_load_dwordx4 a[48:51], v16, s[8:11], s55 offen sc1
    ds_read_b64_tr_b16 v[192:193], v20 offset:16384
    v_mfma_f32_16x16x32_bf16 v[72:75], v[196:199], a[56:59], v[72:75]
    ds_read_b64_tr_b16 v[194:195], v20 offset:20480
    v_mfma_f32_16x16x32_bf16 v[76:79], v[196:199], a[60:63], v[76:79]
    s_waitcnt lgkmcnt(12)
    ds_read_b64_tr_b16 v[196:197], v21 offset:16384
    v_mfma_f32_16x16x32_bf16 v[80:83], v[200:203], a[56:59], v[80:83]
    ds_read_b64_tr_b16 v[198:199], v21 offset:20480
    v_mfma_f32_16x16x32_bf16 v[84:87], v[200:203], a[60:63], v[84:87]
    buffer_load_dwordx4 a[52:55], v17, s[8:11], s55 offen sc1
    ds_read_b64_tr_b16 v[200:201], v22 offset:16384
    v_mfma_f32_16x16x32_bf16 v[88:91], v[204:207], a[56:59], v[88:91]
    ds_read_b64_tr_b16 v[202:203], v22 offset:20480
    s_add_u32 m0, s53, 65536
    v_mfma_f32_16x16x32_bf16 v[92:95], v[204:207], a[60:63], v[92:95]
    s_waitcnt lgkmcnt(12)
    ds_read_b64_tr_b16 v[204:205], v23 offset:16384
    v_mfma_f32_16x16x32_bf16 v[96:99], v[208:211], a[56:59], v[96:99]
    s_add_u32 s55, s55, 1024
    ds_read_b64_tr_b16 v[206:207], v23 offset:20480
    v_mfma_f32_16x16x32_bf16 v[100:103], v[208:211], a[60:63], v[100:103]
    buffer_load_dwordx4 v18, s[12:15], s54 offen lds
    ds_read_b64_tr_b16 v[208:209], v24 offset:16384
    v_mfma_f32_16x16x32_bf16 v[104:107], v[212:215], a[56:59], v[104:107]
    ds_read_b64_tr_b16 v[210:211], v24 offset:20480
    v_mfma_f32_16x16x32_bf16 v[108:111], v[212:215], a[60:63], v[108:111]
    s_waitcnt lgkmcnt(10)
    ds_read_b64_tr_b16 v[212:213], v25 offset:16384
    v_mfma_f32_16x16x32_bf16 v[112:115], v[216:219], a[56:59], v[112:115]
    ds_read_b64_tr_b16 v[214:215], v25 offset:20480
    v_cmp_gt_u32 vcc, 32, v11
    v_mfma_f32_16x16x32_bf16 v[116:119], v[216:219], a[60:63], v[116:119]
    buffer_load_dwordx4 v19, s[12:15], s54 offen offset:1024 lds
    ds_read_b64_tr_b16 v[216:217], v26 offset:16384
    v_mfma_f32_16x16x32_bf16 v[120:123], v[220:223], a[56:59], v[120:123]
    ds_read_b64_tr_b16 v[218:219], v26 offset:20480
    s_cbranch_vccnz k2_st_165
k2_bk_166:
    v_mfma_f32_16x16x32_bf16 v[124:127], v[220:223], a[60:63], v[124:127]
    ds_read_b64_tr_b16 v[220:221], v27 offset:16384
    ds_read_b64_tr_b16 v[222:223], v27 offset:20480
    s_add_u32 s54, s54, 32768
    s_waitcnt vmcnt(12) lgkmcnt(12)
    v_cmp_eq_u32 vcc, 0, v37
    s_nop 1
    s_and_b32 s63, vcc_lo, 0xf00000
    s_cbranch_scc1 mg_ps_169
mg_pb_170:
    v_mfma_f32_16x16x32_bf16 v[64:67], v[192:195], a[0:3], v[64:67]
    ds_add_u32 v45, v10 offset:0
    ds_read_b32 v11, v45 offset:512
    v_mfma_f32_16x16x32_bf16 v[68:71], v[192:195], a[4:7], v[68:71]
    buffer_load_dwordx4 a[56:59], v16, s[8:11], s55 offen sc1
    ds_read_b64_tr_b16 v[192:193], v20 offset:24576
    v_mfma_f32_16x16x32_bf16 v[72:75], v[196:199], a[0:3], v[72:75]
    ds_read_b64_tr_b16 v[194:195], v20 offset:28672
    v_mfma_f32_16x16x32_bf16 v[76:79], v[196:199], a[4:7], v[76:79]
    s_waitcnt lgkmcnt(12)
    ds_read_b64_tr_b16 v[196:197], v21 offset:24576
    v_mfma_f32_16x16x32_bf16 v[80:83], v[200:203], a[0:3], v[80:83]
    ds_read_b64_tr_b16 v[198:199], v21 offset:28672
    v_mfma_f32_16x16x32_bf16 v[84:87], v[200:203], a[4:7], v[84:87]
    buffer_load_dwordx4 a[60:63], v17, s[8:11], s55 offen sc1
    ds_read_b64_tr_b16 v[200:201], v22 offset:24576
    v_mfma_f32_16x16x32_bf16 v[88:91], v[204:207], a[0:3], v[88:91]
    ds_read_b64_tr_b16 v[202:203], v22 offset:28672
    s_add_u32 m0, s53, 73728
    v_mfma_f32_16x16x32_bf16 v[92:95], v[204:207], a[4:7], v[92:95]
    s_waitcnt lgkmcnt(12)
    ds_read_b64_tr_b16 v[204:205], v23 offset:24576
    v_mfma_f32_16x16x32_bf16 v[96:99], v[208:211], a[0:3], v[96:99]
    s_add_u32 s55, s55, 1024
    ds_read_b64_tr_b16 v[206:207], v23 offset:28672
    v_mfma_f32_16x16x32_bf16 v[100:103], v[208:211], a[4:7], v[100:103]
    buffer_load_dwordx4 v18, s[12:15], s54 offen lds
    ds_read_b64_tr_b16 v[208:209], v24 offset:24576
    v_mfma_f32_16x16x32_bf16 v[104:107], v[212:215], a[0:3], v[104:107]
    ds_read_b64_tr_b16 v[210:211], v24 offset:28672
    v_mfma_f32_16x16x32_bf16 v[108:111], v[212:215], a[4:7], v[108:111]
    s_waitcnt lgkmcnt(10)
    ds_read_b64_tr_b16 v[212:213], v25 offset:24576
    v_mfma_f32_16x16x32_bf16 v[112:115], v[216:219], a[0:3], v[112:115]
    ds_read_b64_tr_b16 v[214:215], v25 offset:28672
    v_cmp_gt_u32 vcc, 32, v11
    v_mfma_f32_16x16x32_bf16 v[116:119], v[216:219], a[4:7], v[116:119]
    buffer_load_dwordx4 v19, s[12:15], s54 offen offset:1024 lds
    ds_read_b64_tr_b16 v[216:217], v26 offset:24576
    v_mfma_f32_16x16x32_bf16 v[120:123], v[220:223], a[0:3], v[120:123]
    ds_read_b64_tr_b16 v[218:219], v26 offset:28672
    s_cbranch_vccnz k2_st_167
k2_bk_168:
    v_mfma_f32_16x16x32_bf16 v[124:127], v[220:223], a[4:7], v[124:127]
    ds_read_b64_tr_b16 v[220:221], v27 offset:24576
    ds_read_b64_tr_b16 v[222:223], v27 offset:28672
    s_add_u32 s54, s54, 32768
    s_waitcnt vmcnt(12) lgkmcnt(12)
    ds_add_u32 v45, v10 offset:256
    v_mfma_f32_16x16x32_bf16 v[64:67], v[192:195], a[8:11], v[64:67]
    ds_read_b32 v11, v45 offset:0
    buffer_load_dword v37, v36, s[8:11], s39 offen sc1
    v_mfma_f32_16x16x32_bf16 v[68:71], v[192:195], a[12:15], v[68:71]
    buffer_load_dwordx4 a[0:3], v16, s[8:11], s55 offen sc1
    ds_read_b64_tr_b16 v[192:193], v20 offset:32768
    v_mfma_f32_16x16x32_bf16 v[72:75], v[196:199], a[8:11], v[72:75]
    ds_read_b64_tr_b16 v[194:195], v20 offset:36864
    v_mfma_f32_16x16x32_bf16 v[76:79], v[196:199], a[12:15], v[76:79]
    s_waitcnt lgkmcnt(12)
    ds_read_b64_tr_b16 v[196:197], v21 offset:32768
    v_mfma_f32_16x16x32_bf16 v[80:83], v[200:203], a[8:11], v[80:83]
    ds_read_b64_tr_b16 v[198:199], v21 offset:36864
    v_mfma_f32_16x16x32_bf16 v[84:87], v[200:203], a[12:15], v[84:87]
    buffer_load_dwordx4 a[4:7], v17, s[8:11], s55 offen sc1
    ds_read_b64_tr_b16 v[200:201], v22 offset:32768
    v_mfma_f32_16x16x32_bf16 v[88:91], v[204:207], a[8:11], v[88:91]
    ds_read_b64_tr_b16 v[202:203], v22 offset:36864
    s_add_u32 m0, s53, 81920
    v_mfma_f32_16x16x32_bf16 v[92:95], v[204:207], a[12:15], v[92:95]
    s_waitcnt lgkmcnt(12)
    ds_read_b64_tr_b16 v[204:205], v23 offset:32768
    v_mfma_f32_16x16x32_bf16 v[96:99], v[208:211], a[8:11], v[96:99]
    s_add_u32 s55, s55, 1024
    ds_read_b64_tr_b16 v[206:207], v23 offset:36864
    v_mfma_f32_16x16x32_bf16 v[100:103], v[208:211], a[12:15], v[100:103]
    buffer_load_dwordx4 v18, s[12:15], s54 offen lds
    ds_read_b64_tr_b16 v[208:209], v24 offset:32768
    v_mfma_f32_16x16x32_bf16 v[104:107], v[212:215], a[8:11], v[104:107]
    ds_read_b64_tr_b16 v[210:211], v24 offset:36864
    v_mfma_f32_16x16x32_bf16 v[108:111], v[212:215], a[12:15], v[108:111]
    s_waitcnt lgkmcnt(10)
    ds_read_b64_tr_b16 v[212:213], v25 offset:32768
    v_mfma_f32_16x16x32_bf16 v[112:115], v[216:219], a[8:11], v[112:115]
    ds_read_b64_tr_b16 v[214:215], v25 offset:36864
    v_cmp_gt_u32 vcc, 36, v11
    v_mfma_f32_16x16x32_bf16 v[116:119], v[216:219], a[12:15], v[116:119]
    buffer_load_dwordx4 v19, s[12:15], s54 offen offset:1024 lds
    ds_read_b64_tr_b16 v[216:217], v26 offset:32768
    v_mfma_f32_16x16x32_bf16 v[120:123], v[220:223], a[8:11], v[120:123]
    ds_read_b64_tr_b16 v[218:219], v26 offset:36864
    s_cbranch_vccnz k2_st_171
k2_bk_172:
    v_mfma_f32_16x16x32_bf16 v[124:127], v[220:223], a[12:15], v[124:127]
    ds_read_b64_tr_b16 v[220:221], v27 offset:32768
    ds_read_b64_tr_b16 v[222:223], v27 offset:36864
    s_add_u32 s54, s54, 32768
    s_waitcnt vmcnt(13) lgkmcnt(12)
    ds_add_u32 v45, v10 offset:512
    v_mfma_f32_16x16x32_bf16 v[64:67], v[192:195], a[16:19], v[64:67]
    ds_read_b32 v11, v45 offset:256
    v_mfma_f32_16x16x32_bf16 v[68:71], v[192:195], a[20:23], v[68:71]
    buffer_load_dwordx4 a[8:11], v16, s[8:11], s55 offen sc1
    ds_read_b64_tr_b16 v[192:193], v20 offset:40960
    v_mfma_f32_16x16x32_bf16 v[72:75], v[196:199], a[16:19], v[72:75]
    ds_read_b64_tr_b16 v[194:195], v20 offset:45056
    v_mfma_f32_16x16x32_bf16 v[76:79], v[196:199], a[20:23], v[76:79]
    s_waitcnt lgkmcnt(12)
    ds_read_b64_tr_b16 v[196:197], v21 offset:40960
    v_mfma_f32_16x16x32_bf16 v[80:83], v[200:203], a[16:19], v[80:83]
    ds_read_b64_tr_b16 v[198:199], v21 offset:45056
    v_mfma_f32_16x16x32_bf16 v[84:87], v[200:203], a[20:23], v[84:87]
    buffer_load_dwordx4 a[12:15], v17, s[8:11], s55 offen sc1
    ds_read_b64_tr_b16 v[200:201], v22 offset:40960
    v_mfma_f32_16x16x32_bf16 v[88:91], v[204:207], a[16:19], v[88:91]
    ds_read_b64_tr_b16 v[202:203], v22 offset:45056
    s_add_u32 m0, s53, 90112
    v_mfma_f32_16x16x32_bf16 v[92:95], v[204:207], a[20:23], v[92:95]
    s_waitcnt lgkmcnt(12)
    ds_read_b64_tr_b16 v[204:205], v23 offset:40960
    v_mfma_f32_16x16x32_bf16 v[96:99], v[208:211], a[16:19], v[96:99]
    s_add_u32 s55, s55, 1024
    ds_read_b64_tr_b16 v[206:207], v23 offset:45056
    v_mfma_f32_16x16x32_bf16 v[100:103], v[208:211], a[20:23], v[100:103]
    buffer_load_dwordx4 v18, s[12:15], s54 offen lds
    ds_read_b64_tr_b16 v[208:209], v24 offset:40960
    v_mfma_f32_16x16x32_bf16 v[104:107], v[212:215], a[16:19], v[104:107]
    ds_read_b64_tr_b16 v[210:211], v24 offset:45056
    v_mfma_f32_16x16x32_bf16 v[108:111], v[212:215], a[20:23], v[108:111]
    s_waitcnt lgkmcnt(10)
    ds_read_b64_tr_b16 v[212:213], v25 offset:40960
    v_mfma_f32_16x16x32_bf16 v[112:115], v[216:219], a[16:19], v[112:115]
    ds_read_b64_tr_b16 v[214:215], v25 offset:45056
    v_cmp_gt_u32 vcc, 36, v11
    v_mfma_f32_16x16x32_bf16 v[116:119], v[216:219], a[20:23], v[116:119]
    buffer_load_dwordx4 v19, s[12:15], s54 offen offset:1024 lds
    ds_read_b64_tr_b16 v[216:217], v26 offset:40960
    v_mfma_f32_16x16x32_bf16 v[120:123], v[220:223], a[16:19], v[120:123]
    ds_read_b64_tr_b16 v[218:219], v26 offset:45056
    s_cbranch_vccnz k2_st_173
k2_bk_174:
    v_mfma_f32_16x16x32_bf16 v[124:127], v[220:223], a[20:23], v[124:127]
    ds_read_b64_tr_b16 v[220:221], v27 offset:40960
    ds_read_b64_tr_b16 v[222:223], v27 offset:45056
    s_add_u32 s54, s54, 32768
    s_waitcnt vmcnt(13) lgkmcnt(12)
    ds_add_u32 v45, v10 offset:0
    v_mfma_f32_16x16x32_bf16 v[64:67], v[192:195], a[24:27], v[64:67]
    ds_read_b32 v11, v45 offset:512
    v_mfma_f32_16x16x32_bf16 v[68:71], v[192:195], a[28:31], v[68:71]
    buffer_load_dwordx4 a[16:19], v16, s[8:11], s55 offen sc1
    ds_read_b64_tr_b16 v[192:193], v20 offset:49152
    v_mfma_f32_16x16x32_bf16 v[72:75], v[196:199], a[24:27], v[72:75]
    ds_read_b64_tr_b16 v[194:195], v20 offset:53248
    v_mfma_f32_16x16x32_bf16 v[76:79], v[196:199], a[28:31], v[76:79]
    s_waitcnt lgkmcnt(12)
    ds_read_b64_tr_b16 v[196:197], v21 offset:49152
    v_mfma_f32_16x16x32_bf16 v[80:83], v[200:203], a[24:27], v[80:83]
    ds_read_b64_tr_b16 v[198:199], v21 offset:53248
    v_mfma_f32_16x16x32_bf16 v[84:87], v[200:203], a[28:31], v[84:87]
    buffer_load_dwordx4 a[20:23], v17, s[8:11], s55 offen sc1
    ds_read_b64_tr_b16 v[200:201], v22 offset:49152
    v_mfma_f32_16x16x32_bf16 v[88:91], v[204:207], a[24:27], v[88:91]
    ds_read_b64_tr_b16 v[202:203], v22 offset:53248
    s_add_u32 m0, s53, 98304
    v_mfma_f32_16x16x32_bf16 v[92:95], v[204:207], a[28:31], v[92:95]
    s_waitcnt lgkmcnt(12)
    ds_read_b64_tr_b16 v[204:205], v23 offset:49152
    v_mfma_f32_16x16x32_bf16 v[96:99], v[208:211], a[24:27], v[96:99]
    s_add_u32 s55, s55, 1024
    ds_read_b64_tr_b16 v[206:207], v23 offset:53248
    v_mfma_f32_16x16x32_bf16 v[100:103], v[208:211], a[28:31], v[100:103]
    buffer_load_dwordx4 v18, s[12:15], s54 offen lds
    ds_read_b64_tr_b16 v[208:209], v24 offset:49152
    v_mfma_f32_16x16x32_bf16 v[104:107], v[212:215], a[24:27], v[104:107]
    ds_read_b64_tr_b16 v[210:211], v24 offset:53248
    v_mfma_f32_16x16x32_bf16 v[108:111], v[212:215], a[28:31], v[108:111]
    s_waitcnt lgkmcnt(10)
    ds_read_b64_tr_b16 v[212:213], v25 offset:49152
    v_mfma_f32_16x16x32_bf16 v[112:115], v[216:219], a[24:27], v[112:115]
    ds_read_b64_tr_b16 v[214:215], v25 offset:53248
    v_cmp_gt_u32 vcc, 36, v11
    v_mfma_f32_16x16x32_bf16 v[116:119], v[216:219], a[28:31], v[116:119]
    buffer_load_dwordx4 v19, s[12:15], s54 offen offset:1024 lds
    ds_read_b64_tr_b16 v[216:217], v26 offset:49152
    v_mfma_f32_16x16x32_bf16 v[120:123], v[220:223], a[24:27], v[120:123]
    ds_read_b64_tr_b16 v[218:219], v26 offset:53248
    s_cbranch_vccnz k2_st_175
k2_bk_176:
    v_mfma_f32_16x16x32_bf16 v[124:127], v[220:223], a[28:31], v[124:127]
    ds_read_b64_tr_b16 v[220:221], v27 offset:49152
    ds_read_b64_tr_b16 v[222:223], v27 offset:53248
    s_add_u32 s54, s54, 32768
    s_waitcnt vmcnt(12) lgkmcnt(12)
    v_cmp_eq_u32 vcc, 0, v37
    s_nop 1
    s_and_b32 s63, vcc_lo, 0xf000000
    s_cbranch_scc1 mg_ps_179
mg_pb_180:
    v_mfma_f32_16x16x32_bf16 v[64:67], v[192:195], a[32:35], v[64:67]
    ds_add_u32 v45, v10 offset:256
    ds_read_b32 v11, v45 offset:0
    v_mfma_f32_16x16x32_bf16 v[68:71], v[192:195], a[36:39], v[68:71]
    buffer_load_dwordx4 a[24:27], v16, s[8:11], s55 offen sc1
    ds_read_b64_tr_b16 v[192:193], v20 offset:57344
    v_mfma_f32_16x16x32_bf16 v[72:75], v[196:199], a[32:35], v[72:75]
    ds_read_b64_tr_b16 v[194:195], v20 offset:61440
    v_mfma_f32_16x16x32_bf16 v[76:79], v[196:199], a[36:39], v[76:79]
    s_waitcnt lgkmcnt(12)
    ds_read_b64_tr_b16 v[196:197], v21 offset:57344
    v_mfma_f32_16x16x32_bf16 v[80:83], v[200:203], a[32:35], v[80:83]
    ds_read_b64_tr_b16 v[198:199], v21 offset:61440
    v_mfma_f32_16x16x32_bf16 v[84:87], v[200:203], a[36:39], v[84:87]
    buffer_load_dwordx4 a[28:31], v17, s[8:11], s55 offen sc1
    ds_read_b64_tr_b16 v[200:201], v22 offset:57344
    v_mfma_f32_16x16x32_bf16 v[88:91], v[204:207], a[32:35], v[88:91]
    ds_read_b64_tr_b16 v[202:203], v22 offset:61440
    s_add_u32 m0, s53, 106496
    v_mfma_f32_16x16x32_bf16 v[92:95], v[204:207], a[36:39], v[92:95]
    s_waitcnt lgkmcnt(12)
    ds_read_b64_tr_b16 v[204:205], v23 offset:57344
    v_mfma_f32_16x16x32_bf16 v[96:99], v[208:211], a[32:35], v[96:99]
    s_add_u32 s55, s55, 1024
    ds_read_b64_tr_b16 v[206:207], v23 offset:61440
    v_mfma_f32_16x16x32_bf16 v[100:103], v[208:211], a[36:39], v[100:103]
    buffer_load_dwordx4 v18, s[12:15], s54 offen lds
    ds_read_b64_tr_b16 v[208:209], v24 offset:57344
    v_mfma_f32_16x16x32_bf16 v[104:107], v[212:215], a[32:35], v[104:107]
    ds_read_b64_tr_b16 v[210:211], v24 offset:61440
    v_mfma_f32_16x16x32_bf16 v[108:111], v[212:215], a[36:39], v[108:111]
    s_waitcnt lgkmcnt(10)
    ds_read_b64_tr_b16 v[212:213], v25 offset:57344
    v_mfma_f32_16x16x32_bf16 v[112:115], v[216:219], a[32:35], v[112:115]
    ds_read_b64_tr_b16 v[214:215], v25 offset:61440
    v_cmp_gt_u32 vcc, 40, v11
    v_mfma_f32_16x16x32_bf16 v[116:119], v[216:219], a[36:39], v[116:119]
    buffer_load_dwordx4 v19, s[12:15], s54 offen offset:1024 lds
    ds_read_b64_tr_b16 v[216:217], v26 offset:57344
    v_mfma_f32_16x16x32_bf16 v[120:123], v[220:223], a[32:35], v[120:123]
    ds_read_b64_tr_b16 v[218:219], v26 offset:61440
    s_cbranch_vccnz k2_st_177
k2_bk_178:
    v_mfma_f32_16x16x32_bf16 v[124:127], v[220:223], a[36:39], v[124:127]
    ds_read_b64_tr_b16 v[220:221], v27 offset:57344
    ds_read_b64_tr_b16 v[222:223], v27 offset:61440
    s_add_u32 s54, s54, 32768
    s_waitcnt vmcnt(12) lgkmcnt(12)
    ds_add_u32 v45, v10 offset:512
    v_mfma_f32_16x16x32_bf16 v[64:67], v[192:195], a[40:43], v[64:67]
    ds_read_b32 v11, v45 offset:256
    buffer_load_dword v37, v36, s[8:11], s39 offen sc1
    v_mfma_f32_16x16x32_bf16 v[68:71], v[192:195], a[44:47], v[68:71]
    buffer_load_dwordx4 a[32:35], v16, s[8:11], s55 offen sc1
    ds_read_b64_tr_b16 v[192:193], v28 offset:0
    v_mfma_f32_16x16x32_bf16 v[72:75], v[196:199], a[40:43], v[72:75]
    ds_read_b64_tr_b16 v[194:195], v28 offset:4096
    v_mfma_f32_16x16x32_bf16 v[76:79], v[196:199], a[44:47], v[76:79]
    s_waitcnt lgkmcnt(12)
    ds_read_b64_tr_b16 v[196:197], v29 offset:0
    v_mfma_f32_16x16x32_bf16 v[80:83], v[200:203], a[40:43], v[80:83]
    ds_read_b64_tr_b16 v[198:199], v29 offset:4096
    v_mfma_f32_16x16x32_bf16 v[84:87], v[200:203], a[44:47], v[84:87]
    buffer_load_dwordx4 a[36:39], v17, s[8:11], s55 offen sc1
    ds_read_b64_tr_b16 v[200:201], v30 offset:0
    v_mfma_f32_16x16x32_bf16 v[88:91], v[204:207], a[40:43], v[88:91]
    ds_read_b64_tr_b16 v[202:203], v30 offset:4096
    s_add_u32 m0, s53, 114688
    v_mfma_f32_16x16x32_bf16 v[92:95], v[204:207], a[44:47], v[92:95]
    s_waitcnt lgkmcnt(12)
    ds_read_b64_tr_b16 v[204:205], v31 offset:0
    v_mfma_f32_16x16x32_bf16 v[96:99], v[208:211], a[40:43], v[96:99]
    s_add_u32 s55, s55, 1024
    ds_read_b64_tr_b16 v[206:207], v31 offset:4096
    v_mfma_f32_16x16x32_bf16 v[100:103], v[208:211], a[44:47], v[100:103]
    buffer_load_dwordx4 v18, s[12:15], s54 offen lds
    ds_read_b64_tr_b16 v[208:209], v32 offset:0
    v_mfma_f32_16x16x32_bf16 v[104:107], v[212:215], a[40:43], v[104:107]
    ds_read_b64_tr_b16 v[210:211], v32 offset:4096
    v_mfma_f32_16x16x32_bf16 v[108:111], v[212:215], a[44:47], v[108:111]
    s_waitcnt lgkmcnt(10)
    ds_read_b64_tr_b16 v[212:213], v33 offset:0
    v_mfma_f32_16x16x32_bf16 v[112:115], v[216:219], a[40:43], v[112:115]
    ds_read_b64_tr_b16 v[214:215], v33 offset:4096
    v_cmp_gt_u32 vcc, 40, v11
    v_mfma_f32_16x16x32_bf16 v[116:119], v[216:219], a[44:47], v[116:119]
    buffer_load_dwordx4 v19, s[12:15], s54 offen offset:1024 lds
    ds_read_b64_tr_b16 v[216:217], v34 offset:0
    v_mfma_f32_16x16x32_bf16 v[120:123], v[220:223], a[40:43], v[120:123]
    ds_read_b64_tr_b16 v[218:219], v34 offset:4096
    s_cbranch_vccnz k2_st_181
k2_bk_182:
    v_mfma_f32_16x16x32_bf16 v[124:127], v[220:223], a[44:47], v[124:127]
    ds_read_b64_tr_b16 v[220:221], v35 offset:0
    ds_read_b64_tr_b16 v[222:223], v35 offset:4096
    s_add_u32 s54, s54, 32768
    s_waitcnt vmcnt(13) lgkmcnt(12)
    ds_add_u32 v45, v10 offset:0
    v_mfma_f32_16x16x32_bf16 v[64:67], v[192:195], a[48:51], v[64:67]
    ds_read_b32 v11, v45 offset:512
    v_mfma_f32_16x16x32_bf16 v[68:71], v[192:195], a[52:55], v[68:71]
    buffer_load_dwordx4 a[40:43], v16, s[8:11], s55 offen sc1
    ds_read_b64_tr_b16 v[192:193], v28 offset:8192
    v_mfma_f32_16x16x32_bf16 v[72:75], v[196:199], a[48:51], v[72:75]
    ds_read_b64_tr_b16 v[194:195], v28 offset:12288
    v_mfma_f32_16x16x32_bf16 v[76:79], v[196:199], a[52:55], v[76:79]
    s_waitcnt lgkmcnt(12)
    ds_read_b64_tr_b16 v[196:197], v29 offset:8192
    v_mfma_f32_16x16x32_bf16 v[80:83], v[200:203], a[48:51], v[80:83]
    ds_read_b64_tr_b16 v[198:199], v29 offset:12288
    v_mfma_f32_16x16x32_bf16 v[84:87], v[200:203], a[52:55], v[84:87]
    buffer_load_dwordx4 a[44:47], v17, s[8:11], s55 offen sc1
    ds_read_b64_tr_b16 v[200:201], v30 offset:8192
    v_mfma_f32_16x16x32_bf16 v[88:91], v[204:207], a[48:51], v[88:91]
    ds_read_b64_tr_b16 v[202:203], v30 offset:12288
    s_add_u32 m0, s53, 122880
    v_mfma_f32_16x16x32_bf16 v[92:95], v[204:207], a[52:55], v[92:95]
    s_waitcnt lgkmcnt(12)
    ds_read_b64_tr_b16 v[204:205], v31 offset:8192
    v_mfma_f32_16x16x32_bf16 v[96:99], v[208:211], a[48:51], v[96:99]
    s_add_u32 s55, s55, 1024
    ds_read_b64_tr_b16 v[206:207], v31 offset:12288
    v_mfma_f32_16x16x32_bf16 v[100:103], v[208:211], a[52:55], v[100:103]
    buffer_load_dwordx4 v18, s[12:15], s54 offen lds
    ds_read_b64_tr_b16 v[208:209], v32 offset:8192
    v_mfma_f32_16x16x32_bf16 v[104:107], v[212:215], a[48:51], v[104:107]
    ds_read_b64_tr_b16 v[210:211], v32 offset:12288
    v_mfma_f32_16x16x32_bf16 v[108:111], v[212:215], a[52:55], v[108:111]
    s_waitcnt lgkmcnt(10)
    ds_read_b64_tr_b16 v[212:213], v33 offset:8192
    v_mfma_f32_16x16x32_bf16 v[112:115], v[216:219], a[48:51], v[112:115]
    ds_read_b64_tr_b16 v[214:215], v33 offset:12288
    v_cmp_gt_u32 vcc, 40, v11
    v_mfma_f32_16x16x32_bf16 v[116:119], v[216:219], a[52:55], v[116:119]
    buffer_load_dwordx4 v19, s[12:15], s54 offen offset:1024 lds
    ds_read_b64_tr_b16 v[216:217], v34 offset:8192
    v_mfma_f32_16x16x32_bf16 v[120:123], v[220:223], a[48:51], v[120:123]
    ds_read_b64_tr_b16 v[218:219], v34 offset:12288
    s_cbranch_vccnz k2_st_183
k2_bk_184:
    v_mfma_f32_16x16x32_bf16 v[124:127], v[220:223], a[52:55], v[124:127]
    ds_read_b64_tr_b16 v[220:221], v35 offset:8192
    ds_read_b64_tr_b16 v[222:223], v35 offset:12288
    s_add_u32 s54, s54, 32768
    s_waitcnt vmcnt(13) lgkmcnt(12)
    ds_add_u32 v45, v10 offset:256
    v_mfma_f32_16x16x32_bf16 v[64:67], v[192:195], a[56:59], v[64:67]
    ds_read_b32 v11, v45 offset:0
    v_mfma_f32_16x16x32_bf16 v[68:71], v[192:195], a[60:63], v[68:71]
    buffer_load_dwordx4 a[48:51], v16, s[8:11], s55 offen sc1
    ds_read_b64_tr_b16 v[192:193], v28 offset:16384
    v_mfma_f32_16x16x32_bf16 v[72:75], v[196:199], a[56:59], v[72:75]
    ds_read_b64_tr_b16 v[194:195], v28 offset:20480
    v_mfma_f32_16x16x32_bf16 v[76:79], v[196:199], a[60:63], v[76:79]
    s_waitcnt lgkmcnt(12)
    ds_read_b64_tr_b16 v[196:197], v29 offset:16384
    v_mfma_f32_16x16x32_bf16 v[80:83], v[200:203], a[56:59], v[80:83]
    ds_read_b64_tr_b16 v[198:199], v29 offset:20480
    v_mfma_f32_16x16x32_bf16 v[84:87], v[200:203], a[60:63], v[84:87]
    buffer_load_dwordx4 a[52:55], v17, s[8:11], s55 offen sc1
    ds_read_b64_tr_b16 v[200:201], v30 offset:16384
    v_mfma_f32_16x16x32_bf16 v[88:91], v[204:207], a[56:59], v[88:91]
    ds_read_b64_tr_b16 v[202:203], v30 offset:20480
    s_add_u32 m0, s53, 0
    v_mfma_f32_16x16x32_bf16 v[92:95], v[204:207], a[60:63], v[92:95]
    s_waitcnt lgkmcnt(12)
    ds_read_b64_tr_b16 v[204:205], v31 offset:16384
    v_mfma_f32_16x16x32_bf16 v[96:99], v[208:211], a[56:59], v[96:99]
    s_add_u32 s55, s55, 1024
    ds_read_b64_tr_b16 v[206:207], v31 offset:20480
    v_mfma_f32_16x16x32_bf16 v[100:103], v[208:211], a[60:63], v[100:103]
    buffer_load_dwordx4 v18, s[12:15], s54 offen lds
    ds_read_b64_tr_b16 v[208:209], v32 offset:16384
    v_mfma_f32_16x16x32_bf16 v[104:107], v[212:215], a[56:59], v[104:107]
    ds_read_b64_tr_b16 v[210:211], v32 offset:20480
    v_mfma_f32_16x16x32_bf16 v[108:111], v[212:215], a[60:63], v[108:111]
    s_waitcnt lgkmcnt(10)
    ds_read_b64_tr_b16 v[212:213], v33 offset:16384
    v_mfma_f32_16x16x32_bf16 v[112:115], v[216:219], a[56:59], v[112:115]
    ds_read_b64_tr_b16 v[214:215], v33 offset:20480
    v_cmp_gt_u32 vcc, 44, v11
    v_mfma_f32_16x16x32_bf16 v[116:119], v[216:219], a[60:63], v[116:119]
    buffer_load_dwordx4 v19, s[12:15], s54 offen offset:1024 lds
    ds_read_b64_tr_b16 v[216:217], v34 offset:16384
    v_mfma_f32_16x16x32_bf16 v[120:123], v[220:223], a[56:59], v[120:123]
    ds_read_b64_tr_b16 v[218:219], v34 offset:20480
    s_cbranch_vccnz k2_st_185
k2_bk_186:
    v_mfma_f32_16x16x32_bf16 v[124:127], v[220:223], a[60:63], v[124:127]
    ds_read_b64_tr_b16 v[220:221], v35 offset:16384
    ds_read_b64_tr_b16 v[222:223], v35 offset:20480
    s_add_u32 s54, s54, 32768
    s_waitcnt vmcnt(12) lgkmcnt(12)
    v_cmp_eq_u32 vcc, 0, v37
    s_nop 1
    s_and_b32 s63, vcc_lo, 0xf0000000
    s_cbranch_scc1 mg_ps_189
mg_pb_190:
    v_mfma_f32_16x16x32_bf16 v[64:67], v[192:195], a[0:3], v[64:67]
    ds_add_u32 v45, v10 offset:512
    ds_read_b32 v11, v45 offset:256
    v_mfma_f32_16x16x32_bf16 v[68:71], v[192:195], a[4:7], v[68:71]
    buffer_load_dwordx4 a[56:59], v16, s[8:11], s55 offen sc1
    ds_read_b64_tr_b16 v[192:193], v28 offset:24576
    v_mfma_f32_16x16x32_bf16 v[72:75], v[196:199], a[0:3], v[72:75]
    ds_read_b64_tr_b16 v[194:195], v28 offset:28672
    v_mfma_f32_16x16x32_bf16 v[76:79], v[196:199], a[4:7], v[76:79]
    s_waitcnt lgkmcnt(12)
    ds_read_b64_tr_b16 v[196:197], v29 offset:24576
    v_mfma_f32_16x16x32_bf16 v[80:83], v[200:203], a[0:3], v[80:83]
    ds_read_b64_tr_b16 v[198:199], v29 offset:28672
    v_mfma_f32_16x16x32_bf16 v[84:87], v[200:203], a[4:7], v[84:87]
    buffer_load_dwordx4 a[60:63], v17, s[8:11], s55 offen sc1
    ds_read_b64_tr_b16 v[200:201], v30 offset:24576
    v_mfma_f32_16x16x32_bf16 v[88:91], v[204:207], a[0:3], v[88:91]
    ds_read_b64_tr_b16 v[202:203], v30 offset:28672
    s_add_u32 m0, s53, 8192
    v_mfma_f32_16x16x32_bf16 v[92:95], v[204:207], a[4:7], v[92:95]
    s_waitcnt lgkmcnt(12)
    ds_read_b64_tr_b16 v[204:205], v31 offset:24576
    v_mfma_f32_16x16x32_bf16 v[96:99], v[208:211], a[0:3], v[96:99]
    s_add_u32 s55, s55, 1024
    ds_read_b64_tr_b16 v[206:207], v31 offset:28672
    v_mfma_f32_16x16x32_bf16 v[100:103], v[208:211], a[4:7], v[100:103]
    buffer_load_dwordx4 v18, s[12:15], s54 offen lds
    ds_read_b64_tr_b16 v[208:209], v32 offset:24576
    v_mfma_f32_16x16x32_bf16 v[104:107], v[212:215], a[0:3], v[104:107]
    ds_read_b64_tr_b16 v[210:211], v32 offset:28672
    v_mfma_f32_16x16x32_bf16 v[108:111], v[212:215], a[4:7], v[108:111]
    s_waitcnt lgkmcnt(10)
    ds_read_b64_tr_b16 v[212:213], v33 offset:24576
    v_mfma_f32_16x16x32_bf16 v[112:115], v[216:219], a[0:3], v[112:115]
    ds_read_b64_tr_b16 v[214:215], v33 offset:28672
    v_cmp_gt_u32 vcc, 44, v11
    v_mfma_f32_16x16x32_bf16 v[116:119], v[216:219], a[4:7], v[116:119]
    buffer_load_dwordx4 v19, s[12:15], s54 offen offset:1024 lds
    ds_read_b64_tr_b16 v[216:217], v34 offset:24576
    v_mfma_f32_16x16x32_bf16 v[120:123], v[220:223], a[0:3], v[120:123]
    ds_read_b64_tr_b16 v[218:219], v34 offset:28672
    s_cbranch_vccnz k2_st_187
k2_bk_188:
    v_mfma_f32_16x16x32_bf16 v[124:127], v[220:223], a[4:7], v[124:127]
    ds_read_b64_tr_b16 v[220:221], v35 offset:24576
    ds_read_b64_tr_b16 v[222:223], v35 offset:28672
    s_add_u32 s54, s54, 32768
    s_waitcnt vmcnt(12) lgkmcnt(12)
    ds_add_u32 v45, v10 offset:0
    v_mfma_f32_16x16x32_bf16 v[64:67], v[192:195], a[8:11], v[64:67]
    ds_read_b32 v11, v45 offset:512
    v_mfma_f32_16x16x32_bf16 v[68:71], v[192:195], a[12:15], v[68:71]
    buffer_load_dwordx4 a[0:3], v16, s[8:11], s55 offen sc1
    ds_read_b64_tr_b16 v[192:193], v28 offset:32768
    v_mfma_f32_16x16x32_bf16 v[72:75], v[196:199], a[8:11], v[72:75]
    ds_read_b64_tr_b16 v[194:195], v28 offset:36864
    buffer_load_dwordx2 v[48:49], v38, s[16:19], s62 offen offset:0
    v_mfma_f32_16x16x32_bf16 v[76:79], v[196:199], a[12:15], v[76:79]
    s_waitcnt lgkmcnt(12)
    ds_read_b64_tr_b16 v[196:197], v29 offset:32768
    v_mfma_f32_16x16x32_bf16 v[80:83], v[200:203], a[8:11], v[80:83]
    ds_read_b64_tr_b16 v[198:199], v29 offset:36864
    v_mfma_f32_16x16x32_bf16 v[84:87], v[200:203], a[12:15], v[84:87]
    buffer_load_dwordx4 a[4:7], v17, s[8:11], s55 offen sc1
    ds_read_b64_tr_b16 v[200:201], v30 offset:32768
    v_mfma_f32_16x16x32_bf16 v[88:91], v[204:207], a[8:11], v[88:91]
    ds_read_b64_tr_b16 v[202:203], v30 offset:36864
    s_add_u32 m0, s53, 16384
    v_mfma_f32_16x16x32_bf16 v[92:95], v[204:207], a[12:15], v[92:95]
    s_waitcnt lgkmcnt(12)
    ds_read_b64_tr_b16 v[204:205], v31 offset:32768
    v_mfma_f32_16x16x32_bf16 v[96:99], v[208:211], a[8:11], v[96:99]
    s_add_u32 s55, s55, 1024
    ds_read_b64_tr_b16 v[206:207], v31 offset:36864
    v_mfma_f32_16x16x32_bf16 v[100:103], v[208:211], a[12:15], v[100:103]
    buffer_load_dwordx4 v18, s[12:15], s54 offen lds
    ds_read_b64_tr_b16 v[208:209], v32 offset:32768
    v_mfma_f32_16x16x32_bf16 v[104:107], v[212:215], a[8:11], v[104:107]
    ds_read_b64_tr_b16 v[210:211], v32 offset:36864
    buffer_load_dwordx2 v[50:51], v38, s[16:19], s62 offen offset:32
    v_mfma_f32_16x16x32_bf16 v[108:111], v[212:215], a[12:15], v[108:111]
    s_waitcnt lgkmcnt(10)
    ds_read_b64_tr_b16 v[212:213], v33 offset:32768
    v_mfma_f32_16x16x32_bf16 v[112:115], v[216:219], a[8:11], v[112:115]
    ds_read_b64_tr_b16 v[214:215], v33 offset:36864
    v_cmp_gt_u32 vcc, 44, v11
    v_mfma_f32_16x16x32_bf16 v[116:119], v[216:219], a[12:15], v[116:119]
    buffer_load_dwordx4 v19, s[12:15], s54 offen offset:1024 lds
    ds_read_b64_tr_b16 v[216:217], v34 offset:32768
    v_mfma_f32_16x16x32_bf16 v[120:123], v[220:223], a[8:11], v[120:123]
    ds_read_b64_tr_b16 v[218:219], v34 offset:36864
    s_cbranch_vccnz k2_st_191
k2_bk_192:
    v_mfma_f32_16x16x32_bf16 v[124:127], v[220:223], a[12:15], v[124:127]
    ds_read_b64_tr_b16 v[220:221], v35 offset:32768
    ds_read_b64_tr_b16 v[222:223], v35 offset:36864
    s_add_u32 s54, s54, 32768
    buffer_load_dwordx2 v[52:53], v38, s[16:19], s62 offen offset:64
    buffer_load_dwordx2 v[54:55], v38, s[16:19], s62 offen offset:96
    s_waitcnt vmcnt(16) lgkmcnt(12)
    ds_add_u32 v45, v10 offset:256
    v_mfma_f32_16x16x32_bf16 v[64:67], v[192:195], a[16:19], v[64:67]
    ds_read_b32 v11, v45 offset:0
    v_mfma_f32_16x16x32_bf16 v[68:71], v[192:195], a[20:23], v[68:71]
    buffer_load_dwordx4 a[8:11], v16, s[8:11], s55 offen sc1
    ds_read_b64_tr_b16 v[192:193], v28 offset:40960
    v_mfma_f32_16x16x32_bf16 v[72:75], v[196:199], a[16:19], v[72:75]
    ds_read_b64_tr_b16 v[194:195], v28 offset:45056
    v_mfma_f32_16x16x32_bf16 v[76:79], v[196:199], a[20:23], v[76:79]
    s_waitcnt lgkmcnt(12)
    ds_read_b64_tr_b16 v[196:197], v29 offset:40960
    v_mfma_f32_16x16x32_bf16 v[80:83], v[200:203], a[16:19], v[80:83]
    ds_read_b64_tr_b16 v[198:199], v29 offset:45056
    v_mfma_f32_16x16x32_bf16 v[84:87], v[200:203], a[20:23], v[84:87]
    buffer_load_dwordx4 a[12:15], v17, s[8:11], s55 offen sc1
    ds_read_b64_tr_b16 v[200:201], v30 offset:40960
    v_mfma_f32_16x16x32_bf16 v[88:91], v[204:207], a[16:19], v[88:91]
    ds_read_b64_tr_b16 v[202:203], v30 offset:45056
    s_add_u32 m0, s53, 24576
    v_mfma_f32_16x16x32_bf16 v[92:95], v[204:207], a[20:23], v[92:95]
    s_waitcnt lgkmcnt(12)
    ds_read_b64_tr_b16 v[204:205], v31 offset:40960
    v_mfma_f32_16x16x32_bf16 v[96:99], v[208:211], a[16:19], v[96:99]
    s_add_u32 s55, s55, 1024
    ds_read_b64_tr_b16 v[206:207], v31 offset:45056
    v_mfma_f32_16x16x32_bf16 v[100:103], v[208:211], a[20:23], v[100:103]
    buffer_load_dwordx4 v18, s[12:15], s54 offen lds
    ds_read_b64_tr_b16 v[208:209], v32 offset:40960
    v_mfma_f32_16x16x32_bf16 v[104:107], v[212:215], a[16:19], v[104:107]
    ds_read_b64_tr_b16 v[210:211], v32 offset:45056
    v_mfma_f32_16x16x32_bf16 v[108:111], v[212:215], a[20:23], v[108:111]
    s_waitcnt lgkmcnt(10)
    ds_read_b64_tr_b16 v[212:213], v33 offset:40960
    v_mfma_f32_16x16x32_bf16 v[112:115], v[216:219], a[16:19], v[112:115]
    ds_read_b64_tr_b16 v[214:215], v33 offset:45056
    v_cmp_gt_u32 vcc, 48, v11
    v_mfma_f32_16x16x32_bf16 v[116:119], v[216:219], a[20:23], v[116:119]
    buffer_load_dwordx4 v19, s[12:15], s54 offen offset:1024 lds
    ds_read_b64_tr_b16 v[216:217], v34 offset:40960
    v_mfma_f32_16x16x32_bf16 v[120:123], v[220:223], a[16:19], v[120:123]
    ds_read_b64_tr_b16 v[218:219], v34 offset:45056
    s_cbranch_vccnz k2_st_193
k2_bk_194:
    v_mfma_f32_16x16x32_bf16 v[124:127], v[220:223], a[20:23], v[124:127]
    ds_read_b64_tr_b16 v[220:221], v35 offset:40960
    ds_read_b64_tr_b16 v[222:223], v35 offset:45056
    s_add_u32 s54, s54, 32768
    s_waitcnt vmcnt(16) lgkmcnt(12)
    ds_add_u32 v45, v10 offset:512
    v_mfma_f32_16x16x32_bf16 v[64:67], v[192:195], a[24:27], v[64:67]
    ds_read_b32 v11, v45 offset:256
    v_mfma_f32_16x16x32_bf16 v[68:71], v[192:195], a[28:31], v[68:71]
    buffer_load_dwordx4 a[16:19], v16, s[8:11], s55 offen sc1
    ds_read_b64_tr_b16 v[192:193], v28 offset:49152
    v_mfma_f32_16x16x32_bf16 v[72:75], v[196:199], a[24:27], v[72:75]
    ds_read_b64_tr_b16 v[194:195], v28 offset:53248
    v_mfma_f32_16x16x32_bf16 v[76:79], v[196:199], a[28:31], v[76:79]
    s_waitcnt lgkmcnt(12)
    ds_read_b64_tr_b16 v[196:197], v29 offset:49152
    v_mfma_f32_16x16x32_bf16 v[80:83], v[200:203], a[24:27], v[80:83]
    ds_read_b64_tr_b16 v[198:199], v29 offset:53248
    v_mfma_f32_16x16x32_bf16 v[84:87], v[200:203], a[28:31], v[84:87]
    buffer_load_dwordx4 a[20:23], v17, s[8:11], s55 offen sc1
    ds_read_b64_tr_b16 v[200:201], v30 offset:49152
    v_mfma_f32_16x16x32_bf16 v[88:91], v[204:207], a[24:27], v[88:91]
    ds_read_b64_tr_b16 v[202:203], v30 offset:53248
    s_add_u32 m0, s53, 32768
    v_mfma_f32_16x16x32_bf16 v[92:95], v[204:207], a[28:31], v[92:95]
    s_waitcnt lgkmcnt(12)
    ds_read_b64_tr_b16 v[204:205], v31 offset:49152
    v_mfma_f32_16x16x32_bf16 v[96:99], v[208:211], a[24:27], v[96:99]
    s_add_u32 s55, s55, 1024
    ds_read_b64_tr_b16 v[206:207], v31 offset:53248
    v_mfma_f32_16x16x32_bf16 v[100:103], v[208:211], a[28:31], v[100:103]
    buffer_load_dwordx4 v18, s[12:15], s54 offen lds
    ds_read_b64_tr_b16 v[208:209], v32 offset:49152
    v_mfma_f32_16x16x32_bf16 v[104:107], v[212:215], a[24:27], v[104:107]
    ds_read_b64_tr_b16 v[210:211], v32 offset:53248
    v_mfma_f32_16x16x32_bf16 v[108:111], v[212:215], a[28:31], v[108:111]
    s_waitcnt lgkmcnt(10)
    ds_read_b64_tr_b16 v[212:213], v33 offset:49152
    v_mfma_f32_16x16x32_bf16 v[112:115], v[216:219], a[24:27], v[112:115]
    ds_read_b64_tr_b16 v[214:215], v33 offset:53248
    v_cmp_gt_u32 vcc, 48, v11
    v_mfma_f32_16x16x32_bf16 v[116:119], v[216:219], a[28:31], v[116:119]
    buffer_load_dwordx4 v19, s[12:15], s54 offen offset:1024 lds
    ds_read_b64_tr_b16 v[216:217], v34 offset:49152
    v_mfma_f32_16x16x32_bf16 v[120:123], v[220:223], a[24:27], v[120:123]
    ds_read_b64_tr_b16 v[218:219], v34 offset:53248
    s_cbranch_vccnz k2_st_195
k2_bk_196:
    v_mfma_f32_16x16x32_bf16 v[124:127], v[220:223], a[28:31], v[124:127]
    ds_read_b64_tr_b16 v[220:221], v35 offset:49152
    ds_read_b64_tr_b16 v[222:223], v35 offset:53248
    s_add_u32 s54, s54, 32768
    s_waitcnt vmcnt(16) lgkmcnt(12)
    ds_add_u32 v45, v10 offset:0
    v_mfma_f32_16x16x32_bf16 v[64:67], v[192:195], a[32:35], v[64:67]
    ds_read_b32 v11, v45 offset:512
    v_mfma_f32_16x16x32_bf16 v[68:71], v[192:195], a[36:39], v[68:71]
    ds_read_b64_tr_b16 v[192:193], v28 offset:57344
    v_mfma_f32_16x16x32_bf16 v[72:75], v[196:199], a[32:35], v[72:75]
    ds_read_b64_tr_b16 v[194:195], v28 offset:61440
    v_mfma_f32_16x16x32_bf16 v[76:79], v[196:199], a[36:39], v[76:79]
    s_waitcnt lgkmcnt(12)
    ds_read_b64_tr_b16 v[196:197], v29 offset:57344
    v_mfma_f32_16x16x32_bf16 v[80:83], v[200:203], a[32:35], v[80:83]
    ds_read_b64_tr_b16 v[198:199], v29 offset:61440
    v_mfma_f32_16x16x32_bf16 v[84:87], v[200:203], a[36:39], v[84:87]
    ds_read_b64_tr_b16 v[200:201], v30 offset:57344
    v_mfma_f32_16x16x32_bf16 v[88:91], v[204:207], a[32:35], v[88:91]
    ds_read_b64_tr_b16 v[202:203], v30 offset:61440
    v_mfma_f32_16x16x32_bf16 v[92:95], v[204:207], a[36:39], v[92:95]
    s_waitcnt lgkmcnt(12)
    ds_read_b64_tr_b16 v[204:205], v31 offset:57344
    v_mfma_f32_16x16x32_bf16 v[96:99], v[208:211], a[32:35], v[96:99]
    ds_read_b64_tr_b16 v[206:207], v31 offset:61440
    v_mfma_f32_16x16x32_bf16 v[100:103], v[208:211], a[36:39], v[100:103]
    ds_read_b64_tr_b16 v[208:209], v32 offset:57344
    v_mfma_f32_16x16x32_bf16 v[104:107], v[212:215], a[32:35], v[104:107]
    ds_read_b64_tr_b16 v[210:211], v32 offset:61440
    v_mfma_f32_16x16x32_bf16 v[108:111], v[212:215], a[36:39], v[108:111]
    s_waitcnt lgkmcnt(10)
    ds_read_b64_tr_b16 v[212:213], v33 offset:57344
    v_mfma_f32_16x16x32_bf16 v[112:115], v[216:219], a[32:35], v[112:115]
    ds_read_b64_tr_b16 v[214:215], v33 offset:61440
    v_cmp_gt_u32 vcc, 48, v11
    v_mfma_f32_16x16x32_bf16 v[116:119], v[216:219], a[36:39], v[116:119]
    ds_read_b64_tr_b16 v[216:217], v34 offset:57344
    s_cbranch_vccnz k2_st_197
k2_bk_198:
    v_mfma_f32_16x16x32_bf16 v[120:123], v[220:223], a[32:35], v[120:123]
    ds_read_b64_tr_b16 v[218:219], v34 offset:61440
    v_mfma_f32_16x16x32_bf16 v[124:127], v[220:223], a[36:39], v[124:127]
    ds_read_b64_tr_b16 v[220:221], v35 offset:57344
    ds_read_b64_tr_b16 v[222:223], v35 offset:61440
    s_waitcnt vmcnt(10) lgkmcnt(12)
    ds_add_u32 v45, v10 offset:256
    v_mfma_f32_16x16x32_bf16 v[64:67], v[192:195], a[40:43], v[64:67]
    ds_read_b32 v11, v45 offset:0
    v_mfma_f32_16x16x32_bf16 v[68:71], v[192:195], a[44:47], v[68:71]
    ds_read_b64_tr_b16 v[192:193], v20 offset:0
    v_mfma_f32_16x16x32_bf16 v[72:75], v[196:199], a[40:43], v[72:75]
    ds_read_b64_tr_b16 v[194:195], v20 offset:4096
    v_mfma_f32_16x16x32_bf16 v[76:79], v[196:199], a[44:47], v[76:79]
    s_waitcnt lgkmcnt(12)
    ds_read_b64_tr_b16 v[196:197], v21 offset:0
    v_mfma_f32_16x16x32_bf16 v[80:83], v[200:203], a[40:43], v[80:83]
    ds_read_b64_tr_b16 v[198:199], v21 offset:4096
    v_mfma_f32_16x16x32_bf16 v[84:87], v[200:203], a[44:47], v[84:87]
    ds_read_b64_tr_b16 v[200:201], v22 offset:0
    v_mfma_f32_16x16x32_bf16 v[88:91], v[204:207], a[40:43], v[88:91]
    ds_read_b64_tr_b16 v[202:203], v22 offset:4096
    v_mfma_f32_16x16x32_bf16 v[92:95], v[204:207], a[44:47], v[92:95]
    s_waitcnt lgkmcnt(12)
    ds_read_b64_tr_b16 v[204:205], v23 offset:0
    v_mfma_f32_16x16x32_bf16 v[96:99], v[208:211], a[40:43], v[96:99]
    ds_read_b64_tr_b16 v[206:207], v23 offset:4096
    v_mfma_f32_16x16x32_bf16 v[100:103], v[208:211], a[44:47], v[100:103]
    ds_read_b64_tr_b16 v[208:209], v24 offset:0
    v_mfma_f32_16x16x32_bf16 v[104:107], v[212:215], a[40:43], v[104:107]
    ds_read_b64_tr_b16 v[210:211], v24 offset:4096
    v_mfma_f32_16x16x32_bf16 v[108:111], v[212:215], a[44:47], v[108:111]
    s_waitcnt lgkmcnt(10)
    ds_read_b64_tr_b16 v[212:213], v25 offset:0
    v_mfma_f32_16x16x32_bf16 v[112:115], v[216:219], a[40:43], v[112:115]
    ds_read_b64_tr_b16 v[214:215], v25 offset:4096
    v_cmp_gt_u32 vcc, 52, v11
    v_mfma_f32_16x16x32_bf16 v[116:119], v[216:219], a[44:47], v[116:119]
    ds_read_b64_tr_b16 v[216:217], v26 offset:0
    s_cbranch_vccnz k2_st_199
k2_bk_200:
    v_mfma_f32_16x16x32_bf16 v[120:123], v[220:223], a[40:43], v[120:123]
    ds_read_b64_tr_b16 v[218:219], v26 offset:4096
    v_mfma_f32_16x16x32_bf16 v[124:127], v[220:223], a[44:47], v[124:127]
    ds_read_b64_tr_b16 v[220:221], v27 offset:0
    ds_read_b64_tr_b16 v[222:223], v27 offset:4096
    s_waitcnt vmcnt(4) lgkmcnt(12)
    ds_add_u32 v45, v10 offset:512
    v_mfma_f32_16x16x32_bf16 v[64:67], v[192:195], a[48:51], v[64:67]
    ds_read_b32 v11, v45 offset:256
    v_mfma_f32_16x16x32_bf16 v[68:71], v[192:195], a[52:55], v[68:71]
    ds_read_b64_tr_b16 v[192:193], v20 offset:8192
    v_mfma_f32_16x16x32_bf16 v[72:75], v[196:199], a[48:51], v[72:75]
    ds_read_b64_tr_b16 v[194:195], v20 offset:12288
    v_mfma_f32_16x16x32_bf16 v[76:79], v[196:199], a[52:55], v[76:79]
    s_waitcnt lgkmcnt(12)
    ds_read_b64_tr_b16 v[196:197], v21 offset:8192
    v_mfma_f32_16x16x32_bf16 v[80:83], v[200:203], a[48:51], v[80:83]
    ds_read_b64_tr_b16 v[198:199], v21 offset:12288
    v_mfma_f32_16x16x32_bf16 v[84:87], v[200:203], a[52:55], v[84:87]
    ds_read_b64_tr_b16 v[200:201], v22 offset:8192
    v_mfma_f32_16x16x32_bf16 v[88:91], v[204:207], a[48:51], v[88:91]
    ds_read_b64_tr_b16 v[202:203], v22 offset:12288
    v_mfma_f32_16x16x32_bf16 v[92:95], v[204:207], a[52:55], v[92:95]
    s_waitcnt lgkmcnt(12)
    ds_read_b64_tr_b16 v[204:205], v23 offset:8192
    v_mfma_f32_16x16x32_bf16 v[96:99], v[208:211], a[48:51], v[96:99]
    ds_read_b64_tr_b16 v[206:207], v23 offset:12288
    v_mfma_f32_16x16x32_bf16 v[100:103], v[208:211], a[52:55], v[100:103]
    ds_read_b64_tr_b16 v[208:209], v24 offset:8192
    v_mfma_f32_16x16x32_bf16 v[104:107], v[212:215], a[48:51], v[104:107]
    ds_read_b64_tr_b16 v[210:211], v24 offset:12288
    v_mfma_f32_16x16x32_bf16 v[108:111], v[212:215], a[52:55], v[108:111]
    s_waitcnt lgkmcnt(10)
    ds_read_b64_tr_b16 v[212:213], v25 offset:8192
    v_mfma_f32_16x16x32_bf16 v[112:115], v[216:219], a[48:51], v[112:115]
    ds_read_b64_tr_b16 v[214:215], v25 offset:12288
    v_cmp_gt_u32 vcc, 52, v11
    v_mfma_f32_16x16x32_bf16 v[116:119], v[216:219], a[52:55], v[116:119]
    ds_read_b64_tr_b16 v[216:217], v26 offset:8192
    s_cbranch_vccnz k2_st_201
k2_bk_202:
    v_mfma_f32_16x16x32_bf16 v[120:123], v[220:223], a[48:51], v[120:123]
    ds_read_b64_tr_b16 v[218:219], v26 offset:12288
    v_mfma_f32_16x16x32_bf16 v[124:127], v[220:223], a[52:55], v[124:127]
    ds_read_b64_tr_b16 v[220:221], v27 offset:8192
    ds_read_b64_tr_b16 v[222:223], v27 offset:12288
    s_waitcnt vmcnt(0) lgkmcnt(12)
    ds_add_u32 v45, v10 offset:0
    v_mfma_f32_16x16x32_bf16 v[64:67], v[192:195], a[56:59], v[64:67]
    ds_read_b32 v11, v45 offset:512
    v_mfma_f32_16x16x32_bf16 v[68:71], v[192:195], a[60:63], v[68:71]
    ds_read_b64_tr_b16 v[192:193], v20 offset:16384
    v_mfma_f32_16x16x32_bf16 v[72:75], v[196:199], a[56:59], v[72:75]
    ds_read_b64_tr_b16 v[194:195], v20 offset:20480
    v_mfma_f32_16x16x32_bf16 v[76:79], v[196:199], a[60:63], v[76:79]
    s_waitcnt lgkmcnt(12)
    ds_read_b64_tr_b16 v[196:197], v21 offset:16384
    v_mfma_f32_16x16x32_bf16 v[80:83], v[200:203], a[56:59], v[80:83]
    ds_read_b64_tr_b16 v[198:199], v21 offset:20480
    v_mfma_f32_16x16x32_bf16 v[84:87], v[200:203], a[60:63], v[84:87]
    ds_read_b64_tr_b16 v[200:201], v22 offset:16384
    v_mfma_f32_16x16x32_bf16 v[88:91], v[204:207], a[56:59], v[88:91]
    ds_read_b64_tr_b16 v[202:203], v22 offset:20480
    v_mfma_f32_16x16x32_bf16 v[92:95], v[204:207], a[60:63], v[92:95]
    s_waitcnt lgkmcnt(12)
    ds_read_b64_tr_b16 v[204:205], v23 offset:16384
    v_mfma_f32_16x16x32_bf16 v[96:99], v[208:211], a[56:59], v[96:99]
    ds_read_b64_tr_b16 v[206:207], v23 offset:20480
    v_mfma_f32_16x16x32_bf16 v[100:103], v[208:211], a[60:63], v[100:103]
    ds_read_b64_tr_b16 v[208:209], v24 offset:16384
    v_mfma_f32_16x16x32_bf16 v[104:107], v[212:215], a[56:59], v[104:107]
    ds_read_b64_tr_b16 v[210:211], v24 offset:20480
    v_mfma_f32_16x16x32_bf16 v[108:111], v[212:215], a[60:63], v[108:111]
    s_waitcnt lgkmcnt(10)
    ds_read_b64_tr_b16 v[212:213], v25 offset:16384
    v_mfma_f32_16x16x32_bf16 v[112:115], v[216:219], a[56:59], v[112:115]
    ds_read_b64_tr_b16 v[214:215], v25 offset:20480
    v_cmp_gt_u32 vcc, 52, v11
    v_mfma_f32_16x16x32_bf16 v[116:119], v[216:219], a[60:63], v[116:119]
    ds_read_b64_tr_b16 v[216:217], v26 offset:16384
    s_cbranch_vccnz k2_st_203
k2_bk_204:
    v_mfma_f32_16x16x32_bf16 v[120:123], v[220:223], a[56:59], v[120:123]
    ds_read_b64_tr_b16 v[218:219], v26 offset:20480
    v_mfma_f32_16x16x32_bf16 v[124:127], v[220:223], a[60:63], v[124:127]
    ds_read_b64_tr_b16 v[220:221], v27 offset:16384
    ds_read_b64_tr_b16 v[222:223], v27 offset:20480
    s_waitcnt vmcnt(63) lgkmcnt(12)
    ds_add_u32 v45, v10 offset:256
    v_mfma_f32_16x16x32_bf16 v[64:67], v[192:195], a[0:3], v[64:67]
    ds_read_b32 v11, v45 offset:0
    v_mfma_f32_16x16x32_bf16 v[68:71], v[192:195], a[4:7], v[68:71]
    ds_read_b64_tr_b16 v[192:193], v20 offset:24576
    v_mfma_f32_16x16x32_bf16 v[72:75], v[196:199], a[0:3], v[72:75]
    ds_read_b64_tr_b16 v[194:195], v20 offset:28672
    v_mfma_f32_16x16x32_bf16 v[76:79], v[196:199], a[4:7], v[76:79]
    s_waitcnt lgkmcnt(12)
    ds_read_b64_tr_b16 v[196:197], v21 offset:24576
    v_mfma_f32_16x16x32_bf16 v[80:83], v[200:203], a[0:3], v[80:83]
    ds_read_b64_tr_b16 v[198:199], v21 offset:28672
    v_mfma_f32_16x16x32_bf16 v[84:87], v[200:203], a[4:7], v[84:87]
    ds_read_b64_tr_b16 v[200:201], v22 offset:24576
    v_mfma_f32_16x16x32_bf16 v[88:91], v[204:207], a[0:3], v[88:91]
    ds_read_b64_tr_b16 v[202:203], v22 offset:28672
    v_mfma_f32_16x16x32_bf16 v[92:95], v[204:207], a[4:7], v[92:95]
    s_waitcnt lgkmcnt(12)
    ds_read_b64_tr_b16 v[204:205], v23 offset:24576
    v_mfma_f32_16x16x32_bf16 v[96:99], v[208:211], a[0:3], v[96:99]
    ds_read_b64_tr_b16 v[206:207], v23 offset:28672
    v_mfma_f32_16x16x32_bf16 v[100:103], v[208:211], a[4:7], v[100:103]
    ds_read_b64_tr_b16 v[208:209], v24 offset:24576
    v_mfma_f32_16x16x32_bf16 v[104:107], v[212:215], a[0:3], v[104:107]
    ds_read_b64_tr_b16 v[210:211], v24 offset:28672
    v_mfma_f32_16x16x32_bf16 v[108:111], v[212:215], a[4:7], v[108:111]
    s_waitcnt lgkmcnt(10)
    ds_read_b64_tr_b16 v[212:213], v25 offset:24576
    v_mfma_f32_16x16x32_bf16 v[112:115], v[216:219], a[0:3], v[112:115]
    ds_read_b64_tr_b16 v[214:215], v25 offset:28672
    v_cmp_gt_u32 vcc, 56, v11
    v_mfma_f32_16x16x32_bf16 v[116:119], v[216:219], a[4:7], v[116:119]
    ds_read_b64_tr_b16 v[216:217], v26 offset:24576
    s_cbranch_vccnz k2_st_205
k2_bk_206:
    v_mfma_f32_16x16x32_bf16 v[120:123], v[220:223], a[0:3], v[120:123]
    ds_read_b64_tr_b16 v[218:219], v26 offset:28672
    v_mfma_f32_16x16x32_bf16 v[124:127], v[220:223], a[4:7], v[124:127]
    ds_read_b64_tr_b16 v[220:221], v27 offset:24576
    ds_read_b64_tr_b16 v[222:223], v27 offset:28672
    s_waitcnt vmcnt(63) lgkmcnt(12)
    v_mfma_f32_16x16x32_bf16 v[64:67], v[192:195], a[8:11], v[64:67]
    ds_read_b32 v11, v45 offset:256
    v_mfma_f32_16x16x32_bf16 v[68:71], v[192:195], a[12:15], v[68:71]
    ds_read_b64_tr_b16 v[192:193], v20 offset:32768
    v_mfma_f32_16x16x32_bf16 v[72:75], v[196:199], a[8:11], v[72:75]
    ds_read_b64_tr_b16 v[194:195], v20 offset:36864
    v_mfma_f32_16x16x32_bf16 v[76:79], v[196:199], a[12:15], v[76:79]
    s_waitcnt lgkmcnt(11)
    ds_read_b64_tr_b16 v[196:197], v21 offset:32768
    v_mfma_f32_16x16x32_bf16 v[80:83], v[200:203], a[8:11], v[80:83]
    ds_read_b64_tr_b16 v[198:199], v21 offset:36864
    v_mfma_f32_16x16x32_bf16 v[84:87], v[200:203], a[12:15], v[84:87]
    ds_read_b64_tr_b16 v[200:201], v22 offset:32768
    v_mfma_f32_16x16x32_bf16 v[88:91], v[204:207], a[8:11], v[88:91]
    ds_read_b64_tr_b16 v[202:203], v22 offset:36864
    v_mfma_f32_16x16x32_bf16 v[92:95], v[204:207], a[12:15], v[92:95]
    s_waitcnt lgkmcnt(11)
    ds_read_b64_tr_b16 v[204:205], v23 offset:32768
    v_mfma_f32_16x16x32_bf16 v[96:99], v[208:211], a[8:11], v[96:99]
    ds_read_b64_tr_b16 v[206:207], v23 offset:36864
    v_mfma_f32_16x16x32_bf16 v[100:103], v[208:211], a[12:15], v[100:103]
    ds_read_b64_tr_b16 v[208:209], v24 offset:32768
    v_mfma_f32_16x16x32_bf16 v[104:107], v[212:215], a[8:11], v[104:107]
    ds_read_b64_tr_b16 v[210:211], v24 offset:36864
    v_mfma_f32_16x16x32_bf16 v[108:111], v[212:215], a[12:15], v[108:111]
    s_waitcnt lgkmcnt(10)
    ds_read_b64_tr_b16 v[212:213], v25 offset:32768
    v_mfma_f32_16x16x32_bf16 v[112:115], v[216:219], a[8:11], v[112:115]
    ds_read_b64_tr_b16 v[214:215], v25 offset:36864
    v_cmp_gt_u32 vcc, 56, v11
    v_mfma_f32_16x16x32_bf16 v[116:119], v[216:219], a[12:15], v[116:119]
    ds_read_b64_tr_b16 v[216:217], v26 offset:32768
    s_cbranch_vccnz k2_st_207
k2_bk_208:
    v_mfma_f32_16x16x32_bf16 v[120:123], v[220:223], a[8:11], v[120:123]
    ds_read_b64_tr_b16 v[218:219], v26 offset:36864
    v_mfma_f32_16x16x32_bf16 v[124:127], v[220:223], a[12:15], v[124:127]
    ds_read_b64_tr_b16 v[220:221], v27 offset:32768
    ds_read_b64_tr_b16 v[222:223], v27 offset:36864
    s_waitcnt vmcnt(63) lgkmcnt(12)
    v_mfma_f32_16x16x32_bf16 v[64:67], v[192:195], a[16:19], v[64:67]
    v_mfma_f32_16x16x32_bf16 v[68:71], v[192:195], a[20:23], v[68:71]
    v_mfma_f32_16x16x32_bf16 v[72:75], v[196:199], a[16:19], v[72:75]
    v_mfma_f32_16x16x32_bf16 v[76:79], v[196:199], a[20:23], v[76:79]
    s_waitcnt lgkmcnt(8)
    v_mfma_f32_16x16x32_bf16 v[80:83], v[200:203], a[16:19], v[80:83]
    v_mfma_f32_16x16x32_bf16 v[84:87], v[200:203], a[20:23], v[84:87]
    v_mfma_f32_16x16x32_bf16 v[88:91], v[204:207], a[16:19], v[88:91]
    v_mfma_f32_16x16x32_bf16 v[92:95], v[204:207], a[20:23], v[92:95]
    s_waitcnt lgkmcnt(4)
    v_mfma_f32_16x16x32_bf16 v[96:99], v[208:211], a[16:19], v[96:99]
    v_mfma_f32_16x16x32_bf16 v[100:103], v[208:211], a[20:23], v[100:103]
    v_mfma_f32_16x16x32_bf16 v[104:107], v[212:215], a[16:19], v[104:107]
    v_mfma_f32_16x16x32_bf16 v[108:111], v[212:215], a[20:23], v[108:111]
    s_waitcnt lgkmcnt(0)
    v_mfma_f32_16x16x32_bf16 v[112:115], v[216:219], a[16:19], v[112:115]
    v_mfma_f32_16x16x32_bf16 v[116:119], v[216:219], a[20:23], v[116:119]
    v_mfma_f32_16x16x32_bf16 v[120:123], v[220:223], a[16:19], v[120:123]
    v_mfma_f32_16x16x32_bf16 v[124:127], v[220:223], a[20:23], v[124:127]
    v_cmp_eq_u32 vcc, 0, v39
    s_nop 3
    s_cbranch_vccnz mg_ps_209
mg_pb_210:
    s_nop 3
    s_cmp_eq_u32 s40, s5
    s_cbranch_scc1 p4_own
    v_cvt_pk_bf16_f32 v64, v64, v65
    v_cvt_pk_bf16_f32 v65, v66, v67
    v_cvt_pk_bf16_f32 v66, v72, v73
    v_cvt_pk_bf16_f32 v67, v74, v75
    buffer_store_dwordx4 v[64:67], v7, s[8:11], s56 offen offset:0 sc1
    v_cvt_pk_bf16_f32 v80, v80, v81
    v_cvt_pk_bf16_f32 v81, v82, v83
    v_cvt_pk_bf16_f32 v82, v88, v89
    v_cvt_pk_bf16_f32 v83, v90, v91
    buffer_store_dwordx4 v[80:83], v7, s[8:11], s56 offen offset:1024 sc1
    v_cvt_pk_bf16_f32 v68, v68, v69
    v_cvt_pk_bf16_f32 v69, v70, v71
    v_cvt_pk_bf16_f32 v70, v76, v77
    v_cvt_pk_bf16_f32 v71, v78, v79
    buffer_store_dwordx4 v[68:71], v7, s[8:11], s56 offen offset:2048 sc1
    v_cvt_pk_bf16_f32 v84, v84, v85
    v_cvt_pk_bf16_f32 v85, v86, v87
    v_cvt_pk_bf16_f32 v86, v92, v93
    v_cvt_pk_bf16_f32 v87, v94, v95
    buffer_store_dwordx4 v[84:87], v7, s[8:11], s56 offen offset:3072 sc1
    s_add_u32 s56, s56, 4096
    v_cvt_pk_bf16_f32 v96, v96, v97
    v_cvt_pk_bf16_f32 v97, v98, v99
    v_cvt_pk_bf16_f32 v98, v104, v105
    v_cvt_pk_bf16_f32 v99, v106, v107
    buffer_store_dwordx4 v[96:99], v7, s[8:11], s56 offen offset:0 sc1
    v_cvt_pk_bf16_f32 v112, v112, v113
    v_cvt_pk_bf16_f32 v113, v114, v115
    v_cvt_pk_bf16_f32 v114, v120, v121
    v_cvt_pk_bf16_f32 v115, v122, v123
    buffer_store_dwordx4 v[112:115], v7, s[8:11], s56 offen offset:1024 sc1
    v_cvt_pk_bf16_f32 v100, v100, v101
    v_cvt_pk_bf16_f32 v101, v102, v103
    v_cvt_pk_bf16_f32 v102, v108, v109
    v_cvt_pk_bf16_f32 v103, v110, v111
    buffer_store_dwordx4 v[100:103], v7, s[8:11], s56 offen offset:2048 sc1
    v_cvt_pk_bf16_f32 v116, v116, v117
    v_cvt_pk_bf16_f32 v117, v118, v119
    v_cvt_pk_bf16_f32 v118, v124, v125
    v_cvt_pk_bf16_f32 v119, v126, v127
    buffer_store_dwordx4 v[116:119], v7, s[8:11], s56 offen offset:3072 sc1
    s_branch p4_exd
p4_own:
    v_add_u32 v3, 131072, v7
    ds_write_b128 v3, v[64:67] offset:0
    ds_write_b128 v3, v[68:71] offset:1024
    ds_write_b128 v3, v[72:75] offset:2048
    ds_write_b128 v3, v[76:79] offset:3072
    ds_write_b128 v3, v[80:83] offset:4096
    ds_write_b128 v3, v[84:87] offset:5120
    ds_write_b128 v3, v[88:91] offset:6144
    ds_write_b128 v3, v[92:95] offset:7168
    ds_write_b128 v3, v[96:99] offset:8192
    ds_write_b128 v3, v[100:103] offset:9216
    ds_write_b128 v3, v[104:107] offset:10240
    ds_write_b128 v3, v[108:111] offset:11264
    ds_write_b128 v3, v[112:115] offset:12288
    ds_write_b128 v3, v[116:119] offset:13312
    ds_write_b128 v3, v[120:123] offset:14336
    ds_write_b128 v3, v[124:127] offset:15360
p4_exd:
    buffer_load_dwordx4 v[192:195], v7, s[8:11], s32 offen offset:0 sc1
    buffer_load_dwordx4 v[196:199], v7, s[8:11], s32 offen offset:1024 sc1
    buffer_load_dwordx4 v[200:203], v7, s[8:11], s33 offen offset:0 sc1
    buffer_load_dwordx4 v[204:207], v7, s[8:11], s33 offen offset:1024 sc1
    buffer_load_dwordx4 v[208:211], v7, s[8:11], s34 offen offset:0 sc1
    buffer_load_dwordx4 v[212:215], v7, s[8:11], s34 offen offset:1024 sc1
    buffer_load_dwordx4 v[216:219], v7, s[8:11], s35 offen offset:0 sc1
    buffer_load_dwordx4 v[220:223], v7, s[8:11], s35 offen offset:1024 sc1
    v_lshlrev_b32 v144, 16, v48
    v_and_b32 v145, 0xffff0000, v48
    v_lshlrev_b32 v146, 16, v49
    v_and_b32 v147, 0xffff0000, v49
    v_lshlrev_b32 v148, 16, v50
    v_and_b32 v149, 0xffff0000, v50
    v_lshlrev_b32 v150, 16, v51
    v_and_b32 v151, 0xffff0000, v51
    v_lshlrev_b32 v152, 16, v52
    v_and_b32 v153, 0xffff0000, v52
    v_lshlrev_b32 v154, 16, v53
    v_and_b32 v155, 0xffff0000, v53
    v_lshlrev_b32 v156, 16, v54
    v_and_b32 v157, 0xffff0000, v54
    v_lshlrev_b32 v158, 16, v55
    v_and_b32 v159, 0xffff0000, v55
    s_and_b32 s63, s40, 1
    s_lshl_b32 s63, s63, 10
    s_lshr_b32 s59, s40, 1
    s_lshl_b32 s59, s59, 13
    s_add_u32 s63, s63, s59
    s_add_u32 s63, s63, 131072
    v_add_u32 v3, s63, v7
    s_waitcnt lgkmcnt(0)
    s_barrier
    ds_read_b128 v[128:131], v3 offset:0
    ds_read_b128 v[132:135], v3 offset:2048
    ds_read_b128 v[136:139], v3 offset:4096
    ds_read_b128 v[140:143], v3 offset:6144
    s_waitcnt lgkmcnt(0)
    v_add_f32 v128, v128, v144
    v_add_f32 v129, v129, v145
    v_add_f32 v130, v130, v146
    v_add_f32 v131, v131, v147
    v_add_f32 v132, v132, v148
    v_add_f32 v133, v133, v149
    v_add_f32 v134, v134, v150
    v_add_f32 v135, v135, v151
    v_add_f32 v136, v136, v152
    v_add_f32 v137, v137, v153
    v_add_f32 v138, v138, v154
    v_add_f32 v139, v139, v155
    v_add_f32 v140, v140, v156
    v_add_f32 v141, v141, v157
    v_add_f32 v142, v142, v158
    v_add_f32 v143, v143, v159
    s_mov_b32 s49, 0x8000
p4_exchk:
    s_waitcnt vmcnt(0)
    v_max3_u32 v224, v192, v196, v200
    v_max3_u32 v225, v204, v208, v212
    v_max3_u32 v224, v216, v220, v224
    v_max_u32 v224, v224, v225
    v_cmp_eq_u32 vcc, -1, v224
    s_sub_u32 s49, s49, 1
    s_cbranch_scc1 p4_exok
    s_cbranch_vccz p4_exok
    s_sleep 1
    buffer_load_dwordx4 v[192:195], v7, s[8:11], s32 offen offset:0 sc1
    buffer_load_dwordx4 v[196:199], v7, s[8:11], s32 offen offset:1024 sc1
    buffer_load_dwordx4 v[200:203], v7, s[8:11], s33 offen offset:0 sc1
    buffer_load_dwordx4 v[204:207], v7, s[8:11], s33 offen offset:1024 sc1
    buffer_load_dwordx4 v[208:211], v7, s[8:11], s34 offen offset:0 sc1
    buffer_load_dwordx4 v[212:215], v7, s[8:11], s34 offen offset:1024 sc1
    buffer_load_dwordx4 v[216:219], v7, s[8:11], s35 offen offset:0 sc1
    buffer_load_dwordx4 v[220:223], v7, s[8:11], s35 offen offset:1024 sc1
    s_branch p4_exchk
p4_exok:
    v_lshlrev_b32 v226, 16, v192
    v_and_b32 v227, 0xffff0000, v192
    v_add_f32 v128, v128, v226
    v_add_f32 v129, v129, v227
    v_lshlrev_b32 v226, 16, v193
    v_and_b32 v227, 0xffff0000, v193
    v_add_f32 v130, v130, v226
    v_add_f32 v131, v131, v227
    v_lshlrev_b32 v226, 16, v194
    v_and_b32 v227, 0xffff0000, v194
    v_add_f32 v132, v132, v226
    v_add_f32 v133, v133, v227
    v_lshlrev_b32 v226, 16, v195
    v_and_b32 v227, 0xffff0000, v195
    v_add_f32 v134, v134, v226
    v_add_f32 v135, v135, v227
    v_lshlrev_b32 v226, 16, v196
    v_and_b32 v227, 0xffff0000, v196
    v_add_f32 v136, v136, v226
    v_add_f32 v137, v137, v227
    v_lshlrev_b32 v226, 16, v197
    v_and_b32 v227, 0xffff0000, v197
    v_add_f32 v138, v138, v226
    v_add_f32 v139, v139, v227
    v_lshlrev_b32 v226, 16, v198
    v_and_b32 v227, 0xffff0000, v198
    v_add_f32 v140, v140, v226
    v_add_f32 v141, v141, v227
    v_lshlrev_b32 v226, 16, v199
    v_and_b32 v227, 0xffff0000, v199
    v_add_f32 v142, v142, v226
    v_add_f32 v143, v143, v227
    v_lshlrev_b32 v226, 16, v200
    v_and_b32 v227, 0xffff0000, v200
    v_add_f32 v128, v128, v226
    v_add_f32 v129, v129, v227
    v_lshlrev_b32 v226, 16, v201
    v_and_b32 v227, 0xffff0000, v201
    v_add_f32 v130, v130, v226
    v_add_f32 v131, v131, v227
    v_lshlrev_b32 v226, 16, v202
    v_and_b32 v227, 0xffff0000, v202
    v_add_f32 v132, v132, v226
    v_add_f32 v133, v133, v227
    v_lshlrev_b32 v226, 16, v203
    v_and_b32 v227, 0xffff0000, v203
    v_add_f32 v134, v134, v226
    v_add_f32 v135, v135, v227
    v_lshlrev_b32 v226, 16, v204
    v_and_b32 v227, 0xffff0000, v204
    v_add_f32 v136, v136, v226
    v_add_f32 v137, v137, v227
    v_lshlrev_b32 v226, 16, v205
    v_and_b32 v227, 0xffff0000, v205
    v_add_f32 v138, v138, v226
    v_add_f32 v139, v139, v227
    v_lshlrev_b32 v226, 16, v206
    v_and_b32 v227, 0xffff0000, v206
    v_add_f32 v140, v140, v226
    v_add_f32 v141, v141, v227
    v_lshlrev_b32 v226, 16, v207
    v_and_b32 v227, 0xffff0000, v207
    v_add_f32 v142, v142, v226
    v_add_f32 v143, v143, v227
    v_lshlrev_b32 v226, 16, v208
    v_and_b32 v227, 0xffff0000, v208
    v_add_f32 v128, v128, v226
    v_add_f32 v129, v129, v227
    v_lshlrev_b32 v226, 16, v209
    v_and_b32 v227, 0xffff0000, v209
    v_add_f32 v130, v130, v226
    v_add_f32 v131, v131, v227
    v_lshlrev_b32 v226, 16, v210
    v_and_b32 v227, 0xffff0000, v210
    v_add_f32 v132, v132, v226
    v_add_f32 v133, v133, v227
    v_lshlrev_b32 v226, 16, v211
    v_and_b32 v227, 0xffff0000, v211
    v_add_f32 v134, v134, v226
    v_add_f32 v135, v135, v227
    v_lshlrev_b32 v226, 16, v212
    v_and_b32 v227, 0xffff0000, v212
    v_add_f32 v136, v136, v226
    v_add_f32 v137, v137, v227
    v_lshlrev_b32 v226, 16, v213
    v_and_b32 v227, 0xffff0000, v213
    v_add_f32 v138, v138, v226
    v_add_f32 v139, v139, v227
    v_lshlrev_b32 v226, 16, v214
    v_and_b32 v227, 0xffff0000, v214
    v_add_f32 v140, v140, v226
    v_add_f32 v141, v141, v227
    v_lshlrev_b32 v226, 16, v215
    v_and_b32 v227, 0xffff0000, v215
    v_add_f32 v142, v142, v226
    v_add_f32 v143, v143, v227
    v_lshlrev_b32 v226, 16, v216
    v_and_b32 v227, 0xffff0000, v216
    v_add_f32 v128, v128, v226
    v_add_f32 v129, v129, v227
    v_lshlrev_b32 v226, 16, v217
    v_and_b32 v227, 0xffff0000, v217
    v_add_f32 v130, v130, v226
    v_add_f32 v131, v131, v227
    v_lshlrev_b32 v226, 16, v218
    v_and_b32 v227, 0xffff0000, v218
    v_add_f32 v132, v132, v226
    v_add_f32 v133, v133, v227
    v_lshlrev_b32 v226, 16, v219
    v_and_b32 v227, 0xffff0000, v219
    v_add_f32 v134, v134, v226
    v_add_f32 v135, v135, v227
    v_lshlrev_b32 v226, 16, v220
    v_and_b32 v227, 0xffff0000, v220
    v_add_f32 v136, v136, v226
    v_add_f32 v137, v137, v227
    v_lshlrev_b32 v226, 16, v221
    v_and_b32 v227, 0xffff0000, v221
    v_add_f32 v138, v138, v226
    v_add_f32 v139, v139, v227
    v_lshlrev_b32 v226, 16, v222
    v_and_b32 v227, 0xffff0000, v222
    v_add_f32 v140, v140, v226
    v_add_f32 v141, v141, v227
    v_lshlrev_b32 v226, 16, v223
    v_and_b32 v227, 0xffff0000, v223
    v_add_f32 v142, v142, v226
    v_add_f32 v143, v143, v227
    v_cvt_pk_bf16_f32 v48, v128, v129
    v_cvt_pk_bf16_f32 v49, v130, v131
    buffer_store_dwordx2 v[48:49], v38, s[20:23], s62 offen offset:0
    v_cvt_pk_bf16_f32 v50, v132, v133
    v_cvt_pk_bf16_f32 v51, v134, v135
    buffer_store_dwordx2 v[50:51], v38, s[20:23], s62 offen offset:32
    v_cvt_pk_bf16_f32 v52, v136, v137
    v_cvt_pk_bf16_f32 v53, v138, v139
    buffer_store_dwordx2 v[52:53], v38, s[20:23], s62 offen offset:64
    v_cvt_pk_bf16_f32 v54, v140, v141
    v_cvt_pk_bf16_f32 v55, v142, v143
    buffer_store_dwordx2 v[54:55], v38, s[20:23], s62 offen offset:96
    s_endpgm
k2_st_27:
    s_mov_b32 s49, 0x100000
k2_st_27_l:
    ds_read_b32 v11, v9
    s_sub_u32 s49, s49, 1
    s_cbranch_scc1 k2_bk_28
    s_waitcnt lgkmcnt(0)
    v_cmp_gt_u32 vcc, s45, v11
    s_cbranch_vccnz k2_st_27_l
    s_branch k2_bk_28
k2_st_33:
    s_call_b64 s[54:55], k2_rare1
    s_branch k2_bk_34
k2_st_35:
    s_mov_b32 s49, 0x100000
k2_st_35_l:
    ds_read_b32 v11, v9
    s_sub_u32 s49, s49, 1
    s_cbranch_scc1 k2_bk_36
    s_waitcnt lgkmcnt(0)
    v_cmp_gt_u32 vcc, s45, v11
    s_cbranch_vccnz k2_st_35_l
    s_branch k2_bk_36
k2_st_37:
    s_call_b64 s[54:55], k2_rare0
    s_branch k2_bk_38
k2_st_39:
    s_call_b64 s[54:55], k2_rare1
    s_branch k2_bk_40
k2_st_41:
    s_mov_b32 s49, 0x100000
k2_st_41_l:
    ds_read_b32 v11, v9
    s_sub_u32 s49, s49, 1
    s_cbranch_scc1 k2_bk_42
    s_waitcnt lgkmcnt(0)
    v_cmp_gt_u32 vcc, s45, v11
    s_cbranch_vccnz k2_st_41_l
    s_branch k2_bk_42
k2_st_43:
    s_call_b64 s[54:55], k2_rare0
    s_branch k2_bk_44
k2_st_47:
    s_call_b64 s[54:55], k2_rare1
    s_branch k2_bk_48
k2_st_49:
    s_mov_b32 s49, 0x100000
k2_st_49_l:
    ds_read_b32 v11, v9
    s_sub_u32 s49, s49, 1
    s_cbranch_scc1 k2_bk_50
    s_waitcnt lgkmcnt(0)
    v_cmp_gt_u32 vcc, s45, v11
    s_cbranch_vccnz k2_st_49_l
    s_branch k2_bk_50
k2_st_51:
    s_call_b64 s[54:55], k2_rare0
    s_branch k2_bk_52
k2_st_53:
    s_call_b64 s[54:55], k2_rare1
    s_branch k2_bk_54
k2_st_55:
    s_mov_b32 s49, 0x100000
k2_st_55_l:
    ds_read_b32 v11, v9
    s_sub_u32 s49, s49, 1
    s_cbranch_scc1 k2_bk_56
    s_waitcnt lgkmcnt(0)
    v_cmp_gt_u32 vcc, s45, v11
    s_cbranch_vccnz k2_st_55_l
    s_branch k2_bk_56
k2_st_57:
    s_call_b64 s[54:55], k2_rare0
    s_branch k2_bk_58
k2_st_61:
    s_call_b64 s[54:55], k2_rare1
    s_branch k2_bk_62
k2_st_63:
    s_mov_b32 s49, 0x100000
k2_st_63_l:
    ds_read_b32 v11, v9
    s_sub_u32 s49, s49, 1
    s_cbranch_scc1 k2_bk_64
    s_waitcnt lgkmcnt(0)
    v_cmp_gt_u32 vcc, s45, v11
    s_cbranch_vccnz k2_st_63_l
    s_branch k2_bk_64
k2_st_67:
    s_mov_b32 s49, 0x100000
k2_st_67_l:
    ds_read_b32 v11, v9
    s_sub_u32 s49, s49, 1
    s_cbranch_scc1 k2_bk_68
    s_waitcnt lgkmcnt(0)
    v_cmp_gt_u32 vcc, s45, v11
    s_cbranch_vccnz k2_st_67_l
    s_branch k2_bk_68
k2_st_73:
    s_call_b64 s[54:55], k2_rare1
    s_branch k2_bk_74
k2_st_75:
    s_mov_b32 s49, 0x100000
k2_st_75_l:
    ds_read_b32 v11, v9
    s_sub_u32 s49, s49, 1
    s_cbranch_scc1 k2_bk_76
    s_waitcnt lgkmcnt(0)
    v_cmp_gt_u32 vcc, s45, v11
    s_cbranch_vccnz k2_st_75_l
    s_branch k2_bk_76
k2_st_77:
    s_call_b64 s[54:55], k2_rare0
    s_branch k2_bk_78
k2_st_81:
    s_call_b64 s[54:55], k2_rare1
    s_branch k2_bk_82
k2_st_83:
    s_mov_b32 s49, 0x100000
k2_st_83_l:
    ds_read_b32 v11, v9
    s_sub_u32 s49, s49, 1
    s_cbranch_scc1 k2_bk_84
    s_waitcnt lgkmcnt(0)
    v_cmp_gt_u32 vcc, s45, v11
    s_cbranch_vccnz k2_st_83_l
    s_branch k2_bk_84
k2_st_89:
    s_mov_b32 s49, 0x100000
k2_st_89_l:
    ds_read_b32 v11, v9
    s_sub_u32 s49, s49, 1
    s_cbranch_scc1 k2_bk_90
    s_waitcnt lgkmcnt(0)
    v_cmp_gt_u32 vcc, s45, v11
    s_cbranch_vccnz k2_st_89_l
    s_branch k2_bk_90
k2_st_93:
    s_mov_b32 s49, 0x100000
k2_st_93_l:
    ds_read_b32 v11, v9
    s_sub_u32 s49, s49, 1
    s_cbranch_scc1 k2_bk_94
    s_waitcnt lgkmcnt(0)
    v_cmp_gt_u32 vcc, s45, v11
    s_cbranch_vccnz k2_st_93_l
    s_branch k2_bk_94
k2_st_95:
    s_mov_b32 s49, 0x100000
k2_st_95_l:
    ds_read_b32 v11, v9
    s_sub_u32 s49, s49, 1
    s_cbranch_scc1 k2_bk_96
    s_waitcnt lgkmcnt(0)
    v_cmp_gt_u32 vcc, s45, v11
    s_cbranch_vccnz k2_st_95_l
    s_branch k2_bk_96
k2_st_99:
    s_mov_b32 s49, 0x100000
k2_st_99_l:
    ds_read_b32 v11, v9
    s_sub_u32 s49, s49, 1
    s_cbranch_scc1 k2_bk_100
    s_waitcnt lgkmcnt(0)
    v_cmp_gt_u32 vcc, s45, v11
    s_cbranch_vccnz k2_st_99_l
    s_branch k2_bk_100
k2_st_103:
    s_mov_b32 s49, 0x100000
k2_st_103_l:
    ds_read_b32 v11, v9
    s_sub_u32 s49, s49, 1
    s_cbranch_scc1 k2_bk_104
    s_waitcnt lgkmcnt(0)
    v_cmp_gt_u32 vcc, s45, v11
    s_cbranch_vccnz k2_st_103_l
    s_branch k2_bk_104
k2_st_109:
    s_mov_b32 s49, 0x100000
k2_st_109_l:
    ds_read_b32 v11, v9
    s_sub_u32 s49, s49, 1
    s_cbranch_scc1 k2_bk_110
    s_waitcnt lgkmcnt(0)
    v_cmp_gt_u32 vcc, s45, v11
    s_cbranch_vccnz k2_st_109_l
    s_branch k2_bk_110
k2_st_111:
    s_mov_b32 s49, 0x100000
k2_st_111_l:
    ds_read_b32 v11, v45 offset:0
    s_sub_u32 s49, s49, 1
    s_cbranch_scc1 k2_bk_112
    s_waitcnt lgkmcnt(0)
    v_cmp_gt_u32 vcc, 4, v11
    s_cbranch_vccnz k2_st_111_l
    s_branch k2_bk_112
k2_st_113:
    s_mov_b32 s49, 0x100000
k2_st_113_l:
    ds_read_b32 v11, v45 offset:256
    s_sub_u32 s49, s49, 1
    s_cbranch_scc1 k2_bk_114
    s_waitcnt lgkmcnt(0)
    v_cmp_gt_u32 vcc, 4, v11
    s_cbranch_vccnz k2_st_113_l
    s_branch k2_bk_114
k2_st_115:
    s_mov_b32 s49, 0x100000
k2_st_115_l:
    ds_read_b32 v11, v45 offset:512
    s_sub_u32 s49, s49, 1
    s_cbranch_scc1 k2_bk_116
    s_waitcnt lgkmcnt(0)
    v_cmp_gt_u32 vcc, 4, v11
    s_cbranch_vccnz k2_st_115_l
    s_branch k2_bk_116
k2_st_117:
    s_mov_b32 s49, 0x100000
k2_st_117_l:
    ds_read_b32 v11, v45 offset:0
    s_sub_u32 s49, s49, 1
    s_cbranch_scc1 k2_bk_118
    s_waitcnt lgkmcnt(0)
    v_cmp_gt_u32 vcc, 8, v11
    s_cbranch_vccnz k2_st_117_l
    s_branch k2_bk_118
k2_st_119:
    s_mov_b32 s49, 0x100000
k2_st_119_l:
    ds_read_b32 v11, v45 offset:256
    s_sub_u32 s49, s49, 1
    s_cbranch_scc1 k2_bk_120
    s_waitcnt lgkmcnt(0)
    v_cmp_gt_u32 vcc, 8, v11
    s_cbranch_vccnz k2_st_119_l
    s_branch k2_bk_120
k2_st_121:
    s_mov_b32 s49, 0x100000
k2_st_121_l:
    ds_read_b32 v11, v45 offset:512
    s_sub_u32 s49, s49, 1
    s_cbranch_scc1 k2_bk_122
    s_waitcnt lgkmcnt(0)
    v_cmp_gt_u32 vcc, 8, v11
    s_cbranch_vccnz k2_st_121_l
    s_branch k2_bk_122
k2_st_125:
    s_mov_b32 s49, 0x100000
k2_st_125_l:
    ds_read_b32 v11, v45 offset:0
    s_sub_u32 s49, s49, 1
    s_cbranch_scc1 k2_bk_126
    s_waitcnt lgkmcnt(0)
    v_cmp_gt_u32 vcc, 12, v11
    s_cbranch_vccnz k2_st_125_l
    s_branch k2_bk_126
k2_st_127:
    s_mov_b32 s49, 0x100000
k2_st_127_l:
    ds_read_b32 v11, v45 offset:256
    s_sub_u32 s49, s49, 1
    s_cbranch_scc1 k2_bk_128
    s_waitcnt lgkmcnt(0)
    v_cmp_gt_u32 vcc, 12, v11
    s_cbranch_vccnz k2_st_127_l
    s_branch k2_bk_128
k2_st_131:
    s_mov_b32 s49, 0x100000
k2_st_131_l:
    ds_read_b32 v11, v45 offset:512
    s_sub_u32 s49, s49, 1
    s_cbranch_scc1 k2_bk_132
    s_waitcnt lgkmcnt(0)
    v_cmp_gt_u32 vcc, 12, v11
    s_cbranch_vccnz k2_st_131_l
    s_branch k2_bk_132
k2_st_133:
    s_mov_b32 s49, 0x100000
k2_st_133_l:
    ds_read_b32 v11, v45 offset:0
    s_sub_u32 s49, s49, 1
    s_cbranch_scc1 k2_bk_134
    s_waitcnt lgkmcnt(0)
    v_cmp_gt_u32 vcc, 16, v11
    s_cbranch_vccnz k2_st_133_l
    s_branch k2_bk_134
k2_st_135:
    s_mov_b32 s49, 0x100000
k2_st_135_l:
    ds_read_b32 v11, v45 offset:256
    s_sub_u32 s49, s49, 1
    s_cbranch_scc1 k2_bk_136
    s_waitcnt lgkmcnt(0)
    v_cmp_gt_u32 vcc, 16, v11
    s_cbranch_vccnz k2_st_135_l
    s_branch k2_bk_136
k2_st_137:
    s_mov_b32 s49, 0x100000
k2_st_137_l:
    ds_read_b32 v11, v45 offset:512
    s_sub_u32 s49, s49, 1
    s_cbranch_scc1 k2_bk_138
    s_waitcnt lgkmcnt(0)
    v_cmp_gt_u32 vcc, 16, v11
    s_cbranch_vccnz k2_st_137_l
    s_branch k2_bk_138
k2_st_141:
    s_mov_b32 s49, 0x100000
k2_st_141_l:
    ds_read_b32 v11, v45 offset:0
    s_sub_u32 s49, s49, 1
    s_cbranch_scc1 k2_bk_142
    s_waitcnt lgkmcnt(0)
    v_cmp_gt_u32 vcc, 20, v11
    s_cbranch_vccnz k2_st_141_l
    s_branch k2_bk_142
k2_st_143:
    s_mov_b32 s49, 0x100000
k2_st_143_l:
    ds_read_b32 v11, v45 offset:256
    s_sub_u32 s49, s49, 1
    s_cbranch_scc1 k2_bk_144
    s_waitcnt lgkmcnt(0)
    v_cmp_gt_u32 vcc, 20, v11
    s_cbranch_vccnz k2_st_143_l
    s_branch k2_bk_144
k2_st_145:
    s_mov_b32 s49, 0x100000
k2_st_145_l:
    ds_read_b32 v11, v45 offset:512
    s_sub_u32 s49, s49, 1
    s_cbranch_scc1 k2_bk_146
    s_waitcnt lgkmcnt(0)
    v_cmp_gt_u32 vcc, 20, v11
    s_cbranch_vccnz k2_st_145_l
    s_branch k2_bk_146
k2_st_147:
    s_mov_b32 s49, 0x100000
k2_st_147_l:
    ds_read_b32 v11, v45 offset:0
    s_sub_u32 s49, s49, 1
    s_cbranch_scc1 k2_bk_148
    s_waitcnt lgkmcnt(0)
    v_cmp_gt_u32 vcc, 24, v11
    s_cbranch_vccnz k2_st_147_l
    s_branch k2_bk_148
k2_st_151:
    s_mov_b32 s49, 0x100000
k2_st_151_l:
    ds_read_b32 v11, v45 offset:256
    s_sub_u32 s49, s49, 1
    s_cbranch_scc1 k2_bk_152
    s_waitcnt lgkmcnt(0)
    v_cmp_gt_u32 vcc, 24, v11
    s_cbranch_vccnz k2_st_151_l
    s_branch k2_bk_152
k2_st_153:
    s_mov_b32 s49, 0x100000
k2_st_153_l:
    ds_read_b32 v11, v45 offset:512
    s_sub_u32 s49, s49, 1
    s_cbranch_scc1 k2_bk_154
    s_waitcnt lgkmcnt(0)
    v_cmp_gt_u32 vcc, 24, v11
    s_cbranch_vccnz k2_st_153_l
    s_branch k2_bk_154
k2_st_155:
    s_mov_b32 s49, 0x100000
k2_st_155_l:
    ds_read_b32 v11, v45 offset:0
    s_sub_u32 s49, s49, 1
    s_cbranch_scc1 k2_bk_156
    s_waitcnt lgkmcnt(0)
    v_cmp_gt_u32 vcc, 28, v11
    s_cbranch_vccnz k2_st_155_l
    s_branch k2_bk_156
k2_st_157:
    s_mov_b32 s49, 0x100000
k2_st_157_l:
    ds_read_b32 v11, v45 offset:256
    s_sub_u32 s49, s49, 1
    s_cbranch_scc1 k2_bk_158
    s_waitcnt lgkmcnt(0)
    v_cmp_gt_u32 vcc, 28, v11
    s_cbranch_vccnz k2_st_157_l
    s_branch k2_bk_158
k2_st_161:
    s_mov_b32 s49, 0x100000
k2_st_161_l:
    ds_read_b32 v11, v45 offset:512
    s_sub_u32 s49, s49, 1
    s_cbranch_scc1 k2_bk_162
    s_waitcnt lgkmcnt(0)
    v_cmp_gt_u32 vcc, 28, v11
    s_cbranch_vccnz k2_st_161_l
    s_branch k2_bk_162
k2_st_163:
    s_mov_b32 s49, 0x100000
k2_st_163_l:
    ds_read_b32 v11, v45 offset:0
    s_sub_u32 s49, s49, 1
    s_cbranch_scc1 k2_bk_164
    s_waitcnt lgkmcnt(0)
    v_cmp_gt_u32 vcc, 32, v11
    s_cbranch_vccnz k2_st_163_l
    s_branch k2_bk_164
k2_st_165:
    s_mov_b32 s49, 0x100000
k2_st_165_l:
    ds_read_b32 v11, v45 offset:256
    s_sub_u32 s49, s49, 1
    s_cbranch_scc1 k2_bk_166
    s_waitcnt lgkmcnt(0)
    v_cmp_gt_u32 vcc, 32, v11
    s_cbranch_vccnz k2_st_165_l
    s_branch k2_bk_166
k2_st_167:
    s_mov_b32 s49, 0x100000
k2_st_167_l:
    ds_read_b32 v11, v45 offset:512
    s_sub_u32 s49, s49, 1
    s_cbranch_scc1 k2_bk_168
    s_waitcnt lgkmcnt(0)
    v_cmp_gt_u32 vcc, 32, v11
    s_cbranch_vccnz k2_st_167_l
    s_branch k2_bk_168
k2_st_171:
    s_mov_b32 s49, 0x100000
k2_st_171_l:
    ds_read_b32 v11, v45 offset:0
    s_sub_u32 s49, s49, 1
    s_cbranch_scc1 k2_bk_172
    s_waitcnt lgkmcnt(0)
    v_cmp_gt_u32 vcc, 36, v11
    s_cbranch_vccnz k2_st_171_l
    s_branch k2_bk_172
k2_st_173:
    s_mov_b32 s49, 0x100000
k2_st_173_l:
    ds_read_b32 v11, v45 offset:256
    s_sub_u32 s49, s49, 1
    s_cbranch_scc1 k2_bk_174
    s_waitcnt lgkmcnt(0)
    v_cmp_gt_u32 vcc, 36, v11
    s_cbranch_vccnz k2_st_173_l
    s_branch k2_bk_174
k2_st_175:
    s_mov_b32 s49, 0x100000
k2_st_175_l:
    ds_read_b32 v11, v45 offset:512
    s_sub_u32 s49, s49, 1
    s_cbranch_scc1 k2_bk_176
    s_waitcnt lgkmcnt(0)
    v_cmp_gt_u32 vcc, 36, v11
    s_cbranch_vccnz k2_st_175_l
    s_branch k2_bk_176
k2_st_177:
    s_mov_b32 s49, 0x100000
k2_st_177_l:
    ds_read_b32 v11, v45 offset:0
    s_sub_u32 s49, s49, 1
    s_cbranch_scc1 k2_bk_178
    s_waitcnt lgkmcnt(0)
    v_cmp_gt_u32 vcc, 40, v11
    s_cbranch_vccnz k2_st_177_l
    s_branch k2_bk_178
k2_st_181:
    s_mov_b32 s49, 0x100000
k2_st_181_l:
    ds_read_b32 v11, v45 offset:256
    s_sub_u32 s49, s49, 1
    s_cbranch_scc1 k2_bk_182
    s_waitcnt lgkmcnt(0)
    v_cmp_gt_u32 vcc, 40, v11
    s_cbranch_vccnz k2_st_181_l
    s_branch k2_bk_182
k2_st_183:
    s_mov_b32 s49, 0x100000
k2_st_183_l:
    ds_read_b32 v11, v45 offset:512
    s_sub_u32 s49, s49, 1
    s_cbranch_scc1 k2_bk_184
    s_waitcnt lgkmcnt(0)
    v_cmp_gt_u32 vcc, 40, v11
    s_cbranch_vccnz k2_st_183_l
    s_branch k2_bk_184
k2_st_185:
    s_mov_b32 s49, 0x100000
k2_st_185_l:
    ds_read_b32 v11, v45 offset:0
    s_sub_u32 s49, s49, 1
    s_cbranch_scc1 k2_bk_186
    s_waitcnt lgkmcnt(0)
    v_cmp_gt_u32 vcc, 44, v11
    s_cbranch_vccnz k2_st_185_l
    s_branch k2_bk_186
k2_st_187:
    s_mov_b32 s49, 0x100000
k2_st_187_l:
    ds_read_b32 v11, v45 offset:256
    s_sub_u32 s49, s49, 1
    s_cbranch_scc1 k2_bk_188
    s_waitcnt lgkmcnt(0)
    v_cmp_gt_u32 vcc, 44, v11
    s_cbranch_vccnz k2_st_187_l
    s_branch k2_bk_188
k2_st_191:
    s_mov_b32 s49, 0x100000
k2_st_191_l:
    ds_read_b32 v11, v45 offset:512
    s_sub_u32 s49, s49, 1
    s_cbranch_scc1 k2_bk_192
    s_waitcnt lgkmcnt(0)
    v_cmp_gt_u32 vcc, 44, v11
    s_cbranch_vccnz k2_st_191_l
    s_branch k2_bk_192
k2_st_193:
    s_mov_b32 s49, 0x100000
k2_st_193_l:
    ds_read_b32 v11, v45 offset:0
    s_sub_u32 s49, s49, 1
    s_cbranch_scc1 k2_bk_194
    s_waitcnt lgkmcnt(0)
    v_cmp_gt_u32 vcc, 48, v11
    s_cbranch_vccnz k2_st_193_l
    s_branch k2_bk_194
k2_st_195:
    s_mov_b32 s49, 0x100000
k2_st_195_l:
    ds_read_b32 v11, v45 offset:256
    s_sub_u32 s49, s49, 1
    s_cbranch_scc1 k2_bk_196
    s_waitcnt lgkmcnt(0)
    v_cmp_gt_u32 vcc, 48, v11
    s_cbranch_vccnz k2_st_195_l
    s_branch k2_bk_196
k2_st_197:
    s_mov_b32 s49, 0x100000
k2_st_197_l:
    ds_read_b32 v11, v45 offset:512
    s_sub_u32 s49, s49, 1
    s_cbranch_scc1 k2_bk_198
    s_waitcnt lgkmcnt(0)
    v_cmp_gt_u32 vcc, 48, v11
    s_cbranch_vccnz k2_st_197_l
    s_branch k2_bk_198
k2_st_199:
    s_mov_b32 s49, 0x100000
k2_st_199_l:
    ds_read_b32 v11, v45 offset:0
    s_sub_u32 s49, s49, 1
    s_cbranch_scc1 k2_bk_200
    s_waitcnt lgkmcnt(0)
    v_cmp_gt_u32 vcc, 52, v11
    s_cbranch_vccnz k2_st_199_l
    s_branch k2_bk_200
k2_st_201:
    s_mov_b32 s49, 0x100000
k2_st_201_l:
    ds_read_b32 v11, v45 offset:256
    s_sub_u32 s49, s49, 1
    s_cbranch_scc1 k2_bk_202
    s_waitcnt lgkmcnt(0)
    v_cmp_gt_u32 vcc, 52, v11
    s_cbranch_vccnz k2_st_201_l
    s_branch k2_bk_202
k2_st_203:
    s_mov_b32 s49, 0x100000
k2_st_203_l:
    ds_read_b32 v11, v45 offset:512
    s_sub_u32 s49, s49, 1
    s_cbranch_scc1 k2_bk_204
    s_waitcnt lgkmcnt(0)
    v_cmp_gt_u32 vcc, 52, v11
    s_cbranch_vccnz k2_st_203_l
    s_branch k2_bk_204
k2_st_205:
    s_mov_b32 s49, 0x100000
k2_st_205_l:
    ds_read_b32 v11, v45 offset:0
    s_sub_u32 s49, s49, 1
    s_cbranch_scc1 k2_bk_206
    s_waitcnt lgkmcnt(0)
    v_cmp_gt_u32 vcc, 56, v11
    s_cbranch_vccnz k2_st_205_l
    s_branch k2_bk_206
k2_st_207:
    s_mov_b32 s49, 0x100000
k2_st_207_l:
    ds_read_b32 v11, v45 offset:256
    s_sub_u32 s49, s49, 1
    s_cbranch_scc1 k2_bk_208
    s_waitcnt lgkmcnt(0)
    v_cmp_gt_u32 vcc, 56, v11
    s_cbranch_vccnz k2_st_207_l
    s_branch k2_bk_208
mg_ps_1:
    s_mov_b32 s49, 0x8000
    s_branch mg_ps_1_m
mg_ps_1_l:
    s_sleep 6
mg_ps_1_m:
    buffer_load_dword v3, v0, s[96:99], 0 offen sc1
    s_sub_u32 s49, s49, 1
    s_waitcnt vmcnt(0)
    s_cbranch_scc1 mg_pb_2
    v_cmp_gt_u32 vcc, 0x80, v3
    s_nop 0
    s_cbranch_vccnz mg_ps_1_l
    s_branch mg_pb_2
mg_ps_11:
    s_mov_b32 s49, 0x8000
    s_branch mg_ps_11_m
mg_ps_11_l:
    s_sleep 6
mg_ps_11_m:
    buffer_load_dword v3, v62, s[8:11], s47 offen sc1
    s_sub_u32 s49, s49, 1
    s_waitcnt vmcnt(0)
    s_cbranch_scc1 mg_pb_12
    v_cmp_eq_u32 vcc, 0, v3
    s_nop 0
    s_cbranch_vccnz mg_ps_11_l
    s_branch mg_pb_12
mg_ps_105:
    s_mov_b32 s49, 0x8000
    s_branch mg_ps_105_m
mg_ps_105_l:
    s_sleep 6
mg_ps_105_m:
    buffer_load_dword v14, v117, s[8:11], 0 offen sc1
    s_sub_u32 s49, s49, 1
    s_waitcnt vmcnt(0)
    s_cbranch_scc1 mg_pb_106
    v_cmp_eq_u32 vcc, 0, v14
    s_nop 0
    s_cbranch_vccnz mg_ps_105_l
    s_branch mg_pb_106
mg_ps_107:
    s_mov_b32 s49, 0x8000
    s_branch mg_ps_107_m
mg_ps_107_l:
    s_sleep 6
mg_ps_107_m:
    buffer_load_dword v14, v117, s[8:11], 0 offen sc1
    s_sub_u32 s49, s49, 1
    s_waitcnt vmcnt(0)
    s_cbranch_scc1 mg_pb_108
    v_cmp_eq_u32 vcc, 0, v14
    s_nop 0
    s_cbranch_vccnz mg_ps_107_l
    s_branch mg_pb_108
mg_ps_123:
    s_mov_b32 s49, 0x8000
    s_branch mg_ps_123_m
mg_ps_123_l:
    s_sleep 6
mg_ps_123_m:
    buffer_load_dword v37, v36, s[8:11], s39 offen sc1
    s_sub_u32 s49, s49, 1
    s_waitcnt vmcnt(0)
    s_cbranch_scc1 mg_pb_124
    v_cmp_eq_u32 vcc, 0, v37
    s_nop 1
    s_and_b32 s63, vcc_lo, 0xf
    s_nop 0
    s_cbranch_scc1 mg_ps_123_l
    s_branch mg_pb_124
mg_ps_129:
    s_mov_b32 s49, 0x8000
    s_branch mg_ps_129_m
mg_ps_129_l:
    s_sleep 6
mg_ps_129_m:
    buffer_load_dword v37, v36, s[8:11], s39 offen sc1
    s_sub_u32 s49, s49, 1
    s_waitcnt vmcnt(0)
    s_cbranch_scc1 mg_pb_130
    v_cmp_eq_u32 vcc, 0, v37
    s_nop 1
    s_and_b32 s63, vcc_lo, 0xf0
    s_nop 0
    s_cbranch_scc1 mg_ps_129_l
    s_branch mg_pb_130
mg_ps_139:
    s_mov_b32 s49, 0x8000
    s_branch mg_ps_139_m
mg_ps_139_l:
    s_sleep 6
mg_ps_139_m:
    buffer_load_dword v37, v36, s[8:11], s39 offen sc1
    s_sub_u32 s49, s49, 1
    s_waitcnt vmcnt(0)
    s_cbranch_scc1 mg_pb_140
    v_cmp_eq_u32 vcc, 0, v37
    s_nop 1
    s_and_b32 s63, vcc_lo, 0xf00
    s_nop 0
    s_cbranch_scc1 mg_ps_139_l
    s_branch mg_pb_140
mg_ps_149:
    s_mov_b32 s49, 0x8000
    s_branch mg_ps_149_m
mg_ps_149_l:
    s_sleep 6
mg_ps_149_m:
    buffer_load_dword v37, v36, s[8:11], s39 offen sc1
    s_sub_u32 s49, s49, 1
    s_waitcnt vmcnt(0)
    s_cbranch_scc1 mg_pb_150
    v_cmp_eq_u32 vcc, 0, v37
    s_nop 1
    s_and_b32 s63, vcc_lo, 0xf000
    s_nop 0
    s_cbranch_scc1 mg_ps_149_l
    s_branch mg_pb_150
mg_ps_159:
    s_mov_b32 s49, 0x8000
    s_branch mg_ps_159_m
mg_ps_159_l:
    s_sleep 6
mg_ps_159_m:
    buffer_load_dword v37, v36, s[8:11], s39 offen sc1
    s_sub_u32 s49, s49, 1
    s_waitcnt vmcnt(0)
    s_cbranch_scc1 mg_pb_160
    v_cmp_eq_u32 vcc, 0, v37
    s_nop 1
    s_and_b32 s63, vcc_lo, 0xf0000
    s_nop 0
    s_cbranch_scc1 mg_ps_159_l
    s_branch mg_pb_160
mg_ps_169:
    s_mov_b32 s49, 0x8000
    s_branch mg_ps_169_m
mg_ps_169_l:
    s_sleep 6
mg_ps_169_m:
    buffer_load_dword v37, v36, s[8:11], s39 offen sc1
    s_sub_u32 s49, s49, 1
    s_waitcnt vmcnt(0)
    s_cbranch_scc1 mg_pb_170
    v_cmp_eq_u32 vcc, 0, v37
    s_nop 1
    s_and_b32 s63, vcc_lo, 0xf00000
    s_nop 0
    s_cbranch_scc1 mg_ps_169_l
    s_branch mg_pb_170
mg_ps_179:
    s_mov_b32 s49, 0x8000
    s_branch mg_ps_179_m
mg_ps_179_l:
    s_sleep 6
mg_ps_179_m:
    buffer_load_dword v37, v36, s[8:11], s39 offen sc1
    s_sub_u32 s49, s49, 1
    s_waitcnt vmcnt(0)
    s_cbranch_scc1 mg_pb_180
    v_cmp_eq_u32 vcc, 0, v37
    s_nop 1
    s_and_b32 s63, vcc_lo, 0xf000000
    s_nop 0
    s_cbranch_scc1 mg_ps_179_l
    s_branch mg_pb_180
mg_ps_189:
    s_mov_b32 s49, 0x8000
    s_branch mg_ps_189_m
mg_ps_189_l:
    s_sleep 6
mg_ps_189_m:
    buffer_load_dword v37, v36, s[8:11], s39 offen sc1
    s_sub_u32 s49, s49, 1
    s_waitcnt vmcnt(0)
    s_cbranch_scc1 mg_pb_190
    v_cmp_eq_u32 vcc, 0, v37
    s_nop 1
    s_and_b32 s63, vcc_lo, 0xf0000000
    s_nop 0
    s_cbranch_scc1 mg_ps_189_l
    s_branch mg_pb_190
mg_ps_209:
    s_mov_b32 s49, 0x8000
    s_branch mg_ps_209_m
mg_ps_209_l:
    s_sleep 6
mg_ps_209_m:
    buffer_load_dword v39, off, s[8:11], s57 sc1
    s_sub_u32 s49, s49, 1
    s_waitcnt vmcnt(0)
    s_cbranch_scc1 mg_pb_210
    v_cmp_eq_u32 vcc, 0, v39
    s_nop 0
    s_cbranch_vccnz mg_ps_209_l
    s_branch mg_pb_210
k2_rare0:
    s_nop 7
    s_nop 7
    v_max3_f32 v88, v16, v17, v18
    v_max3_f32 v89, v19, v20, v21
    v_max3_f32 v88, v88, v22, v23
    v_max_f32 v88, v88, v89
    v_mov_b32 v89, v88
    s_nop 1
    v_permlane16_swap_b32 v88, v89
    v_max_f32 v88, v88, v89
    v_mov_b32 v89, v88
    s_nop 1
    v_permlane32_swap_b32 v88, v89
    v_max_f32 v88, v88, v89
    v_add_f32 v88, 0x42000000, v88
    v_max_f32 v88, 0, v88
    v_sub_f32 v89, 0, v88
    v_exp_f32 v90, v89
    v_sub_f32 v72, v72, v88
    v_sub_f32 v73, v73, v88
    v_sub_f32 v74, v74, v88
    v_sub_f32 v75, v75, v88
    v_sub_f32 v16, v16, v88
    v_sub_f32 v17, v17, v88
    v_sub_f32 v18, v18, v88
    v_sub_f32 v19, v19, v88
    v_sub_f32 v20, v20, v88
    v_sub_f32 v21, v21, v88
    v_sub_f32 v22, v22, v88
    v_sub_f32 v23, v23, v88
    v_mul_f32 v128, v128, v90
    v_mul_f32 v129, v129, v90
    v_mul_f32 v130, v130, v90
    v_mul_f32 v131, v131, v90
    v_mul_f32 v132, v132, v90
    v_mul_f32 v133, v133, v90
    v_mul_f32 v134, v134, v90
    v_mul_f32 v135, v135, v90
    v_mul_f32 v136, v136, v90
    v_mul_f32 v137, v137, v90
    v_mul_f32 v138, v138, v90
    v_mul_f32 v139, v139, v90
    v_mul_f32 v140, v140, v90
    v_mul_f32 v141, v141, v90
    v_mul_f32 v142, v142, v90
    v_mul_f32 v143, v143, v90
    v_mul_f32 v144, v144, v90
    v_mul_f32 v145, v145, v90
    v_mul_f32 v146, v146, v90
    v_mul_f32 v147, v147, v90
    v_mul_f32 v148, v148, v90
    v_mul_f32 v149, v149, v90
    v_mul_f32 v150, v150, v90
    v_mul_f32 v151, v151, v90
    v_mul_f32 v152, v152, v90
    v_mul_f32 v153, v153, v90
    v_mul_f32 v154, v154, v90
    v_mul_f32 v155, v155, v90
    v_mul_f32 v156, v156, v90
    v_mul_f32 v157, v157, v90
    v_mul_f32 v158, v158, v90
    v_mul_f32 v159, v159, v90
    v_accvgpr_read_b32 v89, a144
    v_mul_f32 v89, v89, v90
    v_accvgpr_write_b32 a144, v89
    v_accvgpr_read_b32 v89, a145
    v_mul_f32 v89, v89, v90
    v_accvgpr_write_b32 a145, v89
    v_accvgpr_read_b32 v89, a146
    v_mul_f32 v89, v89, v90
    v_accvgpr_write_b32 a146, v89
    v_accvgpr_read_b32 v89, a147
    v_mul_f32 v89, v89, v90
    v_accvgpr_write_b32 a147, v89
    v_exp_f32 v96, v16
    v_exp_f32 v97, v17
    v_exp_f32 v98, v18
    v_exp_f32 v99, v19
    v_exp_f32 v100, v20
    v_exp_f32 v101, v21
    v_exp_f32 v102, v22
    v_exp_f32 v103, v23
    s_nop 0
    v_cvt_pk_bf16_f32 v56, v96, v97
    v_cvt_pk_bf16_f32 v57, v98, v99
    v_cvt_pk_bf16_f32 v58, v100, v101
    v_cvt_pk_bf16_f32 v59, v102, v103
    v_max3_f32 v88, v24, v25, v26
    v_max3_f32 v89, v27, v28, v29
    v_max3_f32 v88, v88, v30, v31
    v_max_f32 v88, v88, v89
    v_mov_b32 v89, v88
    s_nop 1
    v_permlane16_swap_b32 v88, v89
    v_max_f32 v88, v88, v89
    v_mov_b32 v89, v88
    s_nop 1
    v_permlane32_swap_b32 v88, v89
    v_max_f32 v88, v88, v89
    v_add_f32 v88, 0x42000000, v88
    v_max_f32 v88, 0, v88
    v_sub_f32 v89, 0, v88
    v_exp_f32 v90, v89
    v_sub_f32 v76, v76, v88
    v_sub_f32 v77, v77, v88
    v_sub_f32 v78, v78, v88
    v_sub_f32 v79, v79, v88
    v_sub_f32 v24, v24, v88
    v_sub_f32 v25, v25, v88
    v_sub_f32 v26, v26, v88
    v_sub_f32 v27, v27, v88
    v_sub_f32 v28, v28, v88
    v_sub_f32 v29, v29, v88
    v_sub_f32 v30, v30, v88
    v_sub_f32 v31, v31, v88
    v_mul_f32 v160, v160, v90
    v_mul_f32 v161, v161, v90
    v_mul_f32 v162, v162, v90
    v_mul_f32 v163, v163, v90
    v_mul_f32 v164, v164, v90
    v_mul_f32 v165, v165, v90
    v_mul_f32 v166, v166, v90
    v_mul_f32 v167, v167, v90
    v_mul_f32 v168, v168, v90
    v_mul_f32 v169, v169, v90
    v_mul_f32 v170, v170, v90
    v_mul_f32 v171, v171, v90
    v_mul_f32 v172, v172, v90
    v_mul_f32 v173, v173, v90
    v_mul_f32 v174, v174, v90
    v_mul_f32 v175, v175, v90
    v_mul_f32 v176, v176, v90
    v_mul_f32 v177, v177, v90
    v_mul_f32 v178, v178, v90
    v_mul_f32 v179, v179, v90
    v_mul_f32 v180, v180, v90
    v_mul_f32 v181, v181, v90
    v_mul_f32 v182, v182, v90
    v_mul_f32 v183, v183, v90
    v_mul_f32 v184, v184, v90
    v_mul_f32 v185, v185, v90
    v_mul_f32 v186, v186, v90
    v_mul_f32 v187, v187, v90
    v_mul_f32 v188, v188, v90
    v_mul_f32 v189, v189, v90
    v_mul_f32 v190, v190, v90
    v_mul_f32 v191, v191, v90
    v_accvgpr_read_b32 v89, a148
    v_mul_f32 v89, v89, v90
    v_accvgpr_write_b32 a148, v89
    v_accvgpr_read_b32 v89, a149
    v_mul_f32 v89, v89, v90
    v_accvgpr_write_b32 a149, v89
    v_accvgpr_read_b32 v89, a150
    v_mul_f32 v89, v89, v90
    v_accvgpr_write_b32 a150, v89
    v_accvgpr_read_b32 v89, a151
    v_mul_f32 v89, v89, v90
    v_accvgpr_write_b32 a151, v89
    v_exp_f32 v96, v24
    v_exp_f32 v97, v25
    v_exp_f32 v98, v26
    v_exp_f32 v99, v27
    v_exp_f32 v100, v28
    v_exp_f32 v101, v29
    v_exp_f32 v102, v30
    v_exp_f32 v103, v31
    s_nop 0
    v_cvt_pk_bf16_f32 v60, v96, v97
    v_cvt_pk_bf16_f32 v61, v98, v99
    v_cvt_pk_bf16_f32 v62, v100, v101
    v_cvt_pk_bf16_f32 v63, v102, v103
    s_nop 1
    s_setpc_b64 s[54:55]
k2_rare1:
    s_nop 7
    s_nop 7
    v_max3_f32 v88, v32, v33, v34
    v_max3_f32 v89, v35, v36, v37
    v_max3_f32 v88, v88, v38, v39
    v_max_f32 v88, v88, v89
    v_mov_b32 v89, v88
    s_nop 1
    v_permlane16_swap_b32 v88, v89
    v_max_f32 v88, v88, v89
    v_mov_b32 v89, v88
    s_nop 1
    v_permlane32_swap_b32 v88, v89
    v_max_f32 v88, v88, v89
    v_add_f32 v88, 0x42000000, v88
    v_max_f32 v88, 0, v88
    v_sub_f32 v89, 0, v88
    v_exp_f32 v90, v89
    v_sub_f32 v80, v80, v88
    v_sub_f32 v81, v81, v88
    v_sub_f32 v82, v82, v88
    v_sub_f32 v83, v83, v88
    v_sub_f32 v32, v32, v88
    v_sub_f32 v33, v33, v88
    v_sub_f32 v34, v34, v88
    v_sub_f32 v35, v35, v88
    v_sub_f32 v36, v36, v88
    v_sub_f32 v37, v37, v88
    v_sub_f32 v38, v38, v88
    v_sub_f32 v39, v39, v88
    v_mul_f32 v192, v192, v90
    v_mul_f32 v193, v193, v90
    v_mul_f32 v194, v194, v90
    v_mul_f32 v195, v195, v90
    v_mul_f32 v196, v196, v90
    v_mul_f32 v197, v197, v90
    v_mul_f32 v198, v198, v90
    v_mul_f32 v199, v199, v90
    v_mul_f32 v200, v200, v90
    v_mul_f32 v201, v201, v90
    v_mul_f32 v202, v202, v90
    v_mul_f32 v203, v203, v90
    v_mul_f32 v204, v204, v90
    v_mul_f32 v205, v205, v90
    v_mul_f32 v206, v206, v90
    v_mul_f32 v207, v207, v90
    v_mul_f32 v208, v208, v90
    v_mul_f32 v209, v209, v90
    v_mul_f32 v210, v210, v90
    v_mul_f32 v211, v211, v90
    v_mul_f32 v212, v212, v90
    v_mul_f32 v213, v213, v90
    v_mul_f32 v214, v214, v90
    v_mul_f32 v215, v215, v90
    v_mul_f32 v216, v216, v90
    v_mul_f32 v217, v217, v90
    v_mul_f32 v218, v218, v90
    v_mul_f32 v219, v219, v90
    v_mul_f32 v220, v220, v90
    v_mul_f32 v221, v221, v90
    v_mul_f32 v222, v222, v90
    v_mul_f32 v223, v223, v90
    v_accvgpr_read_b32 v89, a152
    v_mul_f32 v89, v89, v90
    v_accvgpr_write_b32 a152, v89
    v_accvgpr_read_b32 v89, a153
    v_mul_f32 v89, v89, v90
    v_accvgpr_write_b32 a153, v89
    v_accvgpr_read_b32 v89, a154
    v_mul_f32 v89, v89, v90
    v_accvgpr_write_b32 a154, v89
    v_accvgpr_read_b32 v89, a155
    v_mul_f32 v89, v89, v90
    v_accvgpr_write_b32 a155, v89
    v_exp_f32 v96, v32
    v_exp_f32 v97, v33
    v_exp_f32 v98, v34
    v_exp_f32 v99, v35
    v_exp_f32 v100, v36
    v_exp_f32 v101, v37
    v_exp_f32 v102, v38
    v_exp_f32 v103, v39
    s_nop 0
    v_cvt_pk_bf16_f32 v64, v96, v97
    v_cvt_pk_bf16_f32 v65, v98, v99
    v_cvt_pk_bf16_f32 v66, v100, v101
    v_cvt_pk_bf16_f32 v67, v102, v103
    v_max3_f32 v88, v40, v41, v42
    v_max3_f32 v89, v43, v44, v45
    v_max3_f32 v88, v88, v46, v47
    v_max_f32 v88, v88, v89
    v_mov_b32 v89, v88
    s_nop 1
    v_permlane16_swap_b32 v88, v89
    v_max_f32 v88, v88, v89
    v_mov_b32 v89, v88
    s_nop 1
    v_permlane32_swap_b32 v88, v89
    v_max_f32 v88, v88, v89
    v_add_f32 v88, 0x42000000, v88
    v_max_f32 v88, 0, v88
    v_sub_f32 v89, 0, v88
    v_exp_f32 v90, v89
    v_sub_f32 v84, v84, v88
    v_sub_f32 v85, v85, v88
    v_sub_f32 v86, v86, v88
    v_sub_f32 v87, v87, v88
    v_sub_f32 v40, v40, v88
    v_sub_f32 v41, v41, v88
    v_sub_f32 v42, v42, v88
    v_sub_f32 v43, v43, v88
    v_sub_f32 v44, v44, v88
    v_sub_f32 v45, v45, v88
    v_sub_f32 v46, v46, v88
    v_sub_f32 v47, v47, v88
    v_mul_f32 v224, v224, v90
    v_mul_f32 v225, v225, v90
    v_mul_f32 v226, v226, v90
    v_mul_f32 v227, v227, v90
    v_mul_f32 v228, v228, v90
    v_mul_f32 v229, v229, v90
    v_mul_f32 v230, v230, v90
    v_mul_f32 v231, v231, v90
    v_mul_f32 v232, v232, v90
    v_mul_f32 v233, v233, v90
    v_mul_f32 v234, v234, v90
    v_mul_f32 v235, v235, v90
    v_mul_f32 v236, v236, v90
    v_mul_f32 v237, v237, v90
    v_mul_f32 v238, v238, v90
    v_mul_f32 v239, v239, v90
    v_mul_f32 v240, v240, v90
    v_mul_f32 v241, v241, v90
    v_mul_f32 v242, v242, v90
    v_mul_f32 v243, v243, v90
    v_mul_f32 v244, v244, v90
    v_mul_f32 v245, v245, v90
    v_mul_f32 v246, v246, v90
    v_mul_f32 v247, v247, v90
    v_mul_f32 v248, v248, v90
    v_mul_f32 v249, v249, v90
    v_mul_f32 v250, v250, v90
    v_mul_f32 v251, v251, v90
    v_mul_f32 v252, v252, v90
    v_mul_f32 v253, v253, v90
    v_mul_f32 v254, v254, v90
    v_mul_f32 v255, v255, v90
    v_accvgpr_read_b32 v89, a156
    v_mul_f32 v89, v89, v90
    v_accvgpr_write_b32 a156, v89
    v_accvgpr_read_b32 v89, a157
    v_mul_f32 v89, v89, v90
    v_accvgpr_write_b32 a157, v89
    v_accvgpr_read_b32 v89, a158
    v_mul_f32 v89, v89, v90
    v_accvgpr_write_b32 a158, v89
    v_accvgpr_read_b32 v89, a159
    v_mul_f32 v89, v89, v90
    v_accvgpr_write_b32 a159, v89
    v_exp_f32 v96, v40
    v_exp_f32 v97, v41
    v_exp_f32 v98, v42
    v_exp_f32 v99, v43
    v_exp_f32 v100, v44
    v_exp_f32 v101, v45
    v_exp_f32 v102, v46
    v_exp_f32 v103, v47
    s_nop 0
    v_cvt_pk_bf16_f32 v68, v96, v97
    v_cvt_pk_bf16_f32 v69, v98, v99
    v_cvt_pk_bf16_f32 v70, v100, v101
    v_cvt_pk_bf16_f32 v71, v102, v103
    s_nop 1
    s_setpc_b64 s[54:55]
mg_exit:
    s_endpgm
.section .rodata,"a"
.p2align 6
.amdhsa_kernel parallel_sum__compressed_kv_cla__dense_activation_mish__prompt_kernel
  .amdhsa_next_free_vgpr 512
  .amdhsa_next_free_sgpr 102
  .amdhsa_accum_offset 256
  .amdhsa_group_segment_fixed_size 0
  .amdhsa_kernarg_size 104
  .amdhsa_user_sgpr_count 2
  .amdhsa_user_sgpr_kernarg_segment_ptr 1
  .amdhsa_system_sgpr_workgroup_id_x 1
.end_amdhsa_kernel
```
